```python
import torch

def _softmax(x, axis=-1):
    return torch.softmax(x, dim=axis)
def _gelu(x):
    return torch.nn.functional.gelu(x, approximate="tanh")
def _silu(x):
    return torch.nn.functional.silu(x)
def _sigmoid(x):
    return torch.sigmoid(x)
def _layernorm(x, axis=-1, eps=1e-5):
    m = x.mean(dim=axis, keepdim=True)
    v = x.var(dim=axis, keepdim=True, unbiased=False)
    return (x - m) / torch.sqrt(v + eps)
def _scatter_add(tgt, idx, src, axis=0):
    return tgt.clone().index_add_(axis, idx, src)
def _segment_sum(src, seg, n):
    out = torch.zeros((n,) + src.shape[1:], dtype=src.dtype)
    return out.index_add_(0, seg, src)
def _pad(x, pw):
    flat = tuple(v for pair in reversed(pw) for v in pair)
    return torch.nn.functional.pad(x, flat)

kernel_name = 'recurrent_scan__gqa_block_cached__glu_gated_swiglu__prompt'

def setup_inputs():

    _w = (lambda a: (lambda t: t.to(torch.bfloat16) if t.is_floating_point() else t)(torch.as_tensor(a)))
    def _A_setup():
        B, Sq, D = 1, 2048, 576
        Hq, Hkv, Sk, Dh = 32, 16, 2048, 128
        assert Hq % Hkv == 0, (Hq, Hkv)
        return {
            "x": _w((lambda *s: torch.randn(*s, dtype=torch.bfloat16) * 0.05)(B, Sq, D)),
            "k_cache": _w((lambda *s: torch.randn(*s, dtype=torch.bfloat16) * 1.6)(B, Hkv, Sk, Dh)),
            "v_cache": _w((lambda *s: torch.randn(*s, dtype=torch.bfloat16) * 1.6)(B, Hkv, Sk, Dh)),
            "wq": _w((lambda *s: torch.randn(*s, dtype=torch.bfloat16) * 1.6)(D, Hq * Dh) * (D ** -0.5)),
            "wo": _w((lambda *s: torch.randn(*s, dtype=torch.bfloat16) * 1.6)(Hq * Dh, D) * ((Hq * Dh) ** -0.5)),
        }
    _A_in = _A_setup()

    def _B_setup():
        B, S, D, F = 1, 2048, 576, 4608
        return {
            "x": _w((lambda *s: torch.randn(*s, dtype=torch.bfloat16) * 0.05)(B, S, D)),
            "w1": _w((lambda *s: torch.randn(*s, dtype=torch.bfloat16) * 0.2)(D, F) * (2.0 / D) ** 0.5),
            "w3": _w((lambda *s: torch.randn(*s, dtype=torch.bfloat16) * 0.2)(D, F) * (2.0 / D) ** 0.5),
            "w2": _w((lambda *s: torch.randn(*s, dtype=torch.bfloat16) * 0.2)(F, D) * (2.0 / F) ** 0.5),
        }
    _B_in = _B_setup()

    return {
        "A_x": _A_in["x"],
        "A_k_cache": _A_in["k_cache"],
        "A_v_cache": _A_in["v_cache"],
        "A_wq": _A_in["wq"],
        "A_wo": _A_in["wo"],
        "B_x": _B_in["x"],
        "B_w1": _B_in["w1"],
        "B_w3": _B_in["w3"],
        "B_w2": _B_in["w2"],
    }

def reference(A_x, A_k_cache, A_v_cache, A_wq, A_wo, B_x, B_w1, B_w3, B_w2):
    def _A_ref(x, k_cache, v_cache, wq, wo):
        B, Sq, D = x.shape
        Hq, Dh = 32, 128
        Hkv = k_cache.shape[1]
        rep = Hq // Hkv
        q = (lambda x, *d: x.permute(*d))((x @ wq).reshape(B, Sq, Hq, Dh), 0, 2, 1, 3)
        k = (lambda x, n, axis: torch.repeat_interleave(x, n, dim=axis))(k_cache, rep, axis=1)
        v = (lambda x, n, axis: torch.repeat_interleave(x, n, dim=axis))(v_cache, rep, axis=1)
        scores = torch.einsum("bhqd,bhkd->bhqk", q, k) * (Dh ** -0.5)
        p = _softmax(scores, axis=-1)
        o = torch.einsum("bhqk,bhkd->bhqd", p, v)
        return (lambda x, *d: x.permute(*d))(o, 0, 2, 1, 3).reshape(B, Sq, Hq * Dh) @ wo

    def _B_ref(x, w1, w3, w2):
        gate = torch.einsum("bsd,df->bsf", x, w1)
        up = torch.einsum("bsd,df->bsf", x, w3)
        h = _silu(gate) * up
        out = torch.einsum("bsf,fd->bsd", h, w2)
        return out

    x = A_x
    xn = _layernorm(x, axis=-1)
    s = _A_ref(xn, A_k_cache, A_v_cache, A_wq, A_wo)
    g = _silu(_B_ref(xn, B_w1, B_w3, B_w2))
    return x + s * g
```

```asm
; @launch grid=(256,1,1) block=(256,1,1) lds=163840
.amdgcn_target "amdgcn-amd-amdhsa--gfx950"
.text
.globl recurrent_scan__gqa_block_cached__glu_gated_swiglu__prompt_kernel
.p2align 8
.type recurrent_scan__gqa_block_cached__glu_gated_swiglu__prompt_kernel,@function
recurrent_scan__gqa_block_cached__glu_gated_swiglu__prompt_kernel:
s_cmp_ge_u32 s2, 256
s_cbranch_scc1 k1_end
s_load_dwordx2 s[32:33], s[0:1], 0
s_load_dwordx2 s[48:49], s[0:1], 88
s_load_dwordx2 s[40:41], s[0:1], 24
s_load_dwordx4 s[44:47], s[0:1], 48
s_load_dwordx4 s[36:39], s[0:1], 8
s_load_dwordx2 s[4:5], s[0:1], 32
s_load_dwordx2 s[6:7], s[0:1], 64
v_lshrrev_b32 v249, 6, v0
v_and_b32 v248, 63, v0
v_lshlrev_b32 v234, 4, v248
v_readfirstlane_b32 s3, v249
s_getpc_b64 s[74:75]
ct1:
s_add_u32 s74, s74, k1_cs-ct1
s_addc_u32 s75, s75, 0
k1_cs:
s_lshr_b32 s76, s2, 3
s_lshl_b32 s76, s76, 2
s_add_u32 s76, s76, s3
s_lshl_b32 s76, s76, 10
v_and_b32 v249, 7, v248
v_lshlrev_b32 v249, 7, v249
v_add_u32 v249, s76, v249
v_min_u32 v249, k1_last-k1_cs, v249
global_load_dword v255, v249, s[74:75]
v_lshrrev_b32 v1, 5, v248
v_and_b32 v2, 31, v248
v_mul_u32_u24 v3, 1152, v1
v_lshl_add_u32 v3, v2, 4, v3
v_mov_b32 v59, 50333696
v_lshrrev_b32 v40, 3, v2
v_min_u32 v40, 1, v40
v_lshl_add_u32 v41, v40, 30, v3
s_lshl_b32 s77, s2, 2
s_add_u32 s77, s77, s3
s_mul_i32 s77, s77, 2304
s_mov_b32 s34, 2359296
s_mov_b32 s35, 0x20000
s_waitcnt lgkmcnt(0)
global_load_dword v52, v59, s[48:49] sc1
buffer_load_dwordx4 v[4:7], v3, s[32:35], s77 offen
buffer_load_dwordx4 v[8:11], v3, s[32:35], s77 offen offset:512
buffer_load_dwordx4 v[12:15], v41, s[32:35], s77 offen offset:1024
s_and_b32 s50, s2, 7
s_lshl_b32 s50, s50, 2
s_lshr_b32 s51, s2, 3
s_and_b32 s74, s51, 3
s_add_u32 s50, s50, s74
s_lshr_b32 s51, s51, 2
s_and_b32 s52, s50, 1
s_lshl_b32 s53, s51, 2
s_add_u32 s53, s53, s3
s_mul_i32 s59, s53, 73728
s_lshl_b32 s65, s3, 12
s_and_b32 s74, s3, 1
s_mul_i32 s54, s74, 294912
s_mul_i32 s75, s50, 288
s_add_u32 s54, s54, s75
s_mul_i32 s60, s3, 9216
s_add_u32 s61, s65, 36864
s_lshl_b32 s55, s74, 15
s_lshr_b32 s75, s3, 1
s_lshl_b32 s75, s75, 18
s_add_u32 s55, s55, s75
s_lshl_b32 s75, s50, 8
s_add_u32 s55, s55, s75
s_add_u32 s56, s55, 64512
s_add_u32 s57, s55, 129024
s_add_u32 s58, s55, 193536
s_lshl_b32 s76, s52, 1
v_lshrrev_b32 v250, 4, v248
v_and_b32 v251, 15, v248
v_lshlrev_b32 v249, 2, v250
v_xor_b32 v249, v249, v251
v_lshlrev_b32 v249, 4, v249
v_lshl_add_u32 v233, v250, 13, v249
s_mov_b32 s20, s36
s_mov_b32 s21, s37
s_mov_b32 s22, 8388608
s_mov_b32 s23, 0x20000
s_mov_b32 s24, s38
s_mov_b32 s25, s39
s_mov_b32 s26, 8388608
s_mov_b32 s27, 0x20000
s_add_u32 s36, s48, 50331648
s_addc_u32 s37, s49, 0
s_mov_b32 s38, 21069824
s_mov_b32 s39, 0x20000
s_mov_b32 s62, 21037056
s_lshl_b32 s74, s53, 3
v_and_b32 v50, 7, v248
v_add_u32 v50, s74, v50
v_lshlrev_b32 v50, 7, v50
s_mov_b32 s16, s40
s_mov_b32 s17, s41
s_mov_b32 s18, 4718592
s_mov_b32 s19, 0x20000
s_cmp_lt_u32 s3, 2
s_cselect_b32 s12, s44, s46
s_cselect_b32 s13, s45, s47
s_mov_b32 s14, 5308416
s_mov_b32 s15, 0x20000
s_lshr_b32 s74, s2, 3
s_lshl_b32 s74, s74, 1
s_and_b32 s75, s3, 1
s_add_u32 s74, s74, s75
s_mul_i32 s75, s74, 27648
s_and_b32 s77, s2, 7
s_mul_i32 s63, s77, 1152
s_add_u32 s75, s75, s63
v_min_u32 v53, 26, v248
v_mul_u32_u24 v54, 7282, v53
v_lshrrev_b32 v54, 16, v54
v_mul_u32_u24 v55, 9, v54
v_sub_u32 v55, v53, v55
v_mul_u32_u24 v54, 9216, v54
v_lshl_add_u32 v54, v55, 7, v54
buffer_load_dword v56, v54, s[12:15], s75 offen
s_mul_i32 s74, s74, 24576
s_lshl_b32 s77, s77, 10
s_add_u32 s74, s74, s77
s_lshr_b32 s77, s3, 1
s_lshl_b32 s77, s77, 9
s_add_u32 s74, s74, s77
v_min_u32 v53, 11, v248
v_lshrrev_b32 v54, 2, v53
v_lshlrev_b32 v54, 13, v54
v_and_b32 v55, 3, v53
v_lshl_add_u32 v54, v55, 7, v54
buffer_load_dword v57, v54, s[16:19], s74 offen
s_mov_b32 s8, s48
s_mov_b32 s9, s49
s_mov_b32 s10, 2359296
s_mov_b32 s11, 0x20000
s_add_u32 s28, s48, 4194304
s_addc_u32 s29, s49, 0
s_mov_b32 s30, 35651584
s_mov_b32 s31, 0x20000
v_add_u32 v249, 0, v248
v_mul_u32_u24 v250, 3641, v249
v_lshrrev_b32 v250, 16, v250
v_mul_u32_u24 v251, 18, v250
v_sub_u32 v249, v249, v251
v_add_u32 v249, s76, v249
v_subrev_u32 v251, 18, v249
v_min_u32 v249, v249, v251
v_and_b32 v251, 12, v250
v_and_b32 v224, 3, v250
v_lshl_add_u32 v251, v251, 1, v224
v_lshrrev_b32 v250, 4, v250
v_lshl_add_u32 v251, v250, 2, v251
v_mul_u32_u24 v251, 9216, v251
v_lshl_add_u32 v224, v249, 4, v251
v_add_u32 v249, 64, v248
v_mul_u32_u24 v250, 3641, v249
v_lshrrev_b32 v250, 16, v250
v_mul_u32_u24 v251, 18, v250
v_sub_u32 v249, v249, v251
v_add_u32 v249, s76, v249
v_subrev_u32 v251, 18, v249
v_min_u32 v249, v249, v251
v_and_b32 v251, 12, v250
v_and_b32 v225, 3, v250
v_lshl_add_u32 v251, v251, 1, v225
v_lshrrev_b32 v250, 4, v250
v_lshl_add_u32 v251, v250, 2, v251
v_mul_u32_u24 v251, 9216, v251
v_lshl_add_u32 v225, v249, 4, v251
v_subrev_u32 v225, 1024, v225
v_add_u32 v249, 128, v248
v_mul_u32_u24 v250, 3641, v249
v_lshrrev_b32 v250, 16, v250
v_mul_u32_u24 v251, 18, v250
v_sub_u32 v249, v249, v251
v_add_u32 v249, s76, v249
v_subrev_u32 v251, 18, v249
v_min_u32 v249, v249, v251
v_and_b32 v251, 12, v250
v_and_b32 v226, 3, v250
v_lshl_add_u32 v251, v251, 1, v226
v_lshrrev_b32 v250, 4, v250
v_lshl_add_u32 v251, v250, 2, v251
v_mul_u32_u24 v251, 9216, v251
v_lshl_add_u32 v226, v249, 4, v251
v_subrev_u32 v226, 2048, v226
v_add_u32 v249, 192, v248
v_mul_u32_u24 v250, 3641, v249
v_lshrrev_b32 v250, 16, v250
v_mul_u32_u24 v251, 18, v250
v_sub_u32 v249, v249, v251
v_add_u32 v249, s76, v249
v_subrev_u32 v251, 18, v249
v_min_u32 v249, v249, v251
v_and_b32 v251, 12, v250
v_and_b32 v227, 3, v250
v_lshl_add_u32 v251, v251, 1, v227
v_lshrrev_b32 v250, 4, v250
v_lshl_add_u32 v251, v250, 2, v251
v_mul_u32_u24 v251, 9216, v251
v_lshl_add_u32 v227, v249, 4, v251
v_subrev_u32 v227, 3072, v227
v_add_u32 v249, 256, v248
v_mul_u32_u24 v250, 3641, v249
v_lshrrev_b32 v250, 16, v250
v_mul_u32_u24 v251, 18, v250
v_sub_u32 v249, v249, v251
v_add_u32 v249, s76, v249
v_subrev_u32 v251, 18, v249
v_min_u32 v249, v249, v251
v_and_b32 v251, 12, v250
v_and_b32 v228, 3, v250
v_lshl_add_u32 v251, v251, 1, v228
v_lshrrev_b32 v250, 4, v250
v_lshl_add_u32 v251, v250, 2, v251
v_mul_u32_u24 v251, 9216, v251
v_lshl_add_u32 v228, v249, 4, v251
v_add_u32 v249, 320, v248
v_mul_u32_u24 v250, 3641, v249
v_lshrrev_b32 v250, 16, v250
v_mul_u32_u24 v251, 18, v250
v_sub_u32 v249, v249, v251
v_add_u32 v249, s76, v249
v_subrev_u32 v251, 18, v249
v_min_u32 v249, v249, v251
v_and_b32 v251, 12, v250
v_and_b32 v229, 3, v250
v_lshl_add_u32 v251, v251, 1, v229
v_lshrrev_b32 v250, 4, v250
v_lshl_add_u32 v251, v250, 2, v251
v_mul_u32_u24 v251, 9216, v251
v_lshl_add_u32 v229, v249, 4, v251
v_subrev_u32 v229, 1024, v229
v_add_u32 v249, 384, v248
v_mul_u32_u24 v250, 3641, v249
v_lshrrev_b32 v250, 16, v250
v_mul_u32_u24 v251, 18, v250
v_sub_u32 v249, v249, v251
v_add_u32 v249, s76, v249
v_subrev_u32 v251, 18, v249
v_min_u32 v249, v249, v251
v_and_b32 v251, 12, v250
v_and_b32 v230, 3, v250
v_lshl_add_u32 v251, v251, 1, v230
v_lshrrev_b32 v250, 4, v250
v_lshl_add_u32 v251, v250, 2, v251
v_mul_u32_u24 v251, 9216, v251
v_lshl_add_u32 v230, v249, 4, v251
v_subrev_u32 v230, 2048, v230
v_add_u32 v249, 448, v248
v_mul_u32_u24 v250, 3641, v249
v_lshrrev_b32 v250, 16, v250
v_mul_u32_u24 v251, 18, v250
v_sub_u32 v249, v249, v251
v_add_u32 v249, s76, v249
v_subrev_u32 v251, 18, v249
v_min_u32 v249, v249, v251
v_and_b32 v251, 12, v250
v_and_b32 v231, 3, v250
v_lshl_add_u32 v251, v251, 1, v231
v_lshrrev_b32 v250, 4, v250
v_lshl_add_u32 v251, v250, 2, v251
v_mul_u32_u24 v251, 9216, v251
v_lshl_add_u32 v231, v249, 4, v251
v_subrev_u32 v231, 3072, v231
v_add_u32 v249, 512, v248
v_mul_u32_u24 v250, 3641, v249
v_lshrrev_b32 v250, 16, v250
v_mul_u32_u24 v251, 18, v250
v_sub_u32 v249, v249, v251
v_add_u32 v249, s76, v249
v_subrev_u32 v251, 18, v249
v_min_u32 v249, v249, v251
v_and_b32 v251, 12, v250
v_and_b32 v232, 3, v250
v_lshl_add_u32 v251, v251, 1, v232
v_lshrrev_b32 v250, 4, v250
v_lshl_add_u32 v251, v250, 2, v251
v_mul_u32_u24 v251, 9216, v251
v_lshl_add_u32 v232, v249, 4, v251
s_mov_b32 s43, 0xffff0000
s_mov_b32 s79, 4
s_lshr_b32 s67, s50, 1
s_lshl_b32 s67, s67, 19
s_add_u32 s67, s67, s65
s_mov_b32 s63, s67
s_mov_b32 s64, s67
s_mov_b32 s66, 0
s_mov_b32 s42, 0x3e0293ee
s_mov_b32 s44, 0xbfb8aa3b
s_mov_b32 s45, 0xbfb8aa3b
s_mov_b32 s46, 1.0
s_mov_b32 s47, 1.0
s_mul_i32 s72, s53, 272
s_lshr_b32 s75, s50, 1
s_mul_i32 s75, s75, 9
s_add_u32 s72, s72, s75
s_add_u32 s72, s72, 132
s_lshl_b32 s73, s72, 12
s_mul_i32 s75, s52, 5
s_add_u32 s72, s72, s75
s_sub_u32 s72, s72, 4
s_lshl_b32 s72, s72, 12
s_lshl_b32 s75, s52, 3
s_add_u32 s73, s73, s75
v_lshrrev_b32 v249, 2, v248
v_and_b32 v250, 3, v248
v_mul_u32_u24 v235, 288, v249
v_lshl_add_u32 v235, v250, 3, v235
v_lshlrev_b32 v251, 8, v249
v_lshl_add_u32 v251, v250, 4, v251
v_and_b32 v249, 3, v249
v_xor_b32 v250, 0, v249
v_lshl_add_u32 v236, v250, 6, v251
v_xor_b32 v250, 1, v249
v_lshl_add_u32 v237, v250, 6, v251
v_xor_b32 v250, 2, v249
v_lshl_add_u32 v238, v250, 6, v251
v_xor_b32 v250, 3, v249
v_lshl_add_u32 v239, v250, 6, v251
v_mov_b32 v249, 159744
v_mov_b32 v250, 0
ds_write_b32 v249, v250
v_lshlrev_b32 v251, 2, v0
v_add_u32 v251, 160768, v251
ds_write_b32 v251, v250
v_and_b32 v252, 3, v0
v_lshlrev_b32 v252, 8, v252
v_add_u32 v252, 160768, v252
v_mov_b32 v253, 1
s_lshr_b32 s74, s2, 3
s_mul_i32 s74, s74, 73728
s_bfe_u32 s75, s2, 0x20001
s_lshl_b32 s75, s75, 10
s_add_u32 s74, s74, s75
s_and_b32 s75, s2, 1
s_lshl_b32 s75, s75, 2
s_add_u32 s75, s75, s3
s_lshl_b32 s75, s75, 7
s_add_u32 s74, s74, s75
v_lshrrev_b32 v3, 2, v2
v_lshlrev_b32 v3, 12, v3
v_and_b32 v2, 3, v2
v_lshl_add_u32 v3, v2, 4, v3
v_lshl_add_u32 v3, v1, 6, v3
v_bfe_u32 v254, v234, 4, 4
v_lshlrev_b32 v254, 6, v254
v_lshrrev_b32 v42, 8, v234
v_lshl_add_u32 v254, v42, 4, v254
v_lshl_add_u32 v41, v40, 30, v3
v_cvt_f32_u32 v40, v40
v_sub_f32 v40, 1.0, v40
v_mov_b32 v44, 0
v_mov_b32 v45, 0
s_waitcnt vmcnt(2)
s_mov_b32 s51, 0x9e3779b1
v_mul_lo_u32 v52, v52, s51
v_add_u32 v52, 0x7f4a7c15, v52
v_lshlrev_b32 v16, 16, v4
v_and_b32 v17, s43, v4
v_add_f32 v44, v44, v16
v_add_f32 v45, v45, v17
v_lshlrev_b32 v18, 16, v5
v_and_b32 v19, s43, v5
v_add_f32 v44, v44, v18
v_add_f32 v45, v45, v19
v_lshlrev_b32 v20, 16, v6
v_and_b32 v21, s43, v6
v_add_f32 v44, v44, v20
v_add_f32 v45, v45, v21
v_lshlrev_b32 v22, 16, v7
v_and_b32 v23, s43, v7
v_add_f32 v44, v44, v22
v_add_f32 v45, v45, v23
v_lshlrev_b32 v24, 16, v8
v_and_b32 v25, s43, v8
v_add_f32 v44, v44, v24
v_add_f32 v45, v45, v25
v_lshlrev_b32 v26, 16, v9
v_and_b32 v27, s43, v9
v_add_f32 v44, v44, v26
v_add_f32 v45, v45, v27
v_lshlrev_b32 v28, 16, v10
v_and_b32 v29, s43, v10
v_add_f32 v44, v44, v28
v_add_f32 v45, v45, v29
v_lshlrev_b32 v30, 16, v11
v_and_b32 v31, s43, v11
v_add_f32 v44, v44, v30
v_add_f32 v45, v45, v31
v_lshlrev_b32 v32, 16, v12
v_and_b32 v33, s43, v12
v_add_f32 v44, v44, v32
v_add_f32 v45, v45, v33
v_lshlrev_b32 v34, 16, v13
v_and_b32 v35, s43, v13
v_add_f32 v44, v44, v34
v_add_f32 v45, v45, v35
v_lshlrev_b32 v36, 16, v14
v_and_b32 v37, s43, v14
v_add_f32 v44, v44, v36
v_add_f32 v45, v45, v37
v_lshlrev_b32 v38, 16, v15
v_and_b32 v39, s43, v15
v_add_f32 v44, v44, v38
v_add_f32 v45, v45, v39
v_add_f32 v44, v44, v45
s_nop 1
v_add_f32_dpp v44, v44, v44 quad_perm:[1,0,3,2] row_mask:0xf bank_mask:0xf
s_nop 1
v_add_f32_dpp v44, v44, v44 quad_perm:[2,3,0,1] row_mask:0xf bank_mask:0xf
s_nop 1
v_add_f32_dpp v44, v44, v44 row_half_mirror row_mask:0xf bank_mask:0xf
s_nop 1
v_add_f32_dpp v44, v44, v44 row_mirror row_mask:0xf bank_mask:0xf
v_mov_b32 v48, v44
s_nop 1
v_permlane16_swap_b32 v44, v48
v_add_f32 v44, v44, v48
v_mul_f32 v44, 0x3ae38e39, v44
v_mov_b32 v45, 0
v_mov_b32 v51, 0
v_mov_b32 v47, 0
v_sub_f32 v48, v16, v44
v_sub_f32 v49, v17, v44
v_fmac_f32 v45, v48, v48
v_fmac_f32 v51, v49, v49
v_sub_f32 v48, v18, v44
v_sub_f32 v49, v19, v44
v_fmac_f32 v45, v48, v48
v_fmac_f32 v51, v49, v49
v_sub_f32 v48, v20, v44
v_sub_f32 v49, v21, v44
v_fmac_f32 v45, v48, v48
v_fmac_f32 v51, v49, v49
v_sub_f32 v48, v22, v44
v_sub_f32 v49, v23, v44
v_fmac_f32 v45, v48, v48
v_fmac_f32 v51, v49, v49
v_sub_f32 v48, v24, v44
v_sub_f32 v49, v25, v44
v_fmac_f32 v45, v48, v48
v_fmac_f32 v51, v49, v49
v_sub_f32 v48, v26, v44
v_sub_f32 v49, v27, v44
v_fmac_f32 v45, v48, v48
v_fmac_f32 v51, v49, v49
v_sub_f32 v48, v28, v44
v_sub_f32 v49, v29, v44
v_fmac_f32 v45, v48, v48
v_fmac_f32 v51, v49, v49
v_sub_f32 v48, v30, v44
v_sub_f32 v49, v31, v44
v_fmac_f32 v45, v48, v48
v_fmac_f32 v51, v49, v49
v_sub_f32 v48, v32, v44
v_sub_f32 v49, v33, v44
v_fmac_f32 v47, v48, v48
v_fmac_f32 v47, v49, v49
v_sub_f32 v48, v34, v44
v_sub_f32 v49, v35, v44
v_fmac_f32 v47, v48, v48
v_fmac_f32 v47, v49, v49
v_sub_f32 v48, v36, v44
v_sub_f32 v49, v37, v44
v_fmac_f32 v47, v48, v48
v_fmac_f32 v47, v49, v49
v_sub_f32 v48, v38, v44
v_sub_f32 v49, v39, v44
v_fmac_f32 v47, v48, v48
v_fmac_f32 v47, v49, v49
v_add_f32 v45, v45, v51
v_fmac_f32 v45, v47, v40
s_nop 1
v_add_f32_dpp v45, v45, v45 quad_perm:[1,0,3,2] row_mask:0xf bank_mask:0xf
s_nop 1
v_add_f32_dpp v45, v45, v45 quad_perm:[2,3,0,1] row_mask:0xf bank_mask:0xf
s_nop 1
v_add_f32_dpp v45, v45, v45 row_half_mirror row_mask:0xf bank_mask:0xf
s_nop 1
v_add_f32_dpp v45, v45, v45 row_mirror row_mask:0xf bank_mask:0xf
v_mov_b32 v48, v45
s_nop 1
v_permlane16_swap_b32 v45, v48
v_add_f32 v45, v45, v48
v_mul_f32 v45, 0x3ae38e39, v45
v_cvt_pk_bf16_f32 v45, v45, v45
v_lshlrev_b32 v45, 16, v45
v_cvt_pk_bf16_f32 v44, v44, v44
v_lshlrev_b32 v44, 16, v44
v_add_f32 v45, 0x3727c5ac, v45
v_cvt_pk_bf16_f32 v45, v45, v45
v_lshlrev_b32 v45, 16, v45
v_sqrt_f32 v45, v45
s_nop 0
v_cvt_pk_bf16_f32 v45, v45, v45
v_lshlrev_b32 v45, 16, v45
v_rcp_f32 v45, v45
s_nop 0
v_sub_f32 v16, v16, v44
v_sub_f32 v17, v17, v44
v_cvt_pk_bf16_f32 v4, v16, v17
v_lshlrev_b32 v16, 16, v4
v_and_b32 v17, s43, v4
v_mul_f32 v16, v16, v45
v_mul_f32 v17, v17, v45
v_cvt_pk_bf16_f32 v4, v16, v17
v_sub_f32 v18, v18, v44
v_sub_f32 v19, v19, v44
v_cvt_pk_bf16_f32 v5, v18, v19
v_lshlrev_b32 v18, 16, v5
v_and_b32 v19, s43, v5
v_mul_f32 v18, v18, v45
v_mul_f32 v19, v19, v45
v_cvt_pk_bf16_f32 v5, v18, v19
v_sub_f32 v20, v20, v44
v_sub_f32 v21, v21, v44
v_cvt_pk_bf16_f32 v6, v20, v21
v_lshlrev_b32 v20, 16, v6
v_and_b32 v21, s43, v6
v_mul_f32 v20, v20, v45
v_mul_f32 v21, v21, v45
v_cvt_pk_bf16_f32 v6, v20, v21
v_sub_f32 v22, v22, v44
v_sub_f32 v23, v23, v44
v_cvt_pk_bf16_f32 v7, v22, v23
v_lshlrev_b32 v22, 16, v7
v_and_b32 v23, s43, v7
v_mul_f32 v22, v22, v45
v_mul_f32 v23, v23, v45
v_cvt_pk_bf16_f32 v7, v22, v23
buffer_store_dwordx4 v[4:7], v3, s[8:11], s74 offen sc1
s_add_u32 s74, s74, 32768
v_sub_f32 v24, v24, v44
v_sub_f32 v25, v25, v44
v_cvt_pk_bf16_f32 v8, v24, v25
v_lshlrev_b32 v24, 16, v8
v_and_b32 v25, s43, v8
v_mul_f32 v24, v24, v45
v_mul_f32 v25, v25, v45
v_cvt_pk_bf16_f32 v8, v24, v25
v_sub_f32 v26, v26, v44
v_sub_f32 v27, v27, v44
v_cvt_pk_bf16_f32 v9, v26, v27
v_lshlrev_b32 v26, 16, v9
v_and_b32 v27, s43, v9
v_mul_f32 v26, v26, v45
v_mul_f32 v27, v27, v45
v_cvt_pk_bf16_f32 v9, v26, v27
v_sub_f32 v28, v28, v44
v_sub_f32 v29, v29, v44
v_cvt_pk_bf16_f32 v10, v28, v29
v_lshlrev_b32 v28, 16, v10
v_and_b32 v29, s43, v10
v_mul_f32 v28, v28, v45
v_mul_f32 v29, v29, v45
v_cvt_pk_bf16_f32 v10, v28, v29
v_sub_f32 v30, v30, v44
v_sub_f32 v31, v31, v44
v_cvt_pk_bf16_f32 v11, v30, v31
v_lshlrev_b32 v30, 16, v11
v_and_b32 v31, s43, v11
v_mul_f32 v30, v30, v45
v_mul_f32 v31, v31, v45
v_cvt_pk_bf16_f32 v11, v30, v31
buffer_store_dwordx4 v[8:11], v3, s[8:11], s74 offen sc1
s_add_u32 s74, s74, 32768
v_sub_f32 v32, v32, v44
v_sub_f32 v33, v33, v44
v_cvt_pk_bf16_f32 v12, v32, v33
v_lshlrev_b32 v32, 16, v12
v_and_b32 v33, s43, v12
v_mul_f32 v32, v32, v45
v_mul_f32 v33, v33, v45
v_cvt_pk_bf16_f32 v12, v32, v33
v_sub_f32 v34, v34, v44
v_sub_f32 v35, v35, v44
v_cvt_pk_bf16_f32 v13, v34, v35
v_lshlrev_b32 v34, 16, v13
v_and_b32 v35, s43, v13
v_mul_f32 v34, v34, v45
v_mul_f32 v35, v35, v45
v_cvt_pk_bf16_f32 v13, v34, v35
v_sub_f32 v36, v36, v44
v_sub_f32 v37, v37, v44
v_cvt_pk_bf16_f32 v14, v36, v37
v_lshlrev_b32 v36, 16, v14
v_and_b32 v37, s43, v14
v_mul_f32 v36, v36, v45
v_mul_f32 v37, v37, v45
v_cvt_pk_bf16_f32 v14, v36, v37
v_sub_f32 v38, v38, v44
v_sub_f32 v39, v39, v44
v_cvt_pk_bf16_f32 v15, v38, v39
v_lshlrev_b32 v38, 16, v15
v_and_b32 v39, s43, v15
v_mul_f32 v38, v38, v45
v_mul_f32 v39, v39, v45
v_cvt_pk_bf16_f32 v15, v38, v39
buffer_store_dwordx4 v[12:15], v41, s[8:11], s74 offen sc1
v_min_u32 v43, 1, v0
v_lshlrev_b32 v43, 30, v43
s_lshl_b32 s76, s2, 7
s_add_u32 s76, s76, s62
v_readfirstlane_b32 s51, v52
s_waitcnt vmcnt(0)
s_waitcnt lgkmcnt(0)
s_barrier
buffer_store_dword v52, v43, s[36:39], s76 offen sc1
s_add_u32 m0, s61, 0
s_nop 0
buffer_load_dwordx4 v233, s[16:19], s55 offen offset:0 lds
s_add_u32 s55, s55, 524288
buffer_load_dwordx4 v233, s[16:19], s56 offen offset:1024 lds
s_add_u32 s56, s56, 524288
buffer_load_dwordx4 v233, s[16:19], s57 offen offset:2048 lds
s_add_u32 s57, s57, 524288
buffer_load_dwordx4 v233, s[16:19], s58 offen offset:3072 lds
s_add_u32 s58, s58, 524288
s_add_u32 m0, s60, 0
s_nop 0
buffer_load_dwordx4 v224, s[12:15], s54 offen offset:0 lds
buffer_load_dwordx4 v225, s[12:15], s54 offen offset:1024 lds
buffer_load_dwordx4 v226, s[12:15], s54 offen offset:2048 lds
buffer_load_dwordx4 v227, s[12:15], s54 offen offset:3072 lds
s_add_u32 m0, s60, 4096
s_nop 0
buffer_load_dwordx4 v228, s[12:15], s54 offen offset:0 lds
buffer_load_dwordx4 v229, s[12:15], s54 offen offset:1024 lds
buffer_load_dwordx4 v230, s[12:15], s54 offen offset:2048 lds
buffer_load_dwordx4 v231, s[12:15], s54 offen offset:3072 lds
s_add_u32 m0, s60, 8192
s_nop 0
buffer_load_dwordx4 v232, s[12:15], s54 offen offset:0 lds
s_add_u32 s54, s54, 589824
buffer_load_dword v53, v50, s[36:39], s62 offen sc1
s_waitcnt vmcnt(0)
v_cmp_ne_u32 vcc, v53, v52
s_nop 4
s_cbranch_vccnz k1_pl_s
k1_pl_b:
buffer_load_dwordx4 a[192:195], v254, s[8:11], s59 offen offset:0 sc1
buffer_load_dwordx4 a[196:199], v254, s[8:11], s59 offen offset:1024 sc1
buffer_load_dwordx4 a[200:203], v254, s[8:11], s59 offen offset:2048 sc1
buffer_load_dwordx4 a[204:207], v254, s[8:11], s59 offen offset:3072 sc1
s_add_u32 s59, s59, 4096
s_add_u32 m0, s61, 53248
s_nop 0
buffer_load_dwordx4 v233, s[16:19], s55 offen offset:0 lds
s_add_u32 s55, s55, 524288
buffer_load_dwordx4 v233, s[16:19], s56 offen offset:1024 lds
s_add_u32 s56, s56, 524288
buffer_load_dwordx4 v233, s[16:19], s57 offen offset:2048 lds
s_add_u32 s57, s57, 524288
buffer_load_dwordx4 v233, s[16:19], s58 offen offset:3072 lds
s_add_u32 s58, s58, 524288
s_add_u32 m0, s60, 53248
s_nop 0
buffer_load_dwordx4 v224, s[12:15], s54 offen offset:0 lds
buffer_load_dwordx4 v225, s[12:15], s54 offen offset:1024 lds
buffer_load_dwordx4 v226, s[12:15], s54 offen offset:2048 lds
buffer_load_dwordx4 v227, s[12:15], s54 offen offset:3072 lds
s_waitcnt lgkmcnt(0)
s_barrier
s_waitcnt vmcnt(8)
ds_read_b64_tr_b16 a[240:241], v236 offset:36864
ds_read_b64_tr_b16 a[242:243], v236 offset:40960
ds_read_b64_tr_b16 a[244:245], v236 offset:36872
ds_read_b64_tr_b16 a[246:247], v236 offset:40968
ds_read_b64_tr_b16 a[248:249], v237 offset:36864
ds_read_b64_tr_b16 a[250:251], v237 offset:40960
ds_read_b64_tr_b16 a[252:253], v237 offset:36872
ds_read_b64_tr_b16 a[254:255], v237 offset:40968
s_waitcnt lgkmcnt(6)
v_mfma_f32_16x16x32_bf16 a[64:67], a[240:243], a[192:195], 0
ds_read_b64_tr_b16 v[240:241], v238 offset:36864
v_mfma_f32_16x16x32_bf16 a[68:71], a[240:243], a[196:199], 0
ds_read_b64_tr_b16 v[242:243], v238 offset:40960
v_mfma_f32_16x16x32_bf16 a[72:75], a[240:243], a[200:203], 0
buffer_load_dwordx4 a[208:211], v254, s[8:11], s59 offen offset:0 sc1
v_mfma_f32_16x16x32_bf16 a[76:79], a[240:243], a[204:207], 0
s_waitcnt lgkmcnt(6)
buffer_load_dwordx4 a[212:215], v254, s[8:11], s59 offen offset:1024 sc1
v_mfma_f32_16x16x32_bf16 a[92:95], a[244:247], a[204:207], 0
ds_read_b64_tr_b16 v[244:245], v238 offset:36872
v_mfma_f32_16x16x32_bf16 a[88:91], a[244:247], a[200:203], 0
ds_read_b64_tr_b16 v[246:247], v238 offset:40968
v_mfma_f32_16x16x32_bf16 a[84:87], a[244:247], a[196:199], 0
buffer_load_dwordx4 a[216:219], v254, s[8:11], s59 offen offset:2048 sc1
v_mfma_f32_16x16x32_bf16 a[80:83], a[244:247], a[192:195], 0
s_waitcnt lgkmcnt(6)
buffer_load_dwordx4 a[220:223], v254, s[8:11], s59 offen offset:3072 sc1
v_mfma_f32_16x16x32_bf16 a[96:99], a[248:251], a[192:195], 0
s_add_u32 s59, s59, 4096
ds_read_b64_tr_b16 a[240:241], v239 offset:36864
v_mfma_f32_16x16x32_bf16 a[100:103], a[248:251], a[196:199], 0
ds_read_b64_tr_b16 a[242:243], v239 offset:40960
v_mfma_f32_16x16x32_bf16 a[104:107], a[248:251], a[200:203], 0
v_mfma_f32_16x16x32_bf16 a[108:111], a[248:251], a[204:207], 0
s_waitcnt lgkmcnt(6)
v_mfma_f32_16x16x32_bf16 a[124:127], a[252:255], a[204:207], 0
s_add_u32 m0, s60, 57344
ds_read_b64_tr_b16 a[244:245], v239 offset:36872
v_mfma_f32_16x16x32_bf16 a[120:123], a[252:255], a[200:203], 0
ds_read_b64_tr_b16 a[246:247], v239 offset:40968
v_mfma_f32_16x16x32_bf16 a[116:119], a[252:255], a[196:199], 0
buffer_load_dwordx4 v228, s[12:15], s54 offen offset:0 lds
v_mfma_f32_16x16x32_bf16 a[112:115], a[252:255], a[192:195], 0
s_waitcnt lgkmcnt(6)
v_mfma_f32_16x16x32_bf16 a[128:131], v[240:243], a[192:195], 0
ds_read_b64_tr_b16 a[248:249], v235 offset:0
v_mfma_f32_16x16x32_bf16 a[132:135], v[240:243], a[196:199], 0
ds_read_b64_tr_b16 a[250:251], v235 offset:4608
v_mfma_f32_16x16x32_bf16 a[136:139], v[240:243], a[200:203], 0
buffer_load_dwordx4 v229, s[12:15], s54 offen offset:1024 lds
v_mfma_f32_16x16x32_bf16 a[140:143], v[240:243], a[204:207], 0
s_waitcnt lgkmcnt(6)
v_mfma_f32_16x16x32_bf16 a[156:159], v[244:247], a[204:207], 0
ds_read_b64_tr_b16 a[252:253], v235 offset:9216
v_mfma_f32_16x16x32_bf16 a[152:155], v[244:247], a[200:203], 0
ds_read_b64_tr_b16 a[254:255], v235 offset:13824
v_mfma_f32_16x16x32_bf16 a[148:151], v[244:247], a[196:199], 0
buffer_load_dwordx4 v230, s[12:15], s54 offen offset:2048 lds
v_mfma_f32_16x16x32_bf16 a[144:147], v[244:247], a[192:195], 0
s_waitcnt lgkmcnt(6)
v_mfma_f32_16x16x32_bf16 a[160:163], a[240:243], a[192:195], 0
ds_read_b64_tr_b16 v[240:241], v235 offset:18432
v_mfma_f32_16x16x32_bf16 a[164:167], a[240:243], a[196:199], 0
ds_read_b64_tr_b16 v[242:243], v235 offset:23040
v_mfma_f32_16x16x32_bf16 a[168:171], a[240:243], a[200:203], 0
buffer_load_dwordx4 v231, s[12:15], s54 offen offset:3072 lds
v_mfma_f32_16x16x32_bf16 a[172:175], a[240:243], a[204:207], 0
s_waitcnt lgkmcnt(6)
v_mfma_f32_16x16x32_bf16 a[188:191], a[244:247], a[204:207], 0
ds_read_b64_tr_b16 v[244:245], v235 offset:27648
v_mfma_f32_16x16x32_bf16 a[184:187], a[244:247], a[200:203], 0
s_add_u32 m0, s60, 61440
ds_read_b64_tr_b16 v[246:247], v235 offset:32256
v_mfma_f32_16x16x32_bf16 a[180:183], a[244:247], a[196:199], 0
s_waitcnt vmcnt(4)
buffer_load_dwordx4 a[224:227], v254, s[8:11], s59 offen offset:0 sc1
v_mfma_f32_16x16x32_bf16 a[176:179], a[244:247], a[192:195], 0
s_waitcnt lgkmcnt(4)
buffer_load_dwordx4 a[228:231], v254, s[8:11], s59 offen offset:1024 sc1
v_mfma_f32_16x16x32_bf16 v[0:3], a[248:251], a[192:195], 0
ds_read_b64_tr_b16 a[240:241], v235 offset:32
v_mfma_f32_16x16x32_bf16 v[0:3], a[252:255], a[208:211], v[0:3]
ds_read_b64_tr_b16 a[242:243], v235 offset:4640
v_mfma_f32_16x16x32_bf16 v[4:7], a[252:255], a[212:215], 0
ds_read_b64_tr_b16 a[244:245], v235 offset:9248
v_mfma_f32_16x16x32_bf16 v[4:7], a[248:251], a[196:199], v[4:7]
s_waitcnt lgkmcnt(7)
ds_read_b64_tr_b16 a[246:247], v235 offset:13856
v_mfma_f32_16x16x32_bf16 v[8:11], a[248:251], a[200:203], 0
buffer_load_dwordx4 a[232:235], v254, s[8:11], s59 offen offset:2048 sc1
v_mfma_f32_16x16x32_bf16 v[8:11], a[252:255], a[216:219], v[8:11]
buffer_load_dwordx4 a[236:239], v254, s[8:11], s59 offen offset:3072 sc1
v_mfma_f32_16x16x32_bf16 v[12:15], a[252:255], a[220:223], 0
s_add_u32 s59, s59, 4096
buffer_load_dwordx4 v232, s[12:15], s54 offen offset:0 lds
v_mfma_f32_16x16x32_bf16 v[12:15], a[248:251], a[204:207], v[12:15]
s_waitcnt lgkmcnt(4)
v_mfma_f32_16x16x32_bf16 v[28:31], v[240:243], a[204:207], 0
s_add_u32 s54, s54, 589824
ds_read_b64_tr_b16 a[248:249], v235 offset:18464
v_mfma_f32_16x16x32_bf16 v[28:31], v[244:247], a[220:223], v[28:31]
s_add_u32 m0, s61, 106496
ds_read_b64_tr_b16 a[250:251], v235 offset:23072
v_mfma_f32_16x16x32_bf16 v[24:27], v[244:247], a[216:219], 0
ds_read_b64_tr_b16 a[252:253], v235 offset:27680
v_mfma_f32_16x16x32_bf16 v[24:27], v[240:243], a[200:203], v[24:27]
s_waitcnt lgkmcnt(7)
ds_read_b64_tr_b16 a[254:255], v235 offset:32288
v_mfma_f32_16x16x32_bf16 v[20:23], v[240:243], a[196:199], 0
buffer_load_dwordx4 v233, s[16:19], s55 offen offset:0 lds
v_mfma_f32_16x16x32_bf16 v[20:23], v[244:247], a[212:215], v[20:23]
s_add_u32 s55, s55, 524288
v_mfma_f32_16x16x32_bf16 v[16:19], v[244:247], a[208:211], 0
v_mfma_f32_16x16x32_bf16 v[16:19], v[240:243], a[192:195], v[16:19]
s_waitcnt lgkmcnt(4)
buffer_load_dwordx4 v233, s[16:19], s56 offen offset:1024 lds
v_mfma_f32_16x16x32_bf16 v[32:35], a[240:243], a[192:195], 0
s_add_u32 s56, s56, 524288
ds_read_b64_tr_b16 v[240:241], v235 offset:64
v_mfma_f32_16x16x32_bf16 v[32:35], a[244:247], a[208:211], v[32:35]
ds_read_b64_tr_b16 v[242:243], v235 offset:4672
v_mfma_f32_16x16x32_bf16 v[36:39], a[244:247], a[212:215], 0
ds_read_b64_tr_b16 v[244:245], v235 offset:9280
v_mfma_f32_16x16x32_bf16 v[36:39], a[240:243], a[196:199], v[36:39]
s_waitcnt lgkmcnt(7)
ds_read_b64_tr_b16 v[246:247], v235 offset:13888
v_mfma_f32_16x16x32_bf16 v[40:43], a[240:243], a[200:203], 0
buffer_load_dwordx4 v233, s[16:19], s57 offen offset:2048 lds
v_mfma_f32_16x16x32_bf16 v[40:43], a[244:247], a[216:219], v[40:43]
s_add_u32 s57, s57, 524288
v_mfma_f32_16x16x32_bf16 v[44:47], a[244:247], a[220:223], 0
v_mfma_f32_16x16x32_bf16 v[44:47], a[240:243], a[204:207], v[44:47]
s_waitcnt lgkmcnt(4)
buffer_load_dwordx4 v233, s[16:19], s58 offen offset:3072 lds
v_mfma_f32_16x16x32_bf16 v[60:63], a[248:251], a[204:207], 0
s_add_u32 s58, s58, 524288
ds_read_b64_tr_b16 a[240:241], v235 offset:18496
v_mfma_f32_16x16x32_bf16 v[60:63], a[252:255], a[220:223], v[60:63]
ds_read_b64_tr_b16 a[242:243], v235 offset:23104
v_mfma_f32_16x16x32_bf16 v[56:59], a[252:255], a[216:219], 0
s_add_u32 m0, s60, 106496
ds_read_b64_tr_b16 a[244:245], v235 offset:27712
v_mfma_f32_16x16x32_bf16 v[56:59], a[248:251], a[200:203], v[56:59]
s_waitcnt lgkmcnt(7)
ds_read_b64_tr_b16 a[246:247], v235 offset:32320
v_mfma_f32_16x16x32_bf16 v[52:55], a[248:251], a[196:199], 0
buffer_load_dwordx4 v224, s[12:15], s54 offen offset:0 lds
v_mfma_f32_16x16x32_bf16 v[52:55], a[252:255], a[212:215], v[52:55]
v_mfma_f32_16x16x32_bf16 v[48:51], a[252:255], a[208:211], 0
v_mfma_f32_16x16x32_bf16 v[48:51], a[248:251], a[192:195], v[48:51]
s_waitcnt lgkmcnt(4)
buffer_load_dwordx4 v225, s[12:15], s54 offen offset:1024 lds
v_mfma_f32_16x16x32_bf16 v[64:67], v[240:243], a[192:195], 0
ds_read_b64_tr_b16 a[248:249], v235 offset:96
v_mfma_f32_16x16x32_bf16 v[64:67], v[244:247], a[208:211], v[64:67]
ds_read_b64_tr_b16 a[250:251], v235 offset:4704
v_mfma_f32_16x16x32_bf16 v[68:71], v[244:247], a[212:215], 0
ds_read_b64_tr_b16 a[252:253], v235 offset:9312
v_mfma_f32_16x16x32_bf16 v[68:71], v[240:243], a[196:199], v[68:71]
s_waitcnt lgkmcnt(7)
ds_read_b64_tr_b16 a[254:255], v235 offset:13920
v_mfma_f32_16x16x32_bf16 v[72:75], v[240:243], a[200:203], 0
buffer_load_dwordx4 v226, s[12:15], s54 offen offset:2048 lds
v_mfma_f32_16x16x32_bf16 v[72:75], v[244:247], a[216:219], v[72:75]
v_mfma_f32_16x16x32_bf16 v[76:79], v[244:247], a[220:223], 0
v_mfma_f32_16x16x32_bf16 v[76:79], v[240:243], a[204:207], v[76:79]
s_waitcnt lgkmcnt(4)
buffer_load_dwordx4 v227, s[12:15], s54 offen offset:3072 lds
v_mfma_f32_16x16x32_bf16 v[92:95], a[240:243], a[204:207], 0
ds_read_b64_tr_b16 v[240:241], v235 offset:18528
v_mfma_f32_16x16x32_bf16 v[92:95], a[244:247], a[220:223], v[92:95]
ds_read_b64_tr_b16 v[242:243], v235 offset:23136
v_mfma_f32_16x16x32_bf16 v[88:91], a[244:247], a[216:219], 0
s_add_u32 m0, s60, 110592
ds_read_b64_tr_b16 v[244:245], v235 offset:27744
v_mfma_f32_16x16x32_bf16 v[88:91], a[240:243], a[200:203], v[88:91]
s_waitcnt lgkmcnt(7)
ds_read_b64_tr_b16 v[246:247], v235 offset:32352
v_mfma_f32_16x16x32_bf16 v[84:87], a[240:243], a[196:199], 0
buffer_load_dwordx4 v228, s[12:15], s54 offen offset:0 lds
v_mfma_f32_16x16x32_bf16 v[84:87], a[244:247], a[212:215], v[84:87]
v_mfma_f32_16x16x32_bf16 v[80:83], a[244:247], a[208:211], 0
v_mfma_f32_16x16x32_bf16 v[80:83], a[240:243], a[192:195], v[80:83]
s_waitcnt lgkmcnt(4)
buffer_load_dwordx4 v229, s[12:15], s54 offen offset:1024 lds
v_mfma_f32_16x16x32_bf16 v[96:99], a[248:251], a[192:195], 0
ds_read_b64_tr_b16 a[240:241], v235 offset:128
v_mfma_f32_16x16x32_bf16 v[96:99], a[252:255], a[208:211], v[96:99]
ds_read_b64_tr_b16 a[242:243], v235 offset:4736
v_mfma_f32_16x16x32_bf16 v[100:103], a[252:255], a[212:215], 0
ds_read_b64_tr_b16 a[244:245], v235 offset:9344
v_mfma_f32_16x16x32_bf16 v[100:103], a[248:251], a[196:199], v[100:103]
s_waitcnt lgkmcnt(7)
ds_read_b64_tr_b16 a[246:247], v235 offset:13952
v_mfma_f32_16x16x32_bf16 v[104:107], a[248:251], a[200:203], 0
buffer_load_dwordx4 v230, s[12:15], s54 offen offset:2048 lds
v_mfma_f32_16x16x32_bf16 v[104:107], a[252:255], a[216:219], v[104:107]
v_mfma_f32_16x16x32_bf16 v[108:111], a[252:255], a[220:223], 0
v_mfma_f32_16x16x32_bf16 v[108:111], a[248:251], a[204:207], v[108:111]
s_waitcnt lgkmcnt(4)
buffer_load_dwordx4 v231, s[12:15], s54 offen offset:3072 lds
v_mfma_f32_16x16x32_bf16 v[124:127], v[240:243], a[204:207], 0
ds_read_b64_tr_b16 a[248:249], v235 offset:18560
v_mfma_f32_16x16x32_bf16 v[124:127], v[244:247], a[220:223], v[124:127]
ds_read_b64_tr_b16 a[250:251], v235 offset:23168
v_mfma_f32_16x16x32_bf16 v[120:123], v[244:247], a[216:219], 0
s_add_u32 m0, s60, 114688
ds_read_b64_tr_b16 a[252:253], v235 offset:27776
v_mfma_f32_16x16x32_bf16 v[120:123], v[240:243], a[200:203], v[120:123]
s_waitcnt lgkmcnt(7)
ds_read_b64_tr_b16 a[254:255], v235 offset:32384
v_mfma_f32_16x16x32_bf16 v[116:119], v[240:243], a[196:199], 0
buffer_load_dwordx4 v232, s[12:15], s54 offen offset:0 lds
v_mfma_f32_16x16x32_bf16 v[116:119], v[244:247], a[212:215], v[116:119]
s_add_u32 s54, s54, 589824
v_mfma_f32_16x16x32_bf16 v[112:115], v[244:247], a[208:211], 0
v_mfma_f32_16x16x32_bf16 v[112:115], v[240:243], a[192:195], v[112:115]
s_waitcnt lgkmcnt(4)
v_mfma_f32_16x16x32_bf16 v[128:131], a[240:243], a[192:195], 0
ds_read_b64_tr_b16 v[240:241], v235 offset:160
v_mfma_f32_16x16x32_bf16 v[128:131], a[244:247], a[208:211], v[128:131]
ds_read_b64_tr_b16 v[242:243], v235 offset:4768
v_mfma_f32_16x16x32_bf16 v[132:135], a[244:247], a[212:215], 0
ds_read_b64_tr_b16 v[244:245], v235 offset:9376
v_mfma_f32_16x16x32_bf16 v[132:135], a[240:243], a[196:199], v[132:135]
s_waitcnt lgkmcnt(7)
ds_read_b64_tr_b16 v[246:247], v235 offset:13984
v_mfma_f32_16x16x32_bf16 v[136:139], a[240:243], a[200:203], 0
v_mfma_f32_16x16x32_bf16 v[136:139], a[244:247], a[216:219], v[136:139]
v_mfma_f32_16x16x32_bf16 v[140:143], a[244:247], a[220:223], 0
v_mfma_f32_16x16x32_bf16 v[140:143], a[240:243], a[204:207], v[140:143]
s_waitcnt lgkmcnt(4)
v_mfma_f32_16x16x32_bf16 v[156:159], a[248:251], a[204:207], 0
ds_read_b64_tr_b16 a[240:241], v235 offset:18592
v_mfma_f32_16x16x32_bf16 v[156:159], a[252:255], a[220:223], v[156:159]
ds_read_b64_tr_b16 a[242:243], v235 offset:23200
v_mfma_f32_16x16x32_bf16 v[152:155], a[252:255], a[216:219], 0
ds_read_b64_tr_b16 a[244:245], v235 offset:27808
v_mfma_f32_16x16x32_bf16 v[152:155], a[248:251], a[200:203], v[152:155]
s_waitcnt lgkmcnt(7)
ds_read_b64_tr_b16 a[246:247], v235 offset:32416
v_mfma_f32_16x16x32_bf16 v[148:151], a[248:251], a[196:199], 0
v_mfma_f32_16x16x32_bf16 v[148:151], a[252:255], a[212:215], v[148:151]
v_mfma_f32_16x16x32_bf16 v[144:147], a[252:255], a[208:211], 0
v_mfma_f32_16x16x32_bf16 v[144:147], a[248:251], a[192:195], v[144:147]
s_waitcnt lgkmcnt(4)
v_mfma_f32_16x16x32_bf16 v[160:163], v[240:243], a[192:195], 0
ds_read_b64_tr_b16 a[248:249], v235 offset:192
v_mfma_f32_16x16x32_bf16 v[160:163], v[244:247], a[208:211], v[160:163]
ds_read_b64_tr_b16 a[250:251], v235 offset:4800
v_mfma_f32_16x16x32_bf16 v[164:167], v[244:247], a[212:215], 0
ds_read_b64_tr_b16 a[252:253], v235 offset:9408
v_mfma_f32_16x16x32_bf16 v[164:167], v[240:243], a[196:199], v[164:167]
s_waitcnt lgkmcnt(7)
ds_read_b64_tr_b16 a[254:255], v235 offset:14016
v_mfma_f32_16x16x32_bf16 v[168:171], v[240:243], a[200:203], 0
v_mfma_f32_16x16x32_bf16 v[168:171], v[244:247], a[216:219], v[168:171]
v_mfma_f32_16x16x32_bf16 v[172:175], v[244:247], a[220:223], 0
v_mfma_f32_16x16x32_bf16 v[172:175], v[240:243], a[204:207], v[172:175]
s_waitcnt lgkmcnt(4)
v_mfma_f32_16x16x32_bf16 v[188:191], a[240:243], a[204:207], 0
ds_read_b64_tr_b16 v[240:241], v235 offset:18624
v_mfma_f32_16x16x32_bf16 v[188:191], a[244:247], a[220:223], v[188:191]
ds_read_b64_tr_b16 v[242:243], v235 offset:23232
v_mfma_f32_16x16x32_bf16 v[184:187], a[244:247], a[216:219], 0
ds_read_b64_tr_b16 v[244:245], v235 offset:27840
v_mfma_f32_16x16x32_bf16 v[184:187], a[240:243], a[200:203], v[184:187]
s_waitcnt lgkmcnt(7)
ds_read_b64_tr_b16 v[246:247], v235 offset:32448
v_mfma_f32_16x16x32_bf16 v[180:183], a[240:243], a[196:199], 0
v_mfma_f32_16x16x32_bf16 v[180:183], a[244:247], a[212:215], v[180:183]
v_mfma_f32_16x16x32_bf16 v[176:179], a[244:247], a[208:211], 0
v_mfma_f32_16x16x32_bf16 v[176:179], a[240:243], a[192:195], v[176:179]
s_waitcnt lgkmcnt(4)
v_mfma_f32_16x16x32_bf16 v[192:195], a[248:251], a[192:195], 0
ds_read_b64_tr_b16 a[240:241], v235 offset:224
v_mfma_f32_16x16x32_bf16 v[192:195], a[252:255], a[208:211], v[192:195]
ds_read_b64_tr_b16 a[242:243], v235 offset:4832
v_mfma_f32_16x16x32_bf16 v[196:199], a[252:255], a[212:215], 0
ds_read_b64_tr_b16 a[244:245], v235 offset:9440
v_mfma_f32_16x16x32_bf16 v[196:199], a[248:251], a[196:199], v[196:199]
s_waitcnt lgkmcnt(7)
ds_read_b64_tr_b16 a[246:247], v235 offset:14048
v_mfma_f32_16x16x32_bf16 v[200:203], a[248:251], a[200:203], 0
v_mfma_f32_16x16x32_bf16 v[200:203], a[252:255], a[216:219], v[200:203]
v_mfma_f32_16x16x32_bf16 v[204:207], a[252:255], a[220:223], 0
v_mfma_f32_16x16x32_bf16 v[204:207], a[248:251], a[204:207], v[204:207]
s_waitcnt lgkmcnt(4)
v_mfma_f32_16x16x32_bf16 v[220:223], v[240:243], a[204:207], 0
ds_read_b64_tr_b16 a[248:249], v235 offset:18656
v_mfma_f32_16x16x32_bf16 v[220:223], v[244:247], a[220:223], v[220:223]
ds_read_b64_tr_b16 a[250:251], v235 offset:23264
v_mfma_f32_16x16x32_bf16 v[216:219], v[244:247], a[216:219], 0
ds_read_b64_tr_b16 a[252:253], v235 offset:27872
v_mfma_f32_16x16x32_bf16 v[216:219], v[240:243], a[200:203], v[216:219]
s_waitcnt lgkmcnt(7)
ds_read_b64_tr_b16 a[254:255], v235 offset:32480
v_mfma_f32_16x16x32_bf16 v[212:215], v[240:243], a[196:199], 0
v_mfma_f32_16x16x32_bf16 v[212:215], v[244:247], a[212:215], v[212:215]
v_mfma_f32_16x16x32_bf16 v[208:211], v[244:247], a[208:211], 0
v_mfma_f32_16x16x32_bf16 v[208:211], v[240:243], a[192:195], v[208:211]
s_waitcnt lgkmcnt(4)
v_mfma_f32_16x16x32_bf16 a[0:3], a[240:243], a[192:195], 0
ds_read_b64_tr_b16 v[240:241], v235 offset:256
v_mfma_f32_16x16x32_bf16 a[0:3], a[244:247], a[208:211], a[0:3]
ds_read_b64_tr_b16 v[242:243], v235 offset:4864
v_mfma_f32_16x16x32_bf16 a[4:7], a[244:247], a[212:215], 0
ds_read_b64_tr_b16 v[244:245], v235 offset:9472
v_mfma_f32_16x16x32_bf16 a[4:7], a[240:243], a[196:199], a[4:7]
s_waitcnt lgkmcnt(7)
ds_read_b64_tr_b16 v[246:247], v235 offset:14080
v_mfma_f32_16x16x32_bf16 a[8:11], a[240:243], a[200:203], 0
v_mfma_f32_16x16x32_bf16 a[8:11], a[244:247], a[216:219], a[8:11]
v_mfma_f32_16x16x32_bf16 a[12:15], a[244:247], a[220:223], 0
v_mfma_f32_16x16x32_bf16 a[12:15], a[240:243], a[204:207], a[12:15]
s_waitcnt lgkmcnt(4)
v_mfma_f32_16x16x32_bf16 a[28:31], a[248:251], a[204:207], 0
ds_read_b64_tr_b16 a[240:241], v235 offset:18688
v_mfma_f32_16x16x32_bf16 a[28:31], a[252:255], a[220:223], a[28:31]
ds_read_b64_tr_b16 a[242:243], v235 offset:23296
v_mfma_f32_16x16x32_bf16 a[24:27], a[252:255], a[216:219], 0
ds_read_b64_tr_b16 a[244:245], v235 offset:27904
v_mfma_f32_16x16x32_bf16 a[24:27], a[248:251], a[200:203], a[24:27]
s_waitcnt lgkmcnt(7)
ds_read_b64_tr_b16 a[246:247], v235 offset:32512
v_add_u32 v235, 0xd000, v235
v_mfma_f32_16x16x32_bf16 a[20:23], a[248:251], a[196:199], 0
s_waitcnt vmcnt(13)
ds_add_u32 v251, v253
v_mfma_f32_16x16x32_bf16 a[20:23], a[252:255], a[212:215], a[20:23]
v_mfma_f32_16x16x32_bf16 a[16:19], a[252:255], a[208:211], 0
v_mfma_f32_16x16x32_bf16 a[16:19], a[248:251], a[192:195], a[16:19]
s_waitcnt lgkmcnt(5)
v_mfma_f32_16x16x32_bf16 a[32:35], v[240:243], a[192:195], 0
ds_read_b64_tr_b16 a[248:249], v236 offset:45056
v_mfma_f32_16x16x32_bf16 a[32:35], v[244:247], a[208:211], a[32:35]
ds_read_b64_tr_b16 a[250:251], v236 offset:49152
v_mfma_f32_16x16x32_bf16 a[36:39], v[244:247], a[212:215], 0
ds_read_b64_tr_b16 a[252:253], v236 offset:45064
v_mfma_f32_16x16x32_bf16 a[36:39], v[240:243], a[196:199], a[36:39]
s_waitcnt lgkmcnt(8)
ds_read_b64_tr_b16 a[254:255], v236 offset:49160
v_add_u32 v236, 0xd000, v236
v_mfma_f32_16x16x32_bf16 a[40:43], v[240:243], a[200:203], 0
v_mfma_f32_16x16x32_bf16 a[40:43], v[244:247], a[216:219], a[40:43]
v_mfma_f32_16x16x32_bf16 a[44:47], v[244:247], a[220:223], 0
v_mfma_f32_16x16x32_bf16 a[44:47], v[240:243], a[204:207], a[44:47]
s_waitcnt lgkmcnt(5)
v_mfma_f32_16x16x32_bf16 a[60:63], a[240:243], a[204:207], 0
ds_read_b64_tr_b16 v[240:241], v237 offset:45056
v_mfma_f32_16x16x32_bf16 a[60:63], a[244:247], a[220:223], a[60:63]
ds_read_b64_tr_b16 v[242:243], v237 offset:49152
v_mfma_f32_16x16x32_bf16 a[56:59], a[244:247], a[216:219], 0
ds_read_b64_tr_b16 v[244:245], v237 offset:45064
v_mfma_f32_16x16x32_bf16 a[56:59], a[240:243], a[200:203], a[56:59]
s_waitcnt lgkmcnt(8)
ds_read_b64_tr_b16 v[246:247], v237 offset:49160
v_add_u32 v237, 0xd000, v237
v_mfma_f32_16x16x32_bf16 a[52:55], a[240:243], a[196:199], 0
v_mfma_f32_16x16x32_bf16 a[52:55], a[244:247], a[212:215], a[52:55]
v_mfma_f32_16x16x32_bf16 a[48:51], a[244:247], a[208:211], 0
v_mfma_f32_16x16x32_bf16 a[48:51], a[240:243], a[192:195], a[48:51]
s_waitcnt lgkmcnt(6)
v_mfma_f32_16x16x32_bf16 a[64:67], a[248:251], a[208:211], a[64:67]
ds_read_b64_tr_b16 a[240:241], v238 offset:45056
v_mfma_f32_16x16x32_bf16 a[68:71], a[248:251], a[212:215], a[68:71]
ds_read_b64_tr_b16 a[242:243], v238 offset:49152
v_mfma_f32_16x16x32_bf16 a[72:75], a[248:251], a[216:219], a[72:75]
ds_read_b32 v255, v252
v_mfma_f32_16x16x32_bf16 a[76:79], a[248:251], a[220:223], a[76:79]
s_waitcnt lgkmcnt(7)
buffer_load_dwordx4 a[192:195], v254, s[8:11], s59 offen offset:0 sc1
v_mfma_f32_16x16x32_bf16 a[92:95], a[252:255], a[220:223], a[92:95]
ds_read_b64_tr_b16 a[244:245], v238 offset:45064
v_mfma_f32_16x16x32_bf16 a[88:91], a[252:255], a[216:219], a[88:91]
ds_read_b64_tr_b16 a[246:247], v238 offset:49160
v_add_u32 v238, 0xd000, v238
v_mfma_f32_16x16x32_bf16 a[84:87], a[252:255], a[212:215], a[84:87]
buffer_load_dwordx4 a[196:199], v254, s[8:11], s59 offen offset:1024 sc1
v_mfma_f32_16x16x32_bf16 a[80:83], a[252:255], a[208:211], a[80:83]
s_waitcnt lgkmcnt(7)
buffer_load_dwordx4 a[200:203], v254, s[8:11], s59 offen offset:2048 sc1
v_mfma_f32_16x16x32_bf16 a[96:99], v[240:243], a[208:211], a[96:99]
ds_read_b64_tr_b16 a[248:249], v239 offset:45056
v_mfma_f32_16x16x32_bf16 a[100:103], v[240:243], a[212:215], a[100:103]
ds_read_b64_tr_b16 a[250:251], v239 offset:49152
v_mfma_f32_16x16x32_bf16 a[104:107], v[240:243], a[216:219], a[104:107]
buffer_load_dwordx4 a[204:207], v254, s[8:11], s59 offen offset:3072 sc1
v_mfma_f32_16x16x32_bf16 a[108:111], v[240:243], a[220:223], a[108:111]
s_waitcnt lgkmcnt(4)
v_mfma_f32_16x16x32_bf16 a[124:127], v[244:247], a[220:223], a[124:127]
s_add_u32 s59, s59, 4096
ds_read_b64_tr_b16 a[252:253], v239 offset:45064
v_cmp_gt_u32 vcc, 1, v255
v_mfma_f32_16x16x32_bf16 a[120:123], v[244:247], a[216:219], a[120:123]
ds_read_b64_tr_b16 a[254:255], v239 offset:49160
v_add_u32 v239, 0xd000, v239
v_mfma_f32_16x16x32_bf16 a[116:119], v[244:247], a[212:215], a[116:119]
v_mfma_f32_16x16x32_bf16 a[112:115], v[244:247], a[208:211], a[112:115]
s_waitcnt lgkmcnt(6)
v_mfma_f32_16x16x32_bf16 a[128:131], a[240:243], a[208:211], a[128:131]
s_cbranch_vccnz k1_g1_s
k1_g1_b:
ds_read_b64_tr_b16 v[240:241], v236 offset:36864
v_mfma_f32_16x16x32_bf16 a[132:135], a[240:243], a[212:215], a[132:135]
ds_read_b64_tr_b16 v[242:243], v236 offset:40960
v_mfma_f32_16x16x32_bf16 a[136:139], a[240:243], a[216:219], a[136:139]
ds_add_u32 v251, v253
v_mfma_f32_16x16x32_bf16 a[140:143], a[240:243], a[220:223], a[140:143]
s_waitcnt lgkmcnt(7)
v_mfma_f32_16x16x32_bf16 a[156:159], a[244:247], a[220:223], a[156:159]
ds_read_b64_tr_b16 v[244:245], v236 offset:36872
v_mfma_f32_16x16x32_bf16 a[152:155], a[244:247], a[216:219], a[152:155]
ds_read_b64_tr_b16 v[246:247], v236 offset:40968
v_mfma_f32_16x16x32_bf16 a[148:151], a[244:247], a[212:215], a[148:151]
v_mfma_f32_16x16x32_bf16 a[144:147], a[244:247], a[208:211], a[144:147]
s_waitcnt lgkmcnt(7)
v_mfma_f32_16x16x32_bf16 a[160:163], a[248:251], a[208:211], a[160:163]
ds_read_b64_tr_b16 a[240:241], v237 offset:36864
v_mfma_f32_16x16x32_bf16 a[164:167], a[248:251], a[212:215], a[164:167]
ds_read_b64_tr_b16 a[242:243], v237 offset:40960
v_mfma_f32_16x16x32_bf16 a[168:171], a[248:251], a[216:219], a[168:171]
v_mfma_f32_16x16x32_bf16 a[172:175], a[248:251], a[220:223], a[172:175]
s_waitcnt lgkmcnt(7)
v_mfma_f32_16x16x32_bf16 a[188:191], a[252:255], a[220:223], a[188:191]
ds_read_b64_tr_b16 a[244:245], v237 offset:36872
v_mfma_f32_16x16x32_bf16 a[184:187], a[252:255], a[216:219], a[184:187]
ds_read_b64_tr_b16 a[246:247], v237 offset:40968
v_mfma_f32_16x16x32_bf16 a[180:183], a[252:255], a[212:215], a[180:183]
s_waitcnt vmcnt(17)
v_mfma_f32_16x16x32_bf16 a[176:179], a[252:255], a[208:211], a[176:179]
s_waitcnt lgkmcnt(7)
v_mfma_f32_16x16x32_bf16 a[64:67], v[240:243], a[224:227], a[64:67]
ds_read_b64_tr_b16 a[248:249], v238 offset:36864
ds_read_b32 v255, v252
v_mfma_f32_16x16x32_bf16 a[68:71], v[240:243], a[228:231], a[68:71]
ds_read_b64_tr_b16 a[250:251], v238 offset:40960
v_mfma_f32_16x16x32_bf16 a[72:75], v[240:243], a[232:235], a[72:75]
buffer_load_dwordx4 a[208:211], v254, s[8:11], s59 offen offset:0 sc1
v_mfma_f32_16x16x32_bf16 a[76:79], v[240:243], a[236:239], a[76:79]
s_waitcnt lgkmcnt(7)
buffer_load_dwordx4 a[212:215], v254, s[8:11], s59 offen offset:1024 sc1
v_mfma_f32_16x16x32_bf16 a[92:95], v[244:247], a[236:239], a[92:95]
ds_read_b64_tr_b16 a[252:253], v238 offset:36872
v_mfma_f32_16x16x32_bf16 a[88:91], v[244:247], a[232:235], a[88:91]
ds_read_b64_tr_b16 a[254:255], v238 offset:40968
v_mfma_f32_16x16x32_bf16 a[84:87], v[244:247], a[228:231], a[84:87]
buffer_load_dwordx4 a[216:219], v254, s[8:11], s59 offen offset:2048 sc1
v_mfma_f32_16x16x32_bf16 a[80:83], v[244:247], a[224:227], a[80:83]
s_waitcnt lgkmcnt(3)
buffer_load_dwordx4 a[220:223], v254, s[8:11], s59 offen offset:3072 sc1
v_mfma_f32_16x16x32_bf16 a[96:99], a[240:243], a[224:227], a[96:99]
s_add_u32 s59, s59, 4096
ds_read_b64_tr_b16 v[240:241], v239 offset:36864
v_cmp_gt_u32 vcc, 2, v255
v_mfma_f32_16x16x32_bf16 a[100:103], a[240:243], a[228:231], a[100:103]
ds_read_b64_tr_b16 v[242:243], v239 offset:40960
v_mfma_f32_16x16x32_bf16 a[104:107], a[240:243], a[232:235], a[104:107]
v_mfma_f32_16x16x32_bf16 a[108:111], a[240:243], a[236:239], a[108:111]
s_waitcnt lgkmcnt(5)
v_mfma_f32_16x16x32_bf16 a[124:127], a[244:247], a[236:239], a[124:127]
s_cbranch_vccnz k1_g2_s
k1_g2_b:
ds_read_b64_tr_b16 v[244:245], v239 offset:36872
v_mfma_f32_16x16x32_bf16 a[120:123], a[244:247], a[232:235], a[120:123]
ds_read_b64_tr_b16 v[246:247], v239 offset:40968
v_mfma_f32_16x16x32_bf16 a[116:119], a[244:247], a[228:231], a[116:119]
v_mfma_f32_16x16x32_bf16 a[112:115], a[244:247], a[224:227], a[112:115]
s_waitcnt lgkmcnt(6)
v_mfma_f32_16x16x32_bf16 a[128:131], a[248:251], a[224:227], a[128:131]
s_add_u32 m0, s61, 0
ds_read_b64_tr_b16 a[240:241], v235 offset:0
v_mfma_f32_16x16x32_bf16 a[132:135], a[248:251], a[228:231], a[132:135]
ds_read_b64_tr_b16 a[242:243], v235 offset:4608
v_mfma_f32_16x16x32_bf16 a[136:139], a[248:251], a[232:235], a[136:139]
buffer_load_dwordx4 v233, s[16:19], s55 offen offset:0 lds
v_mfma_f32_16x16x32_bf16 a[140:143], a[248:251], a[236:239], a[140:143]
s_waitcnt lgkmcnt(6)
v_mfma_f32_16x16x32_bf16 a[156:159], a[252:255], a[236:239], a[156:159]
s_add_u32 s55, s55, 524288
ds_read_b64_tr_b16 a[244:245], v235 offset:9216
v_mfma_f32_16x16x32_bf16 a[152:155], a[252:255], a[232:235], a[152:155]
ds_read_b64_tr_b16 a[246:247], v235 offset:13824
v_mfma_f32_16x16x32_bf16 a[148:151], a[252:255], a[228:231], a[148:151]
v_mfma_f32_16x16x32_bf16 a[144:147], a[252:255], a[224:227], a[144:147]
s_waitcnt lgkmcnt(6)
v_mfma_f32_16x16x32_bf16 a[160:163], v[240:243], a[224:227], a[160:163]
ds_read_b64_tr_b16 a[248:249], v235 offset:18432
v_mfma_f32_16x16x32_bf16 a[164:167], v[240:243], a[228:231], a[164:167]
ds_read_b64_tr_b16 a[250:251], v235 offset:23040
v_mfma_f32_16x16x32_bf16 a[168:171], v[240:243], a[232:235], a[168:171]
buffer_load_dwordx4 v233, s[16:19], s56 offen offset:1024 lds
v_mfma_f32_16x16x32_bf16 a[172:175], v[240:243], a[236:239], a[172:175]
s_waitcnt lgkmcnt(6)
v_mfma_f32_16x16x32_bf16 a[188:191], v[244:247], a[236:239], a[188:191]
s_add_u32 s56, s56, 524288
ds_read_b64_tr_b16 a[252:253], v235 offset:27648
v_mfma_f32_16x16x32_bf16 a[184:187], v[244:247], a[232:235], a[184:187]
ds_read_b64_tr_b16 a[254:255], v235 offset:32256
v_mfma_f32_16x16x32_bf16 a[180:183], v[244:247], a[228:231], a[180:183]
s_waitcnt vmcnt(6)
v_mfma_f32_16x16x32_bf16 a[176:179], v[244:247], a[224:227], a[176:179]
s_waitcnt lgkmcnt(4)
v_mfma_f32_16x16x32_bf16 v[0:3], a[240:243], a[224:227], v[0:3]
ds_read_b64_tr_b16 v[240:241], v235 offset:32
v_mfma_f32_16x16x32_bf16 v[0:3], a[244:247], a[192:195], v[0:3]
ds_read_b64_tr_b16 v[242:243], v235 offset:4640
v_mfma_f32_16x16x32_bf16 v[4:7], a[244:247], a[196:199], v[4:7]
ds_read_b64_tr_b16 v[244:245], v235 offset:9248
v_mfma_f32_16x16x32_bf16 v[4:7], a[240:243], a[228:231], v[4:7]
s_waitcnt lgkmcnt(7)
ds_read_b64_tr_b16 v[246:247], v235 offset:13856
v_mfma_f32_16x16x32_bf16 v[8:11], a[240:243], a[232:235], v[8:11]
buffer_load_dwordx4 v233, s[16:19], s57 offen offset:2048 lds
v_mfma_f32_16x16x32_bf16 v[8:11], a[244:247], a[200:203], v[8:11]
s_add_u32 s57, s57, 524288
v_mfma_f32_16x16x32_bf16 v[12:15], a[244:247], a[204:207], v[12:15]
v_mfma_f32_16x16x32_bf16 v[12:15], a[240:243], a[236:239], v[12:15]
s_waitcnt lgkmcnt(4)
v_mfma_f32_16x16x32_bf16 v[28:31], a[248:251], a[236:239], v[28:31]
ds_read_b64_tr_b16 a[240:241], v235 offset:18464
v_mfma_f32_16x16x32_bf16 v[28:31], a[252:255], a[204:207], v[28:31]
ds_read_b64_tr_b16 a[242:243], v235 offset:23072
v_mfma_f32_16x16x32_bf16 v[24:27], a[252:255], a[200:203], v[24:27]
ds_read_b64_tr_b16 a[244:245], v235 offset:27680
v_mfma_f32_16x16x32_bf16 v[24:27], a[248:251], a[232:235], v[24:27]
s_waitcnt lgkmcnt(7)
ds_read_b64_tr_b16 a[246:247], v235 offset:32288
v_mfma_f32_16x16x32_bf16 v[20:23], a[248:251], a[228:231], v[20:23]
buffer_load_dwordx4 v233, s[16:19], s58 offen offset:3072 lds
v_mfma_f32_16x16x32_bf16 v[20:23], a[252:255], a[196:199], v[20:23]
s_add_u32 s58, s58, 524288
v_mfma_f32_16x16x32_bf16 v[16:19], a[252:255], a[192:195], v[16:19]
v_mfma_f32_16x16x32_bf16 v[16:19], a[248:251], a[224:227], v[16:19]
s_waitcnt lgkmcnt(4)
v_mfma_f32_16x16x32_bf16 v[32:35], v[240:243], a[224:227], v[32:35]
ds_read_b64_tr_b16 a[248:249], v235 offset:64
v_mfma_f32_16x16x32_bf16 v[32:35], v[244:247], a[192:195], v[32:35]
ds_read_b64_tr_b16 a[250:251], v235 offset:4672
v_mfma_f32_16x16x32_bf16 v[36:39], v[244:247], a[196:199], v[36:39]
ds_read_b64_tr_b16 a[252:253], v235 offset:9280
v_mfma_f32_16x16x32_bf16 v[36:39], v[240:243], a[228:231], v[36:39]
s_waitcnt lgkmcnt(7)
ds_read_b64_tr_b16 a[254:255], v235 offset:13888
v_mfma_f32_16x16x32_bf16 v[40:43], v[240:243], a[232:235], v[40:43]
s_add_u32 m0, s60, 0
v_mfma_f32_16x16x32_bf16 v[40:43], v[244:247], a[200:203], v[40:43]
buffer_load_dwordx4 v224, s[12:15], s54 offen offset:0 lds
v_mfma_f32_16x16x32_bf16 v[44:47], v[244:247], a[204:207], v[44:47]
v_mfma_f32_16x16x32_bf16 v[44:47], v[240:243], a[236:239], v[44:47]
s_waitcnt lgkmcnt(4)
v_mfma_f32_16x16x32_bf16 v[60:63], a[240:243], a[236:239], v[60:63]
ds_read_b64_tr_b16 v[240:241], v235 offset:18496
v_mfma_f32_16x16x32_bf16 v[60:63], a[244:247], a[204:207], v[60:63]
ds_read_b64_tr_b16 v[242:243], v235 offset:23104
v_mfma_f32_16x16x32_bf16 v[56:59], a[244:247], a[200:203], v[56:59]
ds_read_b64_tr_b16 v[244:245], v235 offset:27712
v_mfma_f32_16x16x32_bf16 v[56:59], a[240:243], a[232:235], v[56:59]
s_waitcnt lgkmcnt(7)
ds_read_b64_tr_b16 v[246:247], v235 offset:32320
v_mfma_f32_16x16x32_bf16 v[52:55], a[240:243], a[228:231], v[52:55]
v_mfma_f32_16x16x32_bf16 v[52:55], a[244:247], a[196:199], v[52:55]
buffer_load_dwordx4 v225, s[12:15], s54 offen offset:1024 lds
v_mfma_f32_16x16x32_bf16 v[48:51], a[244:247], a[192:195], v[48:51]
v_mfma_f32_16x16x32_bf16 v[48:51], a[240:243], a[224:227], v[48:51]
s_waitcnt lgkmcnt(4)
v_mfma_f32_16x16x32_bf16 v[64:67], a[248:251], a[224:227], v[64:67]
ds_read_b64_tr_b16 a[240:241], v235 offset:96
v_mfma_f32_16x16x32_bf16 v[64:67], a[252:255], a[192:195], v[64:67]
ds_read_b64_tr_b16 a[242:243], v235 offset:4704
v_mfma_f32_16x16x32_bf16 v[68:71], a[252:255], a[196:199], v[68:71]
ds_read_b64_tr_b16 a[244:245], v235 offset:9312
v_mfma_f32_16x16x32_bf16 v[68:71], a[248:251], a[228:231], v[68:71]
s_waitcnt lgkmcnt(7)
ds_read_b64_tr_b16 a[246:247], v235 offset:13920
v_mfma_f32_16x16x32_bf16 v[72:75], a[248:251], a[232:235], v[72:75]
v_mfma_f32_16x16x32_bf16 v[72:75], a[252:255], a[200:203], v[72:75]
buffer_load_dwordx4 v226, s[12:15], s54 offen offset:2048 lds
v_mfma_f32_16x16x32_bf16 v[76:79], a[252:255], a[204:207], v[76:79]
v_mfma_f32_16x16x32_bf16 v[76:79], a[248:251], a[236:239], v[76:79]
s_waitcnt lgkmcnt(4)
v_mfma_f32_16x16x32_bf16 v[92:95], v[240:243], a[236:239], v[92:95]
ds_read_b64_tr_b16 a[248:249], v235 offset:18528
v_mfma_f32_16x16x32_bf16 v[92:95], v[244:247], a[204:207], v[92:95]
ds_read_b64_tr_b16 a[250:251], v235 offset:23136
v_mfma_f32_16x16x32_bf16 v[88:91], v[244:247], a[200:203], v[88:91]
ds_read_b64_tr_b16 a[252:253], v235 offset:27744
v_mfma_f32_16x16x32_bf16 v[88:91], v[240:243], a[232:235], v[88:91]
s_waitcnt lgkmcnt(7)
ds_read_b64_tr_b16 a[254:255], v235 offset:32352
v_mfma_f32_16x16x32_bf16 v[84:87], v[240:243], a[228:231], v[84:87]
v_mfma_f32_16x16x32_bf16 v[84:87], v[244:247], a[196:199], v[84:87]
buffer_load_dwordx4 v227, s[12:15], s54 offen offset:3072 lds
v_mfma_f32_16x16x32_bf16 v[80:83], v[244:247], a[192:195], v[80:83]
v_mfma_f32_16x16x32_bf16 v[80:83], v[240:243], a[224:227], v[80:83]
s_waitcnt lgkmcnt(4)
v_mfma_f32_16x16x32_bf16 v[96:99], a[240:243], a[224:227], v[96:99]
ds_read_b64_tr_b16 v[240:241], v235 offset:128
v_mfma_f32_16x16x32_bf16 v[96:99], a[244:247], a[192:195], v[96:99]
ds_read_b64_tr_b16 v[242:243], v235 offset:4736
v_mfma_f32_16x16x32_bf16 v[100:103], a[244:247], a[196:199], v[100:103]
ds_read_b64_tr_b16 v[244:245], v235 offset:9344
v_mfma_f32_16x16x32_bf16 v[100:103], a[240:243], a[228:231], v[100:103]
s_waitcnt lgkmcnt(7)
ds_read_b64_tr_b16 v[246:247], v235 offset:13952
v_mfma_f32_16x16x32_bf16 v[104:107], a[240:243], a[232:235], v[104:107]
v_mfma_f32_16x16x32_bf16 v[104:107], a[244:247], a[200:203], v[104:107]
s_add_u32 m0, s60, 4096
v_mfma_f32_16x16x32_bf16 v[108:111], a[244:247], a[204:207], v[108:111]
buffer_load_dwordx4 v228, s[12:15], s54 offen offset:0 lds
v_mfma_f32_16x16x32_bf16 v[108:111], a[240:243], a[236:239], v[108:111]
s_waitcnt lgkmcnt(4)
v_mfma_f32_16x16x32_bf16 v[124:127], a[248:251], a[236:239], v[124:127]
ds_read_b64_tr_b16 a[240:241], v235 offset:18560
v_mfma_f32_16x16x32_bf16 v[124:127], a[252:255], a[204:207], v[124:127]
ds_read_b64_tr_b16 a[242:243], v235 offset:23168
v_mfma_f32_16x16x32_bf16 v[120:123], a[252:255], a[200:203], v[120:123]
ds_read_b64_tr_b16 a[244:245], v235 offset:27776
v_mfma_f32_16x16x32_bf16 v[120:123], a[248:251], a[232:235], v[120:123]
s_waitcnt lgkmcnt(7)
ds_read_b64_tr_b16 a[246:247], v235 offset:32384
v_mfma_f32_16x16x32_bf16 v[116:119], a[248:251], a[228:231], v[116:119]
v_mfma_f32_16x16x32_bf16 v[116:119], a[252:255], a[196:199], v[116:119]
v_mfma_f32_16x16x32_bf16 v[112:115], a[252:255], a[192:195], v[112:115]
buffer_load_dwordx4 v229, s[12:15], s54 offen offset:1024 lds
v_mfma_f32_16x16x32_bf16 v[112:115], a[248:251], a[224:227], v[112:115]
s_waitcnt lgkmcnt(4)
v_mfma_f32_16x16x32_bf16 v[128:131], v[240:243], a[224:227], v[128:131]
ds_read_b64_tr_b16 a[248:249], v235 offset:160
v_mfma_f32_16x16x32_bf16 v[128:131], v[244:247], a[192:195], v[128:131]
ds_read_b64_tr_b16 a[250:251], v235 offset:4768
v_mfma_f32_16x16x32_bf16 v[132:135], v[244:247], a[196:199], v[132:135]
ds_read_b64_tr_b16 a[252:253], v235 offset:9376
v_mfma_f32_16x16x32_bf16 v[132:135], v[240:243], a[228:231], v[132:135]
s_waitcnt lgkmcnt(7)
ds_read_b64_tr_b16 a[254:255], v235 offset:13984
v_mfma_f32_16x16x32_bf16 v[136:139], v[240:243], a[232:235], v[136:139]
v_mfma_f32_16x16x32_bf16 v[136:139], v[244:247], a[200:203], v[136:139]
v_mfma_f32_16x16x32_bf16 v[140:143], v[244:247], a[204:207], v[140:143]
buffer_load_dwordx4 v230, s[12:15], s54 offen offset:2048 lds
v_mfma_f32_16x16x32_bf16 v[140:143], v[240:243], a[236:239], v[140:143]
s_waitcnt lgkmcnt(4)
v_mfma_f32_16x16x32_bf16 v[156:159], a[240:243], a[236:239], v[156:159]
ds_read_b64_tr_b16 v[240:241], v235 offset:18592
v_mfma_f32_16x16x32_bf16 v[156:159], a[244:247], a[204:207], v[156:159]
ds_read_b64_tr_b16 v[242:243], v235 offset:23200
v_mfma_f32_16x16x32_bf16 v[152:155], a[244:247], a[200:203], v[152:155]
ds_read_b64_tr_b16 v[244:245], v235 offset:27808
v_mfma_f32_16x16x32_bf16 v[152:155], a[240:243], a[232:235], v[152:155]
s_waitcnt lgkmcnt(7)
ds_read_b64_tr_b16 v[246:247], v235 offset:32416
v_mfma_f32_16x16x32_bf16 v[148:151], a[240:243], a[228:231], v[148:151]
v_mfma_f32_16x16x32_bf16 v[148:151], a[244:247], a[196:199], v[148:151]
v_mfma_f32_16x16x32_bf16 v[144:147], a[244:247], a[192:195], v[144:147]
buffer_load_dwordx4 v231, s[12:15], s54 offen offset:3072 lds
v_mfma_f32_16x16x32_bf16 v[144:147], a[240:243], a[224:227], v[144:147]
s_waitcnt lgkmcnt(4)
v_mfma_f32_16x16x32_bf16 v[160:163], a[248:251], a[224:227], v[160:163]
ds_read_b64_tr_b16 a[240:241], v235 offset:192
v_mfma_f32_16x16x32_bf16 v[160:163], a[252:255], a[192:195], v[160:163]
ds_read_b64_tr_b16 a[242:243], v235 offset:4800
v_mfma_f32_16x16x32_bf16 v[164:167], a[252:255], a[196:199], v[164:167]
ds_read_b64_tr_b16 a[244:245], v235 offset:9408
v_mfma_f32_16x16x32_bf16 v[164:167], a[248:251], a[228:231], v[164:167]
s_waitcnt lgkmcnt(7)
ds_read_b64_tr_b16 a[246:247], v235 offset:14016
v_mfma_f32_16x16x32_bf16 v[168:171], a[248:251], a[232:235], v[168:171]
v_mfma_f32_16x16x32_bf16 v[168:171], a[252:255], a[200:203], v[168:171]
v_mfma_f32_16x16x32_bf16 v[172:175], a[252:255], a[204:207], v[172:175]
s_add_u32 m0, s60, 8192
v_mfma_f32_16x16x32_bf16 v[172:175], a[248:251], a[236:239], v[172:175]
s_waitcnt lgkmcnt(4)
buffer_load_dwordx4 v232, s[12:15], s54 offen offset:0 lds
v_mfma_f32_16x16x32_bf16 v[188:191], v[240:243], a[236:239], v[188:191]
s_add_u32 s54, s54, 589824
ds_read_b64_tr_b16 a[248:249], v235 offset:18624
v_mfma_f32_16x16x32_bf16 v[188:191], v[244:247], a[204:207], v[188:191]
ds_read_b64_tr_b16 a[250:251], v235 offset:23232
v_mfma_f32_16x16x32_bf16 v[184:187], v[244:247], a[200:203], v[184:187]
ds_read_b64_tr_b16 a[252:253], v235 offset:27840
v_mfma_f32_16x16x32_bf16 v[184:187], v[240:243], a[232:235], v[184:187]
s_waitcnt lgkmcnt(7)
ds_read_b64_tr_b16 a[254:255], v235 offset:32448
v_mfma_f32_16x16x32_bf16 v[180:183], v[240:243], a[228:231], v[180:183]
v_mfma_f32_16x16x32_bf16 v[180:183], v[244:247], a[196:199], v[180:183]
v_mfma_f32_16x16x32_bf16 v[176:179], v[244:247], a[192:195], v[176:179]
v_mfma_f32_16x16x32_bf16 v[176:179], v[240:243], a[224:227], v[176:179]
s_waitcnt lgkmcnt(4)
v_mfma_f32_16x16x32_bf16 v[192:195], a[240:243], a[224:227], v[192:195]
ds_read_b64_tr_b16 v[240:241], v235 offset:224
v_mfma_f32_16x16x32_bf16 v[192:195], a[244:247], a[192:195], v[192:195]
ds_read_b64_tr_b16 v[242:243], v235 offset:4832
v_mfma_f32_16x16x32_bf16 v[196:199], a[244:247], a[196:199], v[196:199]
ds_read_b64_tr_b16 v[244:245], v235 offset:9440
v_mfma_f32_16x16x32_bf16 v[196:199], a[240:243], a[228:231], v[196:199]
s_waitcnt lgkmcnt(7)
ds_read_b64_tr_b16 v[246:247], v235 offset:14048
v_mfma_f32_16x16x32_bf16 v[200:203], a[240:243], a[232:235], v[200:203]
v_mfma_f32_16x16x32_bf16 v[200:203], a[244:247], a[200:203], v[200:203]
v_mfma_f32_16x16x32_bf16 v[204:207], a[244:247], a[204:207], v[204:207]
v_mfma_f32_16x16x32_bf16 v[204:207], a[240:243], a[236:239], v[204:207]
s_waitcnt lgkmcnt(4)
v_mfma_f32_16x16x32_bf16 v[220:223], a[248:251], a[236:239], v[220:223]
ds_read_b64_tr_b16 a[240:241], v235 offset:18656
v_mfma_f32_16x16x32_bf16 v[220:223], a[252:255], a[204:207], v[220:223]
ds_read_b64_tr_b16 a[242:243], v235 offset:23264
v_mfma_f32_16x16x32_bf16 v[216:219], a[252:255], a[200:203], v[216:219]
ds_read_b64_tr_b16 a[244:245], v235 offset:27872
v_mfma_f32_16x16x32_bf16 v[216:219], a[248:251], a[232:235], v[216:219]
s_waitcnt lgkmcnt(7)
ds_read_b64_tr_b16 a[246:247], v235 offset:32480
v_mfma_f32_16x16x32_bf16 v[212:215], a[248:251], a[228:231], v[212:215]
v_mfma_f32_16x16x32_bf16 v[212:215], a[252:255], a[196:199], v[212:215]
v_mfma_f32_16x16x32_bf16 v[208:211], a[252:255], a[192:195], v[208:211]
v_mfma_f32_16x16x32_bf16 v[208:211], a[248:251], a[224:227], v[208:211]
s_waitcnt lgkmcnt(4)
v_mfma_f32_16x16x32_bf16 a[0:3], v[240:243], a[224:227], a[0:3]
ds_read_b64_tr_b16 a[248:249], v235 offset:256
v_mfma_f32_16x16x32_bf16 a[0:3], v[244:247], a[192:195], a[0:3]
ds_read_b64_tr_b16 a[250:251], v235 offset:4864
v_mfma_f32_16x16x32_bf16 a[4:7], v[244:247], a[196:199], a[4:7]
ds_read_b64_tr_b16 a[252:253], v235 offset:9472
v_mfma_f32_16x16x32_bf16 a[4:7], v[240:243], a[228:231], a[4:7]
s_waitcnt lgkmcnt(7)
ds_read_b64_tr_b16 a[254:255], v235 offset:14080
v_mfma_f32_16x16x32_bf16 a[8:11], v[240:243], a[232:235], a[8:11]
v_mfma_f32_16x16x32_bf16 a[8:11], v[244:247], a[200:203], a[8:11]
v_mfma_f32_16x16x32_bf16 a[12:15], v[244:247], a[204:207], a[12:15]
v_mfma_f32_16x16x32_bf16 a[12:15], v[240:243], a[236:239], a[12:15]
s_waitcnt lgkmcnt(4)
v_mfma_f32_16x16x32_bf16 a[28:31], a[240:243], a[236:239], a[28:31]
ds_read_b64_tr_b16 v[240:241], v235 offset:18688
v_mfma_f32_16x16x32_bf16 a[28:31], a[244:247], a[204:207], a[28:31]
ds_read_b64_tr_b16 v[242:243], v235 offset:23296
v_mfma_f32_16x16x32_bf16 a[24:27], a[244:247], a[200:203], a[24:27]
ds_read_b64_tr_b16 v[244:245], v235 offset:27904
v_mfma_f32_16x16x32_bf16 a[24:27], a[240:243], a[232:235], a[24:27]
s_waitcnt lgkmcnt(7)
ds_read_b64_tr_b16 v[246:247], v235 offset:32512
v_add_u32 v235, 0xd000, v235
v_mfma_f32_16x16x32_bf16 a[20:23], a[240:243], a[228:231], a[20:23]
s_waitcnt vmcnt(17)
ds_add_u32 v251, v253
v_mfma_f32_16x16x32_bf16 a[20:23], a[244:247], a[196:199], a[20:23]
v_mfma_f32_16x16x32_bf16 a[16:19], a[244:247], a[192:195], a[16:19]
v_mfma_f32_16x16x32_bf16 a[16:19], a[240:243], a[224:227], a[16:19]
s_waitcnt lgkmcnt(5)
v_mfma_f32_16x16x32_bf16 a[32:35], a[248:251], a[224:227], a[32:35]
ds_read_b64_tr_b16 a[240:241], v236 offset:45056
v_mfma_f32_16x16x32_bf16 a[32:35], a[252:255], a[192:195], a[32:35]
ds_read_b64_tr_b16 a[242:243], v236 offset:49152
v_mfma_f32_16x16x32_bf16 a[36:39], a[252:255], a[196:199], a[36:39]
ds_read_b64_tr_b16 a[244:245], v236 offset:45064
v_mfma_f32_16x16x32_bf16 a[36:39], a[248:251], a[228:231], a[36:39]
s_waitcnt lgkmcnt(8)
ds_read_b64_tr_b16 a[246:247], v236 offset:49160
v_add_u32 v236, 0xd000, v236
v_mfma_f32_16x16x32_bf16 a[40:43], a[248:251], a[232:235], a[40:43]
v_mfma_f32_16x16x32_bf16 a[40:43], a[252:255], a[200:203], a[40:43]
v_mfma_f32_16x16x32_bf16 a[44:47], a[252:255], a[204:207], a[44:47]
v_mfma_f32_16x16x32_bf16 a[44:47], a[248:251], a[236:239], a[44:47]
s_waitcnt lgkmcnt(5)
v_mfma_f32_16x16x32_bf16 a[60:63], v[240:243], a[236:239], a[60:63]
ds_read_b64_tr_b16 a[248:249], v237 offset:45056
v_mfma_f32_16x16x32_bf16 a[60:63], v[244:247], a[204:207], a[60:63]
ds_read_b64_tr_b16 a[250:251], v237 offset:49152
v_mfma_f32_16x16x32_bf16 a[56:59], v[244:247], a[200:203], a[56:59]
ds_read_b64_tr_b16 a[252:253], v237 offset:45064
v_mfma_f32_16x16x32_bf16 a[56:59], v[240:243], a[232:235], a[56:59]
s_waitcnt lgkmcnt(8)
ds_read_b64_tr_b16 a[254:255], v237 offset:49160
v_add_u32 v237, 0xd000, v237
v_mfma_f32_16x16x32_bf16 a[52:55], v[240:243], a[228:231], a[52:55]
v_mfma_f32_16x16x32_bf16 a[52:55], v[244:247], a[196:199], a[52:55]
v_mfma_f32_16x16x32_bf16 a[48:51], v[244:247], a[192:195], a[48:51]
v_mfma_f32_16x16x32_bf16 a[48:51], v[240:243], a[224:227], a[48:51]
s_waitcnt lgkmcnt(6)
v_mfma_f32_16x16x32_bf16 a[64:67], a[240:243], a[192:195], a[64:67]
ds_read_b64_tr_b16 v[240:241], v238 offset:45056
v_mfma_f32_16x16x32_bf16 a[68:71], a[240:243], a[196:199], a[68:71]
ds_read_b64_tr_b16 v[242:243], v238 offset:49152
v_mfma_f32_16x16x32_bf16 a[72:75], a[240:243], a[200:203], a[72:75]
ds_read_b32 v255, v252
v_mfma_f32_16x16x32_bf16 a[76:79], a[240:243], a[204:207], a[76:79]
s_waitcnt lgkmcnt(7)
buffer_load_dwordx4 a[224:227], v254, s[8:11], s59 offen offset:0 sc1
v_mfma_f32_16x16x32_bf16 a[92:95], a[244:247], a[204:207], a[92:95]
ds_read_b64_tr_b16 v[244:245], v238 offset:45064
v_mfma_f32_16x16x32_bf16 a[88:91], a[244:247], a[200:203], a[88:91]
ds_read_b64_tr_b16 v[246:247], v238 offset:49160
v_add_u32 v238, 0xd000, v238
v_mfma_f32_16x16x32_bf16 a[84:87], a[244:247], a[196:199], a[84:87]
buffer_load_dwordx4 a[228:231], v254, s[8:11], s59 offen offset:1024 sc1
v_mfma_f32_16x16x32_bf16 a[80:83], a[244:247], a[192:195], a[80:83]
s_waitcnt lgkmcnt(7)
buffer_load_dwordx4 a[232:235], v254, s[8:11], s59 offen offset:2048 sc1
v_mfma_f32_16x16x32_bf16 a[96:99], a[248:251], a[192:195], a[96:99]
ds_read_b64_tr_b16 a[240:241], v239 offset:45056
v_mfma_f32_16x16x32_bf16 a[100:103], a[248:251], a[196:199], a[100:103]
ds_read_b64_tr_b16 a[242:243], v239 offset:49152
v_mfma_f32_16x16x32_bf16 a[104:107], a[248:251], a[200:203], a[104:107]
buffer_load_dwordx4 a[236:239], v254, s[8:11], s59 offen offset:3072 sc1
v_mfma_f32_16x16x32_bf16 a[108:111], a[248:251], a[204:207], a[108:111]
s_waitcnt lgkmcnt(4)
v_mfma_f32_16x16x32_bf16 a[124:127], a[252:255], a[204:207], a[124:127]
s_add_u32 s59, s59, 4096
ds_read_b64_tr_b16 a[244:245], v239 offset:45064
v_cmp_gt_u32 vcc, 3, v255
v_mfma_f32_16x16x32_bf16 a[120:123], a[252:255], a[200:203], a[120:123]
ds_read_b64_tr_b16 a[246:247], v239 offset:49160
v_add_u32 v239, 0xd000, v239
v_mfma_f32_16x16x32_bf16 a[116:119], a[252:255], a[196:199], a[116:119]
v_mfma_f32_16x16x32_bf16 a[112:115], a[252:255], a[192:195], a[112:115]
s_waitcnt lgkmcnt(6)
v_mfma_f32_16x16x32_bf16 a[128:131], v[240:243], a[192:195], a[128:131]
s_cbranch_vccnz k1_g3_s
k1_g3_b:
ds_read_b64_tr_b16 a[248:249], v236 offset:36864
v_mfma_f32_16x16x32_bf16 a[132:135], v[240:243], a[196:199], a[132:135]
ds_read_b64_tr_b16 a[250:251], v236 offset:40960
v_mfma_f32_16x16x32_bf16 a[136:139], v[240:243], a[200:203], a[136:139]
ds_add_u32 v251, v253
v_mfma_f32_16x16x32_bf16 a[140:143], v[240:243], a[204:207], a[140:143]
s_waitcnt lgkmcnt(7)
v_mfma_f32_16x16x32_bf16 a[156:159], v[244:247], a[204:207], a[156:159]
ds_read_b64_tr_b16 a[252:253], v236 offset:36872
v_mfma_f32_16x16x32_bf16 a[152:155], v[244:247], a[200:203], a[152:155]
ds_read_b64_tr_b16 a[254:255], v236 offset:40968
v_mfma_f32_16x16x32_bf16 a[148:151], v[244:247], a[196:199], a[148:151]
v_mfma_f32_16x16x32_bf16 a[144:147], v[244:247], a[192:195], a[144:147]
s_waitcnt lgkmcnt(7)
v_mfma_f32_16x16x32_bf16 a[160:163], a[240:243], a[192:195], a[160:163]
ds_read_b64_tr_b16 v[240:241], v237 offset:36864
v_mfma_f32_16x16x32_bf16 a[164:167], a[240:243], a[196:199], a[164:167]
ds_read_b64_tr_b16 v[242:243], v237 offset:40960
v_mfma_f32_16x16x32_bf16 a[168:171], a[240:243], a[200:203], a[168:171]
v_mfma_f32_16x16x32_bf16 a[172:175], a[240:243], a[204:207], a[172:175]
s_waitcnt lgkmcnt(7)
v_mfma_f32_16x16x32_bf16 a[188:191], a[244:247], a[204:207], a[188:191]
ds_read_b64_tr_b16 v[244:245], v237 offset:36872
v_mfma_f32_16x16x32_bf16 a[184:187], a[244:247], a[200:203], a[184:187]
ds_read_b64_tr_b16 v[246:247], v237 offset:40968
v_mfma_f32_16x16x32_bf16 a[180:183], a[244:247], a[196:199], a[180:183]
s_waitcnt vmcnt(17)
v_mfma_f32_16x16x32_bf16 a[176:179], a[244:247], a[192:195], a[176:179]
s_waitcnt lgkmcnt(7)
v_mfma_f32_16x16x32_bf16 a[64:67], a[248:251], a[208:211], a[64:67]
ds_read_b64_tr_b16 a[240:241], v238 offset:36864
ds_read_b32 v255, v252
v_mfma_f32_16x16x32_bf16 a[68:71], a[248:251], a[212:215], a[68:71]
ds_read_b64_tr_b16 a[242:243], v238 offset:40960
v_mfma_f32_16x16x32_bf16 a[72:75], a[248:251], a[216:219], a[72:75]
buffer_load_dwordx4 a[192:195], v254, s[8:11], s59 offen offset:0 sc1
v_mfma_f32_16x16x32_bf16 a[76:79], a[248:251], a[220:223], a[76:79]
s_waitcnt lgkmcnt(7)
buffer_load_dwordx4 a[196:199], v254, s[8:11], s59 offen offset:1024 sc1
v_mfma_f32_16x16x32_bf16 a[92:95], a[252:255], a[220:223], a[92:95]
ds_read_b64_tr_b16 a[244:245], v238 offset:36872
v_mfma_f32_16x16x32_bf16 a[88:91], a[252:255], a[216:219], a[88:91]
ds_read_b64_tr_b16 a[246:247], v238 offset:40968
v_mfma_f32_16x16x32_bf16 a[84:87], a[252:255], a[212:215], a[84:87]
buffer_load_dwordx4 a[200:203], v254, s[8:11], s59 offen offset:2048 sc1
v_mfma_f32_16x16x32_bf16 a[80:83], a[252:255], a[208:211], a[80:83]
s_waitcnt lgkmcnt(3)
buffer_load_dwordx4 a[204:207], v254, s[8:11], s59 offen offset:3072 sc1
v_mfma_f32_16x16x32_bf16 a[96:99], v[240:243], a[208:211], a[96:99]
s_add_u32 s59, s59, 4096
ds_read_b64_tr_b16 a[248:249], v239 offset:36864
v_cmp_gt_u32 vcc, 4, v255
v_mfma_f32_16x16x32_bf16 a[100:103], v[240:243], a[212:215], a[100:103]
ds_read_b64_tr_b16 a[250:251], v239 offset:40960
v_mfma_f32_16x16x32_bf16 a[104:107], v[240:243], a[216:219], a[104:107]
v_mfma_f32_16x16x32_bf16 a[108:111], v[240:243], a[220:223], a[108:111]
s_waitcnt lgkmcnt(5)
v_mfma_f32_16x16x32_bf16 a[124:127], v[244:247], a[220:223], a[124:127]
s_cbranch_vccnz k1_g4_s
k1_g4_b:
ds_read_b64_tr_b16 a[252:253], v239 offset:36872
v_mfma_f32_16x16x32_bf16 a[120:123], v[244:247], a[216:219], a[120:123]
ds_read_b64_tr_b16 a[254:255], v239 offset:40968
v_mfma_f32_16x16x32_bf16 a[116:119], v[244:247], a[212:215], a[116:119]
v_mfma_f32_16x16x32_bf16 a[112:115], v[244:247], a[208:211], a[112:115]
s_waitcnt lgkmcnt(6)
v_mfma_f32_16x16x32_bf16 a[128:131], a[240:243], a[208:211], a[128:131]
s_add_u32 m0, s61, 53248
ds_read_b64_tr_b16 v[240:241], v235 offset:0
v_mfma_f32_16x16x32_bf16 a[132:135], a[240:243], a[212:215], a[132:135]
ds_read_b64_tr_b16 v[242:243], v235 offset:4608
v_mfma_f32_16x16x32_bf16 a[136:139], a[240:243], a[216:219], a[136:139]
buffer_load_dwordx4 v233, s[16:19], s55 offen offset:0 lds
v_mfma_f32_16x16x32_bf16 a[140:143], a[240:243], a[220:223], a[140:143]
s_waitcnt lgkmcnt(6)
v_mfma_f32_16x16x32_bf16 a[156:159], a[244:247], a[220:223], a[156:159]
s_add_u32 s55, s55, 524288
ds_read_b64_tr_b16 v[244:245], v235 offset:9216
v_mfma_f32_16x16x32_bf16 a[152:155], a[244:247], a[216:219], a[152:155]
ds_read_b64_tr_b16 v[246:247], v235 offset:13824
v_mfma_f32_16x16x32_bf16 a[148:151], a[244:247], a[212:215], a[148:151]
v_mfma_f32_16x16x32_bf16 a[144:147], a[244:247], a[208:211], a[144:147]
s_waitcnt lgkmcnt(6)
v_mfma_f32_16x16x32_bf16 a[160:163], a[248:251], a[208:211], a[160:163]
ds_read_b64_tr_b16 a[240:241], v235 offset:18432
v_mfma_f32_16x16x32_bf16 a[164:167], a[248:251], a[212:215], a[164:167]
ds_read_b64_tr_b16 a[242:243], v235 offset:23040
v_mfma_f32_16x16x32_bf16 a[168:171], a[248:251], a[216:219], a[168:171]
buffer_load_dwordx4 v233, s[16:19], s56 offen offset:1024 lds
v_mfma_f32_16x16x32_bf16 a[172:175], a[248:251], a[220:223], a[172:175]
s_waitcnt lgkmcnt(6)
v_mfma_f32_16x16x32_bf16 a[188:191], a[252:255], a[220:223], a[188:191]
s_add_u32 s56, s56, 524288
ds_read_b64_tr_b16 a[244:245], v235 offset:27648
v_mfma_f32_16x16x32_bf16 a[184:187], a[252:255], a[216:219], a[184:187]
ds_read_b64_tr_b16 a[246:247], v235 offset:32256
v_mfma_f32_16x16x32_bf16 a[180:183], a[252:255], a[212:215], a[180:183]
s_waitcnt vmcnt(6)
v_mfma_f32_16x16x32_bf16 a[176:179], a[252:255], a[208:211], a[176:179]
s_waitcnt lgkmcnt(4)
v_mfma_f32_16x16x32_bf16 v[0:3], v[240:243], a[208:211], v[0:3]
ds_read_b64_tr_b16 a[248:249], v235 offset:32
v_mfma_f32_16x16x32_bf16 v[0:3], v[244:247], a[224:227], v[0:3]
ds_read_b64_tr_b16 a[250:251], v235 offset:4640
v_mfma_f32_16x16x32_bf16 v[4:7], v[244:247], a[228:231], v[4:7]
ds_read_b64_tr_b16 a[252:253], v235 offset:9248
v_mfma_f32_16x16x32_bf16 v[4:7], v[240:243], a[212:215], v[4:7]
s_waitcnt lgkmcnt(7)
ds_read_b64_tr_b16 a[254:255], v235 offset:13856
v_mfma_f32_16x16x32_bf16 v[8:11], v[240:243], a[216:219], v[8:11]
buffer_load_dwordx4 v233, s[16:19], s57 offen offset:2048 lds
v_mfma_f32_16x16x32_bf16 v[8:11], v[244:247], a[232:235], v[8:11]
s_add_u32 s57, s57, 524288
v_mfma_f32_16x16x32_bf16 v[12:15], v[244:247], a[236:239], v[12:15]
v_mfma_f32_16x16x32_bf16 v[12:15], v[240:243], a[220:223], v[12:15]
s_waitcnt lgkmcnt(4)
v_mfma_f32_16x16x32_bf16 v[28:31], a[240:243], a[220:223], v[28:31]
ds_read_b64_tr_b16 v[240:241], v235 offset:18464
v_mfma_f32_16x16x32_bf16 v[28:31], a[244:247], a[236:239], v[28:31]
ds_read_b64_tr_b16 v[242:243], v235 offset:23072
v_mfma_f32_16x16x32_bf16 v[24:27], a[244:247], a[232:235], v[24:27]
ds_read_b64_tr_b16 v[244:245], v235 offset:27680
v_mfma_f32_16x16x32_bf16 v[24:27], a[240:243], a[216:219], v[24:27]
s_waitcnt lgkmcnt(7)
ds_read_b64_tr_b16 v[246:247], v235 offset:32288
v_mfma_f32_16x16x32_bf16 v[20:23], a[240:243], a[212:215], v[20:23]
buffer_load_dwordx4 v233, s[16:19], s58 offen offset:3072 lds
v_mfma_f32_16x16x32_bf16 v[20:23], a[244:247], a[228:231], v[20:23]
s_add_u32 s58, s58, 524288
v_mfma_f32_16x16x32_bf16 v[16:19], a[244:247], a[224:227], v[16:19]
v_mfma_f32_16x16x32_bf16 v[16:19], a[240:243], a[208:211], v[16:19]
s_waitcnt lgkmcnt(4)
v_mfma_f32_16x16x32_bf16 v[32:35], a[248:251], a[208:211], v[32:35]
ds_read_b64_tr_b16 a[240:241], v235 offset:64
v_mfma_f32_16x16x32_bf16 v[32:35], a[252:255], a[224:227], v[32:35]
ds_read_b64_tr_b16 a[242:243], v235 offset:4672
v_mfma_f32_16x16x32_bf16 v[36:39], a[252:255], a[228:231], v[36:39]
ds_read_b64_tr_b16 a[244:245], v235 offset:9280
v_mfma_f32_16x16x32_bf16 v[36:39], a[248:251], a[212:215], v[36:39]
s_waitcnt lgkmcnt(7)
ds_read_b64_tr_b16 a[246:247], v235 offset:13888
v_mfma_f32_16x16x32_bf16 v[40:43], a[248:251], a[216:219], v[40:43]
s_add_u32 m0, s60, 53248
v_mfma_f32_16x16x32_bf16 v[40:43], a[252:255], a[232:235], v[40:43]
buffer_load_dwordx4 v224, s[12:15], s54 offen offset:0 lds
v_mfma_f32_16x16x32_bf16 v[44:47], a[252:255], a[236:239], v[44:47]
v_mfma_f32_16x16x32_bf16 v[44:47], a[248:251], a[220:223], v[44:47]
s_waitcnt lgkmcnt(4)
v_mfma_f32_16x16x32_bf16 v[60:63], v[240:243], a[220:223], v[60:63]
ds_read_b64_tr_b16 a[248:249], v235 offset:18496
v_mfma_f32_16x16x32_bf16 v[60:63], v[244:247], a[236:239], v[60:63]
ds_read_b64_tr_b16 a[250:251], v235 offset:23104
v_mfma_f32_16x16x32_bf16 v[56:59], v[244:247], a[232:235], v[56:59]
ds_read_b64_tr_b16 a[252:253], v235 offset:27712
v_mfma_f32_16x16x32_bf16 v[56:59], v[240:243], a[216:219], v[56:59]
s_waitcnt lgkmcnt(7)
ds_read_b64_tr_b16 a[254:255], v235 offset:32320
v_mfma_f32_16x16x32_bf16 v[52:55], v[240:243], a[212:215], v[52:55]
v_mfma_f32_16x16x32_bf16 v[52:55], v[244:247], a[228:231], v[52:55]
buffer_load_dwordx4 v225, s[12:15], s54 offen offset:1024 lds
v_mfma_f32_16x16x32_bf16 v[48:51], v[244:247], a[224:227], v[48:51]
v_mfma_f32_16x16x32_bf16 v[48:51], v[240:243], a[208:211], v[48:51]
s_waitcnt lgkmcnt(4)
v_mfma_f32_16x16x32_bf16 v[64:67], a[240:243], a[208:211], v[64:67]
ds_read_b64_tr_b16 v[240:241], v235 offset:96
v_mfma_f32_16x16x32_bf16 v[64:67], a[244:247], a[224:227], v[64:67]
ds_read_b64_tr_b16 v[242:243], v235 offset:4704
v_mfma_f32_16x16x32_bf16 v[68:71], a[244:247], a[228:231], v[68:71]
ds_read_b64_tr_b16 v[244:245], v235 offset:9312
v_mfma_f32_16x16x32_bf16 v[68:71], a[240:243], a[212:215], v[68:71]
s_waitcnt lgkmcnt(7)
ds_read_b64_tr_b16 v[246:247], v235 offset:13920
v_mfma_f32_16x16x32_bf16 v[72:75], a[240:243], a[216:219], v[72:75]
v_mfma_f32_16x16x32_bf16 v[72:75], a[244:247], a[232:235], v[72:75]
buffer_load_dwordx4 v226, s[12:15], s54 offen offset:2048 lds
v_mfma_f32_16x16x32_bf16 v[76:79], a[244:247], a[236:239], v[76:79]
v_mfma_f32_16x16x32_bf16 v[76:79], a[240:243], a[220:223], v[76:79]
s_waitcnt lgkmcnt(4)
v_mfma_f32_16x16x32_bf16 v[92:95], a[248:251], a[220:223], v[92:95]
ds_read_b64_tr_b16 a[240:241], v235 offset:18528
v_mfma_f32_16x16x32_bf16 v[92:95], a[252:255], a[236:239], v[92:95]
ds_read_b64_tr_b16 a[242:243], v235 offset:23136
v_mfma_f32_16x16x32_bf16 v[88:91], a[252:255], a[232:235], v[88:91]
ds_read_b64_tr_b16 a[244:245], v235 offset:27744
v_mfma_f32_16x16x32_bf16 v[88:91], a[248:251], a[216:219], v[88:91]
s_waitcnt lgkmcnt(7)
ds_read_b64_tr_b16 a[246:247], v235 offset:32352
v_mfma_f32_16x16x32_bf16 v[84:87], a[248:251], a[212:215], v[84:87]
v_mfma_f32_16x16x32_bf16 v[84:87], a[252:255], a[228:231], v[84:87]
buffer_load_dwordx4 v227, s[12:15], s54 offen offset:3072 lds
v_mfma_f32_16x16x32_bf16 v[80:83], a[252:255], a[224:227], v[80:83]
v_mfma_f32_16x16x32_bf16 v[80:83], a[248:251], a[208:211], v[80:83]
s_waitcnt lgkmcnt(4)
v_mfma_f32_16x16x32_bf16 v[96:99], v[240:243], a[208:211], v[96:99]
ds_read_b64_tr_b16 a[248:249], v235 offset:128
v_mfma_f32_16x16x32_bf16 v[96:99], v[244:247], a[224:227], v[96:99]
ds_read_b64_tr_b16 a[250:251], v235 offset:4736
v_mfma_f32_16x16x32_bf16 v[100:103], v[244:247], a[228:231], v[100:103]
ds_read_b64_tr_b16 a[252:253], v235 offset:9344
v_mfma_f32_16x16x32_bf16 v[100:103], v[240:243], a[212:215], v[100:103]
s_waitcnt lgkmcnt(7)
ds_read_b64_tr_b16 a[254:255], v235 offset:13952
v_mfma_f32_16x16x32_bf16 v[104:107], v[240:243], a[216:219], v[104:107]
v_mfma_f32_16x16x32_bf16 v[104:107], v[244:247], a[232:235], v[104:107]
s_add_u32 m0, s60, 57344
v_mfma_f32_16x16x32_bf16 v[108:111], v[244:247], a[236:239], v[108:111]
buffer_load_dwordx4 v228, s[12:15], s54 offen offset:0 lds
v_mfma_f32_16x16x32_bf16 v[108:111], v[240:243], a[220:223], v[108:111]
s_waitcnt lgkmcnt(4)
v_mfma_f32_16x16x32_bf16 v[124:127], a[240:243], a[220:223], v[124:127]
ds_read_b64_tr_b16 v[240:241], v235 offset:18560
v_mfma_f32_16x16x32_bf16 v[124:127], a[244:247], a[236:239], v[124:127]
ds_read_b64_tr_b16 v[242:243], v235 offset:23168
v_mfma_f32_16x16x32_bf16 v[120:123], a[244:247], a[232:235], v[120:123]
ds_read_b64_tr_b16 v[244:245], v235 offset:27776
v_mfma_f32_16x16x32_bf16 v[120:123], a[240:243], a[216:219], v[120:123]
s_waitcnt lgkmcnt(7)
ds_read_b64_tr_b16 v[246:247], v235 offset:32384
v_mfma_f32_16x16x32_bf16 v[116:119], a[240:243], a[212:215], v[116:119]
v_mfma_f32_16x16x32_bf16 v[116:119], a[244:247], a[228:231], v[116:119]
v_mfma_f32_16x16x32_bf16 v[112:115], a[244:247], a[224:227], v[112:115]
buffer_load_dwordx4 v229, s[12:15], s54 offen offset:1024 lds
v_mfma_f32_16x16x32_bf16 v[112:115], a[240:243], a[208:211], v[112:115]
s_waitcnt lgkmcnt(4)
v_mfma_f32_16x16x32_bf16 v[128:131], a[248:251], a[208:211], v[128:131]
ds_read_b64_tr_b16 a[240:241], v235 offset:160
v_mfma_f32_16x16x32_bf16 v[128:131], a[252:255], a[224:227], v[128:131]
ds_read_b64_tr_b16 a[242:243], v235 offset:4768
v_mfma_f32_16x16x32_bf16 v[132:135], a[252:255], a[228:231], v[132:135]
ds_read_b64_tr_b16 a[244:245], v235 offset:9376
v_mfma_f32_16x16x32_bf16 v[132:135], a[248:251], a[212:215], v[132:135]
s_waitcnt lgkmcnt(7)
ds_read_b64_tr_b16 a[246:247], v235 offset:13984
v_mfma_f32_16x16x32_bf16 v[136:139], a[248:251], a[216:219], v[136:139]
v_mfma_f32_16x16x32_bf16 v[136:139], a[252:255], a[232:235], v[136:139]
v_mfma_f32_16x16x32_bf16 v[140:143], a[252:255], a[236:239], v[140:143]
buffer_load_dwordx4 v230, s[12:15], s54 offen offset:2048 lds
v_mfma_f32_16x16x32_bf16 v[140:143], a[248:251], a[220:223], v[140:143]
s_waitcnt lgkmcnt(4)
v_mfma_f32_16x16x32_bf16 v[156:159], v[240:243], a[220:223], v[156:159]
ds_read_b64_tr_b16 a[248:249], v235 offset:18592
v_mfma_f32_16x16x32_bf16 v[156:159], v[244:247], a[236:239], v[156:159]
ds_read_b64_tr_b16 a[250:251], v235 offset:23200
v_mfma_f32_16x16x32_bf16 v[152:155], v[244:247], a[232:235], v[152:155]
ds_read_b64_tr_b16 a[252:253], v235 offset:27808
v_mfma_f32_16x16x32_bf16 v[152:155], v[240:243], a[216:219], v[152:155]
s_waitcnt lgkmcnt(7)
ds_read_b64_tr_b16 a[254:255], v235 offset:32416
v_mfma_f32_16x16x32_bf16 v[148:151], v[240:243], a[212:215], v[148:151]
v_mfma_f32_16x16x32_bf16 v[148:151], v[244:247], a[228:231], v[148:151]
v_mfma_f32_16x16x32_bf16 v[144:147], v[244:247], a[224:227], v[144:147]
buffer_load_dwordx4 v231, s[12:15], s54 offen offset:3072 lds
v_mfma_f32_16x16x32_bf16 v[144:147], v[240:243], a[208:211], v[144:147]
s_waitcnt lgkmcnt(4)
v_mfma_f32_16x16x32_bf16 v[160:163], a[240:243], a[208:211], v[160:163]
ds_read_b64_tr_b16 v[240:241], v235 offset:192
v_mfma_f32_16x16x32_bf16 v[160:163], a[244:247], a[224:227], v[160:163]
ds_read_b64_tr_b16 v[242:243], v235 offset:4800
v_mfma_f32_16x16x32_bf16 v[164:167], a[244:247], a[228:231], v[164:167]
ds_read_b64_tr_b16 v[244:245], v235 offset:9408
v_mfma_f32_16x16x32_bf16 v[164:167], a[240:243], a[212:215], v[164:167]
s_waitcnt lgkmcnt(7)
ds_read_b64_tr_b16 v[246:247], v235 offset:14016
v_mfma_f32_16x16x32_bf16 v[168:171], a[240:243], a[216:219], v[168:171]
v_mfma_f32_16x16x32_bf16 v[168:171], a[244:247], a[232:235], v[168:171]
v_mfma_f32_16x16x32_bf16 v[172:175], a[244:247], a[236:239], v[172:175]
s_add_u32 m0, s60, 61440
v_mfma_f32_16x16x32_bf16 v[172:175], a[240:243], a[220:223], v[172:175]
s_waitcnt lgkmcnt(4)
buffer_load_dwordx4 v232, s[12:15], s54 offen offset:0 lds
v_mfma_f32_16x16x32_bf16 v[188:191], a[248:251], a[220:223], v[188:191]
s_add_u32 s54, s54, 589824
ds_read_b64_tr_b16 a[240:241], v235 offset:18624
v_mfma_f32_16x16x32_bf16 v[188:191], a[252:255], a[236:239], v[188:191]
ds_read_b64_tr_b16 a[242:243], v235 offset:23232
v_mfma_f32_16x16x32_bf16 v[184:187], a[252:255], a[232:235], v[184:187]
ds_read_b64_tr_b16 a[244:245], v235 offset:27840
v_mfma_f32_16x16x32_bf16 v[184:187], a[248:251], a[216:219], v[184:187]
s_waitcnt lgkmcnt(7)
ds_read_b64_tr_b16 a[246:247], v235 offset:32448
v_mfma_f32_16x16x32_bf16 v[180:183], a[248:251], a[212:215], v[180:183]
v_mfma_f32_16x16x32_bf16 v[180:183], a[252:255], a[228:231], v[180:183]
v_mfma_f32_16x16x32_bf16 v[176:179], a[252:255], a[224:227], v[176:179]
v_mfma_f32_16x16x32_bf16 v[176:179], a[248:251], a[208:211], v[176:179]
s_waitcnt lgkmcnt(4)
v_mfma_f32_16x16x32_bf16 v[192:195], v[240:243], a[208:211], v[192:195]
ds_read_b64_tr_b16 a[248:249], v235 offset:224
v_mfma_f32_16x16x32_bf16 v[192:195], v[244:247], a[224:227], v[192:195]
ds_read_b64_tr_b16 a[250:251], v235 offset:4832
v_mfma_f32_16x16x32_bf16 v[196:199], v[244:247], a[228:231], v[196:199]
ds_read_b64_tr_b16 a[252:253], v235 offset:9440
v_mfma_f32_16x16x32_bf16 v[196:199], v[240:243], a[212:215], v[196:199]
s_waitcnt lgkmcnt(7)
ds_read_b64_tr_b16 a[254:255], v235 offset:14048
v_mfma_f32_16x16x32_bf16 v[200:203], v[240:243], a[216:219], v[200:203]
v_mfma_f32_16x16x32_bf16 v[200:203], v[244:247], a[232:235], v[200:203]
v_mfma_f32_16x16x32_bf16 v[204:207], v[244:247], a[236:239], v[204:207]
v_mfma_f32_16x16x32_bf16 v[204:207], v[240:243], a[220:223], v[204:207]
s_waitcnt lgkmcnt(4)
v_mfma_f32_16x16x32_bf16 v[220:223], a[240:243], a[220:223], v[220:223]
ds_read_b64_tr_b16 v[240:241], v235 offset:18656
v_mfma_f32_16x16x32_bf16 v[220:223], a[244:247], a[236:239], v[220:223]
ds_read_b64_tr_b16 v[242:243], v235 offset:23264
v_mfma_f32_16x16x32_bf16 v[216:219], a[244:247], a[232:235], v[216:219]
ds_read_b64_tr_b16 v[244:245], v235 offset:27872
v_mfma_f32_16x16x32_bf16 v[216:219], a[240:243], a[216:219], v[216:219]
s_waitcnt lgkmcnt(7)
ds_read_b64_tr_b16 v[246:247], v235 offset:32480
v_mfma_f32_16x16x32_bf16 v[212:215], a[240:243], a[212:215], v[212:215]
v_mfma_f32_16x16x32_bf16 v[212:215], a[244:247], a[228:231], v[212:215]
v_mfma_f32_16x16x32_bf16 v[208:211], a[244:247], a[224:227], v[208:211]
v_mfma_f32_16x16x32_bf16 v[208:211], a[240:243], a[208:211], v[208:211]
s_waitcnt lgkmcnt(4)
v_mfma_f32_16x16x32_bf16 a[0:3], a[248:251], a[208:211], a[0:3]
ds_read_b64_tr_b16 a[240:241], v235 offset:256
v_mfma_f32_16x16x32_bf16 a[0:3], a[252:255], a[224:227], a[0:3]
ds_read_b64_tr_b16 a[242:243], v235 offset:4864
v_mfma_f32_16x16x32_bf16 a[4:7], a[252:255], a[228:231], a[4:7]
ds_read_b64_tr_b16 a[244:245], v235 offset:9472
v_mfma_f32_16x16x32_bf16 a[4:7], a[248:251], a[212:215], a[4:7]
s_waitcnt lgkmcnt(7)
ds_read_b64_tr_b16 a[246:247], v235 offset:14080
v_mfma_f32_16x16x32_bf16 a[8:11], a[248:251], a[216:219], a[8:11]
v_mfma_f32_16x16x32_bf16 a[8:11], a[252:255], a[232:235], a[8:11]
v_mfma_f32_16x16x32_bf16 a[12:15], a[252:255], a[236:239], a[12:15]
v_mfma_f32_16x16x32_bf16 a[12:15], a[248:251], a[220:223], a[12:15]
s_waitcnt lgkmcnt(4)
v_mfma_f32_16x16x32_bf16 a[28:31], v[240:243], a[220:223], a[28:31]
ds_read_b64_tr_b16 a[248:249], v235 offset:18688
v_mfma_f32_16x16x32_bf16 a[28:31], v[244:247], a[236:239], a[28:31]
ds_read_b64_tr_b16 a[250:251], v235 offset:23296
v_mfma_f32_16x16x32_bf16 a[24:27], v[244:247], a[232:235], a[24:27]
ds_read_b64_tr_b16 a[252:253], v235 offset:27904
v_mfma_f32_16x16x32_bf16 a[24:27], v[240:243], a[216:219], a[24:27]
s_waitcnt lgkmcnt(7)
ds_read_b64_tr_b16 a[254:255], v235 offset:32512
v_add_u32 v235, 0xfffe6000, v235
v_mfma_f32_16x16x32_bf16 a[20:23], v[240:243], a[212:215], a[20:23]
s_waitcnt vmcnt(17)
ds_add_u32 v251, v253
v_mfma_f32_16x16x32_bf16 a[20:23], v[244:247], a[228:231], a[20:23]
v_mfma_f32_16x16x32_bf16 a[16:19], v[244:247], a[224:227], a[16:19]
v_mfma_f32_16x16x32_bf16 a[16:19], v[240:243], a[208:211], a[16:19]
s_waitcnt lgkmcnt(5)
v_mfma_f32_16x16x32_bf16 a[32:35], a[240:243], a[208:211], a[32:35]
ds_read_b64_tr_b16 v[240:241], v236 offset:45056
v_mfma_f32_16x16x32_bf16 a[32:35], a[244:247], a[224:227], a[32:35]
ds_read_b64_tr_b16 v[242:243], v236 offset:49152
v_mfma_f32_16x16x32_bf16 a[36:39], a[244:247], a[228:231], a[36:39]
ds_read_b64_tr_b16 v[244:245], v236 offset:45064
v_mfma_f32_16x16x32_bf16 a[36:39], a[240:243], a[212:215], a[36:39]
s_waitcnt lgkmcnt(8)
ds_read_b64_tr_b16 v[246:247], v236 offset:49160
v_add_u32 v236, 0xfffe6000, v236
v_mfma_f32_16x16x32_bf16 a[40:43], a[240:243], a[216:219], a[40:43]
v_mfma_f32_16x16x32_bf16 a[40:43], a[244:247], a[232:235], a[40:43]
v_mfma_f32_16x16x32_bf16 a[44:47], a[244:247], a[236:239], a[44:47]
v_mfma_f32_16x16x32_bf16 a[44:47], a[240:243], a[220:223], a[44:47]
s_waitcnt lgkmcnt(5)
v_mfma_f32_16x16x32_bf16 a[60:63], a[248:251], a[220:223], a[60:63]
ds_read_b64_tr_b16 a[240:241], v237 offset:45056
v_mfma_f32_16x16x32_bf16 a[60:63], a[252:255], a[236:239], a[60:63]
ds_read_b64_tr_b16 a[242:243], v237 offset:49152
v_mfma_f32_16x16x32_bf16 a[56:59], a[252:255], a[232:235], a[56:59]
ds_read_b64_tr_b16 a[244:245], v237 offset:45064
v_mfma_f32_16x16x32_bf16 a[56:59], a[248:251], a[216:219], a[56:59]
s_waitcnt lgkmcnt(8)
ds_read_b64_tr_b16 a[246:247], v237 offset:49160
v_add_u32 v237, 0xfffe6000, v237
v_mfma_f32_16x16x32_bf16 a[52:55], a[248:251], a[212:215], a[52:55]
v_mfma_f32_16x16x32_bf16 a[52:55], a[252:255], a[228:231], a[52:55]
v_mfma_f32_16x16x32_bf16 a[48:51], a[252:255], a[224:227], a[48:51]
v_mfma_f32_16x16x32_bf16 a[48:51], a[248:251], a[208:211], a[48:51]
s_waitcnt lgkmcnt(6)
v_mfma_f32_16x16x32_bf16 a[64:67], v[240:243], a[224:227], a[64:67]
ds_read_b64_tr_b16 a[248:249], v238 offset:45056
v_mfma_f32_16x16x32_bf16 a[68:71], v[240:243], a[228:231], a[68:71]
ds_read_b64_tr_b16 a[250:251], v238 offset:49152
v_mfma_f32_16x16x32_bf16 a[72:75], v[240:243], a[232:235], a[72:75]
ds_read_b32 v255, v252
v_mfma_f32_16x16x32_bf16 a[76:79], v[240:243], a[236:239], a[76:79]
s_waitcnt lgkmcnt(7)
buffer_load_dwordx4 a[208:211], v254, s[8:11], s59 offen offset:0 sc1
v_mfma_f32_16x16x32_bf16 a[92:95], v[244:247], a[236:239], a[92:95]
ds_read_b64_tr_b16 a[252:253], v238 offset:45064
v_mfma_f32_16x16x32_bf16 a[88:91], v[244:247], a[232:235], a[88:91]
ds_read_b64_tr_b16 a[254:255], v238 offset:49160
v_add_u32 v238, 0xfffe6000, v238
v_mfma_f32_16x16x32_bf16 a[84:87], v[244:247], a[228:231], a[84:87]
buffer_load_dwordx4 a[212:215], v254, s[8:11], s59 offen offset:1024 sc1
v_mfma_f32_16x16x32_bf16 a[80:83], v[244:247], a[224:227], a[80:83]
s_waitcnt lgkmcnt(7)
buffer_load_dwordx4 a[216:219], v254, s[8:11], s59 offen offset:2048 sc1
v_mfma_f32_16x16x32_bf16 a[96:99], a[240:243], a[224:227], a[96:99]
ds_read_b64_tr_b16 v[240:241], v239 offset:45056
v_mfma_f32_16x16x32_bf16 a[100:103], a[240:243], a[228:231], a[100:103]
ds_read_b64_tr_b16 v[242:243], v239 offset:49152
v_mfma_f32_16x16x32_bf16 a[104:107], a[240:243], a[232:235], a[104:107]
buffer_load_dwordx4 a[220:223], v254, s[8:11], s59 offen offset:3072 sc1
v_mfma_f32_16x16x32_bf16 a[108:111], a[240:243], a[236:239], a[108:111]
s_waitcnt lgkmcnt(4)
v_mfma_f32_16x16x32_bf16 a[124:127], a[244:247], a[236:239], a[124:127]
s_add_u32 s59, s59, 4096
ds_read_b64_tr_b16 v[244:245], v239 offset:45064
v_cmp_gt_u32 vcc, 5, v255
v_mfma_f32_16x16x32_bf16 a[120:123], a[244:247], a[232:235], a[120:123]
ds_read_b64_tr_b16 v[246:247], v239 offset:49160
v_add_u32 v239, 0xfffe6000, v239
v_mfma_f32_16x16x32_bf16 a[116:119], a[244:247], a[228:231], a[116:119]
v_mfma_f32_16x16x32_bf16 a[112:115], a[244:247], a[224:227], a[112:115]
s_waitcnt lgkmcnt(6)
v_mfma_f32_16x16x32_bf16 a[128:131], a[248:251], a[224:227], a[128:131]
s_cbranch_vccnz k1_g5_s
k1_g5_b:
ds_read_b64_tr_b16 a[240:241], v236 offset:36864
v_mfma_f32_16x16x32_bf16 a[132:135], a[248:251], a[228:231], a[132:135]
ds_read_b64_tr_b16 a[242:243], v236 offset:40960
v_mfma_f32_16x16x32_bf16 a[136:139], a[248:251], a[232:235], a[136:139]
ds_add_u32 v251, v253
v_mfma_f32_16x16x32_bf16 a[140:143], a[248:251], a[236:239], a[140:143]
s_waitcnt lgkmcnt(7)
v_mfma_f32_16x16x32_bf16 a[156:159], a[252:255], a[236:239], a[156:159]
ds_read_b64_tr_b16 a[244:245], v236 offset:36872
v_mfma_f32_16x16x32_bf16 a[152:155], a[252:255], a[232:235], a[152:155]
ds_read_b64_tr_b16 a[246:247], v236 offset:40968
v_mfma_f32_16x16x32_bf16 a[148:151], a[252:255], a[228:231], a[148:151]
v_mfma_f32_16x16x32_bf16 a[144:147], a[252:255], a[224:227], a[144:147]
s_waitcnt lgkmcnt(7)
v_mfma_f32_16x16x32_bf16 a[160:163], v[240:243], a[224:227], a[160:163]
ds_read_b64_tr_b16 a[248:249], v237 offset:36864
v_mfma_f32_16x16x32_bf16 a[164:167], v[240:243], a[228:231], a[164:167]
ds_read_b64_tr_b16 a[250:251], v237 offset:40960
v_mfma_f32_16x16x32_bf16 a[168:171], v[240:243], a[232:235], a[168:171]
v_mfma_f32_16x16x32_bf16 a[172:175], v[240:243], a[236:239], a[172:175]
s_waitcnt lgkmcnt(7)
v_mfma_f32_16x16x32_bf16 a[188:191], v[244:247], a[236:239], a[188:191]
ds_read_b64_tr_b16 a[252:253], v237 offset:36872
v_mfma_f32_16x16x32_bf16 a[184:187], v[244:247], a[232:235], a[184:187]
ds_read_b64_tr_b16 a[254:255], v237 offset:40968
v_mfma_f32_16x16x32_bf16 a[180:183], v[244:247], a[228:231], a[180:183]
s_waitcnt vmcnt(17)
v_mfma_f32_16x16x32_bf16 a[176:179], v[244:247], a[224:227], a[176:179]
s_waitcnt lgkmcnt(7)
v_mfma_f32_16x16x32_bf16 a[64:67], a[240:243], a[192:195], a[64:67]
ds_read_b64_tr_b16 v[240:241], v238 offset:36864
ds_read_b32 v255, v252
v_mfma_f32_16x16x32_bf16 a[68:71], a[240:243], a[196:199], a[68:71]
ds_read_b64_tr_b16 v[242:243], v238 offset:40960
v_mfma_f32_16x16x32_bf16 a[72:75], a[240:243], a[200:203], a[72:75]
buffer_load_dwordx4 a[224:227], v254, s[8:11], s59 offen offset:0 sc1
v_mfma_f32_16x16x32_bf16 a[76:79], a[240:243], a[204:207], a[76:79]
s_waitcnt lgkmcnt(7)
buffer_load_dwordx4 a[228:231], v254, s[8:11], s59 offen offset:1024 sc1
v_mfma_f32_16x16x32_bf16 a[92:95], a[244:247], a[204:207], a[92:95]
ds_read_b64_tr_b16 v[244:245], v238 offset:36872
v_mfma_f32_16x16x32_bf16 a[88:91], a[244:247], a[200:203], a[88:91]
ds_read_b64_tr_b16 v[246:247], v238 offset:40968
v_mfma_f32_16x16x32_bf16 a[84:87], a[244:247], a[196:199], a[84:87]
buffer_load_dwordx4 a[232:235], v254, s[8:11], s59 offen offset:2048 sc1
v_mfma_f32_16x16x32_bf16 a[80:83], a[244:247], a[192:195], a[80:83]
s_waitcnt lgkmcnt(3)
buffer_load_dwordx4 a[236:239], v254, s[8:11], s59 offen offset:3072 sc1
v_mfma_f32_16x16x32_bf16 a[96:99], a[248:251], a[192:195], a[96:99]
s_add_u32 s59, s59, 4096
ds_read_b64_tr_b16 a[240:241], v239 offset:36864
v_cmp_gt_u32 vcc, 6, v255
v_mfma_f32_16x16x32_bf16 a[100:103], a[248:251], a[196:199], a[100:103]
ds_read_b64_tr_b16 a[242:243], v239 offset:40960
v_mfma_f32_16x16x32_bf16 a[104:107], a[248:251], a[200:203], a[104:107]
v_mfma_f32_16x16x32_bf16 a[108:111], a[248:251], a[204:207], a[108:111]
s_waitcnt lgkmcnt(5)
v_mfma_f32_16x16x32_bf16 a[124:127], a[252:255], a[204:207], a[124:127]
s_cbranch_vccnz k1_g6_s
k1_g6_b:
ds_read_b64_tr_b16 a[244:245], v239 offset:36872
v_mfma_f32_16x16x32_bf16 a[120:123], a[252:255], a[200:203], a[120:123]
ds_read_b64_tr_b16 a[246:247], v239 offset:40968
v_mfma_f32_16x16x32_bf16 a[116:119], a[252:255], a[196:199], a[116:119]
v_mfma_f32_16x16x32_bf16 a[112:115], a[252:255], a[192:195], a[112:115]
s_waitcnt lgkmcnt(6)
v_mfma_f32_16x16x32_bf16 a[128:131], v[240:243], a[192:195], a[128:131]
s_add_u32 m0, s61, 106496
ds_read_b64_tr_b16 a[248:249], v235 offset:0
v_mfma_f32_16x16x32_bf16 a[132:135], v[240:243], a[196:199], a[132:135]
ds_read_b64_tr_b16 a[250:251], v235 offset:4608
v_mfma_f32_16x16x32_bf16 a[136:139], v[240:243], a[200:203], a[136:139]
buffer_load_dwordx4 v233, s[16:19], s55 offen offset:0 lds
v_mfma_f32_16x16x32_bf16 a[140:143], v[240:243], a[204:207], a[140:143]
s_waitcnt lgkmcnt(6)
v_mfma_f32_16x16x32_bf16 a[156:159], v[244:247], a[204:207], a[156:159]
s_add_u32 s55, s55, 524288
ds_read_b64_tr_b16 a[252:253], v235 offset:9216
v_mfma_f32_16x16x32_bf16 a[152:155], v[244:247], a[200:203], a[152:155]
ds_read_b64_tr_b16 a[254:255], v235 offset:13824
v_mfma_f32_16x16x32_bf16 a[148:151], v[244:247], a[196:199], a[148:151]
v_mfma_f32_16x16x32_bf16 a[144:147], v[244:247], a[192:195], a[144:147]
s_waitcnt lgkmcnt(6)
v_mfma_f32_16x16x32_bf16 a[160:163], a[240:243], a[192:195], a[160:163]
ds_read_b64_tr_b16 v[240:241], v235 offset:18432
v_mfma_f32_16x16x32_bf16 a[164:167], a[240:243], a[196:199], a[164:167]
ds_read_b64_tr_b16 v[242:243], v235 offset:23040
v_mfma_f32_16x16x32_bf16 a[168:171], a[240:243], a[200:203], a[168:171]
buffer_load_dwordx4 v233, s[16:19], s56 offen offset:1024 lds
v_mfma_f32_16x16x32_bf16 a[172:175], a[240:243], a[204:207], a[172:175]
s_waitcnt lgkmcnt(6)
v_mfma_f32_16x16x32_bf16 a[188:191], a[244:247], a[204:207], a[188:191]
s_add_u32 s56, s56, 524288
ds_read_b64_tr_b16 v[244:245], v235 offset:27648
v_mfma_f32_16x16x32_bf16 a[184:187], a[244:247], a[200:203], a[184:187]
ds_read_b64_tr_b16 v[246:247], v235 offset:32256
v_mfma_f32_16x16x32_bf16 a[180:183], a[244:247], a[196:199], a[180:183]
s_waitcnt vmcnt(6)
v_mfma_f32_16x16x32_bf16 a[176:179], a[244:247], a[192:195], a[176:179]
s_waitcnt lgkmcnt(4)
v_mfma_f32_16x16x32_bf16 v[0:3], a[248:251], a[192:195], v[0:3]
ds_read_b64_tr_b16 a[240:241], v235 offset:32
v_mfma_f32_16x16x32_bf16 v[0:3], a[252:255], a[208:211], v[0:3]
ds_read_b64_tr_b16 a[242:243], v235 offset:4640
v_mfma_f32_16x16x32_bf16 v[4:7], a[252:255], a[212:215], v[4:7]
ds_read_b64_tr_b16 a[244:245], v235 offset:9248
v_mfma_f32_16x16x32_bf16 v[4:7], a[248:251], a[196:199], v[4:7]
s_waitcnt lgkmcnt(7)
ds_read_b64_tr_b16 a[246:247], v235 offset:13856
v_mfma_f32_16x16x32_bf16 v[8:11], a[248:251], a[200:203], v[8:11]
buffer_load_dwordx4 v233, s[16:19], s57 offen offset:2048 lds
v_mfma_f32_16x16x32_bf16 v[8:11], a[252:255], a[216:219], v[8:11]
s_add_u32 s57, s57, 524288
v_mfma_f32_16x16x32_bf16 v[12:15], a[252:255], a[220:223], v[12:15]
v_mfma_f32_16x16x32_bf16 v[12:15], a[248:251], a[204:207], v[12:15]
s_waitcnt lgkmcnt(4)
v_mfma_f32_16x16x32_bf16 v[28:31], v[240:243], a[204:207], v[28:31]
ds_read_b64_tr_b16 a[248:249], v235 offset:18464
v_mfma_f32_16x16x32_bf16 v[28:31], v[244:247], a[220:223], v[28:31]
ds_read_b64_tr_b16 a[250:251], v235 offset:23072
v_mfma_f32_16x16x32_bf16 v[24:27], v[244:247], a[216:219], v[24:27]
ds_read_b64_tr_b16 a[252:253], v235 offset:27680
v_mfma_f32_16x16x32_bf16 v[24:27], v[240:243], a[200:203], v[24:27]
s_waitcnt lgkmcnt(7)
ds_read_b64_tr_b16 a[254:255], v235 offset:32288
v_mfma_f32_16x16x32_bf16 v[20:23], v[240:243], a[196:199], v[20:23]
buffer_load_dwordx4 v233, s[16:19], s58 offen offset:3072 lds
v_mfma_f32_16x16x32_bf16 v[20:23], v[244:247], a[212:215], v[20:23]
s_add_u32 s58, s58, 524288
v_mfma_f32_16x16x32_bf16 v[16:19], v[244:247], a[208:211], v[16:19]
v_mfma_f32_16x16x32_bf16 v[16:19], v[240:243], a[192:195], v[16:19]
s_waitcnt lgkmcnt(4)
v_mfma_f32_16x16x32_bf16 v[32:35], a[240:243], a[192:195], v[32:35]
ds_read_b64_tr_b16 v[240:241], v235 offset:64
v_mfma_f32_16x16x32_bf16 v[32:35], a[244:247], a[208:211], v[32:35]
ds_read_b64_tr_b16 v[242:243], v235 offset:4672
v_mfma_f32_16x16x32_bf16 v[36:39], a[244:247], a[212:215], v[36:39]
ds_read_b64_tr_b16 v[244:245], v235 offset:9280
v_mfma_f32_16x16x32_bf16 v[36:39], a[240:243], a[196:199], v[36:39]
s_waitcnt lgkmcnt(7)
ds_read_b64_tr_b16 v[246:247], v235 offset:13888
v_mfma_f32_16x16x32_bf16 v[40:43], a[240:243], a[200:203], v[40:43]
s_add_u32 m0, s60, 106496
v_mfma_f32_16x16x32_bf16 v[40:43], a[244:247], a[216:219], v[40:43]
buffer_load_dwordx4 v224, s[12:15], s54 offen offset:0 lds
v_mfma_f32_16x16x32_bf16 v[44:47], a[244:247], a[220:223], v[44:47]
v_mfma_f32_16x16x32_bf16 v[44:47], a[240:243], a[204:207], v[44:47]
s_waitcnt lgkmcnt(4)
v_mfma_f32_16x16x32_bf16 v[60:63], a[248:251], a[204:207], v[60:63]
ds_read_b64_tr_b16 a[240:241], v235 offset:18496
v_mfma_f32_16x16x32_bf16 v[60:63], a[252:255], a[220:223], v[60:63]
ds_read_b64_tr_b16 a[242:243], v235 offset:23104
v_mfma_f32_16x16x32_bf16 v[56:59], a[252:255], a[216:219], v[56:59]
ds_read_b64_tr_b16 a[244:245], v235 offset:27712
v_mfma_f32_16x16x32_bf16 v[56:59], a[248:251], a[200:203], v[56:59]
s_waitcnt lgkmcnt(7)
ds_read_b64_tr_b16 a[246:247], v235 offset:32320
v_mfma_f32_16x16x32_bf16 v[52:55], a[248:251], a[196:199], v[52:55]
v_mfma_f32_16x16x32_bf16 v[52:55], a[252:255], a[212:215], v[52:55]
buffer_load_dwordx4 v225, s[12:15], s54 offen offset:1024 lds
v_mfma_f32_16x16x32_bf16 v[48:51], a[252:255], a[208:211], v[48:51]
v_mfma_f32_16x16x32_bf16 v[48:51], a[248:251], a[192:195], v[48:51]
s_waitcnt lgkmcnt(4)
v_mfma_f32_16x16x32_bf16 v[64:67], v[240:243], a[192:195], v[64:67]
ds_read_b64_tr_b16 a[248:249], v235 offset:96
v_mfma_f32_16x16x32_bf16 v[64:67], v[244:247], a[208:211], v[64:67]
ds_read_b64_tr_b16 a[250:251], v235 offset:4704
v_mfma_f32_16x16x32_bf16 v[68:71], v[244:247], a[212:215], v[68:71]
ds_read_b64_tr_b16 a[252:253], v235 offset:9312
v_mfma_f32_16x16x32_bf16 v[68:71], v[240:243], a[196:199], v[68:71]
s_waitcnt lgkmcnt(7)
ds_read_b64_tr_b16 a[254:255], v235 offset:13920
v_mfma_f32_16x16x32_bf16 v[72:75], v[240:243], a[200:203], v[72:75]
v_mfma_f32_16x16x32_bf16 v[72:75], v[244:247], a[216:219], v[72:75]
buffer_load_dwordx4 v226, s[12:15], s54 offen offset:2048 lds
v_mfma_f32_16x16x32_bf16 v[76:79], v[244:247], a[220:223], v[76:79]
v_mfma_f32_16x16x32_bf16 v[76:79], v[240:243], a[204:207], v[76:79]
s_waitcnt lgkmcnt(4)
v_mfma_f32_16x16x32_bf16 v[92:95], a[240:243], a[204:207], v[92:95]
ds_read_b64_tr_b16 v[240:241], v235 offset:18528
v_mfma_f32_16x16x32_bf16 v[92:95], a[244:247], a[220:223], v[92:95]
ds_read_b64_tr_b16 v[242:243], v235 offset:23136
v_mfma_f32_16x16x32_bf16 v[88:91], a[244:247], a[216:219], v[88:91]
ds_read_b64_tr_b16 v[244:245], v235 offset:27744
v_mfma_f32_16x16x32_bf16 v[88:91], a[240:243], a[200:203], v[88:91]
s_waitcnt lgkmcnt(7)
ds_read_b64_tr_b16 v[246:247], v235 offset:32352
v_mfma_f32_16x16x32_bf16 v[84:87], a[240:243], a[196:199], v[84:87]
v_mfma_f32_16x16x32_bf16 v[84:87], a[244:247], a[212:215], v[84:87]
buffer_load_dwordx4 v227, s[12:15], s54 offen offset:3072 lds
v_mfma_f32_16x16x32_bf16 v[80:83], a[244:247], a[208:211], v[80:83]
v_mfma_f32_16x16x32_bf16 v[80:83], a[240:243], a[192:195], v[80:83]
s_waitcnt lgkmcnt(4)
v_mfma_f32_16x16x32_bf16 v[96:99], a[248:251], a[192:195], v[96:99]
ds_read_b64_tr_b16 a[240:241], v235 offset:128
v_mfma_f32_16x16x32_bf16 v[96:99], a[252:255], a[208:211], v[96:99]
ds_read_b64_tr_b16 a[242:243], v235 offset:4736
v_mfma_f32_16x16x32_bf16 v[100:103], a[252:255], a[212:215], v[100:103]
ds_read_b64_tr_b16 a[244:245], v235 offset:9344
v_mfma_f32_16x16x32_bf16 v[100:103], a[248:251], a[196:199], v[100:103]
s_waitcnt lgkmcnt(7)
ds_read_b64_tr_b16 a[246:247], v235 offset:13952
v_mfma_f32_16x16x32_bf16 v[104:107], a[248:251], a[200:203], v[104:107]
v_mfma_f32_16x16x32_bf16 v[104:107], a[252:255], a[216:219], v[104:107]
s_add_u32 m0, s60, 110592
v_mfma_f32_16x16x32_bf16 v[108:111], a[252:255], a[220:223], v[108:111]
buffer_load_dwordx4 v228, s[12:15], s54 offen offset:0 lds
v_mfma_f32_16x16x32_bf16 v[108:111], a[248:251], a[204:207], v[108:111]
s_waitcnt lgkmcnt(4)
v_mfma_f32_16x16x32_bf16 v[124:127], v[240:243], a[204:207], v[124:127]
ds_read_b64_tr_b16 a[248:249], v235 offset:18560
v_mfma_f32_16x16x32_bf16 v[124:127], v[244:247], a[220:223], v[124:127]
ds_read_b64_tr_b16 a[250:251], v235 offset:23168
v_mfma_f32_16x16x32_bf16 v[120:123], v[244:247], a[216:219], v[120:123]
ds_read_b64_tr_b16 a[252:253], v235 offset:27776
v_mfma_f32_16x16x32_bf16 v[120:123], v[240:243], a[200:203], v[120:123]
s_waitcnt lgkmcnt(7)
ds_read_b64_tr_b16 a[254:255], v235 offset:32384
v_mfma_f32_16x16x32_bf16 v[116:119], v[240:243], a[196:199], v[116:119]
v_mfma_f32_16x16x32_bf16 v[116:119], v[244:247], a[212:215], v[116:119]
v_mfma_f32_16x16x32_bf16 v[112:115], v[244:247], a[208:211], v[112:115]
buffer_load_dwordx4 v229, s[12:15], s54 offen offset:1024 lds
v_mfma_f32_16x16x32_bf16 v[112:115], v[240:243], a[192:195], v[112:115]
s_waitcnt lgkmcnt(4)
v_mfma_f32_16x16x32_bf16 v[128:131], a[240:243], a[192:195], v[128:131]
ds_read_b64_tr_b16 v[240:241], v235 offset:160
v_mfma_f32_16x16x32_bf16 v[128:131], a[244:247], a[208:211], v[128:131]
ds_read_b64_tr_b16 v[242:243], v235 offset:4768
v_mfma_f32_16x16x32_bf16 v[132:135], a[244:247], a[212:215], v[132:135]
ds_read_b64_tr_b16 v[244:245], v235 offset:9376
v_mfma_f32_16x16x32_bf16 v[132:135], a[240:243], a[196:199], v[132:135]
s_waitcnt lgkmcnt(7)
ds_read_b64_tr_b16 v[246:247], v235 offset:13984
v_mfma_f32_16x16x32_bf16 v[136:139], a[240:243], a[200:203], v[136:139]
v_mfma_f32_16x16x32_bf16 v[136:139], a[244:247], a[216:219], v[136:139]
v_mfma_f32_16x16x32_bf16 v[140:143], a[244:247], a[220:223], v[140:143]
buffer_load_dwordx4 v230, s[12:15], s54 offen offset:2048 lds
v_mfma_f32_16x16x32_bf16 v[140:143], a[240:243], a[204:207], v[140:143]
s_waitcnt lgkmcnt(4)
v_mfma_f32_16x16x32_bf16 v[156:159], a[248:251], a[204:207], v[156:159]
ds_read_b64_tr_b16 a[240:241], v235 offset:18592
v_mfma_f32_16x16x32_bf16 v[156:159], a[252:255], a[220:223], v[156:159]
ds_read_b64_tr_b16 a[242:243], v235 offset:23200
v_mfma_f32_16x16x32_bf16 v[152:155], a[252:255], a[216:219], v[152:155]
ds_read_b64_tr_b16 a[244:245], v235 offset:27808
v_mfma_f32_16x16x32_bf16 v[152:155], a[248:251], a[200:203], v[152:155]
s_waitcnt lgkmcnt(7)
ds_read_b64_tr_b16 a[246:247], v235 offset:32416
v_mfma_f32_16x16x32_bf16 v[148:151], a[248:251], a[196:199], v[148:151]
v_mfma_f32_16x16x32_bf16 v[148:151], a[252:255], a[212:215], v[148:151]
v_mfma_f32_16x16x32_bf16 v[144:147], a[252:255], a[208:211], v[144:147]
buffer_load_dwordx4 v231, s[12:15], s54 offen offset:3072 lds
v_mfma_f32_16x16x32_bf16 v[144:147], a[248:251], a[192:195], v[144:147]
s_waitcnt lgkmcnt(4)
v_mfma_f32_16x16x32_bf16 v[160:163], v[240:243], a[192:195], v[160:163]
ds_read_b64_tr_b16 a[248:249], v235 offset:192
v_mfma_f32_16x16x32_bf16 v[160:163], v[244:247], a[208:211], v[160:163]
ds_read_b64_tr_b16 a[250:251], v235 offset:4800
v_mfma_f32_16x16x32_bf16 v[164:167], v[244:247], a[212:215], v[164:167]
ds_read_b64_tr_b16 a[252:253], v235 offset:9408
v_mfma_f32_16x16x32_bf16 v[164:167], v[240:243], a[196:199], v[164:167]
s_waitcnt lgkmcnt(7)
ds_read_b64_tr_b16 a[254:255], v235 offset:14016
v_mfma_f32_16x16x32_bf16 v[168:171], v[240:243], a[200:203], v[168:171]
v_mfma_f32_16x16x32_bf16 v[168:171], v[244:247], a[216:219], v[168:171]
v_mfma_f32_16x16x32_bf16 v[172:175], v[244:247], a[220:223], v[172:175]
s_add_u32 m0, s60, 114688
v_mfma_f32_16x16x32_bf16 v[172:175], v[240:243], a[204:207], v[172:175]
s_waitcnt lgkmcnt(4)
buffer_load_dwordx4 v232, s[12:15], s54 offen offset:0 lds
v_mfma_f32_16x16x32_bf16 v[188:191], a[240:243], a[204:207], v[188:191]
s_add_u32 s54, s54, 589824
ds_read_b64_tr_b16 v[240:241], v235 offset:18624
v_mfma_f32_16x16x32_bf16 v[188:191], a[244:247], a[220:223], v[188:191]
ds_read_b64_tr_b16 v[242:243], v235 offset:23232
v_mfma_f32_16x16x32_bf16 v[184:187], a[244:247], a[216:219], v[184:187]
ds_read_b64_tr_b16 v[244:245], v235 offset:27840
v_mfma_f32_16x16x32_bf16 v[184:187], a[240:243], a[200:203], v[184:187]
s_waitcnt lgkmcnt(7)
ds_read_b64_tr_b16 v[246:247], v235 offset:32448
v_mfma_f32_16x16x32_bf16 v[180:183], a[240:243], a[196:199], v[180:183]
v_mfma_f32_16x16x32_bf16 v[180:183], a[244:247], a[212:215], v[180:183]
v_mfma_f32_16x16x32_bf16 v[176:179], a[244:247], a[208:211], v[176:179]
v_mfma_f32_16x16x32_bf16 v[176:179], a[240:243], a[192:195], v[176:179]
s_waitcnt lgkmcnt(4)
v_mfma_f32_16x16x32_bf16 v[192:195], a[248:251], a[192:195], v[192:195]
ds_read_b64_tr_b16 a[240:241], v235 offset:224
v_mfma_f32_16x16x32_bf16 v[192:195], a[252:255], a[208:211], v[192:195]
ds_read_b64_tr_b16 a[242:243], v235 offset:4832
v_mfma_f32_16x16x32_bf16 v[196:199], a[252:255], a[212:215], v[196:199]
ds_read_b64_tr_b16 a[244:245], v235 offset:9440
v_mfma_f32_16x16x32_bf16 v[196:199], a[248:251], a[196:199], v[196:199]
s_waitcnt lgkmcnt(7)
ds_read_b64_tr_b16 a[246:247], v235 offset:14048
v_mfma_f32_16x16x32_bf16 v[200:203], a[248:251], a[200:203], v[200:203]
v_mfma_f32_16x16x32_bf16 v[200:203], a[252:255], a[216:219], v[200:203]
v_mfma_f32_16x16x32_bf16 v[204:207], a[252:255], a[220:223], v[204:207]
v_mfma_f32_16x16x32_bf16 v[204:207], a[248:251], a[204:207], v[204:207]
s_waitcnt lgkmcnt(4)
v_mfma_f32_16x16x32_bf16 v[220:223], v[240:243], a[204:207], v[220:223]
ds_read_b64_tr_b16 a[248:249], v235 offset:18656
v_mfma_f32_16x16x32_bf16 v[220:223], v[244:247], a[220:223], v[220:223]
ds_read_b64_tr_b16 a[250:251], v235 offset:23264
v_mfma_f32_16x16x32_bf16 v[216:219], v[244:247], a[216:219], v[216:219]
ds_read_b64_tr_b16 a[252:253], v235 offset:27872
v_mfma_f32_16x16x32_bf16 v[216:219], v[240:243], a[200:203], v[216:219]
s_waitcnt lgkmcnt(7)
ds_read_b64_tr_b16 a[254:255], v235 offset:32480
v_mfma_f32_16x16x32_bf16 v[212:215], v[240:243], a[196:199], v[212:215]
v_mfma_f32_16x16x32_bf16 v[212:215], v[244:247], a[212:215], v[212:215]
v_mfma_f32_16x16x32_bf16 v[208:211], v[244:247], a[208:211], v[208:211]
v_mfma_f32_16x16x32_bf16 v[208:211], v[240:243], a[192:195], v[208:211]
s_waitcnt lgkmcnt(4)
v_mfma_f32_16x16x32_bf16 a[0:3], a[240:243], a[192:195], a[0:3]
ds_read_b64_tr_b16 v[240:241], v235 offset:256
v_mfma_f32_16x16x32_bf16 a[0:3], a[244:247], a[208:211], a[0:3]
ds_read_b64_tr_b16 v[242:243], v235 offset:4864
v_mfma_f32_16x16x32_bf16 a[4:7], a[244:247], a[212:215], a[4:7]
ds_read_b64_tr_b16 v[244:245], v235 offset:9472
v_mfma_f32_16x16x32_bf16 a[4:7], a[240:243], a[196:199], a[4:7]
s_waitcnt lgkmcnt(7)
ds_read_b64_tr_b16 v[246:247], v235 offset:14080
v_mfma_f32_16x16x32_bf16 a[8:11], a[240:243], a[200:203], a[8:11]
v_mfma_f32_16x16x32_bf16 a[8:11], a[244:247], a[216:219], a[8:11]
v_mfma_f32_16x16x32_bf16 a[12:15], a[244:247], a[220:223], a[12:15]
v_mfma_f32_16x16x32_bf16 a[12:15], a[240:243], a[204:207], a[12:15]
s_waitcnt lgkmcnt(4)
v_mfma_f32_16x16x32_bf16 a[28:31], a[248:251], a[204:207], a[28:31]
ds_read_b64_tr_b16 a[240:241], v235 offset:18688
v_mfma_f32_16x16x32_bf16 a[28:31], a[252:255], a[220:223], a[28:31]
ds_read_b64_tr_b16 a[242:243], v235 offset:23296
v_mfma_f32_16x16x32_bf16 a[24:27], a[252:255], a[216:219], a[24:27]
ds_read_b64_tr_b16 a[244:245], v235 offset:27904
v_mfma_f32_16x16x32_bf16 a[24:27], a[248:251], a[200:203], a[24:27]
s_waitcnt lgkmcnt(7)
ds_read_b64_tr_b16 a[246:247], v235 offset:32512
v_add_u32 v235, 0xd000, v235
v_mfma_f32_16x16x32_bf16 a[20:23], a[248:251], a[196:199], a[20:23]
s_waitcnt vmcnt(17)
ds_add_u32 v251, v253
v_mfma_f32_16x16x32_bf16 a[20:23], a[252:255], a[212:215], a[20:23]
v_mfma_f32_16x16x32_bf16 a[16:19], a[252:255], a[208:211], a[16:19]
v_mfma_f32_16x16x32_bf16 a[16:19], a[248:251], a[192:195], a[16:19]
s_waitcnt lgkmcnt(5)
v_mfma_f32_16x16x32_bf16 a[32:35], v[240:243], a[192:195], a[32:35]
ds_read_b64_tr_b16 a[248:249], v236 offset:45056
v_mfma_f32_16x16x32_bf16 a[32:35], v[244:247], a[208:211], a[32:35]
ds_read_b64_tr_b16 a[250:251], v236 offset:49152
v_mfma_f32_16x16x32_bf16 a[36:39], v[244:247], a[212:215], a[36:39]
ds_read_b64_tr_b16 a[252:253], v236 offset:45064
v_mfma_f32_16x16x32_bf16 a[36:39], v[240:243], a[196:199], a[36:39]
s_waitcnt lgkmcnt(8)
ds_read_b64_tr_b16 a[254:255], v236 offset:49160
v_add_u32 v236, 0xd000, v236
v_mfma_f32_16x16x32_bf16 a[40:43], v[240:243], a[200:203], a[40:43]
v_mfma_f32_16x16x32_bf16 a[40:43], v[244:247], a[216:219], a[40:43]
v_mfma_f32_16x16x32_bf16 a[44:47], v[244:247], a[220:223], a[44:47]
v_mfma_f32_16x16x32_bf16 a[44:47], v[240:243], a[204:207], a[44:47]
s_waitcnt lgkmcnt(5)
v_mfma_f32_16x16x32_bf16 a[60:63], a[240:243], a[204:207], a[60:63]
ds_read_b64_tr_b16 v[240:241], v237 offset:45056
v_mfma_f32_16x16x32_bf16 a[60:63], a[244:247], a[220:223], a[60:63]
ds_read_b64_tr_b16 v[242:243], v237 offset:49152
v_mfma_f32_16x16x32_bf16 a[56:59], a[244:247], a[216:219], a[56:59]
ds_read_b64_tr_b16 v[244:245], v237 offset:45064
v_mfma_f32_16x16x32_bf16 a[56:59], a[240:243], a[200:203], a[56:59]
s_waitcnt lgkmcnt(8)
ds_read_b64_tr_b16 v[246:247], v237 offset:49160
v_add_u32 v237, 0xd000, v237
v_mfma_f32_16x16x32_bf16 a[52:55], a[240:243], a[196:199], a[52:55]
v_mfma_f32_16x16x32_bf16 a[52:55], a[244:247], a[212:215], a[52:55]
v_mfma_f32_16x16x32_bf16 a[48:51], a[244:247], a[208:211], a[48:51]
v_mfma_f32_16x16x32_bf16 a[48:51], a[240:243], a[192:195], a[48:51]
s_waitcnt lgkmcnt(6)
v_mfma_f32_16x16x32_bf16 a[64:67], a[248:251], a[208:211], a[64:67]
ds_read_b64_tr_b16 a[240:241], v238 offset:45056
v_mfma_f32_16x16x32_bf16 a[68:71], a[248:251], a[212:215], a[68:71]
ds_read_b64_tr_b16 a[242:243], v238 offset:49152
v_mfma_f32_16x16x32_bf16 a[72:75], a[248:251], a[216:219], a[72:75]
ds_read_b32 v255, v252
v_mfma_f32_16x16x32_bf16 a[76:79], a[248:251], a[220:223], a[76:79]
s_waitcnt lgkmcnt(7)
buffer_load_dwordx4 a[192:195], v254, s[8:11], s59 offen offset:0 sc1
v_mfma_f32_16x16x32_bf16 a[92:95], a[252:255], a[220:223], a[92:95]
ds_read_b64_tr_b16 a[244:245], v238 offset:45064
v_mfma_f32_16x16x32_bf16 a[88:91], a[252:255], a[216:219], a[88:91]
ds_read_b64_tr_b16 a[246:247], v238 offset:49160
v_add_u32 v238, 0xd000, v238
v_mfma_f32_16x16x32_bf16 a[84:87], a[252:255], a[212:215], a[84:87]
buffer_load_dwordx4 a[196:199], v254, s[8:11], s59 offen offset:1024 sc1
v_mfma_f32_16x16x32_bf16 a[80:83], a[252:255], a[208:211], a[80:83]
s_waitcnt lgkmcnt(7)
buffer_load_dwordx4 a[200:203], v254, s[8:11], s59 offen offset:2048 sc1
v_mfma_f32_16x16x32_bf16 a[96:99], v[240:243], a[208:211], a[96:99]
ds_read_b64_tr_b16 a[248:249], v239 offset:45056
v_mfma_f32_16x16x32_bf16 a[100:103], v[240:243], a[212:215], a[100:103]
ds_read_b64_tr_b16 a[250:251], v239 offset:49152
v_mfma_f32_16x16x32_bf16 a[104:107], v[240:243], a[216:219], a[104:107]
buffer_load_dwordx4 a[204:207], v254, s[8:11], s59 offen offset:3072 sc1
v_mfma_f32_16x16x32_bf16 a[108:111], v[240:243], a[220:223], a[108:111]
s_waitcnt lgkmcnt(4)
v_mfma_f32_16x16x32_bf16 a[124:127], v[244:247], a[220:223], a[124:127]
s_add_u32 s59, s59, 4096
ds_read_b64_tr_b16 a[252:253], v239 offset:45064
v_cmp_gt_u32 vcc, 7, v255
v_mfma_f32_16x16x32_bf16 a[120:123], v[244:247], a[216:219], a[120:123]
ds_read_b64_tr_b16 a[254:255], v239 offset:49160
v_add_u32 v239, 0xd000, v239
v_mfma_f32_16x16x32_bf16 a[116:119], v[244:247], a[212:215], a[116:119]
v_mfma_f32_16x16x32_bf16 a[112:115], v[244:247], a[208:211], a[112:115]
s_waitcnt lgkmcnt(6)
v_mfma_f32_16x16x32_bf16 a[128:131], a[240:243], a[208:211], a[128:131]
s_cbranch_vccnz k1_g7_s
k1_g7_b:
ds_read_b64_tr_b16 v[240:241], v236 offset:36864
v_mfma_f32_16x16x32_bf16 a[132:135], a[240:243], a[212:215], a[132:135]
ds_read_b64_tr_b16 v[242:243], v236 offset:40960
v_mfma_f32_16x16x32_bf16 a[136:139], a[240:243], a[216:219], a[136:139]
ds_add_u32 v251, v253
v_mfma_f32_16x16x32_bf16 a[140:143], a[240:243], a[220:223], a[140:143]
s_waitcnt lgkmcnt(7)
v_mfma_f32_16x16x32_bf16 a[156:159], a[244:247], a[220:223], a[156:159]
ds_read_b64_tr_b16 v[244:245], v236 offset:36872
v_mfma_f32_16x16x32_bf16 a[152:155], a[244:247], a[216:219], a[152:155]
ds_read_b64_tr_b16 v[246:247], v236 offset:40968
v_mfma_f32_16x16x32_bf16 a[148:151], a[244:247], a[212:215], a[148:151]
v_mfma_f32_16x16x32_bf16 a[144:147], a[244:247], a[208:211], a[144:147]
s_waitcnt lgkmcnt(7)
v_mfma_f32_16x16x32_bf16 a[160:163], a[248:251], a[208:211], a[160:163]
ds_read_b64_tr_b16 a[240:241], v237 offset:36864
v_mfma_f32_16x16x32_bf16 a[164:167], a[248:251], a[212:215], a[164:167]
ds_read_b64_tr_b16 a[242:243], v237 offset:40960
v_mfma_f32_16x16x32_bf16 a[168:171], a[248:251], a[216:219], a[168:171]
v_mfma_f32_16x16x32_bf16 a[172:175], a[248:251], a[220:223], a[172:175]
s_waitcnt lgkmcnt(7)
v_mfma_f32_16x16x32_bf16 a[188:191], a[252:255], a[220:223], a[188:191]
ds_read_b64_tr_b16 a[244:245], v237 offset:36872
v_mfma_f32_16x16x32_bf16 a[184:187], a[252:255], a[216:219], a[184:187]
ds_read_b64_tr_b16 a[246:247], v237 offset:40968
v_mfma_f32_16x16x32_bf16 a[180:183], a[252:255], a[212:215], a[180:183]
s_waitcnt vmcnt(17)
v_mfma_f32_16x16x32_bf16 a[176:179], a[252:255], a[208:211], a[176:179]
s_waitcnt lgkmcnt(7)
v_mfma_f32_16x16x32_bf16 a[64:67], v[240:243], a[224:227], a[64:67]
ds_read_b64_tr_b16 a[248:249], v238 offset:36864
ds_read_b32 v255, v252
v_mfma_f32_16x16x32_bf16 a[68:71], v[240:243], a[228:231], a[68:71]
ds_read_b64_tr_b16 a[250:251], v238 offset:40960
v_mfma_f32_16x16x32_bf16 a[72:75], v[240:243], a[232:235], a[72:75]
buffer_load_dwordx4 a[208:211], v254, s[8:11], s59 offen offset:0 sc1
v_mfma_f32_16x16x32_bf16 a[76:79], v[240:243], a[236:239], a[76:79]
s_waitcnt lgkmcnt(7)
buffer_load_dwordx4 a[212:215], v254, s[8:11], s59 offen offset:1024 sc1
v_mfma_f32_16x16x32_bf16 a[92:95], v[244:247], a[236:239], a[92:95]
ds_read_b64_tr_b16 a[252:253], v238 offset:36872
v_mfma_f32_16x16x32_bf16 a[88:91], v[244:247], a[232:235], a[88:91]
ds_read_b64_tr_b16 a[254:255], v238 offset:40968
v_mfma_f32_16x16x32_bf16 a[84:87], v[244:247], a[228:231], a[84:87]
buffer_load_dwordx4 a[216:219], v254, s[8:11], s59 offen offset:2048 sc1
v_mfma_f32_16x16x32_bf16 a[80:83], v[244:247], a[224:227], a[80:83]
s_waitcnt lgkmcnt(3)
buffer_load_dwordx4 a[220:223], v254, s[8:11], s59 offen offset:3072 sc1
v_mfma_f32_16x16x32_bf16 a[96:99], a[240:243], a[224:227], a[96:99]
s_add_u32 s59, s59, 4096
ds_read_b64_tr_b16 v[240:241], v239 offset:36864
v_cmp_gt_u32 vcc, 8, v255
v_mfma_f32_16x16x32_bf16 a[100:103], a[240:243], a[228:231], a[100:103]
ds_read_b64_tr_b16 v[242:243], v239 offset:40960
v_mfma_f32_16x16x32_bf16 a[104:107], a[240:243], a[232:235], a[104:107]
v_mfma_f32_16x16x32_bf16 a[108:111], a[240:243], a[236:239], a[108:111]
s_waitcnt lgkmcnt(5)
v_mfma_f32_16x16x32_bf16 a[124:127], a[244:247], a[236:239], a[124:127]
s_cbranch_vccnz k1_g8_s
k1_g8_b:
ds_read_b64_tr_b16 v[244:245], v239 offset:36872
v_mfma_f32_16x16x32_bf16 a[120:123], a[244:247], a[232:235], a[120:123]
ds_read_b64_tr_b16 v[246:247], v239 offset:40968
v_mfma_f32_16x16x32_bf16 a[116:119], a[244:247], a[228:231], a[116:119]
v_mfma_f32_16x16x32_bf16 a[112:115], a[244:247], a[224:227], a[112:115]
s_waitcnt lgkmcnt(6)
v_mfma_f32_16x16x32_bf16 a[128:131], a[248:251], a[224:227], a[128:131]
s_add_u32 m0, s61, 0
ds_read_b64_tr_b16 a[240:241], v235 offset:0
v_mfma_f32_16x16x32_bf16 a[132:135], a[248:251], a[228:231], a[132:135]
ds_read_b64_tr_b16 a[242:243], v235 offset:4608
v_mfma_f32_16x16x32_bf16 a[136:139], a[248:251], a[232:235], a[136:139]
buffer_load_dwordx4 v233, s[16:19], s55 offen offset:0 lds
v_mfma_f32_16x16x32_bf16 a[140:143], a[248:251], a[236:239], a[140:143]
s_waitcnt lgkmcnt(6)
v_mfma_f32_16x16x32_bf16 a[156:159], a[252:255], a[236:239], a[156:159]
s_add_u32 s55, s55, 524288
ds_read_b64_tr_b16 a[244:245], v235 offset:9216
v_mfma_f32_16x16x32_bf16 a[152:155], a[252:255], a[232:235], a[152:155]
ds_read_b64_tr_b16 a[246:247], v235 offset:13824
v_mfma_f32_16x16x32_bf16 a[148:151], a[252:255], a[228:231], a[148:151]
v_mfma_f32_16x16x32_bf16 a[144:147], a[252:255], a[224:227], a[144:147]
s_waitcnt lgkmcnt(6)
v_mfma_f32_16x16x32_bf16 a[160:163], v[240:243], a[224:227], a[160:163]
ds_read_b64_tr_b16 a[248:249], v235 offset:18432
v_mfma_f32_16x16x32_bf16 a[164:167], v[240:243], a[228:231], a[164:167]
ds_read_b64_tr_b16 a[250:251], v235 offset:23040
v_mfma_f32_16x16x32_bf16 a[168:171], v[240:243], a[232:235], a[168:171]
buffer_load_dwordx4 v233, s[16:19], s56 offen offset:1024 lds
v_mfma_f32_16x16x32_bf16 a[172:175], v[240:243], a[236:239], a[172:175]
s_waitcnt lgkmcnt(6)
v_mfma_f32_16x16x32_bf16 a[188:191], v[244:247], a[236:239], a[188:191]
s_add_u32 s56, s56, 524288
ds_read_b64_tr_b16 a[252:253], v235 offset:27648
v_mfma_f32_16x16x32_bf16 a[184:187], v[244:247], a[232:235], a[184:187]
ds_read_b64_tr_b16 a[254:255], v235 offset:32256
v_mfma_f32_16x16x32_bf16 a[180:183], v[244:247], a[228:231], a[180:183]
s_waitcnt vmcnt(6)
v_mfma_f32_16x16x32_bf16 a[176:179], v[244:247], a[224:227], a[176:179]
s_waitcnt lgkmcnt(4)
v_mfma_f32_16x16x32_bf16 v[0:3], a[240:243], a[224:227], v[0:3]
ds_read_b64_tr_b16 v[240:241], v235 offset:32
v_mfma_f32_16x16x32_bf16 v[0:3], a[244:247], a[192:195], v[0:3]
ds_read_b64_tr_b16 v[242:243], v235 offset:4640
v_mfma_f32_16x16x32_bf16 v[4:7], a[244:247], a[196:199], v[4:7]
ds_read_b64_tr_b16 v[244:245], v235 offset:9248
v_mfma_f32_16x16x32_bf16 v[4:7], a[240:243], a[228:231], v[4:7]
s_waitcnt lgkmcnt(7)
ds_read_b64_tr_b16 v[246:247], v235 offset:13856
v_mfma_f32_16x16x32_bf16 v[8:11], a[240:243], a[232:235], v[8:11]
buffer_load_dwordx4 v233, s[16:19], s57 offen offset:2048 lds
v_mfma_f32_16x16x32_bf16 v[8:11], a[244:247], a[200:203], v[8:11]
s_add_u32 s57, s57, 524288
v_mfma_f32_16x16x32_bf16 v[12:15], a[244:247], a[204:207], v[12:15]
v_mfma_f32_16x16x32_bf16 v[12:15], a[240:243], a[236:239], v[12:15]
s_waitcnt lgkmcnt(4)
v_mfma_f32_16x16x32_bf16 v[28:31], a[248:251], a[236:239], v[28:31]
ds_read_b64_tr_b16 a[240:241], v235 offset:18464
v_mfma_f32_16x16x32_bf16 v[28:31], a[252:255], a[204:207], v[28:31]
ds_read_b64_tr_b16 a[242:243], v235 offset:23072
v_mfma_f32_16x16x32_bf16 v[24:27], a[252:255], a[200:203], v[24:27]
ds_read_b64_tr_b16 a[244:245], v235 offset:27680
v_mfma_f32_16x16x32_bf16 v[24:27], a[248:251], a[232:235], v[24:27]
s_waitcnt lgkmcnt(7)
ds_read_b64_tr_b16 a[246:247], v235 offset:32288
v_mfma_f32_16x16x32_bf16 v[20:23], a[248:251], a[228:231], v[20:23]
buffer_load_dwordx4 v233, s[16:19], s58 offen offset:3072 lds
v_mfma_f32_16x16x32_bf16 v[20:23], a[252:255], a[196:199], v[20:23]
s_add_u32 s58, s58, 524288
v_mfma_f32_16x16x32_bf16 v[16:19], a[252:255], a[192:195], v[16:19]
v_mfma_f32_16x16x32_bf16 v[16:19], a[248:251], a[224:227], v[16:19]
s_waitcnt lgkmcnt(4)
v_mfma_f32_16x16x32_bf16 v[32:35], v[240:243], a[224:227], v[32:35]
ds_read_b64_tr_b16 a[248:249], v235 offset:64
v_mfma_f32_16x16x32_bf16 v[32:35], v[244:247], a[192:195], v[32:35]
ds_read_b64_tr_b16 a[250:251], v235 offset:4672
v_mfma_f32_16x16x32_bf16 v[36:39], v[244:247], a[196:199], v[36:39]
ds_read_b64_tr_b16 a[252:253], v235 offset:9280
v_mfma_f32_16x16x32_bf16 v[36:39], v[240:243], a[228:231], v[36:39]
s_waitcnt lgkmcnt(7)
ds_read_b64_tr_b16 a[254:255], v235 offset:13888
v_mfma_f32_16x16x32_bf16 v[40:43], v[240:243], a[232:235], v[40:43]
s_add_u32 m0, s60, 0
v_mfma_f32_16x16x32_bf16 v[40:43], v[244:247], a[200:203], v[40:43]
buffer_load_dwordx4 v224, s[12:15], s54 offen offset:0 lds
v_mfma_f32_16x16x32_bf16 v[44:47], v[244:247], a[204:207], v[44:47]
v_mfma_f32_16x16x32_bf16 v[44:47], v[240:243], a[236:239], v[44:47]
s_waitcnt lgkmcnt(4)
v_mfma_f32_16x16x32_bf16 v[60:63], a[240:243], a[236:239], v[60:63]
ds_read_b64_tr_b16 v[240:241], v235 offset:18496
v_mfma_f32_16x16x32_bf16 v[60:63], a[244:247], a[204:207], v[60:63]
ds_read_b64_tr_b16 v[242:243], v235 offset:23104
v_mfma_f32_16x16x32_bf16 v[56:59], a[244:247], a[200:203], v[56:59]
ds_read_b64_tr_b16 v[244:245], v235 offset:27712
v_mfma_f32_16x16x32_bf16 v[56:59], a[240:243], a[232:235], v[56:59]
s_waitcnt lgkmcnt(7)
ds_read_b64_tr_b16 v[246:247], v235 offset:32320
v_mfma_f32_16x16x32_bf16 v[52:55], a[240:243], a[228:231], v[52:55]
v_mfma_f32_16x16x32_bf16 v[52:55], a[244:247], a[196:199], v[52:55]
buffer_load_dwordx4 v225, s[12:15], s54 offen offset:1024 lds
v_mfma_f32_16x16x32_bf16 v[48:51], a[244:247], a[192:195], v[48:51]
v_mfma_f32_16x16x32_bf16 v[48:51], a[240:243], a[224:227], v[48:51]
s_waitcnt lgkmcnt(4)
v_mfma_f32_16x16x32_bf16 v[64:67], a[248:251], a[224:227], v[64:67]
ds_read_b64_tr_b16 a[240:241], v235 offset:96
v_mfma_f32_16x16x32_bf16 v[64:67], a[252:255], a[192:195], v[64:67]
ds_read_b64_tr_b16 a[242:243], v235 offset:4704
v_mfma_f32_16x16x32_bf16 v[68:71], a[252:255], a[196:199], v[68:71]
ds_read_b64_tr_b16 a[244:245], v235 offset:9312
v_mfma_f32_16x16x32_bf16 v[68:71], a[248:251], a[228:231], v[68:71]
s_waitcnt lgkmcnt(7)
ds_read_b64_tr_b16 a[246:247], v235 offset:13920
v_mfma_f32_16x16x32_bf16 v[72:75], a[248:251], a[232:235], v[72:75]
v_mfma_f32_16x16x32_bf16 v[72:75], a[252:255], a[200:203], v[72:75]
buffer_load_dwordx4 v226, s[12:15], s54 offen offset:2048 lds
v_mfma_f32_16x16x32_bf16 v[76:79], a[252:255], a[204:207], v[76:79]
v_mfma_f32_16x16x32_bf16 v[76:79], a[248:251], a[236:239], v[76:79]
s_waitcnt lgkmcnt(4)
v_mfma_f32_16x16x32_bf16 v[92:95], v[240:243], a[236:239], v[92:95]
ds_read_b64_tr_b16 a[248:249], v235 offset:18528
v_mfma_f32_16x16x32_bf16 v[92:95], v[244:247], a[204:207], v[92:95]
ds_read_b64_tr_b16 a[250:251], v235 offset:23136
v_mfma_f32_16x16x32_bf16 v[88:91], v[244:247], a[200:203], v[88:91]
ds_read_b64_tr_b16 a[252:253], v235 offset:27744
v_mfma_f32_16x16x32_bf16 v[88:91], v[240:243], a[232:235], v[88:91]
s_waitcnt lgkmcnt(7)
ds_read_b64_tr_b16 a[254:255], v235 offset:32352
v_mfma_f32_16x16x32_bf16 v[84:87], v[240:243], a[228:231], v[84:87]
v_mfma_f32_16x16x32_bf16 v[84:87], v[244:247], a[196:199], v[84:87]
buffer_load_dwordx4 v227, s[12:15], s54 offen offset:3072 lds
v_mfma_f32_16x16x32_bf16 v[80:83], v[244:247], a[192:195], v[80:83]
v_mfma_f32_16x16x32_bf16 v[80:83], v[240:243], a[224:227], v[80:83]
s_waitcnt lgkmcnt(4)
v_mfma_f32_16x16x32_bf16 v[96:99], a[240:243], a[224:227], v[96:99]
ds_read_b64_tr_b16 v[240:241], v235 offset:128
v_mfma_f32_16x16x32_bf16 v[96:99], a[244:247], a[192:195], v[96:99]
ds_read_b64_tr_b16 v[242:243], v235 offset:4736
v_mfma_f32_16x16x32_bf16 v[100:103], a[244:247], a[196:199], v[100:103]
ds_read_b64_tr_b16 v[244:245], v235 offset:9344
v_mfma_f32_16x16x32_bf16 v[100:103], a[240:243], a[228:231], v[100:103]
s_waitcnt lgkmcnt(7)
ds_read_b64_tr_b16 v[246:247], v235 offset:13952
v_mfma_f32_16x16x32_bf16 v[104:107], a[240:243], a[232:235], v[104:107]
v_mfma_f32_16x16x32_bf16 v[104:107], a[244:247], a[200:203], v[104:107]
s_add_u32 m0, s60, 4096
v_mfma_f32_16x16x32_bf16 v[108:111], a[244:247], a[204:207], v[108:111]
buffer_load_dwordx4 v228, s[12:15], s54 offen offset:0 lds
v_mfma_f32_16x16x32_bf16 v[108:111], a[240:243], a[236:239], v[108:111]
s_waitcnt lgkmcnt(4)
v_mfma_f32_16x16x32_bf16 v[124:127], a[248:251], a[236:239], v[124:127]
ds_read_b64_tr_b16 a[240:241], v235 offset:18560
v_mfma_f32_16x16x32_bf16 v[124:127], a[252:255], a[204:207], v[124:127]
ds_read_b64_tr_b16 a[242:243], v235 offset:23168
v_mfma_f32_16x16x32_bf16 v[120:123], a[252:255], a[200:203], v[120:123]
ds_read_b64_tr_b16 a[244:245], v235 offset:27776
v_mfma_f32_16x16x32_bf16 v[120:123], a[248:251], a[232:235], v[120:123]
s_waitcnt lgkmcnt(7)
ds_read_b64_tr_b16 a[246:247], v235 offset:32384
v_mfma_f32_16x16x32_bf16 v[116:119], a[248:251], a[228:231], v[116:119]
v_mfma_f32_16x16x32_bf16 v[116:119], a[252:255], a[196:199], v[116:119]
v_mfma_f32_16x16x32_bf16 v[112:115], a[252:255], a[192:195], v[112:115]
buffer_load_dwordx4 v229, s[12:15], s54 offen offset:1024 lds
v_mfma_f32_16x16x32_bf16 v[112:115], a[248:251], a[224:227], v[112:115]
s_waitcnt lgkmcnt(4)
v_mfma_f32_16x16x32_bf16 v[128:131], v[240:243], a[224:227], v[128:131]
ds_read_b64_tr_b16 a[248:249], v235 offset:160
v_mfma_f32_16x16x32_bf16 v[128:131], v[244:247], a[192:195], v[128:131]
ds_read_b64_tr_b16 a[250:251], v235 offset:4768
v_mfma_f32_16x16x32_bf16 v[132:135], v[244:247], a[196:199], v[132:135]
ds_read_b64_tr_b16 a[252:253], v235 offset:9376
v_mfma_f32_16x16x32_bf16 v[132:135], v[240:243], a[228:231], v[132:135]
s_waitcnt lgkmcnt(7)
ds_read_b64_tr_b16 a[254:255], v235 offset:13984
v_mfma_f32_16x16x32_bf16 v[136:139], v[240:243], a[232:235], v[136:139]
v_mfma_f32_16x16x32_bf16 v[136:139], v[244:247], a[200:203], v[136:139]
v_mfma_f32_16x16x32_bf16 v[140:143], v[244:247], a[204:207], v[140:143]
buffer_load_dwordx4 v230, s[12:15], s54 offen offset:2048 lds
v_mfma_f32_16x16x32_bf16 v[140:143], v[240:243], a[236:239], v[140:143]
s_waitcnt lgkmcnt(4)
v_mfma_f32_16x16x32_bf16 v[156:159], a[240:243], a[236:239], v[156:159]
ds_read_b64_tr_b16 v[240:241], v235 offset:18592
v_mfma_f32_16x16x32_bf16 v[156:159], a[244:247], a[204:207], v[156:159]
ds_read_b64_tr_b16 v[242:243], v235 offset:23200
v_mfma_f32_16x16x32_bf16 v[152:155], a[244:247], a[200:203], v[152:155]
ds_read_b64_tr_b16 v[244:245], v235 offset:27808
v_mfma_f32_16x16x32_bf16 v[152:155], a[240:243], a[232:235], v[152:155]
s_waitcnt lgkmcnt(7)
ds_read_b64_tr_b16 v[246:247], v235 offset:32416
v_mfma_f32_16x16x32_bf16 v[148:151], a[240:243], a[228:231], v[148:151]
v_mfma_f32_16x16x32_bf16 v[148:151], a[244:247], a[196:199], v[148:151]
v_mfma_f32_16x16x32_bf16 v[144:147], a[244:247], a[192:195], v[144:147]
buffer_load_dwordx4 v231, s[12:15], s54 offen offset:3072 lds
v_mfma_f32_16x16x32_bf16 v[144:147], a[240:243], a[224:227], v[144:147]
s_waitcnt lgkmcnt(4)
v_mfma_f32_16x16x32_bf16 v[160:163], a[248:251], a[224:227], v[160:163]
ds_read_b64_tr_b16 a[240:241], v235 offset:192
v_mfma_f32_16x16x32_bf16 v[160:163], a[252:255], a[192:195], v[160:163]
ds_read_b64_tr_b16 a[242:243], v235 offset:4800
v_mfma_f32_16x16x32_bf16 v[164:167], a[252:255], a[196:199], v[164:167]
ds_read_b64_tr_b16 a[244:245], v235 offset:9408
v_mfma_f32_16x16x32_bf16 v[164:167], a[248:251], a[228:231], v[164:167]
s_waitcnt lgkmcnt(7)
ds_read_b64_tr_b16 a[246:247], v235 offset:14016
v_mfma_f32_16x16x32_bf16 v[168:171], a[248:251], a[232:235], v[168:171]
v_mfma_f32_16x16x32_bf16 v[168:171], a[252:255], a[200:203], v[168:171]
v_mfma_f32_16x16x32_bf16 v[172:175], a[252:255], a[204:207], v[172:175]
s_add_u32 m0, s60, 8192
v_mfma_f32_16x16x32_bf16 v[172:175], a[248:251], a[236:239], v[172:175]
s_waitcnt lgkmcnt(4)
buffer_load_dwordx4 v232, s[12:15], s54 offen offset:0 lds
v_mfma_f32_16x16x32_bf16 v[188:191], v[240:243], a[236:239], v[188:191]
s_add_u32 s54, s54, 589824
ds_read_b64_tr_b16 a[248:249], v235 offset:18624
v_mfma_f32_16x16x32_bf16 v[188:191], v[244:247], a[204:207], v[188:191]
ds_read_b64_tr_b16 a[250:251], v235 offset:23232
v_mfma_f32_16x16x32_bf16 v[184:187], v[244:247], a[200:203], v[184:187]
ds_read_b64_tr_b16 a[252:253], v235 offset:27840
v_mfma_f32_16x16x32_bf16 v[184:187], v[240:243], a[232:235], v[184:187]
s_waitcnt lgkmcnt(7)
ds_read_b64_tr_b16 a[254:255], v235 offset:32448
v_mfma_f32_16x16x32_bf16 v[180:183], v[240:243], a[228:231], v[180:183]
v_mfma_f32_16x16x32_bf16 v[180:183], v[244:247], a[196:199], v[180:183]
v_mfma_f32_16x16x32_bf16 v[176:179], v[244:247], a[192:195], v[176:179]
v_mfma_f32_16x16x32_bf16 v[176:179], v[240:243], a[224:227], v[176:179]
s_waitcnt lgkmcnt(4)
v_mfma_f32_16x16x32_bf16 v[192:195], a[240:243], a[224:227], v[192:195]
ds_read_b64_tr_b16 v[240:241], v235 offset:224
v_mfma_f32_16x16x32_bf16 v[192:195], a[244:247], a[192:195], v[192:195]
ds_read_b64_tr_b16 v[242:243], v235 offset:4832
v_mfma_f32_16x16x32_bf16 v[196:199], a[244:247], a[196:199], v[196:199]
ds_read_b64_tr_b16 v[244:245], v235 offset:9440
v_mfma_f32_16x16x32_bf16 v[196:199], a[240:243], a[228:231], v[196:199]
s_waitcnt lgkmcnt(7)
ds_read_b64_tr_b16 v[246:247], v235 offset:14048
v_mfma_f32_16x16x32_bf16 v[200:203], a[240:243], a[232:235], v[200:203]
v_mfma_f32_16x16x32_bf16 v[200:203], a[244:247], a[200:203], v[200:203]
v_mfma_f32_16x16x32_bf16 v[204:207], a[244:247], a[204:207], v[204:207]
v_mfma_f32_16x16x32_bf16 v[204:207], a[240:243], a[236:239], v[204:207]
s_waitcnt lgkmcnt(4)
v_mfma_f32_16x16x32_bf16 v[220:223], a[248:251], a[236:239], v[220:223]
ds_read_b64_tr_b16 a[240:241], v235 offset:18656
v_mfma_f32_16x16x32_bf16 v[220:223], a[252:255], a[204:207], v[220:223]
ds_read_b64_tr_b16 a[242:243], v235 offset:23264
v_mfma_f32_16x16x32_bf16 v[216:219], a[252:255], a[200:203], v[216:219]
ds_read_b64_tr_b16 a[244:245], v235 offset:27872
v_mfma_f32_16x16x32_bf16 v[216:219], a[248:251], a[232:235], v[216:219]
s_waitcnt lgkmcnt(7)
ds_read_b64_tr_b16 a[246:247], v235 offset:32480
v_mfma_f32_16x16x32_bf16 v[212:215], a[248:251], a[228:231], v[212:215]
v_mfma_f32_16x16x32_bf16 v[212:215], a[252:255], a[196:199], v[212:215]
v_mfma_f32_16x16x32_bf16 v[208:211], a[252:255], a[192:195], v[208:211]
v_mfma_f32_16x16x32_bf16 v[208:211], a[248:251], a[224:227], v[208:211]
s_waitcnt lgkmcnt(4)
v_mfma_f32_16x16x32_bf16 a[0:3], v[240:243], a[224:227], a[0:3]
ds_read_b64_tr_b16 a[248:249], v235 offset:256
v_mfma_f32_16x16x32_bf16 a[0:3], v[244:247], a[192:195], a[0:3]
ds_read_b64_tr_b16 a[250:251], v235 offset:4864
v_mfma_f32_16x16x32_bf16 a[4:7], v[244:247], a[196:199], a[4:7]
ds_read_b64_tr_b16 a[252:253], v235 offset:9472
v_mfma_f32_16x16x32_bf16 a[4:7], v[240:243], a[228:231], a[4:7]
s_waitcnt lgkmcnt(7)
ds_read_b64_tr_b16 a[254:255], v235 offset:14080
v_mfma_f32_16x16x32_bf16 a[8:11], v[240:243], a[232:235], a[8:11]
v_mfma_f32_16x16x32_bf16 a[8:11], v[244:247], a[200:203], a[8:11]
v_mfma_f32_16x16x32_bf16 a[12:15], v[244:247], a[204:207], a[12:15]
v_mfma_f32_16x16x32_bf16 a[12:15], v[240:243], a[236:239], a[12:15]
s_waitcnt lgkmcnt(4)
v_mfma_f32_16x16x32_bf16 a[28:31], a[240:243], a[236:239], a[28:31]
ds_read_b64_tr_b16 v[240:241], v235 offset:18688
v_mfma_f32_16x16x32_bf16 a[28:31], a[244:247], a[204:207], a[28:31]
ds_read_b64_tr_b16 v[242:243], v235 offset:23296
v_mfma_f32_16x16x32_bf16 a[24:27], a[244:247], a[200:203], a[24:27]
ds_read_b64_tr_b16 v[244:245], v235 offset:27904
v_mfma_f32_16x16x32_bf16 a[24:27], a[240:243], a[232:235], a[24:27]
s_waitcnt lgkmcnt(7)
ds_read_b64_tr_b16 v[246:247], v235 offset:32512
v_add_u32 v235, 0xd000, v235
v_mfma_f32_16x16x32_bf16 a[20:23], a[240:243], a[228:231], a[20:23]
s_waitcnt vmcnt(17)
ds_add_u32 v251, v253
v_mfma_f32_16x16x32_bf16 a[20:23], a[244:247], a[196:199], a[20:23]
v_mfma_f32_16x16x32_bf16 a[16:19], a[244:247], a[192:195], a[16:19]
v_mfma_f32_16x16x32_bf16 a[16:19], a[240:243], a[224:227], a[16:19]
s_waitcnt lgkmcnt(5)
v_mfma_f32_16x16x32_bf16 a[32:35], a[248:251], a[224:227], a[32:35]
ds_read_b64_tr_b16 a[240:241], v236 offset:45056
v_mfma_f32_16x16x32_bf16 a[32:35], a[252:255], a[192:195], a[32:35]
ds_read_b64_tr_b16 a[242:243], v236 offset:49152
v_mfma_f32_16x16x32_bf16 a[36:39], a[252:255], a[196:199], a[36:39]
ds_read_b64_tr_b16 a[244:245], v236 offset:45064
v_mfma_f32_16x16x32_bf16 a[36:39], a[248:251], a[228:231], a[36:39]
s_waitcnt lgkmcnt(8)
ds_read_b64_tr_b16 a[246:247], v236 offset:49160
v_add_u32 v236, 0xd000, v236
v_mfma_f32_16x16x32_bf16 a[40:43], a[248:251], a[232:235], a[40:43]
v_mfma_f32_16x16x32_bf16 a[40:43], a[252:255], a[200:203], a[40:43]
v_mfma_f32_16x16x32_bf16 a[44:47], a[252:255], a[204:207], a[44:47]
v_mfma_f32_16x16x32_bf16 a[44:47], a[248:251], a[236:239], a[44:47]
s_waitcnt lgkmcnt(5)
v_mfma_f32_16x16x32_bf16 a[60:63], v[240:243], a[236:239], a[60:63]
ds_read_b64_tr_b16 a[248:249], v237 offset:45056
v_mfma_f32_16x16x32_bf16 a[60:63], v[244:247], a[204:207], a[60:63]
ds_read_b64_tr_b16 a[250:251], v237 offset:49152
v_mfma_f32_16x16x32_bf16 a[56:59], v[244:247], a[200:203], a[56:59]
ds_read_b64_tr_b16 a[252:253], v237 offset:45064
v_mfma_f32_16x16x32_bf16 a[56:59], v[240:243], a[232:235], a[56:59]
s_waitcnt lgkmcnt(8)
ds_read_b64_tr_b16 a[254:255], v237 offset:49160
v_add_u32 v237, 0xd000, v237
v_mfma_f32_16x16x32_bf16 a[52:55], v[240:243], a[228:231], a[52:55]
v_mfma_f32_16x16x32_bf16 a[52:55], v[244:247], a[196:199], a[52:55]
v_mfma_f32_16x16x32_bf16 a[48:51], v[244:247], a[192:195], a[48:51]
v_mfma_f32_16x16x32_bf16 a[48:51], v[240:243], a[224:227], a[48:51]
s_waitcnt lgkmcnt(6)
v_mfma_f32_16x16x32_bf16 a[64:67], a[240:243], a[192:195], a[64:67]
ds_read_b64_tr_b16 v[240:241], v238 offset:45056
v_mfma_f32_16x16x32_bf16 a[68:71], a[240:243], a[196:199], a[68:71]
ds_read_b64_tr_b16 v[242:243], v238 offset:49152
v_mfma_f32_16x16x32_bf16 a[72:75], a[240:243], a[200:203], a[72:75]
ds_read_b32 v255, v252
v_mfma_f32_16x16x32_bf16 a[76:79], a[240:243], a[204:207], a[76:79]
s_waitcnt lgkmcnt(7)
buffer_load_dwordx4 a[224:227], v254, s[8:11], s59 offen offset:0 sc1
v_mfma_f32_16x16x32_bf16 a[92:95], a[244:247], a[204:207], a[92:95]
ds_read_b64_tr_b16 v[244:245], v238 offset:45064
v_mfma_f32_16x16x32_bf16 a[88:91], a[244:247], a[200:203], a[88:91]
ds_read_b64_tr_b16 v[246:247], v238 offset:49160
v_add_u32 v238, 0xd000, v238
v_mfma_f32_16x16x32_bf16 a[84:87], a[244:247], a[196:199], a[84:87]
buffer_load_dwordx4 a[228:231], v254, s[8:11], s59 offen offset:1024 sc1
v_mfma_f32_16x16x32_bf16 a[80:83], a[244:247], a[192:195], a[80:83]
s_waitcnt lgkmcnt(7)
buffer_load_dwordx4 a[232:235], v254, s[8:11], s59 offen offset:2048 sc1
v_mfma_f32_16x16x32_bf16 a[96:99], a[248:251], a[192:195], a[96:99]
ds_read_b64_tr_b16 a[240:241], v239 offset:45056
v_mfma_f32_16x16x32_bf16 a[100:103], a[248:251], a[196:199], a[100:103]
ds_read_b64_tr_b16 a[242:243], v239 offset:49152
v_mfma_f32_16x16x32_bf16 a[104:107], a[248:251], a[200:203], a[104:107]
buffer_load_dwordx4 a[236:239], v254, s[8:11], s59 offen offset:3072 sc1
v_mfma_f32_16x16x32_bf16 a[108:111], a[248:251], a[204:207], a[108:111]
s_waitcnt lgkmcnt(4)
v_mfma_f32_16x16x32_bf16 a[124:127], a[252:255], a[204:207], a[124:127]
s_add_u32 s59, s59, 4096
ds_read_b64_tr_b16 a[244:245], v239 offset:45064
v_cmp_gt_u32 vcc, 9, v255
v_mfma_f32_16x16x32_bf16 a[120:123], a[252:255], a[200:203], a[120:123]
ds_read_b64_tr_b16 a[246:247], v239 offset:49160
v_add_u32 v239, 0xd000, v239
v_mfma_f32_16x16x32_bf16 a[116:119], a[252:255], a[196:199], a[116:119]
v_mfma_f32_16x16x32_bf16 a[112:115], a[252:255], a[192:195], a[112:115]
s_waitcnt lgkmcnt(6)
v_mfma_f32_16x16x32_bf16 a[128:131], v[240:243], a[192:195], a[128:131]
s_cbranch_vccnz k1_g9_s
k1_g9_b:
ds_read_b64_tr_b16 a[248:249], v236 offset:36864
v_mfma_f32_16x16x32_bf16 a[132:135], v[240:243], a[196:199], a[132:135]
ds_read_b64_tr_b16 a[250:251], v236 offset:40960
v_mfma_f32_16x16x32_bf16 a[136:139], v[240:243], a[200:203], a[136:139]
ds_add_u32 v251, v253
v_mfma_f32_16x16x32_bf16 a[140:143], v[240:243], a[204:207], a[140:143]
s_waitcnt lgkmcnt(7)
v_mfma_f32_16x16x32_bf16 a[156:159], v[244:247], a[204:207], a[156:159]
ds_read_b64_tr_b16 a[252:253], v236 offset:36872
v_mfma_f32_16x16x32_bf16 a[152:155], v[244:247], a[200:203], a[152:155]
ds_read_b64_tr_b16 a[254:255], v236 offset:40968
v_mfma_f32_16x16x32_bf16 a[148:151], v[244:247], a[196:199], a[148:151]
v_mfma_f32_16x16x32_bf16 a[144:147], v[244:247], a[192:195], a[144:147]
s_waitcnt lgkmcnt(7)
v_mfma_f32_16x16x32_bf16 a[160:163], a[240:243], a[192:195], a[160:163]
ds_read_b64_tr_b16 v[240:241], v237 offset:36864
v_mfma_f32_16x16x32_bf16 a[164:167], a[240:243], a[196:199], a[164:167]
ds_read_b64_tr_b16 v[242:243], v237 offset:40960
v_mfma_f32_16x16x32_bf16 a[168:171], a[240:243], a[200:203], a[168:171]
v_mfma_f32_16x16x32_bf16 a[172:175], a[240:243], a[204:207], a[172:175]
s_waitcnt lgkmcnt(7)
v_mfma_f32_16x16x32_bf16 a[188:191], a[244:247], a[204:207], a[188:191]
ds_read_b64_tr_b16 v[244:245], v237 offset:36872
v_mfma_f32_16x16x32_bf16 a[184:187], a[244:247], a[200:203], a[184:187]
ds_read_b64_tr_b16 v[246:247], v237 offset:40968
v_mfma_f32_16x16x32_bf16 a[180:183], a[244:247], a[196:199], a[180:183]
s_waitcnt vmcnt(17)
v_mfma_f32_16x16x32_bf16 a[176:179], a[244:247], a[192:195], a[176:179]
s_waitcnt lgkmcnt(7)
v_mfma_f32_16x16x32_bf16 a[64:67], a[248:251], a[208:211], a[64:67]
ds_read_b64_tr_b16 a[240:241], v238 offset:36864
ds_read_b32 v255, v252
v_mfma_f32_16x16x32_bf16 a[68:71], a[248:251], a[212:215], a[68:71]
ds_read_b64_tr_b16 a[242:243], v238 offset:40960
v_mfma_f32_16x16x32_bf16 a[72:75], a[248:251], a[216:219], a[72:75]
buffer_load_dwordx4 a[192:195], v254, s[8:11], s59 offen offset:0 sc1
v_mfma_f32_16x16x32_bf16 a[76:79], a[248:251], a[220:223], a[76:79]
s_waitcnt lgkmcnt(7)
buffer_load_dwordx4 a[196:199], v254, s[8:11], s59 offen offset:1024 sc1
v_mfma_f32_16x16x32_bf16 a[92:95], a[252:255], a[220:223], a[92:95]
ds_read_b64_tr_b16 a[244:245], v238 offset:36872
v_mfma_f32_16x16x32_bf16 a[88:91], a[252:255], a[216:219], a[88:91]
ds_read_b64_tr_b16 a[246:247], v238 offset:40968
v_mfma_f32_16x16x32_bf16 a[84:87], a[252:255], a[212:215], a[84:87]
buffer_load_dwordx4 a[200:203], v254, s[8:11], s59 offen offset:2048 sc1
v_mfma_f32_16x16x32_bf16 a[80:83], a[252:255], a[208:211], a[80:83]
s_waitcnt lgkmcnt(3)
buffer_load_dwordx4 a[204:207], v254, s[8:11], s59 offen offset:3072 sc1
v_mfma_f32_16x16x32_bf16 a[96:99], v[240:243], a[208:211], a[96:99]
s_add_u32 s59, s59, 4096
ds_read_b64_tr_b16 a[248:249], v239 offset:36864
v_cmp_gt_u32 vcc, 10, v255
v_mfma_f32_16x16x32_bf16 a[100:103], v[240:243], a[212:215], a[100:103]
ds_read_b64_tr_b16 a[250:251], v239 offset:40960
v_mfma_f32_16x16x32_bf16 a[104:107], v[240:243], a[216:219], a[104:107]
v_mfma_f32_16x16x32_bf16 a[108:111], v[240:243], a[220:223], a[108:111]
s_waitcnt lgkmcnt(5)
v_mfma_f32_16x16x32_bf16 a[124:127], v[244:247], a[220:223], a[124:127]
s_cbranch_vccnz k1_g10_s
k1_g10_b:
ds_read_b64_tr_b16 a[252:253], v239 offset:36872
v_mfma_f32_16x16x32_bf16 a[120:123], v[244:247], a[216:219], a[120:123]
ds_read_b64_tr_b16 a[254:255], v239 offset:40968
v_mfma_f32_16x16x32_bf16 a[116:119], v[244:247], a[212:215], a[116:119]
v_mfma_f32_16x16x32_bf16 a[112:115], v[244:247], a[208:211], a[112:115]
s_waitcnt lgkmcnt(6)
v_mfma_f32_16x16x32_bf16 a[128:131], a[240:243], a[208:211], a[128:131]
s_add_u32 m0, s61, 53248
ds_read_b64_tr_b16 v[240:241], v235 offset:0
v_mfma_f32_16x16x32_bf16 a[132:135], a[240:243], a[212:215], a[132:135]
ds_read_b64_tr_b16 v[242:243], v235 offset:4608
v_mfma_f32_16x16x32_bf16 a[136:139], a[240:243], a[216:219], a[136:139]
buffer_load_dwordx4 v233, s[16:19], s55 offen offset:0 lds
v_mfma_f32_16x16x32_bf16 a[140:143], a[240:243], a[220:223], a[140:143]
s_waitcnt lgkmcnt(6)
v_mfma_f32_16x16x32_bf16 a[156:159], a[244:247], a[220:223], a[156:159]
s_add_u32 s55, s55, 524288
ds_read_b64_tr_b16 v[244:245], v235 offset:9216
v_mfma_f32_16x16x32_bf16 a[152:155], a[244:247], a[216:219], a[152:155]
ds_read_b64_tr_b16 v[246:247], v235 offset:13824
v_mfma_f32_16x16x32_bf16 a[148:151], a[244:247], a[212:215], a[148:151]
v_mfma_f32_16x16x32_bf16 a[144:147], a[244:247], a[208:211], a[144:147]
s_waitcnt lgkmcnt(6)
v_mfma_f32_16x16x32_bf16 a[160:163], a[248:251], a[208:211], a[160:163]
ds_read_b64_tr_b16 a[240:241], v235 offset:18432
v_mfma_f32_16x16x32_bf16 a[164:167], a[248:251], a[212:215], a[164:167]
ds_read_b64_tr_b16 a[242:243], v235 offset:23040
v_mfma_f32_16x16x32_bf16 a[168:171], a[248:251], a[216:219], a[168:171]
buffer_load_dwordx4 v233, s[16:19], s56 offen offset:1024 lds
v_mfma_f32_16x16x32_bf16 a[172:175], a[248:251], a[220:223], a[172:175]
s_waitcnt lgkmcnt(6)
v_mfma_f32_16x16x32_bf16 a[188:191], a[252:255], a[220:223], a[188:191]
s_add_u32 s56, s56, 524288
ds_read_b64_tr_b16 a[244:245], v235 offset:27648
v_mfma_f32_16x16x32_bf16 a[184:187], a[252:255], a[216:219], a[184:187]
ds_read_b64_tr_b16 a[246:247], v235 offset:32256
v_mfma_f32_16x16x32_bf16 a[180:183], a[252:255], a[212:215], a[180:183]
s_waitcnt vmcnt(6)
v_mfma_f32_16x16x32_bf16 a[176:179], a[252:255], a[208:211], a[176:179]
s_waitcnt lgkmcnt(4)
v_mfma_f32_16x16x32_bf16 v[0:3], v[240:243], a[208:211], v[0:3]
ds_read_b64_tr_b16 a[248:249], v235 offset:32
v_mfma_f32_16x16x32_bf16 v[0:3], v[244:247], a[224:227], v[0:3]
ds_read_b64_tr_b16 a[250:251], v235 offset:4640
v_mfma_f32_16x16x32_bf16 v[4:7], v[244:247], a[228:231], v[4:7]
ds_read_b64_tr_b16 a[252:253], v235 offset:9248
v_mfma_f32_16x16x32_bf16 v[4:7], v[240:243], a[212:215], v[4:7]
s_waitcnt lgkmcnt(7)
ds_read_b64_tr_b16 a[254:255], v235 offset:13856
v_mfma_f32_16x16x32_bf16 v[8:11], v[240:243], a[216:219], v[8:11]
buffer_load_dwordx4 v233, s[16:19], s57 offen offset:2048 lds
v_mfma_f32_16x16x32_bf16 v[8:11], v[244:247], a[232:235], v[8:11]
s_add_u32 s57, s57, 524288
v_mfma_f32_16x16x32_bf16 v[12:15], v[244:247], a[236:239], v[12:15]
v_mfma_f32_16x16x32_bf16 v[12:15], v[240:243], a[220:223], v[12:15]
s_waitcnt lgkmcnt(4)
v_mfma_f32_16x16x32_bf16 v[28:31], a[240:243], a[220:223], v[28:31]
ds_read_b64_tr_b16 v[240:241], v235 offset:18464
v_mfma_f32_16x16x32_bf16 v[28:31], a[244:247], a[236:239], v[28:31]
ds_read_b64_tr_b16 v[242:243], v235 offset:23072
v_mfma_f32_16x16x32_bf16 v[24:27], a[244:247], a[232:235], v[24:27]
ds_read_b64_tr_b16 v[244:245], v235 offset:27680
v_mfma_f32_16x16x32_bf16 v[24:27], a[240:243], a[216:219], v[24:27]
s_waitcnt lgkmcnt(7)
ds_read_b64_tr_b16 v[246:247], v235 offset:32288
v_mfma_f32_16x16x32_bf16 v[20:23], a[240:243], a[212:215], v[20:23]
buffer_load_dwordx4 v233, s[16:19], s58 offen offset:3072 lds
v_mfma_f32_16x16x32_bf16 v[20:23], a[244:247], a[228:231], v[20:23]
s_add_u32 s58, s58, 524288
v_mfma_f32_16x16x32_bf16 v[16:19], a[244:247], a[224:227], v[16:19]
v_mfma_f32_16x16x32_bf16 v[16:19], a[240:243], a[208:211], v[16:19]
s_waitcnt lgkmcnt(4)
v_mfma_f32_16x16x32_bf16 v[32:35], a[248:251], a[208:211], v[32:35]
ds_read_b64_tr_b16 a[240:241], v235 offset:64
v_mfma_f32_16x16x32_bf16 v[32:35], a[252:255], a[224:227], v[32:35]
ds_read_b64_tr_b16 a[242:243], v235 offset:4672
v_mfma_f32_16x16x32_bf16 v[36:39], a[252:255], a[228:231], v[36:39]
ds_read_b64_tr_b16 a[244:245], v235 offset:9280
v_mfma_f32_16x16x32_bf16 v[36:39], a[248:251], a[212:215], v[36:39]
s_waitcnt lgkmcnt(7)
ds_read_b64_tr_b16 a[246:247], v235 offset:13888
v_mfma_f32_16x16x32_bf16 v[40:43], a[248:251], a[216:219], v[40:43]
s_add_u32 m0, s60, 53248
v_mfma_f32_16x16x32_bf16 v[40:43], a[252:255], a[232:235], v[40:43]
buffer_load_dwordx4 v224, s[12:15], s54 offen offset:0 lds
v_mfma_f32_16x16x32_bf16 v[44:47], a[252:255], a[236:239], v[44:47]
v_mfma_f32_16x16x32_bf16 v[44:47], a[248:251], a[220:223], v[44:47]
s_waitcnt lgkmcnt(4)
v_mfma_f32_16x16x32_bf16 v[60:63], v[240:243], a[220:223], v[60:63]
ds_read_b64_tr_b16 a[248:249], v235 offset:18496
v_mfma_f32_16x16x32_bf16 v[60:63], v[244:247], a[236:239], v[60:63]
ds_read_b64_tr_b16 a[250:251], v235 offset:23104
v_mfma_f32_16x16x32_bf16 v[56:59], v[244:247], a[232:235], v[56:59]
ds_read_b64_tr_b16 a[252:253], v235 offset:27712
v_mfma_f32_16x16x32_bf16 v[56:59], v[240:243], a[216:219], v[56:59]
s_waitcnt lgkmcnt(7)
ds_read_b64_tr_b16 a[254:255], v235 offset:32320
v_mfma_f32_16x16x32_bf16 v[52:55], v[240:243], a[212:215], v[52:55]
v_mfma_f32_16x16x32_bf16 v[52:55], v[244:247], a[228:231], v[52:55]
buffer_load_dwordx4 v225, s[12:15], s54 offen offset:1024 lds
v_mfma_f32_16x16x32_bf16 v[48:51], v[244:247], a[224:227], v[48:51]
v_mfma_f32_16x16x32_bf16 v[48:51], v[240:243], a[208:211], v[48:51]
s_waitcnt lgkmcnt(4)
v_mfma_f32_16x16x32_bf16 v[64:67], a[240:243], a[208:211], v[64:67]
ds_read_b64_tr_b16 v[240:241], v235 offset:96
v_mfma_f32_16x16x32_bf16 v[64:67], a[244:247], a[224:227], v[64:67]
ds_read_b64_tr_b16 v[242:243], v235 offset:4704
v_mfma_f32_16x16x32_bf16 v[68:71], a[244:247], a[228:231], v[68:71]
ds_read_b64_tr_b16 v[244:245], v235 offset:9312
v_mfma_f32_16x16x32_bf16 v[68:71], a[240:243], a[212:215], v[68:71]
s_waitcnt lgkmcnt(7)
ds_read_b64_tr_b16 v[246:247], v235 offset:13920
v_mfma_f32_16x16x32_bf16 v[72:75], a[240:243], a[216:219], v[72:75]
v_mfma_f32_16x16x32_bf16 v[72:75], a[244:247], a[232:235], v[72:75]
buffer_load_dwordx4 v226, s[12:15], s54 offen offset:2048 lds
v_mfma_f32_16x16x32_bf16 v[76:79], a[244:247], a[236:239], v[76:79]
v_mfma_f32_16x16x32_bf16 v[76:79], a[240:243], a[220:223], v[76:79]
s_waitcnt lgkmcnt(4)
v_mfma_f32_16x16x32_bf16 v[92:95], a[248:251], a[220:223], v[92:95]
ds_read_b64_tr_b16 a[240:241], v235 offset:18528
v_mfma_f32_16x16x32_bf16 v[92:95], a[252:255], a[236:239], v[92:95]
ds_read_b64_tr_b16 a[242:243], v235 offset:23136
v_mfma_f32_16x16x32_bf16 v[88:91], a[252:255], a[232:235], v[88:91]
ds_read_b64_tr_b16 a[244:245], v235 offset:27744
v_mfma_f32_16x16x32_bf16 v[88:91], a[248:251], a[216:219], v[88:91]
s_waitcnt lgkmcnt(7)
ds_read_b64_tr_b16 a[246:247], v235 offset:32352
v_mfma_f32_16x16x32_bf16 v[84:87], a[248:251], a[212:215], v[84:87]
v_mfma_f32_16x16x32_bf16 v[84:87], a[252:255], a[228:231], v[84:87]
buffer_load_dwordx4 v227, s[12:15], s54 offen offset:3072 lds
v_mfma_f32_16x16x32_bf16 v[80:83], a[252:255], a[224:227], v[80:83]
v_mfma_f32_16x16x32_bf16 v[80:83], a[248:251], a[208:211], v[80:83]
s_waitcnt lgkmcnt(4)
v_mfma_f32_16x16x32_bf16 v[96:99], v[240:243], a[208:211], v[96:99]
ds_read_b64_tr_b16 a[248:249], v235 offset:128
v_mfma_f32_16x16x32_bf16 v[96:99], v[244:247], a[224:227], v[96:99]
ds_read_b64_tr_b16 a[250:251], v235 offset:4736
v_mfma_f32_16x16x32_bf16 v[100:103], v[244:247], a[228:231], v[100:103]
ds_read_b64_tr_b16 a[252:253], v235 offset:9344
v_mfma_f32_16x16x32_bf16 v[100:103], v[240:243], a[212:215], v[100:103]
s_waitcnt lgkmcnt(7)
ds_read_b64_tr_b16 a[254:255], v235 offset:13952
v_mfma_f32_16x16x32_bf16 v[104:107], v[240:243], a[216:219], v[104:107]
v_mfma_f32_16x16x32_bf16 v[104:107], v[244:247], a[232:235], v[104:107]
s_add_u32 m0, s60, 57344
v_mfma_f32_16x16x32_bf16 v[108:111], v[244:247], a[236:239], v[108:111]
buffer_load_dwordx4 v228, s[12:15], s54 offen offset:0 lds
v_mfma_f32_16x16x32_bf16 v[108:111], v[240:243], a[220:223], v[108:111]
s_waitcnt lgkmcnt(4)
v_mfma_f32_16x16x32_bf16 v[124:127], a[240:243], a[220:223], v[124:127]
ds_read_b64_tr_b16 v[240:241], v235 offset:18560
v_mfma_f32_16x16x32_bf16 v[124:127], a[244:247], a[236:239], v[124:127]
ds_read_b64_tr_b16 v[242:243], v235 offset:23168
v_mfma_f32_16x16x32_bf16 v[120:123], a[244:247], a[232:235], v[120:123]
ds_read_b64_tr_b16 v[244:245], v235 offset:27776
v_mfma_f32_16x16x32_bf16 v[120:123], a[240:243], a[216:219], v[120:123]
s_waitcnt lgkmcnt(7)
ds_read_b64_tr_b16 v[246:247], v235 offset:32384
v_mfma_f32_16x16x32_bf16 v[116:119], a[240:243], a[212:215], v[116:119]
v_mfma_f32_16x16x32_bf16 v[116:119], a[244:247], a[228:231], v[116:119]
v_mfma_f32_16x16x32_bf16 v[112:115], a[244:247], a[224:227], v[112:115]
buffer_load_dwordx4 v229, s[12:15], s54 offen offset:1024 lds
v_mfma_f32_16x16x32_bf16 v[112:115], a[240:243], a[208:211], v[112:115]
s_waitcnt lgkmcnt(4)
v_mfma_f32_16x16x32_bf16 v[128:131], a[248:251], a[208:211], v[128:131]
ds_read_b64_tr_b16 a[240:241], v235 offset:160
v_mfma_f32_16x16x32_bf16 v[128:131], a[252:255], a[224:227], v[128:131]
ds_read_b64_tr_b16 a[242:243], v235 offset:4768
v_mfma_f32_16x16x32_bf16 v[132:135], a[252:255], a[228:231], v[132:135]
ds_read_b64_tr_b16 a[244:245], v235 offset:9376
v_mfma_f32_16x16x32_bf16 v[132:135], a[248:251], a[212:215], v[132:135]
s_waitcnt lgkmcnt(7)
ds_read_b64_tr_b16 a[246:247], v235 offset:13984
v_mfma_f32_16x16x32_bf16 v[136:139], a[248:251], a[216:219], v[136:139]
v_mfma_f32_16x16x32_bf16 v[136:139], a[252:255], a[232:235], v[136:139]
v_mfma_f32_16x16x32_bf16 v[140:143], a[252:255], a[236:239], v[140:143]
buffer_load_dwordx4 v230, s[12:15], s54 offen offset:2048 lds
v_mfma_f32_16x16x32_bf16 v[140:143], a[248:251], a[220:223], v[140:143]
s_waitcnt lgkmcnt(4)
v_mfma_f32_16x16x32_bf16 v[156:159], v[240:243], a[220:223], v[156:159]
ds_read_b64_tr_b16 a[248:249], v235 offset:18592
v_mfma_f32_16x16x32_bf16 v[156:159], v[244:247], a[236:239], v[156:159]
ds_read_b64_tr_b16 a[250:251], v235 offset:23200
v_mfma_f32_16x16x32_bf16 v[152:155], v[244:247], a[232:235], v[152:155]
ds_read_b64_tr_b16 a[252:253], v235 offset:27808
v_mfma_f32_16x16x32_bf16 v[152:155], v[240:243], a[216:219], v[152:155]
s_waitcnt lgkmcnt(7)
ds_read_b64_tr_b16 a[254:255], v235 offset:32416
v_mfma_f32_16x16x32_bf16 v[148:151], v[240:243], a[212:215], v[148:151]
v_mfma_f32_16x16x32_bf16 v[148:151], v[244:247], a[228:231], v[148:151]
v_mfma_f32_16x16x32_bf16 v[144:147], v[244:247], a[224:227], v[144:147]
buffer_load_dwordx4 v231, s[12:15], s54 offen offset:3072 lds
v_mfma_f32_16x16x32_bf16 v[144:147], v[240:243], a[208:211], v[144:147]
s_waitcnt lgkmcnt(4)
v_mfma_f32_16x16x32_bf16 v[160:163], a[240:243], a[208:211], v[160:163]
ds_read_b64_tr_b16 v[240:241], v235 offset:192
v_mfma_f32_16x16x32_bf16 v[160:163], a[244:247], a[224:227], v[160:163]
ds_read_b64_tr_b16 v[242:243], v235 offset:4800
v_mfma_f32_16x16x32_bf16 v[164:167], a[244:247], a[228:231], v[164:167]
ds_read_b64_tr_b16 v[244:245], v235 offset:9408
v_mfma_f32_16x16x32_bf16 v[164:167], a[240:243], a[212:215], v[164:167]
s_waitcnt lgkmcnt(7)
ds_read_b64_tr_b16 v[246:247], v235 offset:14016
v_mfma_f32_16x16x32_bf16 v[168:171], a[240:243], a[216:219], v[168:171]
v_mfma_f32_16x16x32_bf16 v[168:171], a[244:247], a[232:235], v[168:171]
v_mfma_f32_16x16x32_bf16 v[172:175], a[244:247], a[236:239], v[172:175]
s_add_u32 m0, s60, 61440
v_mfma_f32_16x16x32_bf16 v[172:175], a[240:243], a[220:223], v[172:175]
s_waitcnt lgkmcnt(4)
buffer_load_dwordx4 v232, s[12:15], s54 offen offset:0 lds
v_mfma_f32_16x16x32_bf16 v[188:191], a[248:251], a[220:223], v[188:191]
s_add_u32 s54, s54, 589824
ds_read_b64_tr_b16 a[240:241], v235 offset:18624
v_mfma_f32_16x16x32_bf16 v[188:191], a[252:255], a[236:239], v[188:191]
ds_read_b64_tr_b16 a[242:243], v235 offset:23232
v_mfma_f32_16x16x32_bf16 v[184:187], a[252:255], a[232:235], v[184:187]
ds_read_b64_tr_b16 a[244:245], v235 offset:27840
v_mfma_f32_16x16x32_bf16 v[184:187], a[248:251], a[216:219], v[184:187]
s_waitcnt lgkmcnt(7)
ds_read_b64_tr_b16 a[246:247], v235 offset:32448
v_mfma_f32_16x16x32_bf16 v[180:183], a[248:251], a[212:215], v[180:183]
v_mfma_f32_16x16x32_bf16 v[180:183], a[252:255], a[228:231], v[180:183]
v_mfma_f32_16x16x32_bf16 v[176:179], a[252:255], a[224:227], v[176:179]
v_mfma_f32_16x16x32_bf16 v[176:179], a[248:251], a[208:211], v[176:179]
s_waitcnt lgkmcnt(4)
v_mfma_f32_16x16x32_bf16 v[192:195], v[240:243], a[208:211], v[192:195]
ds_read_b64_tr_b16 a[248:249], v235 offset:224
v_mfma_f32_16x16x32_bf16 v[192:195], v[244:247], a[224:227], v[192:195]
ds_read_b64_tr_b16 a[250:251], v235 offset:4832
v_mfma_f32_16x16x32_bf16 v[196:199], v[244:247], a[228:231], v[196:199]
ds_read_b64_tr_b16 a[252:253], v235 offset:9440
v_mfma_f32_16x16x32_bf16 v[196:199], v[240:243], a[212:215], v[196:199]
s_waitcnt lgkmcnt(7)
ds_read_b64_tr_b16 a[254:255], v235 offset:14048
v_mfma_f32_16x16x32_bf16 v[200:203], v[240:243], a[216:219], v[200:203]
v_mfma_f32_16x16x32_bf16 v[200:203], v[244:247], a[232:235], v[200:203]
v_mfma_f32_16x16x32_bf16 v[204:207], v[244:247], a[236:239], v[204:207]
v_mfma_f32_16x16x32_bf16 v[204:207], v[240:243], a[220:223], v[204:207]
s_waitcnt lgkmcnt(4)
v_mfma_f32_16x16x32_bf16 v[220:223], a[240:243], a[220:223], v[220:223]
ds_read_b64_tr_b16 v[240:241], v235 offset:18656
v_mfma_f32_16x16x32_bf16 v[220:223], a[244:247], a[236:239], v[220:223]
ds_read_b64_tr_b16 v[242:243], v235 offset:23264
v_mfma_f32_16x16x32_bf16 v[216:219], a[244:247], a[232:235], v[216:219]
ds_read_b64_tr_b16 v[244:245], v235 offset:27872
v_mfma_f32_16x16x32_bf16 v[216:219], a[240:243], a[216:219], v[216:219]
s_waitcnt lgkmcnt(7)
ds_read_b64_tr_b16 v[246:247], v235 offset:32480
v_mfma_f32_16x16x32_bf16 v[212:215], a[240:243], a[212:215], v[212:215]
v_mfma_f32_16x16x32_bf16 v[212:215], a[244:247], a[228:231], v[212:215]
v_mfma_f32_16x16x32_bf16 v[208:211], a[244:247], a[224:227], v[208:211]
v_mfma_f32_16x16x32_bf16 v[208:211], a[240:243], a[208:211], v[208:211]
s_waitcnt lgkmcnt(4)
v_mfma_f32_16x16x32_bf16 a[0:3], a[248:251], a[208:211], a[0:3]
ds_read_b64_tr_b16 a[240:241], v235 offset:256
v_mfma_f32_16x16x32_bf16 a[0:3], a[252:255], a[224:227], a[0:3]
ds_read_b64_tr_b16 a[242:243], v235 offset:4864
v_mfma_f32_16x16x32_bf16 a[4:7], a[252:255], a[228:231], a[4:7]
ds_read_b64_tr_b16 a[244:245], v235 offset:9472
v_mfma_f32_16x16x32_bf16 a[4:7], a[248:251], a[212:215], a[4:7]
s_waitcnt lgkmcnt(7)
ds_read_b64_tr_b16 a[246:247], v235 offset:14080
v_mfma_f32_16x16x32_bf16 a[8:11], a[248:251], a[216:219], a[8:11]
v_mfma_f32_16x16x32_bf16 a[8:11], a[252:255], a[232:235], a[8:11]
v_mfma_f32_16x16x32_bf16 a[12:15], a[252:255], a[236:239], a[12:15]
v_mfma_f32_16x16x32_bf16 a[12:15], a[248:251], a[220:223], a[12:15]
s_waitcnt lgkmcnt(4)
v_mfma_f32_16x16x32_bf16 a[28:31], v[240:243], a[220:223], a[28:31]
ds_read_b64_tr_b16 a[248:249], v235 offset:18688
v_mfma_f32_16x16x32_bf16 a[28:31], v[244:247], a[236:239], a[28:31]
ds_read_b64_tr_b16 a[250:251], v235 offset:23296
v_mfma_f32_16x16x32_bf16 a[24:27], v[244:247], a[232:235], a[24:27]
ds_read_b64_tr_b16 a[252:253], v235 offset:27904
v_mfma_f32_16x16x32_bf16 a[24:27], v[240:243], a[216:219], a[24:27]
s_waitcnt lgkmcnt(7)
ds_read_b64_tr_b16 a[254:255], v235 offset:32512
v_add_u32 v235, 0xfffe6000, v235
v_mfma_f32_16x16x32_bf16 a[20:23], v[240:243], a[212:215], a[20:23]
s_waitcnt vmcnt(17)
ds_add_u32 v251, v253
v_mfma_f32_16x16x32_bf16 a[20:23], v[244:247], a[228:231], a[20:23]
v_mfma_f32_16x16x32_bf16 a[16:19], v[244:247], a[224:227], a[16:19]
v_mfma_f32_16x16x32_bf16 a[16:19], v[240:243], a[208:211], a[16:19]
s_waitcnt lgkmcnt(5)
v_mfma_f32_16x16x32_bf16 a[32:35], a[240:243], a[208:211], a[32:35]
ds_read_b64_tr_b16 v[240:241], v236 offset:45056
v_mfma_f32_16x16x32_bf16 a[32:35], a[244:247], a[224:227], a[32:35]
ds_read_b64_tr_b16 v[242:243], v236 offset:49152
v_mfma_f32_16x16x32_bf16 a[36:39], a[244:247], a[228:231], a[36:39]
ds_read_b64_tr_b16 v[244:245], v236 offset:45064
v_mfma_f32_16x16x32_bf16 a[36:39], a[240:243], a[212:215], a[36:39]
s_waitcnt lgkmcnt(8)
ds_read_b64_tr_b16 v[246:247], v236 offset:49160
v_add_u32 v236, 0xfffe6000, v236
v_mfma_f32_16x16x32_bf16 a[40:43], a[240:243], a[216:219], a[40:43]
v_mfma_f32_16x16x32_bf16 a[40:43], a[244:247], a[232:235], a[40:43]
v_mfma_f32_16x16x32_bf16 a[44:47], a[244:247], a[236:239], a[44:47]
v_mfma_f32_16x16x32_bf16 a[44:47], a[240:243], a[220:223], a[44:47]
s_waitcnt lgkmcnt(5)
v_mfma_f32_16x16x32_bf16 a[60:63], a[248:251], a[220:223], a[60:63]
ds_read_b64_tr_b16 a[240:241], v237 offset:45056
v_mfma_f32_16x16x32_bf16 a[60:63], a[252:255], a[236:239], a[60:63]
ds_read_b64_tr_b16 a[242:243], v237 offset:49152
v_mfma_f32_16x16x32_bf16 a[56:59], a[252:255], a[232:235], a[56:59]
ds_read_b64_tr_b16 a[244:245], v237 offset:45064
v_mfma_f32_16x16x32_bf16 a[56:59], a[248:251], a[216:219], a[56:59]
s_waitcnt lgkmcnt(8)
ds_read_b64_tr_b16 a[246:247], v237 offset:49160
v_add_u32 v237, 0xfffe6000, v237
v_mfma_f32_16x16x32_bf16 a[52:55], a[248:251], a[212:215], a[52:55]
v_mfma_f32_16x16x32_bf16 a[52:55], a[252:255], a[228:231], a[52:55]
v_mfma_f32_16x16x32_bf16 a[48:51], a[252:255], a[224:227], a[48:51]
v_mfma_f32_16x16x32_bf16 a[48:51], a[248:251], a[208:211], a[48:51]
s_waitcnt lgkmcnt(6)
v_mfma_f32_16x16x32_bf16 a[64:67], v[240:243], a[224:227], a[64:67]
ds_read_b64_tr_b16 a[248:249], v238 offset:45056
v_mfma_f32_16x16x32_bf16 a[68:71], v[240:243], a[228:231], a[68:71]
ds_read_b64_tr_b16 a[250:251], v238 offset:49152
v_mfma_f32_16x16x32_bf16 a[72:75], v[240:243], a[232:235], a[72:75]
ds_read_b32 v255, v252
v_mfma_f32_16x16x32_bf16 a[76:79], v[240:243], a[236:239], a[76:79]
s_waitcnt lgkmcnt(7)
buffer_load_dwordx4 a[208:211], v254, s[8:11], s59 offen offset:0 sc1
v_mfma_f32_16x16x32_bf16 a[92:95], v[244:247], a[236:239], a[92:95]
ds_read_b64_tr_b16 a[252:253], v238 offset:45064
v_mfma_f32_16x16x32_bf16 a[88:91], v[244:247], a[232:235], a[88:91]
ds_read_b64_tr_b16 a[254:255], v238 offset:49160
v_add_u32 v238, 0xfffe6000, v238
v_mfma_f32_16x16x32_bf16 a[84:87], v[244:247], a[228:231], a[84:87]
buffer_load_dwordx4 a[212:215], v254, s[8:11], s59 offen offset:1024 sc1
v_mfma_f32_16x16x32_bf16 a[80:83], v[244:247], a[224:227], a[80:83]
s_waitcnt lgkmcnt(7)
buffer_load_dwordx4 a[216:219], v254, s[8:11], s59 offen offset:2048 sc1
v_mfma_f32_16x16x32_bf16 a[96:99], a[240:243], a[224:227], a[96:99]
ds_read_b64_tr_b16 v[240:241], v239 offset:45056
v_mfma_f32_16x16x32_bf16 a[100:103], a[240:243], a[228:231], a[100:103]
ds_read_b64_tr_b16 v[242:243], v239 offset:49152
v_mfma_f32_16x16x32_bf16 a[104:107], a[240:243], a[232:235], a[104:107]
buffer_load_dwordx4 a[220:223], v254, s[8:11], s59 offen offset:3072 sc1
v_mfma_f32_16x16x32_bf16 a[108:111], a[240:243], a[236:239], a[108:111]
s_waitcnt lgkmcnt(4)
v_mfma_f32_16x16x32_bf16 a[124:127], a[244:247], a[236:239], a[124:127]
s_add_u32 s59, s59, 4096
ds_read_b64_tr_b16 v[244:245], v239 offset:45064
v_cmp_gt_u32 vcc, 11, v255
v_mfma_f32_16x16x32_bf16 a[120:123], a[244:247], a[232:235], a[120:123]
ds_read_b64_tr_b16 v[246:247], v239 offset:49160
v_add_u32 v239, 0xfffe6000, v239
v_mfma_f32_16x16x32_bf16 a[116:119], a[244:247], a[228:231], a[116:119]
v_mfma_f32_16x16x32_bf16 a[112:115], a[244:247], a[224:227], a[112:115]
s_waitcnt lgkmcnt(6)
v_mfma_f32_16x16x32_bf16 a[128:131], a[248:251], a[224:227], a[128:131]
s_cbranch_vccnz k1_g11_s
k1_g11_b:
ds_read_b64_tr_b16 a[240:241], v236 offset:36864
v_mfma_f32_16x16x32_bf16 a[132:135], a[248:251], a[228:231], a[132:135]
ds_read_b64_tr_b16 a[242:243], v236 offset:40960
v_mfma_f32_16x16x32_bf16 a[136:139], a[248:251], a[232:235], a[136:139]
ds_add_u32 v251, v253
v_mfma_f32_16x16x32_bf16 a[140:143], a[248:251], a[236:239], a[140:143]
s_waitcnt lgkmcnt(7)
v_mfma_f32_16x16x32_bf16 a[156:159], a[252:255], a[236:239], a[156:159]
ds_read_b64_tr_b16 a[244:245], v236 offset:36872
v_mfma_f32_16x16x32_bf16 a[152:155], a[252:255], a[232:235], a[152:155]
ds_read_b64_tr_b16 a[246:247], v236 offset:40968
v_mfma_f32_16x16x32_bf16 a[148:151], a[252:255], a[228:231], a[148:151]
v_mfma_f32_16x16x32_bf16 a[144:147], a[252:255], a[224:227], a[144:147]
s_waitcnt lgkmcnt(7)
v_mfma_f32_16x16x32_bf16 a[160:163], v[240:243], a[224:227], a[160:163]
ds_read_b64_tr_b16 a[248:249], v237 offset:36864
v_mfma_f32_16x16x32_bf16 a[164:167], v[240:243], a[228:231], a[164:167]
ds_read_b64_tr_b16 a[250:251], v237 offset:40960
v_mfma_f32_16x16x32_bf16 a[168:171], v[240:243], a[232:235], a[168:171]
v_mfma_f32_16x16x32_bf16 a[172:175], v[240:243], a[236:239], a[172:175]
s_waitcnt lgkmcnt(7)
v_mfma_f32_16x16x32_bf16 a[188:191], v[244:247], a[236:239], a[188:191]
ds_read_b64_tr_b16 a[252:253], v237 offset:36872
v_mfma_f32_16x16x32_bf16 a[184:187], v[244:247], a[232:235], a[184:187]
ds_read_b64_tr_b16 a[254:255], v237 offset:40968
v_mfma_f32_16x16x32_bf16 a[180:183], v[244:247], a[228:231], a[180:183]
s_waitcnt vmcnt(17)
v_mfma_f32_16x16x32_bf16 a[176:179], v[244:247], a[224:227], a[176:179]
s_waitcnt lgkmcnt(7)
v_mfma_f32_16x16x32_bf16 a[64:67], a[240:243], a[192:195], a[64:67]
ds_read_b64_tr_b16 v[240:241], v238 offset:36864
ds_read_b32 v255, v252
v_mfma_f32_16x16x32_bf16 a[68:71], a[240:243], a[196:199], a[68:71]
ds_read_b64_tr_b16 v[242:243], v238 offset:40960
v_mfma_f32_16x16x32_bf16 a[72:75], a[240:243], a[200:203], a[72:75]
buffer_load_dwordx4 a[224:227], v254, s[8:11], s59 offen offset:0 sc1
v_mfma_f32_16x16x32_bf16 a[76:79], a[240:243], a[204:207], a[76:79]
s_waitcnt lgkmcnt(7)
buffer_load_dwordx4 a[228:231], v254, s[8:11], s59 offen offset:1024 sc1
v_mfma_f32_16x16x32_bf16 a[92:95], a[244:247], a[204:207], a[92:95]
ds_read_b64_tr_b16 v[244:245], v238 offset:36872
v_mfma_f32_16x16x32_bf16 a[88:91], a[244:247], a[200:203], a[88:91]
ds_read_b64_tr_b16 v[246:247], v238 offset:40968
v_mfma_f32_16x16x32_bf16 a[84:87], a[244:247], a[196:199], a[84:87]
buffer_load_dwordx4 a[232:235], v254, s[8:11], s59 offen offset:2048 sc1
v_mfma_f32_16x16x32_bf16 a[80:83], a[244:247], a[192:195], a[80:83]
s_waitcnt lgkmcnt(3)
buffer_load_dwordx4 a[236:239], v254, s[8:11], s59 offen offset:3072 sc1
v_mfma_f32_16x16x32_bf16 a[96:99], a[248:251], a[192:195], a[96:99]
s_add_u32 s59, s59, 4096
ds_read_b64_tr_b16 a[240:241], v239 offset:36864
v_cmp_gt_u32 vcc, 12, v255
v_mfma_f32_16x16x32_bf16 a[100:103], a[248:251], a[196:199], a[100:103]
ds_read_b64_tr_b16 a[242:243], v239 offset:40960
v_mfma_f32_16x16x32_bf16 a[104:107], a[248:251], a[200:203], a[104:107]
v_mfma_f32_16x16x32_bf16 a[108:111], a[248:251], a[204:207], a[108:111]
s_waitcnt lgkmcnt(5)
v_mfma_f32_16x16x32_bf16 a[124:127], a[252:255], a[204:207], a[124:127]
s_cbranch_vccnz k1_g12_s
k1_g12_b:
ds_read_b64_tr_b16 a[244:245], v239 offset:36872
v_mfma_f32_16x16x32_bf16 a[120:123], a[252:255], a[200:203], a[120:123]
ds_read_b64_tr_b16 a[246:247], v239 offset:40968
v_mfma_f32_16x16x32_bf16 a[116:119], a[252:255], a[196:199], a[116:119]
v_mfma_f32_16x16x32_bf16 a[112:115], a[252:255], a[192:195], a[112:115]
s_waitcnt lgkmcnt(6)
v_mfma_f32_16x16x32_bf16 a[128:131], v[240:243], a[192:195], a[128:131]
s_add_u32 m0, s61, 106496
ds_read_b64_tr_b16 a[248:249], v235 offset:0
v_mfma_f32_16x16x32_bf16 a[132:135], v[240:243], a[196:199], a[132:135]
ds_read_b64_tr_b16 a[250:251], v235 offset:4608
v_mfma_f32_16x16x32_bf16 a[136:139], v[240:243], a[200:203], a[136:139]
buffer_load_dwordx4 v233, s[16:19], s55 offen offset:0 lds
v_mfma_f32_16x16x32_bf16 a[140:143], v[240:243], a[204:207], a[140:143]
s_waitcnt lgkmcnt(6)
v_mfma_f32_16x16x32_bf16 a[156:159], v[244:247], a[204:207], a[156:159]
s_add_u32 s55, s55, 524288
ds_read_b64_tr_b16 a[252:253], v235 offset:9216
v_mfma_f32_16x16x32_bf16 a[152:155], v[244:247], a[200:203], a[152:155]
ds_read_b64_tr_b16 a[254:255], v235 offset:13824
v_mfma_f32_16x16x32_bf16 a[148:151], v[244:247], a[196:199], a[148:151]
v_mfma_f32_16x16x32_bf16 a[144:147], v[244:247], a[192:195], a[144:147]
s_waitcnt lgkmcnt(6)
v_mfma_f32_16x16x32_bf16 a[160:163], a[240:243], a[192:195], a[160:163]
ds_read_b64_tr_b16 v[240:241], v235 offset:18432
v_mfma_f32_16x16x32_bf16 a[164:167], a[240:243], a[196:199], a[164:167]
ds_read_b64_tr_b16 v[242:243], v235 offset:23040
v_mfma_f32_16x16x32_bf16 a[168:171], a[240:243], a[200:203], a[168:171]
buffer_load_dwordx4 v233, s[16:19], s56 offen offset:1024 lds
v_mfma_f32_16x16x32_bf16 a[172:175], a[240:243], a[204:207], a[172:175]
s_waitcnt lgkmcnt(6)
v_mfma_f32_16x16x32_bf16 a[188:191], a[244:247], a[204:207], a[188:191]
s_add_u32 s56, s56, 524288
ds_read_b64_tr_b16 v[244:245], v235 offset:27648
v_mfma_f32_16x16x32_bf16 a[184:187], a[244:247], a[200:203], a[184:187]
ds_read_b64_tr_b16 v[246:247], v235 offset:32256
v_mfma_f32_16x16x32_bf16 a[180:183], a[244:247], a[196:199], a[180:183]
s_waitcnt vmcnt(6)
v_mfma_f32_16x16x32_bf16 a[176:179], a[244:247], a[192:195], a[176:179]
s_waitcnt lgkmcnt(4)
v_mfma_f32_16x16x32_bf16 v[0:3], a[248:251], a[192:195], v[0:3]
ds_read_b64_tr_b16 a[240:241], v235 offset:32
v_mfma_f32_16x16x32_bf16 v[0:3], a[252:255], a[208:211], v[0:3]
ds_read_b64_tr_b16 a[242:243], v235 offset:4640
v_mfma_f32_16x16x32_bf16 v[4:7], a[252:255], a[212:215], v[4:7]
ds_read_b64_tr_b16 a[244:245], v235 offset:9248
v_mfma_f32_16x16x32_bf16 v[4:7], a[248:251], a[196:199], v[4:7]
s_waitcnt lgkmcnt(7)
ds_read_b64_tr_b16 a[246:247], v235 offset:13856
v_mfma_f32_16x16x32_bf16 v[8:11], a[248:251], a[200:203], v[8:11]
buffer_load_dwordx4 v233, s[16:19], s57 offen offset:2048 lds
v_mfma_f32_16x16x32_bf16 v[8:11], a[252:255], a[216:219], v[8:11]
s_add_u32 s57, s57, 524288
v_mfma_f32_16x16x32_bf16 v[12:15], a[252:255], a[220:223], v[12:15]
v_mfma_f32_16x16x32_bf16 v[12:15], a[248:251], a[204:207], v[12:15]
s_waitcnt lgkmcnt(4)
v_mfma_f32_16x16x32_bf16 v[28:31], v[240:243], a[204:207], v[28:31]
ds_read_b64_tr_b16 a[248:249], v235 offset:18464
v_mfma_f32_16x16x32_bf16 v[28:31], v[244:247], a[220:223], v[28:31]
ds_read_b64_tr_b16 a[250:251], v235 offset:23072
v_mfma_f32_16x16x32_bf16 v[24:27], v[244:247], a[216:219], v[24:27]
ds_read_b64_tr_b16 a[252:253], v235 offset:27680
v_mfma_f32_16x16x32_bf16 v[24:27], v[240:243], a[200:203], v[24:27]
s_waitcnt lgkmcnt(7)
ds_read_b64_tr_b16 a[254:255], v235 offset:32288
v_mfma_f32_16x16x32_bf16 v[20:23], v[240:243], a[196:199], v[20:23]
buffer_load_dwordx4 v233, s[16:19], s58 offen offset:3072 lds
v_mfma_f32_16x16x32_bf16 v[20:23], v[244:247], a[212:215], v[20:23]
s_add_u32 s58, s58, 524288
v_mfma_f32_16x16x32_bf16 v[16:19], v[244:247], a[208:211], v[16:19]
v_mfma_f32_16x16x32_bf16 v[16:19], v[240:243], a[192:195], v[16:19]
s_waitcnt lgkmcnt(4)
v_mfma_f32_16x16x32_bf16 v[32:35], a[240:243], a[192:195], v[32:35]
ds_read_b64_tr_b16 v[240:241], v235 offset:64
v_mfma_f32_16x16x32_bf16 v[32:35], a[244:247], a[208:211], v[32:35]
ds_read_b64_tr_b16 v[242:243], v235 offset:4672
v_mfma_f32_16x16x32_bf16 v[36:39], a[244:247], a[212:215], v[36:39]
ds_read_b64_tr_b16 v[244:245], v235 offset:9280
v_mfma_f32_16x16x32_bf16 v[36:39], a[240:243], a[196:199], v[36:39]
s_waitcnt lgkmcnt(7)
ds_read_b64_tr_b16 v[246:247], v235 offset:13888
v_mfma_f32_16x16x32_bf16 v[40:43], a[240:243], a[200:203], v[40:43]
s_add_u32 m0, s60, 106496
v_mfma_f32_16x16x32_bf16 v[40:43], a[244:247], a[216:219], v[40:43]
buffer_load_dwordx4 v224, s[12:15], s54 offen offset:0 lds
v_mfma_f32_16x16x32_bf16 v[44:47], a[244:247], a[220:223], v[44:47]
v_mfma_f32_16x16x32_bf16 v[44:47], a[240:243], a[204:207], v[44:47]
s_waitcnt lgkmcnt(4)
v_mfma_f32_16x16x32_bf16 v[60:63], a[248:251], a[204:207], v[60:63]
ds_read_b64_tr_b16 a[240:241], v235 offset:18496
v_mfma_f32_16x16x32_bf16 v[60:63], a[252:255], a[220:223], v[60:63]
ds_read_b64_tr_b16 a[242:243], v235 offset:23104
v_mfma_f32_16x16x32_bf16 v[56:59], a[252:255], a[216:219], v[56:59]
ds_read_b64_tr_b16 a[244:245], v235 offset:27712
v_mfma_f32_16x16x32_bf16 v[56:59], a[248:251], a[200:203], v[56:59]
s_waitcnt lgkmcnt(7)
ds_read_b64_tr_b16 a[246:247], v235 offset:32320
v_mfma_f32_16x16x32_bf16 v[52:55], a[248:251], a[196:199], v[52:55]
v_mfma_f32_16x16x32_bf16 v[52:55], a[252:255], a[212:215], v[52:55]
buffer_load_dwordx4 v225, s[12:15], s54 offen offset:1024 lds
v_mfma_f32_16x16x32_bf16 v[48:51], a[252:255], a[208:211], v[48:51]
v_mfma_f32_16x16x32_bf16 v[48:51], a[248:251], a[192:195], v[48:51]
s_waitcnt lgkmcnt(4)
v_mfma_f32_16x16x32_bf16 v[64:67], v[240:243], a[192:195], v[64:67]
ds_read_b64_tr_b16 a[248:249], v235 offset:96
v_mfma_f32_16x16x32_bf16 v[64:67], v[244:247], a[208:211], v[64:67]
ds_read_b64_tr_b16 a[250:251], v235 offset:4704
v_mfma_f32_16x16x32_bf16 v[68:71], v[244:247], a[212:215], v[68:71]
ds_read_b64_tr_b16 a[252:253], v235 offset:9312
v_mfma_f32_16x16x32_bf16 v[68:71], v[240:243], a[196:199], v[68:71]
s_waitcnt lgkmcnt(7)
ds_read_b64_tr_b16 a[254:255], v235 offset:13920
v_mfma_f32_16x16x32_bf16 v[72:75], v[240:243], a[200:203], v[72:75]
v_mfma_f32_16x16x32_bf16 v[72:75], v[244:247], a[216:219], v[72:75]
buffer_load_dwordx4 v226, s[12:15], s54 offen offset:2048 lds
v_mfma_f32_16x16x32_bf16 v[76:79], v[244:247], a[220:223], v[76:79]
v_mfma_f32_16x16x32_bf16 v[76:79], v[240:243], a[204:207], v[76:79]
s_waitcnt lgkmcnt(4)
v_mfma_f32_16x16x32_bf16 v[92:95], a[240:243], a[204:207], v[92:95]
ds_read_b64_tr_b16 v[240:241], v235 offset:18528
v_mfma_f32_16x16x32_bf16 v[92:95], a[244:247], a[220:223], v[92:95]
ds_read_b64_tr_b16 v[242:243], v235 offset:23136
v_mfma_f32_16x16x32_bf16 v[88:91], a[244:247], a[216:219], v[88:91]
ds_read_b64_tr_b16 v[244:245], v235 offset:27744
v_mfma_f32_16x16x32_bf16 v[88:91], a[240:243], a[200:203], v[88:91]
s_waitcnt lgkmcnt(7)
ds_read_b64_tr_b16 v[246:247], v235 offset:32352
v_mfma_f32_16x16x32_bf16 v[84:87], a[240:243], a[196:199], v[84:87]
v_mfma_f32_16x16x32_bf16 v[84:87], a[244:247], a[212:215], v[84:87]
buffer_load_dwordx4 v227, s[12:15], s54 offen offset:3072 lds
v_mfma_f32_16x16x32_bf16 v[80:83], a[244:247], a[208:211], v[80:83]
v_mfma_f32_16x16x32_bf16 v[80:83], a[240:243], a[192:195], v[80:83]
s_waitcnt lgkmcnt(4)
v_mfma_f32_16x16x32_bf16 v[96:99], a[248:251], a[192:195], v[96:99]
ds_read_b64_tr_b16 a[240:241], v235 offset:128
v_mfma_f32_16x16x32_bf16 v[96:99], a[252:255], a[208:211], v[96:99]
ds_read_b64_tr_b16 a[242:243], v235 offset:4736
v_mfma_f32_16x16x32_bf16 v[100:103], a[252:255], a[212:215], v[100:103]
ds_read_b64_tr_b16 a[244:245], v235 offset:9344
v_mfma_f32_16x16x32_bf16 v[100:103], a[248:251], a[196:199], v[100:103]
s_waitcnt lgkmcnt(7)
ds_read_b64_tr_b16 a[246:247], v235 offset:13952
v_mfma_f32_16x16x32_bf16 v[104:107], a[248:251], a[200:203], v[104:107]
v_mfma_f32_16x16x32_bf16 v[104:107], a[252:255], a[216:219], v[104:107]
s_add_u32 m0, s60, 110592
v_mfma_f32_16x16x32_bf16 v[108:111], a[252:255], a[220:223], v[108:111]
buffer_load_dwordx4 v228, s[12:15], s54 offen offset:0 lds
v_mfma_f32_16x16x32_bf16 v[108:111], a[248:251], a[204:207], v[108:111]
s_waitcnt lgkmcnt(4)
v_mfma_f32_16x16x32_bf16 v[124:127], v[240:243], a[204:207], v[124:127]
ds_read_b64_tr_b16 a[248:249], v235 offset:18560
v_mfma_f32_16x16x32_bf16 v[124:127], v[244:247], a[220:223], v[124:127]
ds_read_b64_tr_b16 a[250:251], v235 offset:23168
v_mfma_f32_16x16x32_bf16 v[120:123], v[244:247], a[216:219], v[120:123]
ds_read_b64_tr_b16 a[252:253], v235 offset:27776
v_mfma_f32_16x16x32_bf16 v[120:123], v[240:243], a[200:203], v[120:123]
s_waitcnt lgkmcnt(7)
ds_read_b64_tr_b16 a[254:255], v235 offset:32384
v_mfma_f32_16x16x32_bf16 v[116:119], v[240:243], a[196:199], v[116:119]
v_mfma_f32_16x16x32_bf16 v[116:119], v[244:247], a[212:215], v[116:119]
v_mfma_f32_16x16x32_bf16 v[112:115], v[244:247], a[208:211], v[112:115]
buffer_load_dwordx4 v229, s[12:15], s54 offen offset:1024 lds
v_mfma_f32_16x16x32_bf16 v[112:115], v[240:243], a[192:195], v[112:115]
s_waitcnt lgkmcnt(4)
v_mfma_f32_16x16x32_bf16 v[128:131], a[240:243], a[192:195], v[128:131]
ds_read_b64_tr_b16 v[240:241], v235 offset:160
v_mfma_f32_16x16x32_bf16 v[128:131], a[244:247], a[208:211], v[128:131]
ds_read_b64_tr_b16 v[242:243], v235 offset:4768
v_mfma_f32_16x16x32_bf16 v[132:135], a[244:247], a[212:215], v[132:135]
ds_read_b64_tr_b16 v[244:245], v235 offset:9376
v_mfma_f32_16x16x32_bf16 v[132:135], a[240:243], a[196:199], v[132:135]
s_waitcnt lgkmcnt(7)
ds_read_b64_tr_b16 v[246:247], v235 offset:13984
v_mfma_f32_16x16x32_bf16 v[136:139], a[240:243], a[200:203], v[136:139]
v_mfma_f32_16x16x32_bf16 v[136:139], a[244:247], a[216:219], v[136:139]
v_mfma_f32_16x16x32_bf16 v[140:143], a[244:247], a[220:223], v[140:143]
buffer_load_dwordx4 v230, s[12:15], s54 offen offset:2048 lds
v_mfma_f32_16x16x32_bf16 v[140:143], a[240:243], a[204:207], v[140:143]
s_waitcnt lgkmcnt(4)
v_mfma_f32_16x16x32_bf16 v[156:159], a[248:251], a[204:207], v[156:159]
ds_read_b64_tr_b16 a[240:241], v235 offset:18592
v_mfma_f32_16x16x32_bf16 v[156:159], a[252:255], a[220:223], v[156:159]
ds_read_b64_tr_b16 a[242:243], v235 offset:23200
v_mfma_f32_16x16x32_bf16 v[152:155], a[252:255], a[216:219], v[152:155]
ds_read_b64_tr_b16 a[244:245], v235 offset:27808
v_mfma_f32_16x16x32_bf16 v[152:155], a[248:251], a[200:203], v[152:155]
s_waitcnt lgkmcnt(7)
ds_read_b64_tr_b16 a[246:247], v235 offset:32416
v_mfma_f32_16x16x32_bf16 v[148:151], a[248:251], a[196:199], v[148:151]
v_mfma_f32_16x16x32_bf16 v[148:151], a[252:255], a[212:215], v[148:151]
v_mfma_f32_16x16x32_bf16 v[144:147], a[252:255], a[208:211], v[144:147]
buffer_load_dwordx4 v231, s[12:15], s54 offen offset:3072 lds
v_mfma_f32_16x16x32_bf16 v[144:147], a[248:251], a[192:195], v[144:147]
s_waitcnt lgkmcnt(4)
v_mfma_f32_16x16x32_bf16 v[160:163], v[240:243], a[192:195], v[160:163]
ds_read_b64_tr_b16 a[248:249], v235 offset:192
v_mfma_f32_16x16x32_bf16 v[160:163], v[244:247], a[208:211], v[160:163]
ds_read_b64_tr_b16 a[250:251], v235 offset:4800
v_mfma_f32_16x16x32_bf16 v[164:167], v[244:247], a[212:215], v[164:167]
ds_read_b64_tr_b16 a[252:253], v235 offset:9408
v_mfma_f32_16x16x32_bf16 v[164:167], v[240:243], a[196:199], v[164:167]
s_waitcnt lgkmcnt(7)
ds_read_b64_tr_b16 a[254:255], v235 offset:14016
v_mfma_f32_16x16x32_bf16 v[168:171], v[240:243], a[200:203], v[168:171]
v_mfma_f32_16x16x32_bf16 v[168:171], v[244:247], a[216:219], v[168:171]
v_mfma_f32_16x16x32_bf16 v[172:175], v[244:247], a[220:223], v[172:175]
s_add_u32 m0, s60, 114688
v_mfma_f32_16x16x32_bf16 v[172:175], v[240:243], a[204:207], v[172:175]
s_waitcnt lgkmcnt(4)
buffer_load_dwordx4 v232, s[12:15], s54 offen offset:0 lds
v_mfma_f32_16x16x32_bf16 v[188:191], a[240:243], a[204:207], v[188:191]
s_add_u32 s54, s54, 589824
ds_read_b64_tr_b16 v[240:241], v235 offset:18624
v_mfma_f32_16x16x32_bf16 v[188:191], a[244:247], a[220:223], v[188:191]
ds_read_b64_tr_b16 v[242:243], v235 offset:23232
v_mfma_f32_16x16x32_bf16 v[184:187], a[244:247], a[216:219], v[184:187]
ds_read_b64_tr_b16 v[244:245], v235 offset:27840
v_mfma_f32_16x16x32_bf16 v[184:187], a[240:243], a[200:203], v[184:187]
s_waitcnt lgkmcnt(7)
ds_read_b64_tr_b16 v[246:247], v235 offset:32448
v_mfma_f32_16x16x32_bf16 v[180:183], a[240:243], a[196:199], v[180:183]
v_mfma_f32_16x16x32_bf16 v[180:183], a[244:247], a[212:215], v[180:183]
v_mfma_f32_16x16x32_bf16 v[176:179], a[244:247], a[208:211], v[176:179]
v_mfma_f32_16x16x32_bf16 v[176:179], a[240:243], a[192:195], v[176:179]
s_waitcnt lgkmcnt(4)
v_mfma_f32_16x16x32_bf16 v[192:195], a[248:251], a[192:195], v[192:195]
ds_read_b64_tr_b16 a[240:241], v235 offset:224
v_mfma_f32_16x16x32_bf16 v[192:195], a[252:255], a[208:211], v[192:195]
ds_read_b64_tr_b16 a[242:243], v235 offset:4832
v_mfma_f32_16x16x32_bf16 v[196:199], a[252:255], a[212:215], v[196:199]
ds_read_b64_tr_b16 a[244:245], v235 offset:9440
v_mfma_f32_16x16x32_bf16 v[196:199], a[248:251], a[196:199], v[196:199]
s_waitcnt lgkmcnt(7)
ds_read_b64_tr_b16 a[246:247], v235 offset:14048
v_mfma_f32_16x16x32_bf16 v[200:203], a[248:251], a[200:203], v[200:203]
v_mfma_f32_16x16x32_bf16 v[200:203], a[252:255], a[216:219], v[200:203]
v_mfma_f32_16x16x32_bf16 v[204:207], a[252:255], a[220:223], v[204:207]
v_mfma_f32_16x16x32_bf16 v[204:207], a[248:251], a[204:207], v[204:207]
s_waitcnt lgkmcnt(4)
v_mfma_f32_16x16x32_bf16 v[220:223], v[240:243], a[204:207], v[220:223]
ds_read_b64_tr_b16 a[248:249], v235 offset:18656
v_mfma_f32_16x16x32_bf16 v[220:223], v[244:247], a[220:223], v[220:223]
ds_read_b64_tr_b16 a[250:251], v235 offset:23264
v_mfma_f32_16x16x32_bf16 v[216:219], v[244:247], a[216:219], v[216:219]
ds_read_b64_tr_b16 a[252:253], v235 offset:27872
v_mfma_f32_16x16x32_bf16 v[216:219], v[240:243], a[200:203], v[216:219]
s_waitcnt lgkmcnt(7)
ds_read_b64_tr_b16 a[254:255], v235 offset:32480
v_mfma_f32_16x16x32_bf16 v[212:215], v[240:243], a[196:199], v[212:215]
v_mfma_f32_16x16x32_bf16 v[212:215], v[244:247], a[212:215], v[212:215]
v_mfma_f32_16x16x32_bf16 v[208:211], v[244:247], a[208:211], v[208:211]
v_mfma_f32_16x16x32_bf16 v[208:211], v[240:243], a[192:195], v[208:211]
s_waitcnt lgkmcnt(4)
v_mfma_f32_16x16x32_bf16 a[0:3], a[240:243], a[192:195], a[0:3]
ds_read_b64_tr_b16 v[240:241], v235 offset:256
v_mfma_f32_16x16x32_bf16 a[0:3], a[244:247], a[208:211], a[0:3]
ds_read_b64_tr_b16 v[242:243], v235 offset:4864
v_mfma_f32_16x16x32_bf16 a[4:7], a[244:247], a[212:215], a[4:7]
ds_read_b64_tr_b16 v[244:245], v235 offset:9472
v_mfma_f32_16x16x32_bf16 a[4:7], a[240:243], a[196:199], a[4:7]
s_waitcnt lgkmcnt(7)
ds_read_b64_tr_b16 v[246:247], v235 offset:14080
v_mfma_f32_16x16x32_bf16 a[8:11], a[240:243], a[200:203], a[8:11]
v_mfma_f32_16x16x32_bf16 a[8:11], a[244:247], a[216:219], a[8:11]
v_mfma_f32_16x16x32_bf16 a[12:15], a[244:247], a[220:223], a[12:15]
v_mfma_f32_16x16x32_bf16 a[12:15], a[240:243], a[204:207], a[12:15]
s_waitcnt lgkmcnt(4)
v_mfma_f32_16x16x32_bf16 a[28:31], a[248:251], a[204:207], a[28:31]
ds_read_b64_tr_b16 a[240:241], v235 offset:18688
v_mfma_f32_16x16x32_bf16 a[28:31], a[252:255], a[220:223], a[28:31]
ds_read_b64_tr_b16 a[242:243], v235 offset:23296
v_mfma_f32_16x16x32_bf16 a[24:27], a[252:255], a[216:219], a[24:27]
ds_read_b64_tr_b16 a[244:245], v235 offset:27904
v_mfma_f32_16x16x32_bf16 a[24:27], a[248:251], a[200:203], a[24:27]
s_waitcnt lgkmcnt(7)
ds_read_b64_tr_b16 a[246:247], v235 offset:32512
v_add_u32 v235, 0xd000, v235
v_mfma_f32_16x16x32_bf16 a[20:23], a[248:251], a[196:199], a[20:23]
s_waitcnt vmcnt(17)
ds_add_u32 v251, v253
v_mfma_f32_16x16x32_bf16 a[20:23], a[252:255], a[212:215], a[20:23]
v_mfma_f32_16x16x32_bf16 a[16:19], a[252:255], a[208:211], a[16:19]
v_mfma_f32_16x16x32_bf16 a[16:19], a[248:251], a[192:195], a[16:19]
s_waitcnt lgkmcnt(5)
v_mfma_f32_16x16x32_bf16 a[32:35], v[240:243], a[192:195], a[32:35]
ds_read_b64_tr_b16 a[248:249], v236 offset:45056
v_mfma_f32_16x16x32_bf16 a[32:35], v[244:247], a[208:211], a[32:35]
ds_read_b64_tr_b16 a[250:251], v236 offset:49152
v_mfma_f32_16x16x32_bf16 a[36:39], v[244:247], a[212:215], a[36:39]
ds_read_b64_tr_b16 a[252:253], v236 offset:45064
v_mfma_f32_16x16x32_bf16 a[36:39], v[240:243], a[196:199], a[36:39]
s_waitcnt lgkmcnt(8)
ds_read_b64_tr_b16 a[254:255], v236 offset:49160
v_add_u32 v236, 0xd000, v236
v_mfma_f32_16x16x32_bf16 a[40:43], v[240:243], a[200:203], a[40:43]
v_mfma_f32_16x16x32_bf16 a[40:43], v[244:247], a[216:219], a[40:43]
v_mfma_f32_16x16x32_bf16 a[44:47], v[244:247], a[220:223], a[44:47]
v_mfma_f32_16x16x32_bf16 a[44:47], v[240:243], a[204:207], a[44:47]
s_waitcnt lgkmcnt(5)
v_mfma_f32_16x16x32_bf16 a[60:63], a[240:243], a[204:207], a[60:63]
ds_read_b64_tr_b16 v[240:241], v237 offset:45056
v_mfma_f32_16x16x32_bf16 a[60:63], a[244:247], a[220:223], a[60:63]
ds_read_b64_tr_b16 v[242:243], v237 offset:49152
v_mfma_f32_16x16x32_bf16 a[56:59], a[244:247], a[216:219], a[56:59]
ds_read_b64_tr_b16 v[244:245], v237 offset:45064
v_mfma_f32_16x16x32_bf16 a[56:59], a[240:243], a[200:203], a[56:59]
s_waitcnt lgkmcnt(8)
ds_read_b64_tr_b16 v[246:247], v237 offset:49160
v_add_u32 v237, 0xd000, v237
v_mfma_f32_16x16x32_bf16 a[52:55], a[240:243], a[196:199], a[52:55]
v_mfma_f32_16x16x32_bf16 a[52:55], a[244:247], a[212:215], a[52:55]
v_mfma_f32_16x16x32_bf16 a[48:51], a[244:247], a[208:211], a[48:51]
v_mfma_f32_16x16x32_bf16 a[48:51], a[240:243], a[192:195], a[48:51]
s_waitcnt lgkmcnt(6)
v_mfma_f32_16x16x32_bf16 a[64:67], a[248:251], a[208:211], a[64:67]
ds_read_b64_tr_b16 a[240:241], v238 offset:45056
v_mfma_f32_16x16x32_bf16 a[68:71], a[248:251], a[212:215], a[68:71]
ds_read_b64_tr_b16 a[242:243], v238 offset:49152
v_mfma_f32_16x16x32_bf16 a[72:75], a[248:251], a[216:219], a[72:75]
ds_read_b32 v255, v252
v_mfma_f32_16x16x32_bf16 a[76:79], a[248:251], a[220:223], a[76:79]
s_waitcnt lgkmcnt(7)
buffer_load_dwordx4 a[192:195], v254, s[8:11], s59 offen offset:0 sc1
v_mfma_f32_16x16x32_bf16 a[92:95], a[252:255], a[220:223], a[92:95]
ds_read_b64_tr_b16 a[244:245], v238 offset:45064
v_mfma_f32_16x16x32_bf16 a[88:91], a[252:255], a[216:219], a[88:91]
ds_read_b64_tr_b16 a[246:247], v238 offset:49160
v_add_u32 v238, 0xd000, v238
v_mfma_f32_16x16x32_bf16 a[84:87], a[252:255], a[212:215], a[84:87]
buffer_load_dwordx4 a[196:199], v254, s[8:11], s59 offen offset:1024 sc1
v_mfma_f32_16x16x32_bf16 a[80:83], a[252:255], a[208:211], a[80:83]
s_waitcnt lgkmcnt(7)
buffer_load_dwordx4 a[200:203], v254, s[8:11], s59 offen offset:2048 sc1
v_mfma_f32_16x16x32_bf16 a[96:99], v[240:243], a[208:211], a[96:99]
ds_read_b64_tr_b16 a[248:249], v239 offset:45056
v_mfma_f32_16x16x32_bf16 a[100:103], v[240:243], a[212:215], a[100:103]
ds_read_b64_tr_b16 a[250:251], v239 offset:49152
v_mfma_f32_16x16x32_bf16 a[104:107], v[240:243], a[216:219], a[104:107]
buffer_load_dwordx4 a[204:207], v254, s[8:11], s59 offen offset:3072 sc1
v_mfma_f32_16x16x32_bf16 a[108:111], v[240:243], a[220:223], a[108:111]
s_waitcnt lgkmcnt(4)
v_mfma_f32_16x16x32_bf16 a[124:127], v[244:247], a[220:223], a[124:127]
s_add_u32 s59, s59, 4096
ds_read_b64_tr_b16 a[252:253], v239 offset:45064
v_cmp_gt_u32 vcc, 13, v255
v_mfma_f32_16x16x32_bf16 a[120:123], v[244:247], a[216:219], a[120:123]
ds_read_b64_tr_b16 a[254:255], v239 offset:49160
v_add_u32 v239, 0xd000, v239
v_mfma_f32_16x16x32_bf16 a[116:119], v[244:247], a[212:215], a[116:119]
v_mfma_f32_16x16x32_bf16 a[112:115], v[244:247], a[208:211], a[112:115]
s_waitcnt lgkmcnt(6)
v_mfma_f32_16x16x32_bf16 a[128:131], a[240:243], a[208:211], a[128:131]
s_cbranch_vccnz k1_g13_s
k1_g13_b:
ds_read_b64_tr_b16 v[240:241], v236 offset:36864
v_mfma_f32_16x16x32_bf16 a[132:135], a[240:243], a[212:215], a[132:135]
ds_read_b64_tr_b16 v[242:243], v236 offset:40960
v_mfma_f32_16x16x32_bf16 a[136:139], a[240:243], a[216:219], a[136:139]
ds_add_u32 v251, v253
v_mfma_f32_16x16x32_bf16 a[140:143], a[240:243], a[220:223], a[140:143]
s_waitcnt lgkmcnt(7)
v_mfma_f32_16x16x32_bf16 a[156:159], a[244:247], a[220:223], a[156:159]
ds_read_b64_tr_b16 v[244:245], v236 offset:36872
v_mfma_f32_16x16x32_bf16 a[152:155], a[244:247], a[216:219], a[152:155]
ds_read_b64_tr_b16 v[246:247], v236 offset:40968
v_mfma_f32_16x16x32_bf16 a[148:151], a[244:247], a[212:215], a[148:151]
v_mfma_f32_16x16x32_bf16 a[144:147], a[244:247], a[208:211], a[144:147]
s_waitcnt lgkmcnt(7)
v_mfma_f32_16x16x32_bf16 a[160:163], a[248:251], a[208:211], a[160:163]
ds_read_b64_tr_b16 a[240:241], v237 offset:36864
v_mfma_f32_16x16x32_bf16 a[164:167], a[248:251], a[212:215], a[164:167]
ds_read_b64_tr_b16 a[242:243], v237 offset:40960
v_mfma_f32_16x16x32_bf16 a[168:171], a[248:251], a[216:219], a[168:171]
v_mfma_f32_16x16x32_bf16 a[172:175], a[248:251], a[220:223], a[172:175]
s_waitcnt lgkmcnt(7)
v_mfma_f32_16x16x32_bf16 a[188:191], a[252:255], a[220:223], a[188:191]
ds_read_b64_tr_b16 a[244:245], v237 offset:36872
v_mfma_f32_16x16x32_bf16 a[184:187], a[252:255], a[216:219], a[184:187]
ds_read_b64_tr_b16 a[246:247], v237 offset:40968
v_mfma_f32_16x16x32_bf16 a[180:183], a[252:255], a[212:215], a[180:183]
s_waitcnt vmcnt(17)
v_mfma_f32_16x16x32_bf16 a[176:179], a[252:255], a[208:211], a[176:179]
s_waitcnt lgkmcnt(7)
v_mfma_f32_16x16x32_bf16 a[64:67], v[240:243], a[224:227], a[64:67]
ds_read_b64_tr_b16 a[248:249], v238 offset:36864
ds_read_b32 v255, v252
v_mfma_f32_16x16x32_bf16 a[68:71], v[240:243], a[228:231], a[68:71]
ds_read_b64_tr_b16 a[250:251], v238 offset:40960
v_mfma_f32_16x16x32_bf16 a[72:75], v[240:243], a[232:235], a[72:75]
buffer_load_dwordx4 a[208:211], v254, s[8:11], s59 offen offset:0 sc1
v_mfma_f32_16x16x32_bf16 a[76:79], v[240:243], a[236:239], a[76:79]
s_waitcnt lgkmcnt(7)
buffer_load_dwordx4 a[212:215], v254, s[8:11], s59 offen offset:1024 sc1
v_mfma_f32_16x16x32_bf16 a[92:95], v[244:247], a[236:239], a[92:95]
ds_read_b64_tr_b16 a[252:253], v238 offset:36872
v_mfma_f32_16x16x32_bf16 a[88:91], v[244:247], a[232:235], a[88:91]
ds_read_b64_tr_b16 a[254:255], v238 offset:40968
v_mfma_f32_16x16x32_bf16 a[84:87], v[244:247], a[228:231], a[84:87]
buffer_load_dwordx4 a[216:219], v254, s[8:11], s59 offen offset:2048 sc1
v_mfma_f32_16x16x32_bf16 a[80:83], v[244:247], a[224:227], a[80:83]
s_waitcnt lgkmcnt(3)
buffer_load_dwordx4 a[220:223], v254, s[8:11], s59 offen offset:3072 sc1
v_mfma_f32_16x16x32_bf16 a[96:99], a[240:243], a[224:227], a[96:99]
s_add_u32 s59, s59, 4096
ds_read_b64_tr_b16 v[240:241], v239 offset:36864
v_cmp_gt_u32 vcc, 14, v255
v_mfma_f32_16x16x32_bf16 a[100:103], a[240:243], a[228:231], a[100:103]
ds_read_b64_tr_b16 v[242:243], v239 offset:40960
v_mfma_f32_16x16x32_bf16 a[104:107], a[240:243], a[232:235], a[104:107]
v_mfma_f32_16x16x32_bf16 a[108:111], a[240:243], a[236:239], a[108:111]
s_waitcnt lgkmcnt(5)
v_mfma_f32_16x16x32_bf16 a[124:127], a[244:247], a[236:239], a[124:127]
s_cbranch_vccnz k1_g14_s
k1_g14_b:
ds_read_b64_tr_b16 v[244:245], v239 offset:36872
v_mfma_f32_16x16x32_bf16 a[120:123], a[244:247], a[232:235], a[120:123]
ds_read_b64_tr_b16 v[246:247], v239 offset:40968
v_mfma_f32_16x16x32_bf16 a[116:119], a[244:247], a[228:231], a[116:119]
v_mfma_f32_16x16x32_bf16 a[112:115], a[244:247], a[224:227], a[112:115]
s_waitcnt lgkmcnt(6)
v_mfma_f32_16x16x32_bf16 a[128:131], a[248:251], a[224:227], a[128:131]
ds_read_b64_tr_b16 a[240:241], v235 offset:0
v_lshrrev_b32 v249, 8, v234
v_mfma_f32_16x16x32_bf16 a[132:135], a[248:251], a[228:231], a[132:135]
ds_read_b64_tr_b16 a[242:243], v235 offset:4608
v_bfe_u32 v250, v234, 4, 4
v_mfma_f32_16x16x32_bf16 a[136:139], a[248:251], a[232:235], a[136:139]
v_add_u32 v248, 0, v249
v_xor_b32 v248, v248, v250
v_mfma_f32_16x16x32_bf16 a[140:143], a[248:251], a[236:239], a[140:143]
s_waitcnt lgkmcnt(6)
v_lshlrev_b32 v248, 4, v248
v_lshl_add_u32 v224, v249, 8, v248
v_mfma_f32_16x16x32_bf16 a[156:159], a[252:255], a[236:239], a[156:159]
ds_read_b64_tr_b16 a[244:245], v235 offset:9216
v_add_u32 v248, 4, v249
v_mfma_f32_16x16x32_bf16 a[152:155], a[252:255], a[232:235], a[152:155]
ds_read_b64_tr_b16 a[246:247], v235 offset:13824
v_xor_b32 v248, v248, v250
v_mfma_f32_16x16x32_bf16 a[148:151], a[252:255], a[228:231], a[148:151]
v_lshlrev_b32 v248, 4, v248
v_lshl_add_u32 v225, v249, 8, v248
v_mfma_f32_16x16x32_bf16 a[144:147], a[252:255], a[224:227], a[144:147]
s_waitcnt lgkmcnt(6)
v_add_u32 v248, 8, v249
v_xor_b32 v248, v248, v250
v_mfma_f32_16x16x32_bf16 a[160:163], v[240:243], a[224:227], a[160:163]
ds_read_b64_tr_b16 a[248:249], v235 offset:18432
v_lshlrev_b32 v248, 4, v248
v_mfma_f32_16x16x32_bf16 a[164:167], v[240:243], a[228:231], a[164:167]
ds_read_b64_tr_b16 a[250:251], v235 offset:23040
v_lshl_add_u32 v226, v249, 8, v248
v_mfma_f32_16x16x32_bf16 a[168:171], v[240:243], a[232:235], a[168:171]
v_add_u32 v248, 12, v249
v_xor_b32 v248, v248, v250
v_mfma_f32_16x16x32_bf16 a[172:175], v[240:243], a[236:239], a[172:175]
s_waitcnt lgkmcnt(6)
v_lshlrev_b32 v248, 4, v248
v_lshl_add_u32 v227, v249, 8, v248
v_mfma_f32_16x16x32_bf16 a[188:191], v[244:247], a[236:239], a[188:191]
ds_read_b64_tr_b16 a[252:253], v235 offset:27648
v_add_u32 v248, 0, v249
v_mfma_f32_16x16x32_bf16 a[184:187], v[244:247], a[232:235], a[184:187]
ds_read_b64_tr_b16 a[254:255], v235 offset:32256
v_lshlrev_b32 v248, 1, v248
v_mfma_f32_16x16x32_bf16 a[180:183], v[244:247], a[228:231], a[180:183]
s_waitcnt vmcnt(4)
v_xor_b32 v248, v248, v250
v_lshlrev_b32 v248, 4, v248
v_mfma_f32_16x16x32_bf16 a[176:179], v[244:247], a[224:227], a[176:179]
s_waitcnt lgkmcnt(4)
v_lshl_add_u32 v228, v249, 8, v248
v_add_u32 v248, 4, v249
v_mfma_f32_16x16x32_bf16 v[0:3], a[240:243], a[224:227], v[0:3]
ds_read_b64_tr_b16 v[240:241], v235 offset:32
v_lshlrev_b32 v248, 1, v248
v_mfma_f32_16x16x32_bf16 v[0:3], a[244:247], a[192:195], v[0:3]
ds_read_b64_tr_b16 v[242:243], v235 offset:4640
v_xor_b32 v248, v248, v250
v_mfma_f32_16x16x32_bf16 v[4:7], a[244:247], a[196:199], v[4:7]
ds_read_b64_tr_b16 v[244:245], v235 offset:9248
v_lshlrev_b32 v248, 4, v248
v_mfma_f32_16x16x32_bf16 v[4:7], a[240:243], a[228:231], v[4:7]
s_waitcnt lgkmcnt(7)
ds_read_b64_tr_b16 v[246:247], v235 offset:13856
v_lshl_add_u32 v229, v249, 8, v248
v_mfma_f32_16x16x32_bf16 v[8:11], a[240:243], a[232:235], v[8:11]
v_lshrrev_b32 v248, 4, v234
v_mul_u32_u24 v249, 3641, v248
v_mfma_f32_16x16x32_bf16 v[8:11], a[244:247], a[200:203], v[8:11]
v_lshrrev_b32 v249, 16, v249
v_mul_u32_u24 v250, 864, v249
v_mfma_f32_16x16x32_bf16 v[12:15], a[244:247], a[204:207], v[12:15]
v_add_u32 v230, v250, v234
v_add_u32 v249, 1, v249
v_mfma_f32_16x16x32_bf16 v[12:15], a[240:243], a[236:239], v[12:15]
s_waitcnt lgkmcnt(4)
v_lshrrev_b32 v249, 2, v249
v_lshlrev_b32 v249, 30, v249
v_mfma_f32_16x16x32_bf16 v[28:31], a[248:251], a[236:239], v[28:31]
ds_read_b64_tr_b16 a[240:241], v235 offset:18464
v_add_u32 v230, v230, v249
v_mfma_f32_16x16x32_bf16 v[28:31], a[252:255], a[204:207], v[28:31]
ds_read_b64_tr_b16 a[242:243], v235 offset:23072
v_add_u32 v231, v234, v249
v_mfma_f32_16x16x32_bf16 v[24:27], a[252:255], a[200:203], v[24:27]
ds_read_b64_tr_b16 a[244:245], v235 offset:27680
v_mfma_f32_16x16x32_bf16 v[24:27], a[248:251], a[232:235], v[24:27]
s_waitcnt lgkmcnt(7)
ds_read_b64_tr_b16 a[246:247], v235 offset:32288
v_mfma_f32_16x16x32_bf16 v[20:23], a[248:251], a[228:231], v[20:23]
s_add_u32 m0, s65, 0
v_mfma_f32_16x16x32_bf16 v[20:23], a[252:255], a[196:199], v[20:23]
buffer_load_dwordx4 v224, s[20:23], s63 offen offset:0 lds
v_mfma_f32_16x16x32_bf16 v[16:19], a[252:255], a[192:195], v[16:19]
v_mfma_f32_16x16x32_bf16 v[16:19], a[248:251], a[224:227], v[16:19]
s_waitcnt lgkmcnt(4)
v_mfma_f32_16x16x32_bf16 v[32:35], v[240:243], a[224:227], v[32:35]
ds_read_b64_tr_b16 a[248:249], v235 offset:64
v_mfma_f32_16x16x32_bf16 v[32:35], v[244:247], a[192:195], v[32:35]
ds_read_b64_tr_b16 a[250:251], v235 offset:4672
v_mfma_f32_16x16x32_bf16 v[36:39], v[244:247], a[196:199], v[36:39]
ds_read_b64_tr_b16 a[252:253], v235 offset:9280
v_mfma_f32_16x16x32_bf16 v[36:39], v[240:243], a[228:231], v[36:39]
s_waitcnt lgkmcnt(7)
ds_read_b64_tr_b16 a[254:255], v235 offset:13888
v_mfma_f32_16x16x32_bf16 v[40:43], v[240:243], a[232:235], v[40:43]
v_mfma_f32_16x16x32_bf16 v[40:43], v[244:247], a[200:203], v[40:43]
buffer_load_dwordx4 v225, s[20:23], s63 offen offset:1024 lds
v_mfma_f32_16x16x32_bf16 v[44:47], v[244:247], a[204:207], v[44:47]
v_mfma_f32_16x16x32_bf16 v[44:47], v[240:243], a[236:239], v[44:47]
s_waitcnt lgkmcnt(4)
v_mfma_f32_16x16x32_bf16 v[60:63], a[240:243], a[236:239], v[60:63]
ds_read_b64_tr_b16 v[240:241], v235 offset:18496
v_mfma_f32_16x16x32_bf16 v[60:63], a[244:247], a[204:207], v[60:63]
ds_read_b64_tr_b16 v[242:243], v235 offset:23104
v_mfma_f32_16x16x32_bf16 v[56:59], a[244:247], a[200:203], v[56:59]
ds_read_b64_tr_b16 v[244:245], v235 offset:27712
v_mfma_f32_16x16x32_bf16 v[56:59], a[240:243], a[232:235], v[56:59]
s_waitcnt lgkmcnt(7)
ds_read_b64_tr_b16 v[246:247], v235 offset:32320
v_mfma_f32_16x16x32_bf16 v[52:55], a[240:243], a[228:231], v[52:55]
v_mfma_f32_16x16x32_bf16 v[52:55], a[244:247], a[196:199], v[52:55]
buffer_load_dwordx4 v226, s[20:23], s63 offen offset:2048 lds
v_mfma_f32_16x16x32_bf16 v[48:51], a[244:247], a[192:195], v[48:51]
v_mfma_f32_16x16x32_bf16 v[48:51], a[240:243], a[224:227], v[48:51]
s_waitcnt lgkmcnt(4)
v_mfma_f32_16x16x32_bf16 v[64:67], a[248:251], a[224:227], v[64:67]
ds_read_b64_tr_b16 a[240:241], v235 offset:96
v_mfma_f32_16x16x32_bf16 v[64:67], a[252:255], a[192:195], v[64:67]
ds_read_b64_tr_b16 a[242:243], v235 offset:4704
v_mfma_f32_16x16x32_bf16 v[68:71], a[252:255], a[196:199], v[68:71]
ds_read_b64_tr_b16 a[244:245], v235 offset:9312
v_mfma_f32_16x16x32_bf16 v[68:71], a[248:251], a[228:231], v[68:71]
s_waitcnt lgkmcnt(7)
ds_read_b64_tr_b16 a[246:247], v235 offset:13920
v_mfma_f32_16x16x32_bf16 v[72:75], a[248:251], a[232:235], v[72:75]
v_mfma_f32_16x16x32_bf16 v[72:75], a[252:255], a[200:203], v[72:75]
buffer_load_dwordx4 v227, s[20:23], s63 offen offset:3072 lds
v_mfma_f32_16x16x32_bf16 v[76:79], a[252:255], a[204:207], v[76:79]
s_add_u32 s63, s63, 16384
v_mfma_f32_16x16x32_bf16 v[76:79], a[248:251], a[236:239], v[76:79]
s_waitcnt lgkmcnt(4)
v_mfma_f32_16x16x32_bf16 v[92:95], v[240:243], a[236:239], v[92:95]
ds_read_b64_tr_b16 a[248:249], v235 offset:18528
v_mfma_f32_16x16x32_bf16 v[92:95], v[244:247], a[204:207], v[92:95]
ds_read_b64_tr_b16 a[250:251], v235 offset:23136
v_mfma_f32_16x16x32_bf16 v[88:91], v[244:247], a[200:203], v[88:91]
ds_read_b64_tr_b16 a[252:253], v235 offset:27744
v_mfma_f32_16x16x32_bf16 v[88:91], v[240:243], a[232:235], v[88:91]
s_waitcnt lgkmcnt(7)
ds_read_b64_tr_b16 a[254:255], v235 offset:32352
v_mfma_f32_16x16x32_bf16 v[84:87], v[240:243], a[228:231], v[84:87]
v_mfma_f32_16x16x32_bf16 v[84:87], v[244:247], a[196:199], v[84:87]
s_add_u32 m0, s65, 16384
v_mfma_f32_16x16x32_bf16 v[80:83], v[244:247], a[192:195], v[80:83]
buffer_load_dwordx4 v224, s[20:23], s63 offen offset:0 lds
v_mfma_f32_16x16x32_bf16 v[80:83], v[240:243], a[224:227], v[80:83]
s_waitcnt lgkmcnt(4)
v_mfma_f32_16x16x32_bf16 v[96:99], a[240:243], a[224:227], v[96:99]
ds_read_b64_tr_b16 v[240:241], v235 offset:128
v_mfma_f32_16x16x32_bf16 v[96:99], a[244:247], a[192:195], v[96:99]
ds_read_b64_tr_b16 v[242:243], v235 offset:4736
v_mfma_f32_16x16x32_bf16 v[100:103], a[244:247], a[196:199], v[100:103]
ds_read_b64_tr_b16 v[244:245], v235 offset:9344
v_mfma_f32_16x16x32_bf16 v[100:103], a[240:243], a[228:231], v[100:103]
s_waitcnt lgkmcnt(7)
ds_read_b64_tr_b16 v[246:247], v235 offset:13952
v_mfma_f32_16x16x32_bf16 v[104:107], a[240:243], a[232:235], v[104:107]
v_mfma_f32_16x16x32_bf16 v[104:107], a[244:247], a[200:203], v[104:107]
v_mfma_f32_16x16x32_bf16 v[108:111], a[244:247], a[204:207], v[108:111]
buffer_load_dwordx4 v225, s[20:23], s63 offen offset:1024 lds
v_mfma_f32_16x16x32_bf16 v[108:111], a[240:243], a[236:239], v[108:111]
s_waitcnt lgkmcnt(4)
v_mfma_f32_16x16x32_bf16 v[124:127], a[248:251], a[236:239], v[124:127]
ds_read_b64_tr_b16 a[240:241], v235 offset:18560
v_mfma_f32_16x16x32_bf16 v[124:127], a[252:255], a[204:207], v[124:127]
ds_read_b64_tr_b16 a[242:243], v235 offset:23168
v_mfma_f32_16x16x32_bf16 v[120:123], a[252:255], a[200:203], v[120:123]
ds_read_b64_tr_b16 a[244:245], v235 offset:27776
v_mfma_f32_16x16x32_bf16 v[120:123], a[248:251], a[232:235], v[120:123]
s_waitcnt lgkmcnt(7)
ds_read_b64_tr_b16 a[246:247], v235 offset:32384
v_mfma_f32_16x16x32_bf16 v[116:119], a[248:251], a[228:231], v[116:119]
v_mfma_f32_16x16x32_bf16 v[116:119], a[252:255], a[196:199], v[116:119]
v_mfma_f32_16x16x32_bf16 v[112:115], a[252:255], a[192:195], v[112:115]
buffer_load_dwordx4 v226, s[20:23], s63 offen offset:2048 lds
v_mfma_f32_16x16x32_bf16 v[112:115], a[248:251], a[224:227], v[112:115]
s_waitcnt lgkmcnt(4)
v_mfma_f32_16x16x32_bf16 v[128:131], v[240:243], a[224:227], v[128:131]
ds_read_b64_tr_b16 a[248:249], v235 offset:160
v_mfma_f32_16x16x32_bf16 v[128:131], v[244:247], a[192:195], v[128:131]
ds_read_b64_tr_b16 a[250:251], v235 offset:4768
v_mfma_f32_16x16x32_bf16 v[132:135], v[244:247], a[196:199], v[132:135]
ds_read_b64_tr_b16 a[252:253], v235 offset:9376
v_mfma_f32_16x16x32_bf16 v[132:135], v[240:243], a[228:231], v[132:135]
s_waitcnt lgkmcnt(7)
ds_read_b64_tr_b16 a[254:255], v235 offset:13984
v_mfma_f32_16x16x32_bf16 v[136:139], v[240:243], a[232:235], v[136:139]
v_mfma_f32_16x16x32_bf16 v[136:139], v[244:247], a[200:203], v[136:139]
v_mfma_f32_16x16x32_bf16 v[140:143], v[244:247], a[204:207], v[140:143]
buffer_load_dwordx4 v227, s[20:23], s63 offen offset:3072 lds
v_mfma_f32_16x16x32_bf16 v[140:143], v[240:243], a[236:239], v[140:143]
s_waitcnt lgkmcnt(4)
v_mfma_f32_16x16x32_bf16 v[156:159], a[240:243], a[236:239], v[156:159]
s_add_u32 s63, s63, 16384
ds_read_b64_tr_b16 v[240:241], v235 offset:18592
v_mfma_f32_16x16x32_bf16 v[156:159], a[244:247], a[204:207], v[156:159]
ds_read_b64_tr_b16 v[242:243], v235 offset:23200
v_mfma_f32_16x16x32_bf16 v[152:155], a[244:247], a[200:203], v[152:155]
ds_read_b64_tr_b16 v[244:245], v235 offset:27808
v_mfma_f32_16x16x32_bf16 v[152:155], a[240:243], a[232:235], v[152:155]
s_waitcnt lgkmcnt(7)
ds_read_b64_tr_b16 v[246:247], v235 offset:32416
v_mfma_f32_16x16x32_bf16 v[148:151], a[240:243], a[228:231], v[148:151]
v_mfma_f32_16x16x32_bf16 v[148:151], a[244:247], a[196:199], v[148:151]
v_mfma_f32_16x16x32_bf16 v[144:147], a[244:247], a[192:195], v[144:147]
s_add_u32 m0, s65, 32768
v_mfma_f32_16x16x32_bf16 v[144:147], a[240:243], a[224:227], v[144:147]
s_waitcnt lgkmcnt(4)
buffer_load_dwordx4 v224, s[20:23], s63 offen offset:0 lds
v_mfma_f32_16x16x32_bf16 v[160:163], a[248:251], a[224:227], v[160:163]
ds_read_b64_tr_b16 a[240:241], v235 offset:192
v_mfma_f32_16x16x32_bf16 v[160:163], a[252:255], a[192:195], v[160:163]
ds_read_b64_tr_b16 a[242:243], v235 offset:4800
v_mfma_f32_16x16x32_bf16 v[164:167], a[252:255], a[196:199], v[164:167]
ds_read_b64_tr_b16 a[244:245], v235 offset:9408
v_mfma_f32_16x16x32_bf16 v[164:167], a[248:251], a[228:231], v[164:167]
s_waitcnt lgkmcnt(7)
ds_read_b64_tr_b16 a[246:247], v235 offset:14016
v_mfma_f32_16x16x32_bf16 v[168:171], a[248:251], a[232:235], v[168:171]
v_mfma_f32_16x16x32_bf16 v[168:171], a[252:255], a[200:203], v[168:171]
v_mfma_f32_16x16x32_bf16 v[172:175], a[252:255], a[204:207], v[172:175]
v_mfma_f32_16x16x32_bf16 v[172:175], a[248:251], a[236:239], v[172:175]
s_waitcnt lgkmcnt(4)
buffer_load_dwordx4 v225, s[20:23], s63 offen offset:1024 lds
v_mfma_f32_16x16x32_bf16 v[188:191], v[240:243], a[236:239], v[188:191]
ds_read_b64_tr_b16 a[248:249], v235 offset:18624
v_mfma_f32_16x16x32_bf16 v[188:191], v[244:247], a[204:207], v[188:191]
ds_read_b64_tr_b16 a[250:251], v235 offset:23232
v_mfma_f32_16x16x32_bf16 v[184:187], v[244:247], a[200:203], v[184:187]
ds_read_b64_tr_b16 a[252:253], v235 offset:27840
v_mfma_f32_16x16x32_bf16 v[184:187], v[240:243], a[232:235], v[184:187]
s_waitcnt lgkmcnt(7)
ds_read_b64_tr_b16 a[254:255], v235 offset:32448
v_mfma_f32_16x16x32_bf16 v[180:183], v[240:243], a[228:231], v[180:183]
v_mfma_f32_16x16x32_bf16 v[180:183], v[244:247], a[196:199], v[180:183]
v_mfma_f32_16x16x32_bf16 v[176:179], v[244:247], a[192:195], v[176:179]
v_mfma_f32_16x16x32_bf16 v[176:179], v[240:243], a[224:227], v[176:179]
s_waitcnt lgkmcnt(4)
buffer_load_dwordx4 v226, s[20:23], s63 offen offset:2048 lds
v_mfma_f32_16x16x32_bf16 v[192:195], a[240:243], a[224:227], v[192:195]
ds_read_b64_tr_b16 v[240:241], v235 offset:224
v_mfma_f32_16x16x32_bf16 v[192:195], a[244:247], a[192:195], v[192:195]
ds_read_b64_tr_b16 v[242:243], v235 offset:4832
v_mfma_f32_16x16x32_bf16 v[196:199], a[244:247], a[196:199], v[196:199]
ds_read_b64_tr_b16 v[244:245], v235 offset:9440
v_mfma_f32_16x16x32_bf16 v[196:199], a[240:243], a[228:231], v[196:199]
s_waitcnt lgkmcnt(7)
ds_read_b64_tr_b16 v[246:247], v235 offset:14048
v_mfma_f32_16x16x32_bf16 v[200:203], a[240:243], a[232:235], v[200:203]
v_mfma_f32_16x16x32_bf16 v[200:203], a[244:247], a[200:203], v[200:203]
v_mfma_f32_16x16x32_bf16 v[204:207], a[244:247], a[204:207], v[204:207]
v_mfma_f32_16x16x32_bf16 v[204:207], a[240:243], a[236:239], v[204:207]
s_waitcnt lgkmcnt(4)
buffer_load_dwordx4 v227, s[20:23], s63 offen offset:3072 lds
v_mfma_f32_16x16x32_bf16 v[220:223], a[248:251], a[236:239], v[220:223]
s_add_u32 s63, s63, 16384
ds_read_b64_tr_b16 a[240:241], v235 offset:18656
v_mfma_f32_16x16x32_bf16 v[220:223], a[252:255], a[204:207], v[220:223]
ds_read_b64_tr_b16 a[242:243], v235 offset:23264
v_mfma_f32_16x16x32_bf16 v[216:219], a[252:255], a[200:203], v[216:219]
ds_read_b64_tr_b16 a[244:245], v235 offset:27872
v_mfma_f32_16x16x32_bf16 v[216:219], a[248:251], a[232:235], v[216:219]
s_waitcnt lgkmcnt(7)
ds_read_b64_tr_b16 a[246:247], v235 offset:32480
v_mfma_f32_16x16x32_bf16 v[212:215], a[248:251], a[228:231], v[212:215]
v_mfma_f32_16x16x32_bf16 v[212:215], a[252:255], a[196:199], v[212:215]
v_mfma_f32_16x16x32_bf16 v[208:211], a[252:255], a[192:195], v[208:211]
v_mfma_f32_16x16x32_bf16 v[208:211], a[248:251], a[224:227], v[208:211]
s_waitcnt lgkmcnt(4)
v_mfma_f32_16x16x32_bf16 a[0:3], v[240:243], a[224:227], a[0:3]
ds_read_b64_tr_b16 a[248:249], v235 offset:256
v_mfma_f32_16x16x32_bf16 a[0:3], v[244:247], a[192:195], a[0:3]
ds_read_b64_tr_b16 a[250:251], v235 offset:4864
v_mfma_f32_16x16x32_bf16 a[4:7], v[244:247], a[196:199], a[4:7]
ds_read_b64_tr_b16 a[252:253], v235 offset:9472
v_mfma_f32_16x16x32_bf16 a[4:7], v[240:243], a[228:231], a[4:7]
s_waitcnt lgkmcnt(7)
ds_read_b64_tr_b16 a[254:255], v235 offset:14080
v_mfma_f32_16x16x32_bf16 a[8:11], v[240:243], a[232:235], a[8:11]
v_mfma_f32_16x16x32_bf16 a[8:11], v[244:247], a[200:203], a[8:11]
v_mfma_f32_16x16x32_bf16 a[12:15], v[244:247], a[204:207], a[12:15]
v_mfma_f32_16x16x32_bf16 a[12:15], v[240:243], a[236:239], a[12:15]
s_waitcnt lgkmcnt(4)
v_mfma_f32_16x16x32_bf16 a[28:31], a[240:243], a[236:239], a[28:31]
ds_read_b64_tr_b16 v[240:241], v235 offset:18688
v_mfma_f32_16x16x32_bf16 a[28:31], a[244:247], a[204:207], a[28:31]
ds_read_b64_tr_b16 v[242:243], v235 offset:23296
v_mfma_f32_16x16x32_bf16 a[24:27], a[244:247], a[200:203], a[24:27]
ds_read_b64_tr_b16 v[244:245], v235 offset:27904
v_mfma_f32_16x16x32_bf16 a[24:27], a[240:243], a[232:235], a[24:27]
s_waitcnt lgkmcnt(7)
ds_read_b64_tr_b16 v[246:247], v235 offset:32512
v_add_u32 v235, 0xd000, v235
v_mfma_f32_16x16x32_bf16 a[20:23], a[240:243], a[228:231], a[20:23]
s_waitcnt vmcnt(16)
ds_add_u32 v251, v253
v_mfma_f32_16x16x32_bf16 a[20:23], a[244:247], a[196:199], a[20:23]
v_mfma_f32_16x16x32_bf16 a[16:19], a[244:247], a[192:195], a[16:19]
v_mfma_f32_16x16x32_bf16 a[16:19], a[240:243], a[224:227], a[16:19]
s_waitcnt lgkmcnt(5)
v_mfma_f32_16x16x32_bf16 a[32:35], a[248:251], a[224:227], a[32:35]
ds_read_b64_tr_b16 a[240:241], v236 offset:45056
v_mfma_f32_16x16x32_bf16 a[32:35], a[252:255], a[192:195], a[32:35]
ds_read_b64_tr_b16 a[242:243], v236 offset:49152
v_mfma_f32_16x16x32_bf16 a[36:39], a[252:255], a[196:199], a[36:39]
ds_read_b64_tr_b16 a[244:245], v236 offset:45064
v_mfma_f32_16x16x32_bf16 a[36:39], a[248:251], a[228:231], a[36:39]
s_waitcnt lgkmcnt(8)
ds_read_b64_tr_b16 a[246:247], v236 offset:49160
v_add_u32 v236, 0xd000, v236
v_mfma_f32_16x16x32_bf16 a[40:43], a[248:251], a[232:235], a[40:43]
v_mfma_f32_16x16x32_bf16 a[40:43], a[252:255], a[200:203], a[40:43]
v_mfma_f32_16x16x32_bf16 a[44:47], a[252:255], a[204:207], a[44:47]
v_mfma_f32_16x16x32_bf16 a[44:47], a[248:251], a[236:239], a[44:47]
s_waitcnt lgkmcnt(5)
v_mfma_f32_16x16x32_bf16 a[60:63], v[240:243], a[236:239], a[60:63]
ds_read_b64_tr_b16 a[248:249], v237 offset:45056
v_mfma_f32_16x16x32_bf16 a[60:63], v[244:247], a[204:207], a[60:63]
ds_read_b64_tr_b16 a[250:251], v237 offset:49152
v_mfma_f32_16x16x32_bf16 a[56:59], v[244:247], a[200:203], a[56:59]
ds_read_b64_tr_b16 a[252:253], v237 offset:45064
v_mfma_f32_16x16x32_bf16 a[56:59], v[240:243], a[232:235], a[56:59]
s_waitcnt lgkmcnt(8)
ds_read_b64_tr_b16 a[254:255], v237 offset:49160
v_add_u32 v237, 0xd000, v237
v_mfma_f32_16x16x32_bf16 a[52:55], v[240:243], a[228:231], a[52:55]
v_mfma_f32_16x16x32_bf16 a[52:55], v[244:247], a[196:199], a[52:55]
v_mfma_f32_16x16x32_bf16 a[48:51], v[244:247], a[192:195], a[48:51]
v_mfma_f32_16x16x32_bf16 a[48:51], v[240:243], a[224:227], a[48:51]
s_waitcnt lgkmcnt(6)
v_mfma_f32_16x16x32_bf16 a[64:67], a[240:243], a[192:195], a[64:67]
ds_read_b64_tr_b16 v[240:241], v238 offset:45056
v_mfma_f32_16x16x32_bf16 a[68:71], a[240:243], a[196:199], a[68:71]
ds_read_b64_tr_b16 v[242:243], v238 offset:49152
v_mfma_f32_16x16x32_bf16 a[72:75], a[240:243], a[200:203], a[72:75]
ds_read_b32 v255, v252
v_mfma_f32_16x16x32_bf16 a[76:79], a[240:243], a[204:207], a[76:79]
s_waitcnt lgkmcnt(7)
buffer_load_dwordx4 a[224:227], v254, s[8:11], s59 offen offset:0 sc1
v_mfma_f32_16x16x32_bf16 a[92:95], a[244:247], a[204:207], a[92:95]
ds_read_b64_tr_b16 v[244:245], v238 offset:45064
v_mfma_f32_16x16x32_bf16 a[88:91], a[244:247], a[200:203], a[88:91]
ds_read_b64_tr_b16 v[246:247], v238 offset:49160
v_add_u32 v238, 0xd000, v238
v_mfma_f32_16x16x32_bf16 a[84:87], a[244:247], a[196:199], a[84:87]
buffer_load_dwordx4 a[228:231], v254, s[8:11], s59 offen offset:1024 sc1
v_mfma_f32_16x16x32_bf16 a[80:83], a[244:247], a[192:195], a[80:83]
s_waitcnt lgkmcnt(7)
buffer_load_dwordx4 a[232:235], v254, s[8:11], s59 offen offset:2048 sc1
v_mfma_f32_16x16x32_bf16 a[96:99], a[248:251], a[192:195], a[96:99]
ds_read_b64_tr_b16 a[240:241], v239 offset:45056
v_mfma_f32_16x16x32_bf16 a[100:103], a[248:251], a[196:199], a[100:103]
ds_read_b64_tr_b16 a[242:243], v239 offset:49152
v_mfma_f32_16x16x32_bf16 a[104:107], a[248:251], a[200:203], a[104:107]
buffer_load_dwordx4 a[236:239], v254, s[8:11], s59 offen offset:3072 sc1
v_mfma_f32_16x16x32_bf16 a[108:111], a[248:251], a[204:207], a[108:111]
s_waitcnt lgkmcnt(4)
v_mfma_f32_16x16x32_bf16 a[124:127], a[252:255], a[204:207], a[124:127]
s_add_u32 s59, s59, 4096
ds_read_b64_tr_b16 a[244:245], v239 offset:45064
v_cmp_gt_u32 vcc, 15, v255
v_mfma_f32_16x16x32_bf16 a[120:123], a[252:255], a[200:203], a[120:123]
ds_read_b64_tr_b16 a[246:247], v239 offset:49160
v_add_u32 v239, 0xd000, v239
v_mfma_f32_16x16x32_bf16 a[116:119], a[252:255], a[196:199], a[116:119]
v_mfma_f32_16x16x32_bf16 a[112:115], a[252:255], a[192:195], a[112:115]
s_waitcnt lgkmcnt(6)
v_mfma_f32_16x16x32_bf16 a[128:131], v[240:243], a[192:195], a[128:131]
s_cbranch_vccnz k1_g15_s
k1_g15_b:
ds_read_b64_tr_b16 a[248:249], v235 offset:160
v_mfma_f32_16x16x32_bf16 a[132:135], v[240:243], a[196:199], a[132:135]
ds_read_b64_tr_b16 a[250:251], v235 offset:4768
v_mfma_f32_16x16x32_bf16 a[136:139], v[240:243], a[200:203], a[136:139]
ds_add_u32 v251, v253
v_mfma_f32_16x16x32_bf16 a[140:143], v[240:243], a[204:207], a[140:143]
s_waitcnt lgkmcnt(7)
v_mfma_f32_16x16x32_bf16 a[156:159], v[244:247], a[204:207], a[156:159]
ds_read_b64_tr_b16 a[252:253], v235 offset:18592
v_mfma_f32_16x16x32_bf16 a[152:155], v[244:247], a[200:203], a[152:155]
ds_read_b64_tr_b16 a[254:255], v235 offset:23200
v_mfma_f32_16x16x32_bf16 a[148:151], v[244:247], a[196:199], a[148:151]
v_mfma_f32_16x16x32_bf16 a[144:147], v[244:247], a[192:195], a[144:147]
s_waitcnt lgkmcnt(7)
v_mfma_f32_16x16x32_bf16 a[160:163], a[240:243], a[192:195], a[160:163]
ds_read_b64_tr_b16 v[240:241], v235 offset:192
v_mfma_f32_16x16x32_bf16 a[164:167], a[240:243], a[196:199], a[164:167]
ds_read_b64_tr_b16 v[242:243], v235 offset:4800
v_mfma_f32_16x16x32_bf16 a[168:171], a[240:243], a[200:203], a[168:171]
v_mfma_f32_16x16x32_bf16 a[172:175], a[240:243], a[204:207], a[172:175]
s_waitcnt lgkmcnt(7)
v_mfma_f32_16x16x32_bf16 a[188:191], a[244:247], a[204:207], a[188:191]
ds_read_b64_tr_b16 v[244:245], v235 offset:18624
v_mfma_f32_16x16x32_bf16 a[184:187], a[244:247], a[200:203], a[184:187]
ds_read_b64_tr_b16 v[246:247], v235 offset:23232
v_mfma_f32_16x16x32_bf16 a[180:183], a[244:247], a[196:199], a[180:183]
s_waitcnt vmcnt(16)
v_mfma_f32_16x16x32_bf16 a[176:179], a[244:247], a[192:195], a[176:179]
s_waitcnt lgkmcnt(7)
v_mfma_f32_16x16x32_bf16 v[160:163], a[248:251], a[208:211], v[160:163]
ds_read_b64_tr_b16 a[240:241], v235 offset:224
ds_read_b32 v255, v252
v_mfma_f32_16x16x32_bf16 v[164:167], a[248:251], a[212:215], v[164:167]
ds_read_b64_tr_b16 a[242:243], v235 offset:4832
v_mfma_f32_16x16x32_bf16 v[168:171], a[248:251], a[216:219], v[168:171]
v_mfma_f32_16x16x32_bf16 v[172:175], a[248:251], a[220:223], v[172:175]
s_waitcnt lgkmcnt(7)
v_mfma_f32_16x16x32_bf16 v[188:191], a[252:255], a[220:223], v[188:191]
ds_read_b64_tr_b16 a[244:245], v235 offset:18656
v_mfma_f32_16x16x32_bf16 v[184:187], a[252:255], a[216:219], v[184:187]
ds_read_b64_tr_b16 a[246:247], v235 offset:23264
v_mfma_f32_16x16x32_bf16 v[180:183], a[252:255], a[212:215], v[180:183]
v_mfma_f32_16x16x32_bf16 v[176:179], a[252:255], a[208:211], v[176:179]
s_waitcnt lgkmcnt(3)
v_mfma_f32_16x16x32_bf16 v[192:195], v[240:243], a[208:211], v[192:195]
ds_read_b64_tr_b16 a[248:249], v235 offset:256
v_cmp_gt_u32 vcc, 16, v255
v_mfma_f32_16x16x32_bf16 v[196:199], v[240:243], a[212:215], v[196:199]
ds_read_b64_tr_b16 a[250:251], v235 offset:4864
v_mfma_f32_16x16x32_bf16 v[200:203], v[240:243], a[216:219], v[200:203]
v_mfma_f32_16x16x32_bf16 v[204:207], v[240:243], a[220:223], v[204:207]
s_waitcnt lgkmcnt(5)
v_mfma_f32_16x16x32_bf16 v[220:223], v[244:247], a[220:223], v[220:223]
s_cbranch_vccnz k1_g16_s
k1_g16_b:
ds_read_b64_tr_b16 a[252:253], v235 offset:18688
v_mfma_f32_16x16x32_bf16 v[216:219], v[244:247], a[216:219], v[216:219]
s_add_u32 m0, s65, 49152
ds_read_b64_tr_b16 a[254:255], v235 offset:23296
v_mfma_f32_16x16x32_bf16 v[212:215], v[244:247], a[212:215], v[212:215]
buffer_load_dwordx4 v224, s[20:23], s63 offen offset:0 lds
v_mfma_f32_16x16x32_bf16 v[208:211], v[244:247], a[208:211], v[208:211]
s_waitcnt lgkmcnt(6)
v_mfma_f32_16x16x32_bf16 a[0:3], a[240:243], a[208:211], a[0:3]
ds_read_b64_tr_b16 v[240:241], v236 offset:36864
v_mfma_f32_16x16x32_bf16 a[4:7], a[240:243], a[212:215], a[4:7]
ds_read_b64_tr_b16 v[242:243], v236 offset:40960
v_mfma_f32_16x16x32_bf16 a[8:11], a[240:243], a[216:219], a[8:11]
buffer_load_dwordx4 v225, s[20:23], s63 offen offset:1024 lds
v_mfma_f32_16x16x32_bf16 a[12:15], a[240:243], a[220:223], a[12:15]
s_waitcnt lgkmcnt(6)
v_mfma_f32_16x16x32_bf16 a[28:31], a[244:247], a[220:223], a[28:31]
ds_read_b64_tr_b16 v[244:245], v236 offset:45056
v_mfma_f32_16x16x32_bf16 a[24:27], a[244:247], a[216:219], a[24:27]
ds_read_b64_tr_b16 v[246:247], v236 offset:49152
v_mfma_f32_16x16x32_bf16 a[20:23], a[244:247], a[212:215], a[20:23]
buffer_load_dwordx4 v226, s[20:23], s63 offen offset:2048 lds
v_mfma_f32_16x16x32_bf16 a[16:19], a[244:247], a[208:211], a[16:19]
s_waitcnt lgkmcnt(6)
v_mfma_f32_16x16x32_bf16 a[32:35], a[248:251], a[208:211], a[32:35]
ds_read_b64_tr_b16 a[240:241], v236 offset:36872
v_mfma_f32_16x16x32_bf16 a[36:39], a[248:251], a[212:215], a[36:39]
ds_read_b64_tr_b16 a[242:243], v236 offset:40968
v_mfma_f32_16x16x32_bf16 a[40:43], a[248:251], a[216:219], a[40:43]
buffer_load_dwordx4 v227, s[20:23], s63 offen offset:3072 lds
v_mfma_f32_16x16x32_bf16 a[44:47], a[248:251], a[220:223], a[44:47]
s_waitcnt lgkmcnt(6)
v_mfma_f32_16x16x32_bf16 a[60:63], a[252:255], a[220:223], a[60:63]
s_add_u32 s63, s63, 16384
ds_read_b64_tr_b16 a[244:245], v236 offset:45064
v_mfma_f32_16x16x32_bf16 a[56:59], a[252:255], a[216:219], a[56:59]
s_add_u32 m0, s65, 65536
ds_read_b64_tr_b16 a[246:247], v236 offset:49160
v_mfma_f32_16x16x32_bf16 a[52:55], a[252:255], a[212:215], a[52:55]
s_waitcnt vmcnt(4)
buffer_load_dwordx4 v228, s[24:27], s64 offen offset:0 lds
v_mfma_f32_16x16x32_bf16 a[48:51], a[252:255], a[208:211], a[48:51]
s_waitcnt lgkmcnt(4)
v_mfma_f32_16x16x32_bf16 a[64:67], v[240:243], a[208:211], a[64:67]
ds_read_b64_tr_b16 a[248:249], v237 offset:36864
v_mfma_f32_16x16x32_bf16 a[64:67], v[244:247], a[224:227], a[64:67]
ds_read_b64_tr_b16 a[250:251], v237 offset:40960
v_mfma_f32_16x16x32_bf16 a[68:71], v[244:247], a[228:231], a[68:71]
ds_read_b64_tr_b16 a[252:253], v237 offset:45056
v_mfma_f32_16x16x32_bf16 a[68:71], v[240:243], a[212:215], a[68:71]
s_waitcnt lgkmcnt(7)
ds_read_b64_tr_b16 a[254:255], v237 offset:49152
v_mfma_f32_16x16x32_bf16 a[72:75], v[240:243], a[216:219], a[72:75]
buffer_load_dwordx4 v229, s[24:27], s64 offen offset:1024 lds
v_mfma_f32_16x16x32_bf16 a[72:75], v[244:247], a[232:235], a[72:75]
v_mfma_f32_16x16x32_bf16 a[76:79], v[244:247], a[236:239], a[76:79]
buffer_load_dwordx4 v228, s[24:27], s64 offen offset:2048 lds
v_mfma_f32_16x16x32_bf16 a[76:79], v[240:243], a[220:223], a[76:79]
s_waitcnt lgkmcnt(4)
v_mfma_f32_16x16x32_bf16 a[92:95], a[240:243], a[220:223], a[92:95]
ds_read_b64_tr_b16 v[240:241], v237 offset:36872
v_mfma_f32_16x16x32_bf16 a[92:95], a[244:247], a[236:239], a[92:95]
s_add_u32 s12, s48, 75497472
s_addc_u32 s13, s49, 0
ds_read_b64_tr_b16 v[242:243], v237 offset:40968
v_mfma_f32_16x16x32_bf16 a[88:91], a[244:247], a[232:235], a[88:91]
s_mov_b32 s14, 10027008
ds_read_b64_tr_b16 v[244:245], v237 offset:45064
v_mfma_f32_16x16x32_bf16 a[88:91], a[240:243], a[216:219], a[88:91]
s_waitcnt lgkmcnt(7)
ds_read_b64_tr_b16 v[246:247], v237 offset:49160
v_mfma_f32_16x16x32_bf16 a[84:87], a[240:243], a[212:215], a[84:87]
s_mov_b32 s34, 5308416
buffer_load_dwordx4 v229, s[24:27], s64 offen offset:3072 lds
v_mfma_f32_16x16x32_bf16 a[84:87], a[244:247], a[228:231], a[84:87]
s_add_u32 s64, s64, 16384
v_mfma_f32_16x16x32_bf16 a[80:83], a[244:247], a[224:227], a[80:83]
s_add_u32 m0, s65, 81920
v_mfma_f32_16x16x32_bf16 a[80:83], a[240:243], a[208:211], a[80:83]
s_waitcnt lgkmcnt(4)
buffer_load_dwordx4 v228, s[24:27], s64 offen offset:0 lds
v_mfma_f32_16x16x32_bf16 a[96:99], a[248:251], a[208:211], a[96:99]
s_mov_b32 s18, 2359296
ds_read_b64_tr_b16 a[240:241], v238 offset:36864
v_mfma_f32_16x16x32_bf16 a[96:99], a[252:255], a[224:227], a[96:99]
s_mov_b32 s68, 0
ds_read_b64_tr_b16 a[242:243], v238 offset:40960
v_mfma_f32_16x16x32_bf16 a[100:103], a[252:255], a[228:231], a[100:103]
s_lshl_b32 s69, s2, 4
ds_read_b64_tr_b16 a[244:245], v238 offset:45056
v_mfma_f32_16x16x32_bf16 a[100:103], a[248:251], a[212:215], a[100:103]
s_waitcnt lgkmcnt(7)
ds_read_b64_tr_b16 a[246:247], v238 offset:49152
v_mfma_f32_16x16x32_bf16 a[104:107], a[248:251], a[216:219], a[104:107]
s_mul_i32 s70, s2, 18
buffer_load_dwordx4 v229, s[24:27], s64 offen offset:1024 lds
v_mfma_f32_16x16x32_bf16 a[104:107], a[252:255], a[232:235], a[104:107]
s_sub_u32 s70, s70, 18
v_mfma_f32_16x16x32_bf16 a[108:111], a[252:255], a[236:239], a[108:111]
s_mul_i32 s71, s3, 288
buffer_load_dwordx4 v228, s[24:27], s64 offen offset:2048 lds
v_mfma_f32_16x16x32_bf16 a[108:111], a[248:251], a[220:223], a[108:111]
s_waitcnt lgkmcnt(4)
v_accvgpr_read_b32 v248, a64
v_accvgpr_read_b32 v249, a65
v_mfma_f32_16x16x32_bf16 a[124:127], v[240:243], a[220:223], a[124:127]
s_mul_i32 s57, s3, 2506752
ds_read_b64_tr_b16 a[248:249], v238 offset:36872
v_accvgpr_read_b32 v250, a66
v_mfma_f32_16x16x32_bf16 a[124:127], v[244:247], a[236:239], a[124:127]
s_lshl_b32 s52, s2, 2
ds_read_b64_tr_b16 a[250:251], v238 offset:40968
v_accvgpr_read_b32 v251, a67
v_mfma_f32_16x16x32_bf16 a[120:123], v[244:247], a[232:235], a[120:123]
s_cmp_eq_u32 s3, 0
s_cselect_b32 s52, s52, 0x40000000
ds_read_b64_tr_b16 a[252:253], v238 offset:45064
v_accvgpr_read_b32 v252, a80
v_mfma_f32_16x16x32_bf16 a[120:123], v[240:243], a[216:219], a[120:123]
s_waitcnt lgkmcnt(7)
ds_read_b64_tr_b16 a[254:255], v238 offset:49160
v_accvgpr_read_b32 v253, a81
v_mfma_f32_16x16x32_bf16 a[116:119], v[240:243], a[212:215], a[116:119]
s_bfe_u32 s59, s2, 0x10000
buffer_load_dwordx4 v229, s[24:27], s64 offen offset:3072 lds
v_mfma_f32_16x16x32_bf16 a[116:119], v[244:247], a[228:231], a[116:119]
s_add_u32 s64, s64, 16384
v_accvgpr_read_b32 v254, a82
v_accvgpr_read_b32 v255, a83
v_mfma_f32_16x16x32_bf16 a[112:115], v[244:247], a[224:227], a[112:115]
s_lshl_b32 s59, s59, 5
v_mul_f32 v248, s42, v248
v_mul_f32 v249, s42, v249
v_mfma_f32_16x16x32_bf16 a[112:115], v[240:243], a[208:211], a[112:115]
s_waitcnt lgkmcnt(4)
v_mul_f32 v250, s42, v250
v_mul_f32 v251, s42, v251
v_mfma_f32_16x16x32_bf16 a[128:131], a[240:243], a[208:211], a[128:131]
s_lshr_b32 s74, s2, 3
ds_read_b64_tr_b16 v[240:241], v239 offset:36864
v_mul_f32 v252, s42, v252
v_mfma_f32_16x16x32_bf16 a[128:131], a[244:247], a[224:227], a[128:131]
s_add_u32 s59, s59, s74
ds_read_b64_tr_b16 v[242:243], v239 offset:40960
v_mul_f32 v253, s42, v253
v_mfma_f32_16x16x32_bf16 a[132:135], a[244:247], a[228:231], a[132:135]
s_lshl_b32 s59, s59, 2
ds_read_b64_tr_b16 v[244:245], v239 offset:45056
v_mul_f32 v254, s42, v254
v_mfma_f32_16x16x32_bf16 a[132:135], a[240:243], a[212:215], a[132:135]
s_waitcnt lgkmcnt(7)
ds_read_b64_tr_b16 v[246:247], v239 offset:49152
v_mul_f32 v255, s42, v255
v_mfma_f32_16x16x32_bf16 a[136:139], a[240:243], a[216:219], a[136:139]
s_bfe_u32 s74, s2, 0x20001
v_cvt_pk_bf16_f32 v248, v248, v249
v_cvt_pk_bf16_f32 v249, v250, v251
v_mfma_f32_16x16x32_bf16 a[136:139], a[244:247], a[232:235], a[136:139]
s_add_u32 s59, s59, s74
v_cvt_pk_bf16_f32 v250, v252, v253
v_cvt_pk_bf16_f32 v251, v254, v255
v_mfma_f32_16x16x32_bf16 a[140:143], a[244:247], a[236:239], a[140:143]
s_lshl_b32 s59, s59, 2
v_accvgpr_write_b32 a80, v248
v_accvgpr_write_b32 a81, v249
v_mfma_f32_16x16x32_bf16 a[140:143], a[240:243], a[220:223], a[140:143]
s_waitcnt lgkmcnt(4)
v_accvgpr_write_b32 a82, v250
v_accvgpr_write_b32 a83, v251
v_mfma_f32_16x16x32_bf16 a[156:159], a[248:251], a[220:223], a[156:159]
s_add_u32 s59, s59, s3
ds_read_b64_tr_b16 a[240:241], v239 offset:36872
v_accvgpr_read_b32 v248, a68
v_mfma_f32_16x16x32_bf16 a[156:159], a[252:255], a[236:239], a[156:159]
s_mul_i32 s59, s59, 10240
ds_read_b64_tr_b16 a[242:243], v239 offset:40968
v_accvgpr_read_b32 v249, a69
v_mfma_f32_16x16x32_bf16 a[152:155], a[252:255], a[232:235], a[152:155]
s_add_u32 s59, s59, 10551296
ds_read_b64_tr_b16 a[244:245], v239 offset:45064
v_accvgpr_read_b32 v250, a70
v_mfma_f32_16x16x32_bf16 a[152:155], a[248:251], a[216:219], a[152:155]
s_waitcnt lgkmcnt(7)
ds_read_b64_tr_b16 a[246:247], v239 offset:49160
v_accvgpr_read_b32 v251, a71
v_mfma_f32_16x16x32_bf16 a[148:151], a[248:251], a[212:215], a[148:151]
s_bfe_u32 s58, s2, 0x10001
v_accvgpr_read_b32 v252, a84
v_accvgpr_read_b32 v253, a85
v_mfma_f32_16x16x32_bf16 a[148:151], a[252:255], a[228:231], a[148:151]
s_mul_i32 s58, s58, 5120
v_accvgpr_read_b32 v254, a86
v_accvgpr_read_b32 v255, a87
v_mfma_f32_16x16x32_bf16 a[144:147], a[252:255], a[224:227], a[144:147]
s_bfe_u32 s74, s2, 0x10002
v_mul_f32 v248, s42, v248
v_mul_f32 v249, s42, v249
v_mfma_f32_16x16x32_bf16 a[144:147], a[248:251], a[208:211], a[144:147]
s_waitcnt lgkmcnt(4)
v_mul_f32 v250, s42, v250
v_mul_f32 v251, s42, v251
v_mfma_f32_16x16x32_bf16 a[160:163], v[240:243], a[208:211], a[160:163]
s_mul_i32 s74, s74, 3072
ds_read_b64_tr_b16 a[248:249], v235 offset:0
v_mul_f32 v252, s42, v252
v_mfma_f32_16x16x32_bf16 a[160:163], v[244:247], a[224:227], a[160:163]
s_add_u32 s58, s58, s74
ds_read_b64_tr_b16 a[250:251], v235 offset:4608
v_mul_f32 v253, s42, v253
v_mfma_f32_16x16x32_bf16 a[164:167], v[244:247], a[228:231], a[164:167]
s_add_u32 s58, s58, s59
ds_read_b64_tr_b16 a[252:253], v235 offset:9216
v_mul_f32 v254, s42, v254
v_mfma_f32_16x16x32_bf16 a[164:167], v[240:243], a[212:215], a[164:167]
s_waitcnt lgkmcnt(7)
ds_read_b64_tr_b16 a[254:255], v235 offset:13824
v_mul_f32 v255, s42, v255
v_mfma_f32_16x16x32_bf16 a[168:171], v[240:243], a[216:219], a[168:171]
v_cvt_pk_bf16_f32 v248, v248, v249
v_cvt_pk_bf16_f32 v249, v250, v251
v_mfma_f32_16x16x32_bf16 a[168:171], v[244:247], a[232:235], a[168:171]
v_cvt_pk_bf16_f32 v250, v252, v253
v_cvt_pk_bf16_f32 v251, v254, v255
v_mfma_f32_16x16x32_bf16 a[172:175], v[244:247], a[236:239], a[172:175]
v_accvgpr_write_b32 a84, v248
v_accvgpr_write_b32 a85, v249
v_mfma_f32_16x16x32_bf16 a[172:175], v[240:243], a[220:223], a[172:175]
s_waitcnt lgkmcnt(4)
v_accvgpr_write_b32 a86, v250
v_accvgpr_write_b32 a87, v251
v_mfma_f32_16x16x32_bf16 a[188:191], a[240:243], a[220:223], a[188:191]
ds_read_b64_tr_b16 v[240:241], v235 offset:18432
v_accvgpr_read_b32 v248, a72
v_mfma_f32_16x16x32_bf16 a[188:191], a[244:247], a[236:239], a[188:191]
ds_read_b64_tr_b16 v[242:243], v235 offset:23040
v_accvgpr_read_b32 v249, a73
v_mfma_f32_16x16x32_bf16 a[184:187], a[244:247], a[232:235], a[184:187]
ds_read_b64_tr_b16 v[244:245], v235 offset:27648
v_accvgpr_read_b32 v250, a74
v_mfma_f32_16x16x32_bf16 a[184:187], a[240:243], a[216:219], a[184:187]
s_waitcnt lgkmcnt(7)
ds_read_b64_tr_b16 v[246:247], v235 offset:32256
v_accvgpr_read_b32 v251, a75
v_mfma_f32_16x16x32_bf16 a[180:183], a[240:243], a[212:215], a[180:183]
v_accvgpr_read_b32 v252, a88
v_accvgpr_read_b32 v253, a89
v_mfma_f32_16x16x32_bf16 a[180:183], a[244:247], a[228:231], a[180:183]
v_accvgpr_read_b32 v254, a90
v_accvgpr_read_b32 v255, a91
v_mfma_f32_16x16x32_bf16 a[176:179], a[244:247], a[224:227], a[176:179]
v_mul_f32 v248, s42, v248
v_mul_f32 v249, s42, v249
v_mfma_f32_16x16x32_bf16 a[176:179], a[240:243], a[208:211], a[176:179]
s_waitcnt lgkmcnt(4)
v_mul_f32 v250, s42, v250
v_mul_f32 v251, s42, v251
v_mfma_f32_16x16x32_bf16 v[0:3], a[248:251], a[208:211], v[0:3]
ds_read_b64_tr_b16 a[240:241], v235 offset:32
v_mul_f32 v252, s42, v252
v_mfma_f32_16x16x32_bf16 v[0:3], a[252:255], a[224:227], v[0:3]
ds_read_b64_tr_b16 a[242:243], v235 offset:4640
v_mul_f32 v253, s42, v253
v_mfma_f32_16x16x32_bf16 v[4:7], a[252:255], a[228:231], v[4:7]
ds_read_b64_tr_b16 a[244:245], v235 offset:9248
v_mul_f32 v254, s42, v254
v_mfma_f32_16x16x32_bf16 v[4:7], a[248:251], a[212:215], v[4:7]
s_waitcnt lgkmcnt(7)
ds_read_b64_tr_b16 a[246:247], v235 offset:13856
v_mul_f32 v255, s42, v255
v_mfma_f32_16x16x32_bf16 v[8:11], a[248:251], a[216:219], v[8:11]
v_cvt_pk_bf16_f32 v248, v248, v249
v_cvt_pk_bf16_f32 v249, v250, v251
v_mfma_f32_16x16x32_bf16 v[8:11], a[252:255], a[232:235], v[8:11]
v_cvt_pk_bf16_f32 v250, v252, v253
v_cvt_pk_bf16_f32 v251, v254, v255
v_mfma_f32_16x16x32_bf16 v[12:15], a[252:255], a[236:239], v[12:15]
v_accvgpr_write_b32 a88, v248
v_accvgpr_write_b32 a89, v249
v_mfma_f32_16x16x32_bf16 v[12:15], a[248:251], a[220:223], v[12:15]
s_waitcnt lgkmcnt(4)
v_accvgpr_write_b32 a90, v250
v_accvgpr_write_b32 a91, v251
v_mfma_f32_16x16x32_bf16 v[28:31], v[240:243], a[220:223], v[28:31]
ds_read_b64_tr_b16 a[248:249], v235 offset:18464
v_accvgpr_read_b32 v248, a76
v_mfma_f32_16x16x32_bf16 v[28:31], v[244:247], a[236:239], v[28:31]
ds_read_b64_tr_b16 a[250:251], v235 offset:23072
v_accvgpr_read_b32 v249, a77
v_mfma_f32_16x16x32_bf16 v[24:27], v[244:247], a[232:235], v[24:27]
ds_read_b64_tr_b16 a[252:253], v235 offset:27680
v_accvgpr_read_b32 v250, a78
v_mfma_f32_16x16x32_bf16 v[24:27], v[240:243], a[216:219], v[24:27]
s_waitcnt lgkmcnt(7)
ds_read_b64_tr_b16 a[254:255], v235 offset:32288
v_accvgpr_read_b32 v251, a79
v_mfma_f32_16x16x32_bf16 v[20:23], v[240:243], a[212:215], v[20:23]
v_accvgpr_read_b32 v252, a92
v_accvgpr_read_b32 v253, a93
v_mfma_f32_16x16x32_bf16 v[20:23], v[244:247], a[228:231], v[20:23]
v_accvgpr_read_b32 v254, a94
v_accvgpr_read_b32 v255, a95
v_mfma_f32_16x16x32_bf16 v[16:19], v[244:247], a[224:227], v[16:19]
v_mul_f32 v248, s42, v248
v_mul_f32 v249, s42, v249
v_mfma_f32_16x16x32_bf16 v[16:19], v[240:243], a[208:211], v[16:19]
s_waitcnt lgkmcnt(4)
v_mul_f32 v250, s42, v250
v_mul_f32 v251, s42, v251
v_mfma_f32_16x16x32_bf16 v[32:35], a[240:243], a[208:211], v[32:35]
ds_read_b64_tr_b16 v[240:241], v235 offset:64
v_mul_f32 v252, s42, v252
v_mfma_f32_16x16x32_bf16 v[32:35], a[244:247], a[224:227], v[32:35]
ds_read_b64_tr_b16 v[242:243], v235 offset:4672
v_mul_f32 v253, s42, v253
v_mfma_f32_16x16x32_bf16 v[36:39], a[244:247], a[228:231], v[36:39]
ds_read_b64_tr_b16 v[244:245], v235 offset:9280
v_mul_f32 v254, s42, v254
v_mfma_f32_16x16x32_bf16 v[36:39], a[240:243], a[212:215], v[36:39]
s_waitcnt lgkmcnt(7)
ds_read_b64_tr_b16 v[246:247], v235 offset:13888
v_mul_f32 v255, s42, v255
v_mfma_f32_16x16x32_bf16 v[40:43], a[240:243], a[216:219], v[40:43]
v_cvt_pk_bf16_f32 v248, v248, v249
v_cvt_pk_bf16_f32 v249, v250, v251
v_mfma_f32_16x16x32_bf16 v[40:43], a[244:247], a[232:235], v[40:43]
v_cvt_pk_bf16_f32 v250, v252, v253
v_cvt_pk_bf16_f32 v251, v254, v255
v_mfma_f32_16x16x32_bf16 v[44:47], a[244:247], a[236:239], v[44:47]
v_accvgpr_write_b32 a92, v248
v_accvgpr_write_b32 a93, v249
v_mfma_f32_16x16x32_bf16 v[44:47], a[240:243], a[220:223], v[44:47]
s_waitcnt lgkmcnt(4)
v_accvgpr_write_b32 a94, v250
v_accvgpr_write_b32 a95, v251
v_mfma_f32_16x16x32_bf16 v[60:63], a[248:251], a[220:223], v[60:63]
ds_read_b64_tr_b16 a[240:241], v235 offset:18496
v_accvgpr_read_b32 v248, a96
v_mfma_f32_16x16x32_bf16 v[60:63], a[252:255], a[236:239], v[60:63]
ds_read_b64_tr_b16 a[242:243], v235 offset:23104
v_accvgpr_read_b32 v249, a97
v_mfma_f32_16x16x32_bf16 v[56:59], a[252:255], a[232:235], v[56:59]
ds_read_b64_tr_b16 a[244:245], v235 offset:27712
v_accvgpr_read_b32 v250, a98
v_mfma_f32_16x16x32_bf16 v[56:59], a[248:251], a[216:219], v[56:59]
s_waitcnt lgkmcnt(7)
ds_read_b64_tr_b16 a[246:247], v235 offset:32320
v_accvgpr_read_b32 v251, a99
v_mfma_f32_16x16x32_bf16 v[52:55], a[248:251], a[212:215], v[52:55]
v_accvgpr_read_b32 v252, a112
v_accvgpr_read_b32 v253, a113
v_mfma_f32_16x16x32_bf16 v[52:55], a[252:255], a[228:231], v[52:55]
v_accvgpr_read_b32 v254, a114
v_accvgpr_read_b32 v255, a115
v_mfma_f32_16x16x32_bf16 v[48:51], a[252:255], a[224:227], v[48:51]
v_mul_f32 v248, s42, v248
v_mul_f32 v249, s42, v249
v_mfma_f32_16x16x32_bf16 v[48:51], a[248:251], a[208:211], v[48:51]
s_waitcnt lgkmcnt(4)
v_mul_f32 v250, s42, v250
v_mul_f32 v251, s42, v251
v_mfma_f32_16x16x32_bf16 v[64:67], v[240:243], a[208:211], v[64:67]
ds_read_b64_tr_b16 a[248:249], v235 offset:96
v_mul_f32 v252, s42, v252
v_mfma_f32_16x16x32_bf16 v[64:67], v[244:247], a[224:227], v[64:67]
ds_read_b64_tr_b16 a[250:251], v235 offset:4704
v_mul_f32 v253, s42, v253
v_mfma_f32_16x16x32_bf16 v[68:71], v[244:247], a[228:231], v[68:71]
ds_read_b64_tr_b16 a[252:253], v235 offset:9312
v_mul_f32 v254, s42, v254
v_mfma_f32_16x16x32_bf16 v[68:71], v[240:243], a[212:215], v[68:71]
s_waitcnt lgkmcnt(7)
ds_read_b64_tr_b16 a[254:255], v235 offset:13920
v_mul_f32 v255, s42, v255
v_mfma_f32_16x16x32_bf16 v[72:75], v[240:243], a[216:219], v[72:75]
v_cvt_pk_bf16_f32 v248, v248, v249
v_cvt_pk_bf16_f32 v249, v250, v251
v_mfma_f32_16x16x32_bf16 v[72:75], v[244:247], a[232:235], v[72:75]
v_cvt_pk_bf16_f32 v250, v252, v253
v_cvt_pk_bf16_f32 v251, v254, v255
v_mfma_f32_16x16x32_bf16 v[76:79], v[244:247], a[236:239], v[76:79]
v_accvgpr_write_b32 a112, v248
v_accvgpr_write_b32 a113, v249
v_mfma_f32_16x16x32_bf16 v[76:79], v[240:243], a[220:223], v[76:79]
s_waitcnt lgkmcnt(4)
v_accvgpr_write_b32 a114, v250
v_accvgpr_write_b32 a115, v251
v_mfma_f32_16x16x32_bf16 v[92:95], a[240:243], a[220:223], v[92:95]
ds_read_b64_tr_b16 v[240:241], v235 offset:18528
v_accvgpr_read_b32 v248, a100
v_mfma_f32_16x16x32_bf16 v[92:95], a[244:247], a[236:239], v[92:95]
ds_read_b64_tr_b16 v[242:243], v235 offset:23136
v_accvgpr_read_b32 v249, a101
v_mfma_f32_16x16x32_bf16 v[88:91], a[244:247], a[232:235], v[88:91]
ds_read_b64_tr_b16 v[244:245], v235 offset:27744
v_accvgpr_read_b32 v250, a102
v_mfma_f32_16x16x32_bf16 v[88:91], a[240:243], a[216:219], v[88:91]
s_waitcnt lgkmcnt(7)
ds_read_b64_tr_b16 v[246:247], v235 offset:32352
v_accvgpr_read_b32 v251, a103
v_mfma_f32_16x16x32_bf16 v[84:87], a[240:243], a[212:215], v[84:87]
v_accvgpr_read_b32 v252, a116
v_accvgpr_read_b32 v253, a117
v_mfma_f32_16x16x32_bf16 v[84:87], a[244:247], a[228:231], v[84:87]
v_accvgpr_read_b32 v254, a118
v_accvgpr_read_b32 v255, a119
v_mfma_f32_16x16x32_bf16 v[80:83], a[244:247], a[224:227], v[80:83]
v_mul_f32 v248, s42, v248
v_mul_f32 v249, s42, v249
v_mfma_f32_16x16x32_bf16 v[80:83], a[240:243], a[208:211], v[80:83]
s_waitcnt lgkmcnt(4)
v_mul_f32 v250, s42, v250
v_mul_f32 v251, s42, v251
v_mfma_f32_16x16x32_bf16 v[96:99], a[248:251], a[208:211], v[96:99]
ds_read_b64_tr_b16 a[240:241], v235 offset:128
v_mul_f32 v252, s42, v252
v_mfma_f32_16x16x32_bf16 v[96:99], a[252:255], a[224:227], v[96:99]
ds_read_b64_tr_b16 a[242:243], v235 offset:4736
v_mul_f32 v253, s42, v253
v_mfma_f32_16x16x32_bf16 v[100:103], a[252:255], a[228:231], v[100:103]
ds_read_b64_tr_b16 a[244:245], v235 offset:9344
v_mul_f32 v254, s42, v254
v_mfma_f32_16x16x32_bf16 v[100:103], a[248:251], a[212:215], v[100:103]
s_waitcnt lgkmcnt(7)
ds_read_b64_tr_b16 a[246:247], v235 offset:13952
v_mul_f32 v255, s42, v255
v_mfma_f32_16x16x32_bf16 v[104:107], a[248:251], a[216:219], v[104:107]
v_cvt_pk_bf16_f32 v248, v248, v249
v_cvt_pk_bf16_f32 v249, v250, v251
v_mfma_f32_16x16x32_bf16 v[104:107], a[252:255], a[232:235], v[104:107]
v_cvt_pk_bf16_f32 v250, v252, v253
v_cvt_pk_bf16_f32 v251, v254, v255
v_mfma_f32_16x16x32_bf16 v[108:111], a[252:255], a[236:239], v[108:111]
v_accvgpr_write_b32 a116, v248
v_accvgpr_write_b32 a117, v249
v_mfma_f32_16x16x32_bf16 v[108:111], a[248:251], a[220:223], v[108:111]
s_waitcnt lgkmcnt(4)
v_accvgpr_write_b32 a118, v250
v_accvgpr_write_b32 a119, v251
v_mfma_f32_16x16x32_bf16 v[124:127], v[240:243], a[220:223], v[124:127]
ds_read_b64_tr_b16 a[248:249], v235 offset:18560
v_accvgpr_read_b32 v248, a104
v_mfma_f32_16x16x32_bf16 v[124:127], v[244:247], a[236:239], v[124:127]
ds_read_b64_tr_b16 a[250:251], v235 offset:23168
v_accvgpr_read_b32 v249, a105
v_mfma_f32_16x16x32_bf16 v[120:123], v[244:247], a[232:235], v[120:123]
ds_read_b64_tr_b16 a[252:253], v235 offset:27776
v_accvgpr_read_b32 v250, a106
v_mfma_f32_16x16x32_bf16 v[120:123], v[240:243], a[216:219], v[120:123]
s_waitcnt lgkmcnt(7)
ds_read_b64_tr_b16 a[254:255], v235 offset:32384
v_accvgpr_read_b32 v251, a107
v_mfma_f32_16x16x32_bf16 v[116:119], v[240:243], a[212:215], v[116:119]
v_accvgpr_read_b32 v252, a120
v_accvgpr_read_b32 v253, a121
v_mfma_f32_16x16x32_bf16 v[116:119], v[244:247], a[228:231], v[116:119]
v_accvgpr_read_b32 v254, a122
v_accvgpr_read_b32 v255, a123
v_mfma_f32_16x16x32_bf16 v[112:115], v[244:247], a[224:227], v[112:115]
v_mul_f32 v248, s42, v248
v_mul_f32 v249, s42, v249
v_mfma_f32_16x16x32_bf16 v[112:115], v[240:243], a[208:211], v[112:115]
s_waitcnt lgkmcnt(4)
v_mul_f32 v250, s42, v250
v_mul_f32 v251, s42, v251
v_mfma_f32_16x16x32_bf16 v[128:131], a[240:243], a[208:211], v[128:131]
ds_read_b64_tr_b16 v[240:241], v235 offset:9376
v_mul_f32 v252, s42, v252
v_mfma_f32_16x16x32_bf16 v[128:131], a[244:247], a[224:227], v[128:131]
ds_read_b64_tr_b16 v[242:243], v235 offset:13984
v_mul_f32 v253, s42, v253
v_mfma_f32_16x16x32_bf16 v[132:135], a[244:247], a[228:231], v[132:135]
ds_read_b64_tr_b16 v[244:245], v235 offset:27808
v_mul_f32 v254, s42, v254
v_mfma_f32_16x16x32_bf16 v[132:135], a[240:243], a[212:215], v[132:135]
s_waitcnt lgkmcnt(7)
ds_read_b64_tr_b16 v[246:247], v235 offset:32416
v_mul_f32 v255, s42, v255
v_mfma_f32_16x16x32_bf16 v[136:139], a[240:243], a[216:219], v[136:139]
v_cvt_pk_bf16_f32 v248, v248, v249
v_cvt_pk_bf16_f32 v249, v250, v251
v_mfma_f32_16x16x32_bf16 v[136:139], a[244:247], a[232:235], v[136:139]
v_cvt_pk_bf16_f32 v250, v252, v253
v_cvt_pk_bf16_f32 v251, v254, v255
v_mfma_f32_16x16x32_bf16 v[140:143], a[244:247], a[236:239], v[140:143]
v_accvgpr_write_b32 a120, v248
v_accvgpr_write_b32 a121, v249
v_mfma_f32_16x16x32_bf16 v[140:143], a[240:243], a[220:223], v[140:143]
s_waitcnt lgkmcnt(4)
v_accvgpr_write_b32 a122, v250
v_accvgpr_write_b32 a123, v251
v_mfma_f32_16x16x32_bf16 v[156:159], a[248:251], a[220:223], v[156:159]
ds_read_b64_tr_b16 a[240:241], v235 offset:9408
v_accvgpr_read_b32 v248, a108
v_mfma_f32_16x16x32_bf16 v[156:159], a[252:255], a[236:239], v[156:159]
ds_read_b64_tr_b16 a[242:243], v235 offset:14016
v_accvgpr_read_b32 v249, a109
v_mfma_f32_16x16x32_bf16 v[152:155], a[252:255], a[232:235], v[152:155]
ds_read_b64_tr_b16 a[244:245], v235 offset:27840
v_accvgpr_read_b32 v250, a110
v_mfma_f32_16x16x32_bf16 v[152:155], a[248:251], a[216:219], v[152:155]
s_waitcnt lgkmcnt(7)
ds_read_b64_tr_b16 a[246:247], v235 offset:32448
v_accvgpr_read_b32 v251, a111
v_mfma_f32_16x16x32_bf16 v[148:151], a[248:251], a[212:215], v[148:151]
v_accvgpr_read_b32 v252, a124
v_accvgpr_read_b32 v253, a125
v_mfma_f32_16x16x32_bf16 v[148:151], a[252:255], a[228:231], v[148:151]
v_accvgpr_read_b32 v254, a126
v_accvgpr_read_b32 v255, a127
v_mfma_f32_16x16x32_bf16 v[144:147], a[252:255], a[224:227], v[144:147]
v_mul_f32 v248, s42, v248
v_mul_f32 v249, s42, v249
v_mfma_f32_16x16x32_bf16 v[144:147], a[248:251], a[208:211], v[144:147]
s_waitcnt lgkmcnt(6)
v_mul_f32 v250, s42, v250
v_mul_f32 v251, s42, v251
v_mfma_f32_16x16x32_bf16 v[160:163], v[240:243], a[224:227], v[160:163]
ds_read_b64_tr_b16 a[248:249], v235 offset:9440
v_mul_f32 v252, s42, v252
v_mfma_f32_16x16x32_bf16 v[164:167], v[240:243], a[228:231], v[164:167]
ds_read_b64_tr_b16 a[250:251], v235 offset:14048
v_mul_f32 v253, s42, v253
v_mfma_f32_16x16x32_bf16 v[168:171], v[240:243], a[232:235], v[168:171]
v_mul_f32 v254, s42, v254
v_mul_f32 v255, s42, v255
v_mfma_f32_16x16x32_bf16 v[172:175], v[240:243], a[236:239], v[172:175]
s_waitcnt lgkmcnt(6)
v_cvt_pk_bf16_f32 v248, v248, v249
v_cvt_pk_bf16_f32 v249, v250, v251
v_mfma_f32_16x16x32_bf16 v[188:191], v[244:247], a[236:239], v[188:191]
ds_read_b64_tr_b16 a[252:253], v235 offset:27872
v_cvt_pk_bf16_f32 v250, v252, v253
v_mfma_f32_16x16x32_bf16 v[184:187], v[244:247], a[232:235], v[184:187]
ds_read_b64_tr_b16 a[254:255], v235 offset:32480
v_cvt_pk_bf16_f32 v251, v254, v255
v_mfma_f32_16x16x32_bf16 v[180:183], v[244:247], a[228:231], v[180:183]
v_accvgpr_write_b32 a124, v248
v_accvgpr_write_b32 a125, v249
v_mfma_f32_16x16x32_bf16 v[176:179], v[244:247], a[224:227], v[176:179]
s_waitcnt lgkmcnt(6)
v_accvgpr_write_b32 a126, v250
v_accvgpr_write_b32 a127, v251
v_mfma_f32_16x16x32_bf16 v[192:195], a[240:243], a[224:227], v[192:195]
ds_read_b64_tr_b16 v[240:241], v235 offset:9472
v_accvgpr_read_b32 v248, a128
v_mfma_f32_16x16x32_bf16 v[196:199], a[240:243], a[228:231], v[196:199]
ds_read_b64_tr_b16 v[242:243], v235 offset:14080
v_accvgpr_read_b32 v249, a129
v_mfma_f32_16x16x32_bf16 v[200:203], a[240:243], a[232:235], v[200:203]
v_accvgpr_read_b32 v250, a130
v_accvgpr_read_b32 v251, a131
v_mfma_f32_16x16x32_bf16 v[204:207], a[240:243], a[236:239], v[204:207]
s_waitcnt lgkmcnt(6)
v_accvgpr_read_b32 v252, a144
v_accvgpr_read_b32 v253, a145
v_mfma_f32_16x16x32_bf16 v[220:223], a[244:247], a[236:239], v[220:223]
ds_read_b64_tr_b16 v[244:245], v235 offset:27904
v_accvgpr_read_b32 v254, a146
v_mfma_f32_16x16x32_bf16 v[216:219], a[244:247], a[232:235], v[216:219]
ds_read_b64_tr_b16 v[246:247], v235 offset:32512
v_accvgpr_read_b32 v255, a147
v_mfma_f32_16x16x32_bf16 v[212:215], a[244:247], a[228:231], v[212:215]
v_mul_f32 v248, s42, v248
v_mul_f32 v249, s42, v249
v_mfma_f32_16x16x32_bf16 v[208:211], a[244:247], a[224:227], v[208:211]
s_waitcnt lgkmcnt(6)
v_mul_f32 v250, s42, v250
v_mul_f32 v251, s42, v251
v_mfma_f32_16x16x32_bf16 a[0:3], a[248:251], a[224:227], a[0:3]
v_mul_f32 v252, s42, v252
v_mul_f32 v253, s42, v253
v_mfma_f32_16x16x32_bf16 a[4:7], a[248:251], a[228:231], a[4:7]
v_mul_f32 v254, s42, v254
v_mul_f32 v255, s42, v255
v_mfma_f32_16x16x32_bf16 a[8:11], a[248:251], a[232:235], a[8:11]
v_cvt_pk_bf16_f32 v248, v248, v249
v_cvt_pk_bf16_f32 v249, v250, v251
v_mfma_f32_16x16x32_bf16 a[12:15], a[248:251], a[236:239], a[12:15]
s_waitcnt lgkmcnt(4)
v_cvt_pk_bf16_f32 v250, v252, v253
v_cvt_pk_bf16_f32 v251, v254, v255
v_mfma_f32_16x16x32_bf16 a[28:31], a[252:255], a[236:239], a[28:31]
v_accvgpr_write_b32 a144, v248
v_accvgpr_write_b32 a145, v249
v_mfma_f32_16x16x32_bf16 a[24:27], a[252:255], a[232:235], a[24:27]
v_accvgpr_write_b32 a146, v250
v_accvgpr_write_b32 a147, v251
v_mfma_f32_16x16x32_bf16 a[20:23], a[252:255], a[228:231], a[20:23]
v_accvgpr_read_b32 v248, a132
v_accvgpr_read_b32 v249, a133
v_mfma_f32_16x16x32_bf16 a[16:19], a[252:255], a[224:227], a[16:19]
s_waitcnt lgkmcnt(2)
v_accvgpr_read_b32 v250, a134
v_accvgpr_read_b32 v251, a135
v_mfma_f32_16x16x32_bf16 a[32:35], v[240:243], a[224:227], a[32:35]
v_accvgpr_read_b32 v252, a148
v_accvgpr_read_b32 v253, a149
v_mfma_f32_16x16x32_bf16 a[36:39], v[240:243], a[228:231], a[36:39]
v_accvgpr_read_b32 v254, a150
v_accvgpr_read_b32 v255, a151
v_mfma_f32_16x16x32_bf16 a[40:43], v[240:243], a[232:235], a[40:43]
v_mul_f32 v248, s42, v248
v_mul_f32 v249, s42, v249
v_mfma_f32_16x16x32_bf16 a[44:47], v[240:243], a[236:239], a[44:47]
s_waitcnt lgkmcnt(0)
v_mul_f32 v250, s42, v250
v_mul_f32 v251, s42, v251
v_mfma_f32_16x16x32_bf16 a[60:63], v[244:247], a[236:239], a[60:63]
v_mul_f32 v252, s42, v252
v_mul_f32 v253, s42, v253
v_mfma_f32_16x16x32_bf16 a[56:59], v[244:247], a[232:235], a[56:59]
v_mul_f32 v254, s42, v254
v_mul_f32 v255, s42, v255
v_mfma_f32_16x16x32_bf16 a[52:55], v[244:247], a[228:231], a[52:55]
v_cvt_pk_bf16_f32 v248, v248, v249
v_cvt_pk_bf16_f32 v249, v250, v251
v_mfma_f32_16x16x32_bf16 a[48:51], v[244:247], a[224:227], a[48:51]
v_cvt_pk_bf16_f32 v250, v252, v253
v_cvt_pk_bf16_f32 v251, v254, v255
v_accvgpr_write_b32 a148, v248
v_accvgpr_write_b32 a149, v249
v_accvgpr_write_b32 a150, v250
v_accvgpr_write_b32 a151, v251
v_accvgpr_read_b32 v248, a136
v_accvgpr_read_b32 v249, a137
v_accvgpr_read_b32 v250, a138
v_accvgpr_read_b32 v251, a139
v_accvgpr_read_b32 v252, a152
v_accvgpr_read_b32 v253, a153
v_accvgpr_read_b32 v254, a154
v_accvgpr_read_b32 v255, a155
v_mul_f32 v248, s42, v248
v_mul_f32 v249, s42, v249
v_mul_f32 v250, s42, v250
v_mul_f32 v251, s42, v251
v_mul_f32 v252, s42, v252
v_mul_f32 v253, s42, v253
v_mul_f32 v254, s42, v254
v_mul_f32 v255, s42, v255
v_cvt_pk_bf16_f32 v248, v248, v249
v_cvt_pk_bf16_f32 v249, v250, v251
v_cvt_pk_bf16_f32 v250, v252, v253
v_cvt_pk_bf16_f32 v251, v254, v255
v_accvgpr_write_b32 a152, v248
v_accvgpr_write_b32 a153, v249
v_accvgpr_write_b32 a154, v250
v_accvgpr_write_b32 a155, v251
v_accvgpr_read_b32 v248, a140
v_accvgpr_read_b32 v249, a141
v_accvgpr_read_b32 v250, a142
v_accvgpr_read_b32 v251, a143
v_accvgpr_read_b32 v252, a156
v_accvgpr_read_b32 v253, a157
v_accvgpr_read_b32 v254, a158
v_accvgpr_read_b32 v255, a159
v_mul_f32 v248, s42, v248
v_mul_f32 v249, s42, v249
v_mul_f32 v250, s42, v250
v_mul_f32 v251, s42, v251
v_mul_f32 v252, s42, v252
v_mul_f32 v253, s42, v253
v_mul_f32 v254, s42, v254
v_mul_f32 v255, s42, v255
v_cvt_pk_bf16_f32 v248, v248, v249
v_cvt_pk_bf16_f32 v249, v250, v251
v_cvt_pk_bf16_f32 v250, v252, v253
v_cvt_pk_bf16_f32 v251, v254, v255
v_accvgpr_write_b32 a156, v248
v_accvgpr_write_b32 a157, v249
v_accvgpr_write_b32 a158, v250
v_accvgpr_write_b32 a159, v251
v_accvgpr_read_b32 v248, a160
v_accvgpr_read_b32 v249, a161
v_accvgpr_read_b32 v250, a162
v_accvgpr_read_b32 v251, a163
v_accvgpr_read_b32 v252, a176
v_accvgpr_read_b32 v253, a177
v_accvgpr_read_b32 v254, a178
v_accvgpr_read_b32 v255, a179
v_mul_f32 v248, s42, v248
v_mul_f32 v249, s42, v249
v_mul_f32 v250, s42, v250
v_mul_f32 v251, s42, v251
v_mul_f32 v252, s42, v252
v_mul_f32 v253, s42, v253
v_mul_f32 v254, s42, v254
v_mul_f32 v255, s42, v255
v_cvt_pk_bf16_f32 v248, v248, v249
v_cvt_pk_bf16_f32 v249, v250, v251
v_cvt_pk_bf16_f32 v250, v252, v253
v_cvt_pk_bf16_f32 v251, v254, v255
v_accvgpr_write_b32 a176, v248
v_accvgpr_write_b32 a177, v249
v_accvgpr_write_b32 a178, v250
v_accvgpr_write_b32 a179, v251
v_accvgpr_read_b32 v248, a164
v_accvgpr_read_b32 v249, a165
v_accvgpr_read_b32 v250, a166
v_accvgpr_read_b32 v251, a167
v_accvgpr_read_b32 v252, a180
v_accvgpr_read_b32 v253, a181
v_accvgpr_read_b32 v254, a182
v_accvgpr_read_b32 v255, a183
v_mul_f32 v248, s42, v248
v_mul_f32 v249, s42, v249
v_mul_f32 v250, s42, v250
v_mul_f32 v251, s42, v251
v_mul_f32 v252, s42, v252
v_mul_f32 v253, s42, v253
v_mul_f32 v254, s42, v254
v_mul_f32 v255, s42, v255
v_cvt_pk_bf16_f32 v248, v248, v249
v_cvt_pk_bf16_f32 v249, v250, v251
v_cvt_pk_bf16_f32 v250, v252, v253
v_cvt_pk_bf16_f32 v251, v254, v255
v_accvgpr_write_b32 a180, v248
v_accvgpr_write_b32 a181, v249
v_accvgpr_write_b32 a182, v250
v_accvgpr_write_b32 a183, v251
v_accvgpr_read_b32 v248, a168
v_accvgpr_read_b32 v249, a169
v_accvgpr_read_b32 v250, a170
v_accvgpr_read_b32 v251, a171
v_accvgpr_read_b32 v252, a184
v_accvgpr_read_b32 v253, a185
v_accvgpr_read_b32 v254, a186
v_accvgpr_read_b32 v255, a187
v_mul_f32 v248, s42, v248
v_mul_f32 v249, s42, v249
v_mul_f32 v250, s42, v250
v_mul_f32 v251, s42, v251
v_mul_f32 v252, s42, v252
v_mul_f32 v253, s42, v253
v_mul_f32 v254, s42, v254
v_mul_f32 v255, s42, v255
v_cvt_pk_bf16_f32 v248, v248, v249
v_cvt_pk_bf16_f32 v249, v250, v251
v_cvt_pk_bf16_f32 v250, v252, v253
v_cvt_pk_bf16_f32 v251, v254, v255
v_accvgpr_write_b32 a184, v248
v_accvgpr_write_b32 a185, v249
v_accvgpr_write_b32 a186, v250
v_accvgpr_write_b32 a187, v251
v_accvgpr_read_b32 v248, a172
v_accvgpr_read_b32 v249, a173
v_accvgpr_read_b32 v250, a174
v_accvgpr_read_b32 v251, a175
v_accvgpr_read_b32 v252, a188
v_accvgpr_read_b32 v253, a189
v_accvgpr_read_b32 v254, a190
v_accvgpr_read_b32 v255, a191
v_mul_f32 v248, s42, v248
v_mul_f32 v249, s42, v249
v_mul_f32 v250, s42, v250
v_mul_f32 v251, s42, v251
v_mul_f32 v252, s42, v252
v_mul_f32 v253, s42, v253
v_mul_f32 v254, s42, v254
v_mul_f32 v255, s42, v255
v_cvt_pk_bf16_f32 v248, v248, v249
v_cvt_pk_bf16_f32 v249, v250, v251
v_cvt_pk_bf16_f32 v250, v252, v253
v_cvt_pk_bf16_f32 v251, v254, v255
v_accvgpr_write_b32 a188, v248
v_accvgpr_write_b32 a189, v249
v_accvgpr_write_b32 a190, v250
v_accvgpr_write_b32 a191, v251
v_lshrrev_b32 v248, 4, v234
v_and_b32 v251, 15, v248
v_lshrrev_b32 v250, 4, v248
v_add_u32 v249, 0, v250
v_xor_b32 v249, v249, v251
v_lshlrev_b32 v249, 4, v249
v_lshl_add_u32 v235, v251, 8, v249
v_add_u32 v249, 4, v250
v_xor_b32 v249, v249, v251
v_lshlrev_b32 v249, 4, v249
v_lshl_add_u32 v236, v251, 8, v249
v_add_u32 v249, 8, v250
v_xor_b32 v249, v249, v251
v_lshlrev_b32 v249, 4, v249
v_lshl_add_u32 v237, v251, 8, v249
v_add_u32 v249, 12, v250
v_xor_b32 v249, v249, v251
v_lshlrev_b32 v249, 4, v249
v_lshl_add_u32 v238, v251, 8, v249
s_load_dwordx2 s[8:9], s[0:1], 0
s_load_dwordx2 s[16:17], s[0:1], 72
s_waitcnt vmcnt(12)
s_barrier
ds_read_b128 a[192:195], v235 offset:0
ds_read_b128 a[196:199], v236 offset:0
ds_read_b128 a[200:203], v237 offset:0
ds_read_b128 a[204:207], v238 offset:0
ds_read_b128 a[208:211], v235 offset:4096
ds_read_b128 a[212:215], v236 offset:4096
ds_read_b128 a[216:219], v237 offset:4096
ds_read_b128 a[220:223], v238 offset:4096
v_lshrrev_b32 v249, 2, v248
v_and_b32 v250, 3, v248
v_lshlrev_b32 v251, 8, v249
v_lshl_add_u32 v251, v250, 3, v251
v_add_u32 v251, 0x10000, v251
v_and_b32 v249, 7, v249
v_xor_b32 v250, 0, v249
v_lshl_add_u32 v239, v250, 5, v251
v_xor_b32 v250, 1, v249
v_lshl_add_u32 v240, v250, 5, v251
v_xor_b32 v250, 2, v249
v_lshl_add_u32 v241, v250, 5, v251
v_xor_b32 v250, 3, v249
v_lshl_add_u32 v242, v250, 5, v251
v_xor_b32 v250, 4, v249
v_lshl_add_u32 v243, v250, 5, v251
v_xor_b32 v250, 5, v249
v_lshl_add_u32 v244, v250, 5, v251
v_xor_b32 v250, 6, v249
v_lshl_add_u32 v245, v250, 5, v251
v_xor_b32 v250, 7, v249
v_lshl_add_u32 v246, v250, 5, v251
v_pk_mul_f32 v[248:249], v[0:1], s[44:45]
v_pk_mul_f32 v[250:251], v[2:3], s[44:45]
v_exp_f32 v248, v248
v_exp_f32 v249, v249
v_exp_f32 v250, v250
v_exp_f32 v251, v251
v_pk_mul_f32 v[0:1], v[0:1], v[16:17]
v_pk_mul_f32 v[2:3], v[2:3], v[18:19]
v_pk_add_f32 v[248:249], v[248:249], s[46:47]
v_pk_add_f32 v[250:251], v[250:251], s[46:47]
v_rcp_f32 v248, v248
v_rcp_f32 v249, v249
v_rcp_f32 v250, v250
v_rcp_f32 v251, v251
v_pk_mul_f32 v[0:1], v[0:1], v[248:249]
v_pk_mul_f32 v[2:3], v[2:3], v[250:251]
v_pk_mul_f32 v[248:249], v[32:33], s[44:45]
v_pk_mul_f32 v[250:251], v[34:35], s[44:45]
v_exp_f32 v248, v248
v_exp_f32 v249, v249
v_exp_f32 v250, v250
v_exp_f32 v251, v251
v_pk_mul_f32 v[32:33], v[32:33], v[48:49]
v_pk_mul_f32 v[34:35], v[34:35], v[50:51]
v_pk_add_f32 v[248:249], v[248:249], s[46:47]
v_pk_add_f32 v[250:251], v[250:251], s[46:47]
v_rcp_f32 v248, v248
v_rcp_f32 v249, v249
v_rcp_f32 v250, v250
v_rcp_f32 v251, v251
v_pk_mul_f32 v[32:33], v[32:33], v[248:249]
v_pk_mul_f32 v[34:35], v[34:35], v[250:251]
v_cvt_pk_bf16_f32 v16, v0, v1
v_cvt_pk_bf16_f32 v17, v2, v3
v_cvt_pk_bf16_f32 v18, v32, v33
v_cvt_pk_bf16_f32 v19, v34, v35
buffer_store_dwordx4 v[16:19], v234, s[28:31], s72 offen offset:0 sc1
v_pk_mul_f32 v[248:249], v[4:5], s[44:45]
v_pk_mul_f32 v[250:251], v[6:7], s[44:45]
v_exp_f32 v248, v248
v_exp_f32 v249, v249
v_exp_f32 v250, v250
v_exp_f32 v251, v251
v_pk_mul_f32 v[4:5], v[4:5], v[20:21]
v_pk_mul_f32 v[6:7], v[6:7], v[22:23]
v_pk_add_f32 v[248:249], v[248:249], s[46:47]
v_pk_add_f32 v[250:251], v[250:251], s[46:47]
v_rcp_f32 v248, v248
v_rcp_f32 v249, v249
v_rcp_f32 v250, v250
v_rcp_f32 v251, v251
v_pk_mul_f32 v[4:5], v[4:5], v[248:249]
v_pk_mul_f32 v[6:7], v[6:7], v[250:251]
v_pk_mul_f32 v[248:249], v[36:37], s[44:45]
v_pk_mul_f32 v[250:251], v[38:39], s[44:45]
v_exp_f32 v248, v248
v_exp_f32 v249, v249
v_exp_f32 v250, v250
v_exp_f32 v251, v251
v_pk_mul_f32 v[36:37], v[36:37], v[52:53]
v_pk_mul_f32 v[38:39], v[38:39], v[54:55]
v_pk_add_f32 v[248:249], v[248:249], s[46:47]
v_pk_add_f32 v[250:251], v[250:251], s[46:47]
v_rcp_f32 v248, v248
v_rcp_f32 v249, v249
v_rcp_f32 v250, v250
v_rcp_f32 v251, v251
v_pk_mul_f32 v[36:37], v[36:37], v[248:249]
v_pk_mul_f32 v[38:39], v[38:39], v[250:251]
v_cvt_pk_bf16_f32 v20, v4, v5
v_cvt_pk_bf16_f32 v21, v6, v7
v_cvt_pk_bf16_f32 v22, v36, v37
v_cvt_pk_bf16_f32 v23, v38, v39
buffer_store_dwordx4 v[20:23], v234, s[28:31], s72 offen offset:1024 sc1
v_pk_mul_f32 v[248:249], v[8:9], s[44:45]
v_pk_mul_f32 v[250:251], v[10:11], s[44:45]
v_exp_f32 v248, v248
v_exp_f32 v249, v249
v_exp_f32 v250, v250
v_exp_f32 v251, v251
v_pk_mul_f32 v[8:9], v[8:9], v[24:25]
v_pk_mul_f32 v[10:11], v[10:11], v[26:27]
v_pk_add_f32 v[248:249], v[248:249], s[46:47]
v_pk_add_f32 v[250:251], v[250:251], s[46:47]
v_rcp_f32 v248, v248
v_rcp_f32 v249, v249
v_rcp_f32 v250, v250
v_rcp_f32 v251, v251
v_pk_mul_f32 v[8:9], v[8:9], v[248:249]
v_pk_mul_f32 v[10:11], v[10:11], v[250:251]
v_pk_mul_f32 v[248:249], v[40:41], s[44:45]
v_pk_mul_f32 v[250:251], v[42:43], s[44:45]
v_exp_f32 v248, v248
v_exp_f32 v249, v249
v_exp_f32 v250, v250
v_exp_f32 v251, v251
v_pk_mul_f32 v[40:41], v[40:41], v[56:57]
v_pk_mul_f32 v[42:43], v[42:43], v[58:59]
v_pk_add_f32 v[248:249], v[248:249], s[46:47]
v_pk_add_f32 v[250:251], v[250:251], s[46:47]
v_rcp_f32 v248, v248
v_rcp_f32 v249, v249
v_rcp_f32 v250, v250
v_rcp_f32 v251, v251
v_pk_mul_f32 v[40:41], v[40:41], v[248:249]
v_pk_mul_f32 v[42:43], v[42:43], v[250:251]
v_cvt_pk_bf16_f32 v24, v8, v9
v_cvt_pk_bf16_f32 v25, v10, v11
v_cvt_pk_bf16_f32 v26, v40, v41
v_cvt_pk_bf16_f32 v27, v42, v43
buffer_store_dwordx4 v[24:27], v234, s[28:31], s72 offen offset:2048 sc1
v_pk_mul_f32 v[248:249], v[12:13], s[44:45]
v_pk_mul_f32 v[250:251], v[14:15], s[44:45]
v_exp_f32 v248, v248
v_exp_f32 v249, v249
v_exp_f32 v250, v250
v_exp_f32 v251, v251
v_pk_mul_f32 v[12:13], v[12:13], v[28:29]
v_pk_mul_f32 v[14:15], v[14:15], v[30:31]
v_pk_add_f32 v[248:249], v[248:249], s[46:47]
v_pk_add_f32 v[250:251], v[250:251], s[46:47]
v_rcp_f32 v248, v248
v_rcp_f32 v249, v249
v_rcp_f32 v250, v250
v_rcp_f32 v251, v251
v_pk_mul_f32 v[12:13], v[12:13], v[248:249]
v_pk_mul_f32 v[14:15], v[14:15], v[250:251]
v_pk_mul_f32 v[248:249], v[44:45], s[44:45]
v_pk_mul_f32 v[250:251], v[46:47], s[44:45]
v_exp_f32 v248, v248
v_exp_f32 v249, v249
v_exp_f32 v250, v250
v_exp_f32 v251, v251
v_pk_mul_f32 v[44:45], v[44:45], v[60:61]
v_pk_mul_f32 v[46:47], v[46:47], v[62:63]
v_pk_add_f32 v[248:249], v[248:249], s[46:47]
v_pk_add_f32 v[250:251], v[250:251], s[46:47]
v_rcp_f32 v248, v248
v_rcp_f32 v249, v249
v_rcp_f32 v250, v250
v_rcp_f32 v251, v251
v_pk_mul_f32 v[44:45], v[44:45], v[248:249]
v_pk_mul_f32 v[46:47], v[46:47], v[250:251]
v_cvt_pk_bf16_f32 v28, v12, v13
v_cvt_pk_bf16_f32 v29, v14, v15
v_cvt_pk_bf16_f32 v30, v44, v45
v_cvt_pk_bf16_f32 v31, v46, v47
buffer_store_dwordx4 v[28:31], v234, s[28:31], s72 offen offset:3072 sc1
s_add_u32 s72, s72, 4096
s_waitcnt lgkmcnt(0)
v_pk_mul_f32 v[248:249], v[64:65], s[44:45]
v_pk_mul_f32 v[250:251], v[66:67], s[44:45]
v_mfma_f32_16x16x32_bf16 v[0:3], a[192:195], a[80:83], 0
v_exp_f32 v248, v248
v_exp_f32 v249, v249
v_mfma_f32_16x16x32_bf16 v[0:3], a[196:199], a[112:115], v[0:3]
v_exp_f32 v250, v250
v_exp_f32 v251, v251
v_pk_mul_f32 v[64:65], v[64:65], v[80:81]
v_pk_mul_f32 v[66:67], v[66:67], v[82:83]
v_pk_add_f32 v[248:249], v[248:249], s[46:47]
v_pk_add_f32 v[250:251], v[250:251], s[46:47]
v_mfma_f32_16x16x32_bf16 v[0:3], a[200:203], a[144:147], v[0:3]
v_rcp_f32 v248, v248
v_rcp_f32 v249, v249
v_mfma_f32_16x16x32_bf16 v[0:3], a[204:207], a[176:179], v[0:3]
v_rcp_f32 v250, v250
v_rcp_f32 v251, v251
v_pk_mul_f32 v[64:65], v[64:65], v[248:249]
v_pk_mul_f32 v[66:67], v[66:67], v[250:251]
v_pk_mul_f32 v[248:249], v[96:97], s[44:45]
v_pk_mul_f32 v[250:251], v[98:99], s[44:45]
v_mfma_f32_16x16x32_bf16 v[4:7], a[204:207], a[180:183], 0
v_exp_f32 v248, v248
v_exp_f32 v249, v249
v_mfma_f32_16x16x32_bf16 v[4:7], a[200:203], a[148:151], v[4:7]
v_exp_f32 v250, v250
v_exp_f32 v251, v251
v_pk_mul_f32 v[96:97], v[96:97], v[112:113]
v_pk_mul_f32 v[98:99], v[98:99], v[114:115]
v_pk_add_f32 v[248:249], v[248:249], s[46:47]
v_pk_add_f32 v[250:251], v[250:251], s[46:47]
v_mfma_f32_16x16x32_bf16 v[4:7], a[196:199], a[116:119], v[4:7]
v_rcp_f32 v248, v248
v_rcp_f32 v249, v249
v_mfma_f32_16x16x32_bf16 v[4:7], a[192:195], a[84:87], v[4:7]
v_rcp_f32 v250, v250
v_rcp_f32 v251, v251
v_pk_mul_f32 v[96:97], v[96:97], v[248:249]
v_pk_mul_f32 v[98:99], v[98:99], v[250:251]
v_cvt_pk_bf16_f32 v80, v64, v65
v_cvt_pk_bf16_f32 v81, v66, v67
v_cvt_pk_bf16_f32 v82, v96, v97
v_cvt_pk_bf16_f32 v83, v98, v99
buffer_store_dwordx4 v[80:83], v234, s[28:31], s72 offen offset:0 sc1
v_pk_mul_f32 v[248:249], v[68:69], s[44:45]
v_pk_mul_f32 v[250:251], v[70:71], s[44:45]
v_mfma_f32_16x16x32_bf16 v[8:11], a[192:195], a[88:91], 0
v_exp_f32 v248, v248
v_exp_f32 v249, v249
v_mfma_f32_16x16x32_bf16 v[8:11], a[196:199], a[120:123], v[8:11]
v_exp_f32 v250, v250
v_exp_f32 v251, v251
v_pk_mul_f32 v[68:69], v[68:69], v[84:85]
v_pk_mul_f32 v[70:71], v[70:71], v[86:87]
v_pk_add_f32 v[248:249], v[248:249], s[46:47]
v_pk_add_f32 v[250:251], v[250:251], s[46:47]
v_mfma_f32_16x16x32_bf16 v[8:11], a[200:203], a[152:155], v[8:11]
v_rcp_f32 v248, v248
v_rcp_f32 v249, v249
v_mfma_f32_16x16x32_bf16 v[8:11], a[204:207], a[184:187], v[8:11]
v_rcp_f32 v250, v250
v_rcp_f32 v251, v251
v_pk_mul_f32 v[68:69], v[68:69], v[248:249]
v_pk_mul_f32 v[70:71], v[70:71], v[250:251]
v_pk_mul_f32 v[248:249], v[100:101], s[44:45]
v_pk_mul_f32 v[250:251], v[102:103], s[44:45]
v_mfma_f32_16x16x32_bf16 v[12:15], a[204:207], a[188:191], 0
v_exp_f32 v248, v248
v_exp_f32 v249, v249
v_mfma_f32_16x16x32_bf16 v[12:15], a[200:203], a[156:159], v[12:15]
v_exp_f32 v250, v250
v_exp_f32 v251, v251
v_pk_mul_f32 v[100:101], v[100:101], v[116:117]
v_pk_mul_f32 v[102:103], v[102:103], v[118:119]
v_pk_add_f32 v[248:249], v[248:249], s[46:47]
v_pk_add_f32 v[250:251], v[250:251], s[46:47]
v_mfma_f32_16x16x32_bf16 v[12:15], a[196:199], a[124:127], v[12:15]
v_rcp_f32 v248, v248
v_rcp_f32 v249, v249
v_mfma_f32_16x16x32_bf16 v[12:15], a[192:195], a[92:95], v[12:15]
v_rcp_f32 v250, v250
v_rcp_f32 v251, v251
v_pk_mul_f32 v[100:101], v[100:101], v[248:249]
v_pk_mul_f32 v[102:103], v[102:103], v[250:251]
v_cvt_pk_bf16_f32 v84, v68, v69
v_cvt_pk_bf16_f32 v85, v70, v71
v_cvt_pk_bf16_f32 v86, v100, v101
v_cvt_pk_bf16_f32 v87, v102, v103
buffer_store_dwordx4 v[84:87], v234, s[28:31], s72 offen offset:1024 sc1
v_pk_mul_f32 v[248:249], v[72:73], s[44:45]
v_pk_mul_f32 v[250:251], v[74:75], s[44:45]
v_mfma_f32_16x16x32_bf16 v[28:31], a[208:211], a[92:95], 0
v_exp_f32 v248, v248
v_exp_f32 v249, v249
v_mfma_f32_16x16x32_bf16 v[28:31], a[212:215], a[124:127], v[28:31]
v_exp_f32 v250, v250
v_exp_f32 v251, v251
v_pk_mul_f32 v[72:73], v[72:73], v[88:89]
v_pk_mul_f32 v[74:75], v[74:75], v[90:91]
v_pk_add_f32 v[248:249], v[248:249], s[46:47]
v_pk_add_f32 v[250:251], v[250:251], s[46:47]
v_mfma_f32_16x16x32_bf16 v[28:31], a[216:219], a[156:159], v[28:31]
v_rcp_f32 v248, v248
v_rcp_f32 v249, v249
v_mfma_f32_16x16x32_bf16 v[28:31], a[220:223], a[188:191], v[28:31]
v_rcp_f32 v250, v250
v_rcp_f32 v251, v251
v_pk_mul_f32 v[72:73], v[72:73], v[248:249]
v_pk_mul_f32 v[74:75], v[74:75], v[250:251]
v_pk_mul_f32 v[248:249], v[104:105], s[44:45]
v_pk_mul_f32 v[250:251], v[106:107], s[44:45]
v_mfma_f32_16x16x32_bf16 v[24:27], a[220:223], a[184:187], 0
v_exp_f32 v248, v248
v_exp_f32 v249, v249
v_mfma_f32_16x16x32_bf16 v[24:27], a[216:219], a[152:155], v[24:27]
v_exp_f32 v250, v250
v_exp_f32 v251, v251
v_pk_mul_f32 v[104:105], v[104:105], v[120:121]
v_pk_mul_f32 v[106:107], v[106:107], v[122:123]
v_pk_add_f32 v[248:249], v[248:249], s[46:47]
v_pk_add_f32 v[250:251], v[250:251], s[46:47]
v_mfma_f32_16x16x32_bf16 v[24:27], a[212:215], a[120:123], v[24:27]
v_rcp_f32 v248, v248
v_rcp_f32 v249, v249
v_mfma_f32_16x16x32_bf16 v[24:27], a[208:211], a[88:91], v[24:27]
v_rcp_f32 v250, v250
v_rcp_f32 v251, v251
v_pk_mul_f32 v[104:105], v[104:105], v[248:249]
v_pk_mul_f32 v[106:107], v[106:107], v[250:251]
v_cvt_pk_bf16_f32 v88, v72, v73
v_cvt_pk_bf16_f32 v89, v74, v75
v_cvt_pk_bf16_f32 v90, v104, v105
v_cvt_pk_bf16_f32 v91, v106, v107
buffer_store_dwordx4 v[88:91], v234, s[28:31], s72 offen offset:2048 sc1
v_pk_mul_f32 v[248:249], v[76:77], s[44:45]
v_pk_mul_f32 v[250:251], v[78:79], s[44:45]
v_mfma_f32_16x16x32_bf16 v[20:23], a[208:211], a[84:87], 0
v_exp_f32 v248, v248
v_exp_f32 v249, v249
v_mfma_f32_16x16x32_bf16 v[20:23], a[212:215], a[116:119], v[20:23]
v_exp_f32 v250, v250
v_exp_f32 v251, v251
v_pk_mul_f32 v[76:77], v[76:77], v[92:93]
v_pk_mul_f32 v[78:79], v[78:79], v[94:95]
v_pk_add_f32 v[248:249], v[248:249], s[46:47]
v_pk_add_f32 v[250:251], v[250:251], s[46:47]
v_mfma_f32_16x16x32_bf16 v[20:23], a[216:219], a[148:151], v[20:23]
v_rcp_f32 v248, v248
v_rcp_f32 v249, v249
v_mfma_f32_16x16x32_bf16 v[20:23], a[220:223], a[180:183], v[20:23]
v_rcp_f32 v250, v250
v_rcp_f32 v251, v251
v_pk_mul_f32 v[76:77], v[76:77], v[248:249]
v_pk_mul_f32 v[78:79], v[78:79], v[250:251]
v_pk_mul_f32 v[248:249], v[108:109], s[44:45]
v_pk_mul_f32 v[250:251], v[110:111], s[44:45]
v_mfma_f32_16x16x32_bf16 v[16:19], a[220:223], a[176:179], 0
v_exp_f32 v248, v248
v_exp_f32 v249, v249
v_mfma_f32_16x16x32_bf16 v[16:19], a[216:219], a[144:147], v[16:19]
v_exp_f32 v250, v250
v_exp_f32 v251, v251
v_pk_mul_f32 v[108:109], v[108:109], v[124:125]
v_pk_mul_f32 v[110:111], v[110:111], v[126:127]
v_pk_add_f32 v[248:249], v[248:249], s[46:47]
v_pk_add_f32 v[250:251], v[250:251], s[46:47]
v_mfma_f32_16x16x32_bf16 v[16:19], a[212:215], a[112:115], v[16:19]
v_rcp_f32 v248, v248
v_rcp_f32 v249, v249
v_mfma_f32_16x16x32_bf16 v[16:19], a[208:211], a[80:83], v[16:19]
v_rcp_f32 v250, v250
v_rcp_f32 v251, v251
v_pk_mul_f32 v[108:109], v[108:109], v[248:249]
v_pk_mul_f32 v[110:111], v[110:111], v[250:251]
v_cvt_pk_bf16_f32 v92, v76, v77
v_cvt_pk_bf16_f32 v93, v78, v79
v_cvt_pk_bf16_f32 v94, v108, v109
v_cvt_pk_bf16_f32 v95, v110, v111
buffer_store_dwordx4 v[92:95], v234, s[28:31], s72 offen offset:3072 sc1
s_add_u32 s72, s72, 4096
v_mov_b32 v124, 0
v_mov_b32 v125, 0
v_mov_b32 v120, 0x3f803f80
v_mov_b32 v121, 0x3f803f80
v_mov_b32 v122, 0x3f803f80
v_mov_b32 v123, 0x3f803f80
v_max3_f32 v252, v0, v1, v2
v_max3_f32 v252, v252, v3, v16
v_max3_f32 v252, v252, v17, v18
v_max_f32 v252, v252, v19
v_max3_f32 v253, v4, v5, v6
v_max3_f32 v253, v253, v7, v20
v_max3_f32 v253, v253, v21, v22
v_max_f32 v253, v253, v23
v_max3_f32 v254, v8, v9, v10
v_max3_f32 v254, v254, v11, v24
v_max3_f32 v254, v254, v25, v26
v_max_f32 v254, v254, v27
v_max3_f32 v255, v12, v13, v14
v_max3_f32 v255, v255, v15, v28
v_max3_f32 v255, v255, v29, v30
v_max_f32 v255, v255, v31
v_mov_b32 v248, v252
v_mov_b32 v249, v253
v_mov_b32 v250, v254
v_mov_b32 v251, v255
s_nop 1
v_permlane16_swap_b32 v252, v248
v_permlane16_swap_b32 v253, v249
v_permlane16_swap_b32 v254, v250
v_permlane16_swap_b32 v255, v251
v_max_f32 v252, v252, v248
v_max_f32 v253, v253, v249
v_max_f32 v254, v254, v250
v_max_f32 v255, v255, v251
v_mov_b32 v248, v252
v_mov_b32 v249, v253
v_mov_b32 v250, v254
v_mov_b32 v251, v255
s_nop 1
v_permlane32_swap_b32 v252, v248
v_permlane32_swap_b32 v253, v249
v_permlane32_swap_b32 v254, v250
v_permlane32_swap_b32 v255, v251
v_max_f32 v252, v252, v248
v_max_f32 v253, v253, v249
v_max_f32 v254, v254, v250
v_max_f32 v255, v255, v251
v_sub_f32 v96, 0, v252
v_sub_f32 v97, 0, v252
v_sub_f32 v98, 0, v252
v_sub_f32 v99, 0, v252
v_sub_f32 v100, 0, v253
v_sub_f32 v101, 0, v253
v_sub_f32 v102, 0, v253
v_sub_f32 v103, 0, v253
v_sub_f32 v104, 0, v254
v_sub_f32 v105, 0, v254
v_sub_f32 v106, 0, v254
v_sub_f32 v107, 0, v254
v_sub_f32 v108, 0, v255
v_sub_f32 v109, 0, v255
v_sub_f32 v110, 0, v255
v_sub_f32 v111, 0, v255
v_pk_add_f32 v[0:1], v[0:1], v[96:97]
v_pk_add_f32 v[2:3], v[2:3], v[96:97]
v_pk_add_f32 v[4:5], v[4:5], v[100:101]
v_pk_add_f32 v[6:7], v[6:7], v[100:101]
v_pk_add_f32 v[8:9], v[8:9], v[104:105]
v_pk_add_f32 v[10:11], v[10:11], v[104:105]
v_pk_add_f32 v[12:13], v[12:13], v[108:109]
v_pk_add_f32 v[14:15], v[14:15], v[108:109]
v_pk_add_f32 v[16:17], v[16:17], v[96:97]
v_pk_add_f32 v[18:19], v[18:19], v[96:97]
v_pk_add_f32 v[20:21], v[20:21], v[100:101]
v_pk_add_f32 v[22:23], v[22:23], v[100:101]
v_pk_add_f32 v[24:25], v[24:25], v[104:105]
v_pk_add_f32 v[26:27], v[26:27], v[104:105]
v_pk_add_f32 v[28:29], v[28:29], v[108:109]
v_pk_add_f32 v[30:31], v[30:31], v[108:109]
ds_read_b128 a[192:195], v235 offset:8192
ds_read_b128 a[196:199], v236 offset:8192
ds_read_b128 a[200:203], v237 offset:8192
ds_read_b128 a[204:207], v238 offset:8192
ds_read_b128 a[208:211], v235 offset:12288
ds_read_b128 a[212:215], v236 offset:12288
ds_read_b128 a[216:219], v237 offset:12288
ds_read_b128 a[220:223], v238 offset:12288
v_pk_mul_f32 v[248:249], v[128:129], s[44:45]
v_pk_mul_f32 v[250:251], v[130:131], s[44:45]
v_exp_f32 v248, v248
v_exp_f32 v249, v249
v_exp_f32 v250, v250
v_exp_f32 v251, v251
v_pk_mul_f32 v[128:129], v[128:129], v[144:145]
v_pk_mul_f32 v[130:131], v[130:131], v[146:147]
v_pk_add_f32 v[248:249], v[248:249], s[46:47]
v_pk_add_f32 v[250:251], v[250:251], s[46:47]
v_rcp_f32 v248, v248
v_rcp_f32 v249, v249
v_rcp_f32 v250, v250
v_rcp_f32 v251, v251
v_pk_mul_f32 v[128:129], v[128:129], v[248:249]
v_pk_mul_f32 v[130:131], v[130:131], v[250:251]
v_pk_mul_f32 v[248:249], v[160:161], s[44:45]
v_pk_mul_f32 v[250:251], v[162:163], s[44:45]
v_exp_f32 v248, v248
v_exp_f32 v249, v249
v_exp_f32 v250, v250
v_exp_f32 v251, v251
v_pk_mul_f32 v[160:161], v[160:161], v[176:177]
v_pk_mul_f32 v[162:163], v[162:163], v[178:179]
v_pk_add_f32 v[248:249], v[248:249], s[46:47]
v_pk_add_f32 v[250:251], v[250:251], s[46:47]
v_rcp_f32 v248, v248
v_rcp_f32 v249, v249
v_rcp_f32 v250, v250
v_rcp_f32 v251, v251
v_pk_mul_f32 v[160:161], v[160:161], v[248:249]
v_pk_mul_f32 v[162:163], v[162:163], v[250:251]
v_cvt_pk_bf16_f32 v144, v128, v129
v_cvt_pk_bf16_f32 v145, v130, v131
v_cvt_pk_bf16_f32 v146, v160, v161
v_cvt_pk_bf16_f32 v147, v162, v163
buffer_store_dwordx4 v[144:147], v234, s[28:31], s72 offen offset:0 sc1
v_pk_mul_f32 v[248:249], v[132:133], s[44:45]
v_pk_mul_f32 v[250:251], v[134:135], s[44:45]
v_exp_f32 v248, v248
v_exp_f32 v249, v249
v_exp_f32 v250, v250
v_exp_f32 v251, v251
v_pk_mul_f32 v[132:133], v[132:133], v[148:149]
v_pk_mul_f32 v[134:135], v[134:135], v[150:151]
v_pk_add_f32 v[248:249], v[248:249], s[46:47]
v_pk_add_f32 v[250:251], v[250:251], s[46:47]
v_rcp_f32 v248, v248
v_rcp_f32 v249, v249
v_rcp_f32 v250, v250
v_rcp_f32 v251, v251
v_pk_mul_f32 v[132:133], v[132:133], v[248:249]
v_pk_mul_f32 v[134:135], v[134:135], v[250:251]
v_pk_mul_f32 v[248:249], v[164:165], s[44:45]
v_pk_mul_f32 v[250:251], v[166:167], s[44:45]
v_exp_f32 v248, v248
v_exp_f32 v249, v249
v_exp_f32 v250, v250
v_exp_f32 v251, v251
v_pk_mul_f32 v[164:165], v[164:165], v[180:181]
v_pk_mul_f32 v[166:167], v[166:167], v[182:183]
v_pk_add_f32 v[248:249], v[248:249], s[46:47]
v_pk_add_f32 v[250:251], v[250:251], s[46:47]
v_rcp_f32 v248, v248
v_rcp_f32 v249, v249
v_rcp_f32 v250, v250
v_rcp_f32 v251, v251
v_pk_mul_f32 v[164:165], v[164:165], v[248:249]
v_pk_mul_f32 v[166:167], v[166:167], v[250:251]
v_cvt_pk_bf16_f32 v148, v132, v133
v_cvt_pk_bf16_f32 v149, v134, v135
v_cvt_pk_bf16_f32 v150, v164, v165
v_cvt_pk_bf16_f32 v151, v166, v167
buffer_store_dwordx4 v[148:151], v234, s[28:31], s72 offen offset:1024 sc1
v_pk_mul_f32 v[248:249], v[136:137], s[44:45]
v_pk_mul_f32 v[250:251], v[138:139], s[44:45]
v_exp_f32 v248, v248
v_exp_f32 v249, v249
v_exp_f32 v250, v250
v_exp_f32 v251, v251
v_pk_mul_f32 v[136:137], v[136:137], v[152:153]
v_pk_mul_f32 v[138:139], v[138:139], v[154:155]
v_pk_add_f32 v[248:249], v[248:249], s[46:47]
v_pk_add_f32 v[250:251], v[250:251], s[46:47]
v_rcp_f32 v248, v248
v_rcp_f32 v249, v249
v_rcp_f32 v250, v250
v_rcp_f32 v251, v251
v_pk_mul_f32 v[136:137], v[136:137], v[248:249]
v_pk_mul_f32 v[138:139], v[138:139], v[250:251]
v_pk_mul_f32 v[248:249], v[168:169], s[44:45]
v_pk_mul_f32 v[250:251], v[170:171], s[44:45]
v_exp_f32 v248, v248
v_exp_f32 v249, v249
v_exp_f32 v250, v250
v_exp_f32 v251, v251
v_pk_mul_f32 v[168:169], v[168:169], v[184:185]
v_pk_mul_f32 v[170:171], v[170:171], v[186:187]
v_pk_add_f32 v[248:249], v[248:249], s[46:47]
v_pk_add_f32 v[250:251], v[250:251], s[46:47]
v_rcp_f32 v248, v248
v_rcp_f32 v249, v249
v_rcp_f32 v250, v250
v_rcp_f32 v251, v251
v_pk_mul_f32 v[168:169], v[168:169], v[248:249]
v_pk_mul_f32 v[170:171], v[170:171], v[250:251]
v_cvt_pk_bf16_f32 v152, v136, v137
v_cvt_pk_bf16_f32 v153, v138, v139
v_cvt_pk_bf16_f32 v154, v168, v169
v_cvt_pk_bf16_f32 v155, v170, v171
buffer_store_dwordx4 v[152:155], v234, s[28:31], s72 offen offset:2048 sc1
v_pk_mul_f32 v[248:249], v[140:141], s[44:45]
v_pk_mul_f32 v[250:251], v[142:143], s[44:45]
v_exp_f32 v248, v248
v_exp_f32 v249, v249
v_exp_f32 v250, v250
v_exp_f32 v251, v251
v_pk_mul_f32 v[140:141], v[140:141], v[156:157]
v_pk_mul_f32 v[142:143], v[142:143], v[158:159]
v_pk_add_f32 v[248:249], v[248:249], s[46:47]
v_pk_add_f32 v[250:251], v[250:251], s[46:47]
v_rcp_f32 v248, v248
v_rcp_f32 v249, v249
v_rcp_f32 v250, v250
v_rcp_f32 v251, v251
v_pk_mul_f32 v[140:141], v[140:141], v[248:249]
v_pk_mul_f32 v[142:143], v[142:143], v[250:251]
v_pk_mul_f32 v[248:249], v[172:173], s[44:45]
v_pk_mul_f32 v[250:251], v[174:175], s[44:45]
v_exp_f32 v248, v248
v_exp_f32 v249, v249
v_exp_f32 v250, v250
v_exp_f32 v251, v251
v_pk_mul_f32 v[172:173], v[172:173], v[188:189]
v_pk_mul_f32 v[174:175], v[174:175], v[190:191]
v_pk_add_f32 v[248:249], v[248:249], s[46:47]
v_pk_add_f32 v[250:251], v[250:251], s[46:47]
v_rcp_f32 v248, v248
v_rcp_f32 v249, v249
v_rcp_f32 v250, v250
v_rcp_f32 v251, v251
v_pk_mul_f32 v[172:173], v[172:173], v[248:249]
v_pk_mul_f32 v[174:175], v[174:175], v[250:251]
v_cvt_pk_bf16_f32 v156, v140, v141
v_cvt_pk_bf16_f32 v157, v142, v143
v_cvt_pk_bf16_f32 v158, v172, v173
v_cvt_pk_bf16_f32 v159, v174, v175
buffer_store_dwordx4 v[156:159], v234, s[28:31], s72 offen offset:3072 sc1
s_add_u32 s72, s72, 4096
v_accvgpr_read_b32 v128, a0
v_accvgpr_read_b32 v129, a1
v_accvgpr_read_b32 v130, a2
v_accvgpr_read_b32 v131, a3
v_accvgpr_read_b32 v132, a4
v_accvgpr_read_b32 v133, a5
v_accvgpr_read_b32 v134, a6
v_accvgpr_read_b32 v135, a7
v_accvgpr_read_b32 v136, a8
v_accvgpr_read_b32 v137, a9
v_accvgpr_read_b32 v138, a10
v_accvgpr_read_b32 v139, a11
v_accvgpr_read_b32 v140, a12
v_accvgpr_read_b32 v141, a13
v_accvgpr_read_b32 v142, a14
v_accvgpr_read_b32 v143, a15
v_accvgpr_read_b32 v144, a16
v_accvgpr_read_b32 v145, a17
v_accvgpr_read_b32 v146, a18
v_accvgpr_read_b32 v147, a19
v_accvgpr_read_b32 v148, a20
v_accvgpr_read_b32 v149, a21
v_accvgpr_read_b32 v150, a22
v_accvgpr_read_b32 v151, a23
v_accvgpr_read_b32 v152, a24
v_accvgpr_read_b32 v153, a25
v_accvgpr_read_b32 v154, a26
v_accvgpr_read_b32 v155, a27
v_accvgpr_read_b32 v156, a28
v_accvgpr_read_b32 v157, a29
v_accvgpr_read_b32 v158, a30
v_accvgpr_read_b32 v159, a31
v_accvgpr_read_b32 v160, a32
v_accvgpr_read_b32 v161, a33
v_accvgpr_read_b32 v162, a34
v_accvgpr_read_b32 v163, a35
v_accvgpr_read_b32 v164, a36
v_accvgpr_read_b32 v165, a37
v_accvgpr_read_b32 v166, a38
v_accvgpr_read_b32 v167, a39
v_accvgpr_read_b32 v168, a40
v_accvgpr_read_b32 v169, a41
v_accvgpr_read_b32 v170, a42
v_accvgpr_read_b32 v171, a43
v_accvgpr_read_b32 v172, a44
v_accvgpr_read_b32 v173, a45
v_accvgpr_read_b32 v174, a46
v_accvgpr_read_b32 v175, a47
v_accvgpr_read_b32 v176, a48
v_accvgpr_read_b32 v177, a49
v_accvgpr_read_b32 v178, a50
v_accvgpr_read_b32 v179, a51
v_accvgpr_read_b32 v180, a52
v_accvgpr_read_b32 v181, a53
v_accvgpr_read_b32 v182, a54
v_accvgpr_read_b32 v183, a55
v_accvgpr_read_b32 v184, a56
v_accvgpr_read_b32 v185, a57
v_accvgpr_read_b32 v186, a58
v_accvgpr_read_b32 v187, a59
v_accvgpr_read_b32 v188, a60
v_accvgpr_read_b32 v189, a61
v_accvgpr_read_b32 v190, a62
v_accvgpr_read_b32 v191, a63
s_waitcnt lgkmcnt(0)
v_pk_mul_f32 v[248:249], v[192:193], s[44:45]
v_pk_mul_f32 v[250:251], v[194:195], s[44:45]
v_mfma_f32_16x16x32_bf16 v[32:35], a[192:195], a[80:83], v[96:99]
v_exp_f32 v248, v248
v_exp_f32 v249, v249
v_mfma_f32_16x16x32_bf16 v[32:35], a[196:199], a[112:115], v[32:35]
v_exp_f32 v250, v250
v_exp_f32 v251, v251
v_pk_mul_f32 v[192:193], v[192:193], v[208:209]
v_pk_mul_f32 v[194:195], v[194:195], v[210:211]
v_pk_add_f32 v[248:249], v[248:249], s[46:47]
v_pk_add_f32 v[250:251], v[250:251], s[46:47]
v_mfma_f32_16x16x32_bf16 v[32:35], a[200:203], a[144:147], v[32:35]
v_rcp_f32 v248, v248
v_rcp_f32 v249, v249
v_mfma_f32_16x16x32_bf16 v[32:35], a[204:207], a[176:179], v[32:35]
v_rcp_f32 v250, v250
v_rcp_f32 v251, v251
v_pk_mul_f32 v[192:193], v[192:193], v[248:249]
v_pk_mul_f32 v[194:195], v[194:195], v[250:251]
v_pk_mul_f32 v[248:249], v[128:129], s[44:45]
v_pk_mul_f32 v[250:251], v[130:131], s[44:45]
v_mfma_f32_16x16x32_bf16 v[36:39], a[204:207], a[180:183], v[100:103]
v_exp_f32 v248, v248
v_exp_f32 v249, v249
v_mfma_f32_16x16x32_bf16 v[36:39], a[200:203], a[148:151], v[36:39]
v_exp_f32 v250, v250
v_exp_f32 v251, v251
v_pk_mul_f32 v[128:129], v[128:129], v[144:145]
v_pk_mul_f32 v[130:131], v[130:131], v[146:147]
v_pk_add_f32 v[248:249], v[248:249], s[46:47]
v_pk_add_f32 v[250:251], v[250:251], s[46:47]
v_mfma_f32_16x16x32_bf16 v[36:39], a[196:199], a[116:119], v[36:39]
v_rcp_f32 v248, v248
v_rcp_f32 v249, v249
v_mfma_f32_16x16x32_bf16 v[36:39], a[192:195], a[84:87], v[36:39]
v_rcp_f32 v250, v250
v_rcp_f32 v251, v251
v_pk_mul_f32 v[128:129], v[128:129], v[248:249]
v_pk_mul_f32 v[130:131], v[130:131], v[250:251]
v_cvt_pk_bf16_f32 v208, v192, v193
v_cvt_pk_bf16_f32 v209, v194, v195
v_cvt_pk_bf16_f32 v210, v128, v129
v_cvt_pk_bf16_f32 v211, v130, v131
buffer_store_dwordx4 v[208:211], v234, s[28:31], s72 offen offset:0 sc1
v_pk_mul_f32 v[248:249], v[196:197], s[44:45]
v_pk_mul_f32 v[250:251], v[198:199], s[44:45]
v_mfma_f32_16x16x32_bf16 v[40:43], a[192:195], a[88:91], v[104:107]
v_exp_f32 v248, v248
v_exp_f32 v249, v249
v_mfma_f32_16x16x32_bf16 v[40:43], a[196:199], a[120:123], v[40:43]
v_exp_f32 v250, v250
v_exp_f32 v251, v251
v_pk_mul_f32 v[196:197], v[196:197], v[212:213]
v_pk_mul_f32 v[198:199], v[198:199], v[214:215]
v_pk_add_f32 v[248:249], v[248:249], s[46:47]
v_pk_add_f32 v[250:251], v[250:251], s[46:47]
v_mfma_f32_16x16x32_bf16 v[40:43], a[200:203], a[152:155], v[40:43]
v_rcp_f32 v248, v248
v_rcp_f32 v249, v249
v_mfma_f32_16x16x32_bf16 v[40:43], a[204:207], a[184:187], v[40:43]
v_rcp_f32 v250, v250
v_rcp_f32 v251, v251
v_pk_mul_f32 v[196:197], v[196:197], v[248:249]
v_pk_mul_f32 v[198:199], v[198:199], v[250:251]
v_pk_mul_f32 v[248:249], v[132:133], s[44:45]
v_pk_mul_f32 v[250:251], v[134:135], s[44:45]
v_mfma_f32_16x16x32_bf16 v[44:47], a[204:207], a[188:191], v[108:111]
v_exp_f32 v248, v248
v_exp_f32 v249, v249
v_mfma_f32_16x16x32_bf16 v[44:47], a[200:203], a[156:159], v[44:47]
v_exp_f32 v250, v250
v_exp_f32 v251, v251
v_pk_mul_f32 v[132:133], v[132:133], v[148:149]
v_pk_mul_f32 v[134:135], v[134:135], v[150:151]
v_pk_add_f32 v[248:249], v[248:249], s[46:47]
v_pk_add_f32 v[250:251], v[250:251], s[46:47]
v_mfma_f32_16x16x32_bf16 v[44:47], a[196:199], a[124:127], v[44:47]
v_rcp_f32 v248, v248
v_rcp_f32 v249, v249
v_mfma_f32_16x16x32_bf16 v[44:47], a[192:195], a[92:95], v[44:47]
v_rcp_f32 v250, v250
v_rcp_f32 v251, v251
v_pk_mul_f32 v[132:133], v[132:133], v[248:249]
v_pk_mul_f32 v[134:135], v[134:135], v[250:251]
v_cvt_pk_bf16_f32 v212, v196, v197
v_cvt_pk_bf16_f32 v213, v198, v199
v_cvt_pk_bf16_f32 v214, v132, v133
v_cvt_pk_bf16_f32 v215, v134, v135
buffer_store_dwordx4 v[212:215], v234, s[28:31], s72 offen offset:1024 sc1
v_pk_mul_f32 v[248:249], v[200:201], s[44:45]
v_pk_mul_f32 v[250:251], v[202:203], s[44:45]
v_mfma_f32_16x16x32_bf16 v[60:63], a[208:211], a[92:95], v[108:111]
v_exp_f32 v248, v248
v_exp_f32 v249, v249
v_mfma_f32_16x16x32_bf16 v[60:63], a[212:215], a[124:127], v[60:63]
v_exp_f32 v250, v250
v_exp_f32 v251, v251
v_pk_mul_f32 v[200:201], v[200:201], v[216:217]
v_pk_mul_f32 v[202:203], v[202:203], v[218:219]
v_pk_add_f32 v[248:249], v[248:249], s[46:47]
v_pk_add_f32 v[250:251], v[250:251], s[46:47]
v_mfma_f32_16x16x32_bf16 v[60:63], a[216:219], a[156:159], v[60:63]
v_rcp_f32 v248, v248
v_rcp_f32 v249, v249
v_mfma_f32_16x16x32_bf16 v[60:63], a[220:223], a[188:191], v[60:63]
v_rcp_f32 v250, v250
v_rcp_f32 v251, v251
v_pk_mul_f32 v[200:201], v[200:201], v[248:249]
v_pk_mul_f32 v[202:203], v[202:203], v[250:251]
v_pk_mul_f32 v[248:249], v[136:137], s[44:45]
v_pk_mul_f32 v[250:251], v[138:139], s[44:45]
v_mfma_f32_16x16x32_bf16 v[56:59], a[220:223], a[184:187], v[104:107]
v_exp_f32 v248, v248
v_exp_f32 v249, v249
v_mfma_f32_16x16x32_bf16 v[56:59], a[216:219], a[152:155], v[56:59]
v_exp_f32 v250, v250
v_exp_f32 v251, v251
v_pk_mul_f32 v[136:137], v[136:137], v[152:153]
v_pk_mul_f32 v[138:139], v[138:139], v[154:155]
v_pk_add_f32 v[248:249], v[248:249], s[46:47]
v_pk_add_f32 v[250:251], v[250:251], s[46:47]
v_mfma_f32_16x16x32_bf16 v[56:59], a[212:215], a[120:123], v[56:59]
v_rcp_f32 v248, v248
v_rcp_f32 v249, v249
v_mfma_f32_16x16x32_bf16 v[56:59], a[208:211], a[88:91], v[56:59]
v_rcp_f32 v250, v250
v_rcp_f32 v251, v251
v_pk_mul_f32 v[136:137], v[136:137], v[248:249]
v_pk_mul_f32 v[138:139], v[138:139], v[250:251]
v_cvt_pk_bf16_f32 v216, v200, v201
v_cvt_pk_bf16_f32 v217, v202, v203
v_cvt_pk_bf16_f32 v218, v136, v137
v_cvt_pk_bf16_f32 v219, v138, v139
buffer_store_dwordx4 v[216:219], v234, s[28:31], s72 offen offset:2048 sc1
v_pk_mul_f32 v[248:249], v[204:205], s[44:45]
v_pk_mul_f32 v[250:251], v[206:207], s[44:45]
v_mfma_f32_16x16x32_bf16 v[52:55], a[208:211], a[84:87], v[100:103]
v_exp_f32 v248, v248
v_exp_f32 v249, v249
v_mfma_f32_16x16x32_bf16 v[52:55], a[212:215], a[116:119], v[52:55]
v_exp_f32 v250, v250
v_exp_f32 v251, v251
v_pk_mul_f32 v[204:205], v[204:205], v[220:221]
v_pk_mul_f32 v[206:207], v[206:207], v[222:223]
v_pk_add_f32 v[248:249], v[248:249], s[46:47]
v_pk_add_f32 v[250:251], v[250:251], s[46:47]
v_mfma_f32_16x16x32_bf16 v[52:55], a[216:219], a[148:151], v[52:55]
v_rcp_f32 v248, v248
v_rcp_f32 v249, v249
v_mfma_f32_16x16x32_bf16 v[52:55], a[220:223], a[180:183], v[52:55]
v_rcp_f32 v250, v250
v_rcp_f32 v251, v251
v_pk_mul_f32 v[204:205], v[204:205], v[248:249]
v_pk_mul_f32 v[206:207], v[206:207], v[250:251]
v_pk_mul_f32 v[248:249], v[140:141], s[44:45]
v_pk_mul_f32 v[250:251], v[142:143], s[44:45]
v_mfma_f32_16x16x32_bf16 v[48:51], a[220:223], a[176:179], v[96:99]
v_exp_f32 v248, v248
v_exp_f32 v249, v249
v_mfma_f32_16x16x32_bf16 v[48:51], a[216:219], a[144:147], v[48:51]
v_exp_f32 v250, v250
v_exp_f32 v251, v251
v_pk_mul_f32 v[140:141], v[140:141], v[156:157]
v_pk_mul_f32 v[142:143], v[142:143], v[158:159]
v_pk_add_f32 v[248:249], v[248:249], s[46:47]
v_pk_add_f32 v[250:251], v[250:251], s[46:47]
v_mfma_f32_16x16x32_bf16 v[48:51], a[212:215], a[112:115], v[48:51]
v_rcp_f32 v248, v248
v_rcp_f32 v249, v249
v_mfma_f32_16x16x32_bf16 v[48:51], a[208:211], a[80:83], v[48:51]
v_rcp_f32 v250, v250
v_rcp_f32 v251, v251
v_pk_mul_f32 v[140:141], v[140:141], v[248:249]
v_pk_mul_f32 v[142:143], v[142:143], v[250:251]
v_cvt_pk_bf16_f32 v220, v204, v205
v_cvt_pk_bf16_f32 v221, v206, v207
v_cvt_pk_bf16_f32 v222, v140, v141
v_cvt_pk_bf16_f32 v223, v142, v143
buffer_store_dwordx4 v[220:223], v234, s[28:31], s72 offen offset:3072 sc1
v_pk_mul_f32 v[248:249], v[160:161], s[44:45]
v_pk_mul_f32 v[250:251], v[162:163], s[44:45]
v_exp_f32 v248, v248
v_exp_f32 v249, v249
v_exp_f32 v250, v250
v_exp_f32 v251, v251
v_pk_mul_f32 v[160:161], v[160:161], v[176:177]
v_pk_mul_f32 v[162:163], v[162:163], v[178:179]
v_pk_add_f32 v[248:249], v[248:249], s[46:47]
v_pk_add_f32 v[250:251], v[250:251], s[46:47]
v_rcp_f32 v248, v248
v_rcp_f32 v249, v249
v_rcp_f32 v250, v250
v_rcp_f32 v251, v251
v_pk_mul_f32 v[160:161], v[160:161], v[248:249]
v_pk_mul_f32 v[162:163], v[162:163], v[250:251]
v_cvt_pk_bf16_f32 v176, v160, v161
v_cvt_pk_bf16_f32 v177, v162, v163
buffer_store_dwordx2 v[176:177], v234, s[28:31], s73 offen offset:0 sc1
v_pk_mul_f32 v[248:249], v[164:165], s[44:45]
v_pk_mul_f32 v[250:251], v[166:167], s[44:45]
v_exp_f32 v248, v248
v_exp_f32 v249, v249
v_exp_f32 v250, v250
v_exp_f32 v251, v251
v_pk_mul_f32 v[164:165], v[164:165], v[180:181]
v_pk_mul_f32 v[166:167], v[166:167], v[182:183]
v_pk_add_f32 v[248:249], v[248:249], s[46:47]
v_pk_add_f32 v[250:251], v[250:251], s[46:47]
v_rcp_f32 v248, v248
v_rcp_f32 v249, v249
v_rcp_f32 v250, v250
v_rcp_f32 v251, v251
v_pk_mul_f32 v[164:165], v[164:165], v[248:249]
v_pk_mul_f32 v[166:167], v[166:167], v[250:251]
v_cvt_pk_bf16_f32 v180, v164, v165
v_cvt_pk_bf16_f32 v181, v166, v167
buffer_store_dwordx2 v[180:181], v234, s[28:31], s73 offen offset:1024 sc1
v_pk_mul_f32 v[248:249], v[168:169], s[44:45]
v_pk_mul_f32 v[250:251], v[170:171], s[44:45]
v_exp_f32 v248, v248
v_exp_f32 v249, v249
v_exp_f32 v250, v250
v_exp_f32 v251, v251
v_pk_mul_f32 v[168:169], v[168:169], v[184:185]
v_pk_mul_f32 v[170:171], v[170:171], v[186:187]
v_pk_add_f32 v[248:249], v[248:249], s[46:47]
v_pk_add_f32 v[250:251], v[250:251], s[46:47]
v_rcp_f32 v248, v248
v_rcp_f32 v249, v249
v_rcp_f32 v250, v250
v_rcp_f32 v251, v251
v_pk_mul_f32 v[168:169], v[168:169], v[248:249]
v_pk_mul_f32 v[170:171], v[170:171], v[250:251]
v_cvt_pk_bf16_f32 v184, v168, v169
v_cvt_pk_bf16_f32 v185, v170, v171
buffer_store_dwordx2 v[184:185], v234, s[28:31], s73 offen offset:2048 sc1
v_pk_mul_f32 v[248:249], v[172:173], s[44:45]
v_pk_mul_f32 v[250:251], v[174:175], s[44:45]
v_exp_f32 v248, v248
v_exp_f32 v249, v249
v_exp_f32 v250, v250
v_exp_f32 v251, v251
v_pk_mul_f32 v[172:173], v[172:173], v[188:189]
v_pk_mul_f32 v[174:175], v[174:175], v[190:191]
v_pk_add_f32 v[248:249], v[248:249], s[46:47]
v_pk_add_f32 v[250:251], v[250:251], s[46:47]
v_rcp_f32 v248, v248
v_rcp_f32 v249, v249
v_rcp_f32 v250, v250
v_rcp_f32 v251, v251
v_pk_mul_f32 v[172:173], v[172:173], v[248:249]
v_pk_mul_f32 v[174:175], v[174:175], v[250:251]
v_cvt_pk_bf16_f32 v188, v172, v173
v_cvt_pk_bf16_f32 v189, v174, v175
buffer_store_dwordx2 v[188:189], v234, s[28:31], s73 offen offset:3072 sc1
v_mov_b32 v186, s51
v_min_u32 v232, 1, v234
v_lshlrev_b32 v232, 30, v232
v_bfe_u32 v187, v234, 2, 5
v_and_b32 v247, 12, v187
v_mov_b32 v128, -1
v_mov_b32 v129, -1
v_mov_b32 v130, -1
v_mov_b32 v131, -1
s_lshl_b32 s74, s3, 8
s_add_u32 s74, s74, 160768
v_lshrrev_b32 v132, 2, v234
v_add_u32 v132, s74, v132
v_bfe_u32 v133, v234, 4, 2
v_lshlrev_b32 v133, 8, v133
v_add_u32 v133, 160768, v133
v_mov_b32 v134, 1
s_mov_b32 s47, 16
k1_att:
v_mov_b32 v152, 0
v_mov_b32 v153, 0
v_mov_b32 v154, 0
v_mov_b32 v155, 0
s_mov_b32 s62, 0
v_exp_f32 v0, v0
s_nop 0
v_add_f32 v124, v124, v0
v_exp_f32 v1, v1
s_nop 0
v_add_f32 v124, v124, v1
v_cvt_pk_bf16_f32 v64, v0, v1
v_exp_f32 v8, v8
v_exp_f32 v9, v9
s_nop 0
v_cvt_pk_bf16_f32 v72, v8, v9
v_exp_f32 v2, v2
s_nop 0
v_add_f32 v124, v124, v2
v_exp_f32 v3, v3
s_nop 0
v_add_f32 v124, v124, v3
v_cvt_pk_bf16_f32 v65, v2, v3
v_exp_f32 v10, v10
v_exp_f32 v11, v11
s_waitcnt lgkmcnt(0)
v_cvt_pk_bf16_f32 v73, v10, v11
v_exp_f32 v16, v16
s_nop 0
v_add_f32 v124, v124, v16
v_exp_f32 v17, v17
s_nop 0
v_add_f32 v124, v124, v17
v_cvt_pk_bf16_f32 v66, v16, v17
v_exp_f32 v24, v24
v_exp_f32 v25, v25
s_nop 0
v_cvt_pk_bf16_f32 v74, v24, v25
v_exp_f32 v18, v18
s_nop 0
v_add_f32 v124, v124, v18
v_exp_f32 v19, v19
s_nop 0
v_add_f32 v124, v124, v19
v_cvt_pk_bf16_f32 v67, v18, v19
v_exp_f32 v26, v26
s_waitcnt vmcnt(24)
v_exp_f32 v27, v27
s_waitcnt lgkmcnt(0)
v_cvt_pk_bf16_f32 v75, v26, v27
s_barrier
v_exp_f32 v4, v4
s_nop 0
ds_read_b128 a[192:195], v235 offset:16384
v_add_f32 v125, v125, v4
v_exp_f32 v5, v5
s_nop 0
v_add_f32 v125, v125, v5
v_cvt_pk_bf16_f32 v68, v4, v5
v_exp_f32 v12, v12
s_nop 0
ds_read_b128 a[196:199], v236 offset:16384
v_exp_f32 v13, v13
s_nop 0
v_cvt_pk_bf16_f32 v76, v12, v13
v_exp_f32 v6, v6
s_nop 0
ds_read_b128 a[200:203], v237 offset:16384
v_add_f32 v125, v125, v6
v_exp_f32 v7, v7
s_nop 0
v_add_f32 v125, v125, v7
v_cvt_pk_bf16_f32 v69, v6, v7
v_exp_f32 v14, v14
s_nop 0
ds_read_b128 a[204:207], v238 offset:16384
v_exp_f32 v15, v15
s_waitcnt lgkmcnt(4)
v_cvt_pk_bf16_f32 v77, v14, v15
v_exp_f32 v20, v20
s_nop 0
ds_read_b128 a[208:211], v235 offset:20480
v_add_f32 v125, v125, v20
v_exp_f32 v21, v21
s_nop 0
v_add_f32 v125, v125, v21
v_cvt_pk_bf16_f32 v70, v20, v21
v_exp_f32 v28, v28
s_nop 0
ds_read_b128 a[212:215], v236 offset:20480
v_exp_f32 v29, v29
s_nop 0
v_cvt_pk_bf16_f32 v78, v28, v29
v_exp_f32 v22, v22
s_nop 0
ds_read_b128 a[216:219], v237 offset:20480
v_add_f32 v125, v125, v22
v_exp_f32 v23, v23
s_nop 0
v_add_f32 v125, v125, v23
v_cvt_pk_bf16_f32 v71, v22, v23
v_exp_f32 v30, v30
s_nop 0
ds_read_b128 a[220:223], v238 offset:20480
v_exp_f32 v31, v31
s_nop 0
v_cvt_pk_bf16_f32 v79, v30, v31
s_waitcnt lgkmcnt(4)
v_mfma_f32_16x16x32_bf16 v[0:3], a[192:195], a[80:83], v[96:99]
v_exp_f32 v32, v32
v_mfma_f32_16x16x32_bf16 v[0:3], a[196:199], a[112:115], v[0:3]
v_add_f32 v124, v124, v32
v_mfma_f32_16x16x32_bf16 v[0:3], a[200:203], a[144:147], v[0:3]
v_exp_f32 v33, v33
v_mfma_f32_16x16x32_bf16 v[0:3], a[204:207], a[176:179], v[0:3]
v_add_f32 v124, v124, v33
v_cvt_pk_bf16_f32 v80, v32, v33
v_mfma_f32_16x16x32_bf16 v[4:7], a[204:207], a[180:183], v[100:103]
v_exp_f32 v40, v40
v_mfma_f32_16x16x32_bf16 v[4:7], a[200:203], a[148:151], v[4:7]
v_mfma_f32_16x16x32_bf16 v[4:7], a[196:199], a[116:119], v[4:7]
v_exp_f32 v41, v41
v_mfma_f32_16x16x32_bf16 v[4:7], a[192:195], a[84:87], v[4:7]
v_cvt_pk_bf16_f32 v88, v40, v41
v_mfma_f32_16x16x32_bf16 v[8:11], a[192:195], a[88:91], v[104:107]
v_exp_f32 v34, v34
v_mfma_f32_16x16x32_bf16 v[8:11], a[196:199], a[120:123], v[8:11]
v_add_f32 v124, v124, v34
v_mfma_f32_16x16x32_bf16 v[8:11], a[200:203], a[152:155], v[8:11]
v_exp_f32 v35, v35
v_mfma_f32_16x16x32_bf16 v[8:11], a[204:207], a[184:187], v[8:11]
v_add_f32 v124, v124, v35
v_cvt_pk_bf16_f32 v81, v34, v35
v_mfma_f32_16x16x32_bf16 v[12:15], a[204:207], a[188:191], v[108:111]
v_exp_f32 v42, v42
v_mfma_f32_16x16x32_bf16 v[12:15], a[200:203], a[156:159], v[12:15]
v_mfma_f32_16x16x32_bf16 v[12:15], a[196:199], a[124:127], v[12:15]
v_exp_f32 v43, v43
v_mfma_f32_16x16x32_bf16 v[12:15], a[192:195], a[92:95], v[12:15]
s_waitcnt lgkmcnt(0)
v_cvt_pk_bf16_f32 v89, v42, v43
v_mfma_f32_16x16x32_bf16 v[28:31], a[208:211], a[92:95], v[108:111]
v_exp_f32 v48, v48
v_mfma_f32_16x16x32_bf16 v[28:31], a[212:215], a[124:127], v[28:31]
v_add_f32 v124, v124, v48
v_mfma_f32_16x16x32_bf16 v[28:31], a[216:219], a[156:159], v[28:31]
v_exp_f32 v49, v49
v_mfma_f32_16x16x32_bf16 v[28:31], a[220:223], a[188:191], v[28:31]
v_add_f32 v124, v124, v49
v_cvt_pk_bf16_f32 v82, v48, v49
v_mfma_f32_16x16x32_bf16 v[24:27], a[220:223], a[184:187], v[104:107]
v_exp_f32 v56, v56
v_mfma_f32_16x16x32_bf16 v[24:27], a[216:219], a[152:155], v[24:27]
v_mfma_f32_16x16x32_bf16 v[24:27], a[212:215], a[120:123], v[24:27]
v_exp_f32 v57, v57
v_mfma_f32_16x16x32_bf16 v[24:27], a[208:211], a[88:91], v[24:27]
v_cvt_pk_bf16_f32 v90, v56, v57
v_mfma_f32_16x16x32_bf16 v[20:23], a[208:211], a[84:87], v[100:103]
v_exp_f32 v50, v50
v_mfma_f32_16x16x32_bf16 v[20:23], a[212:215], a[116:119], v[20:23]
v_add_f32 v124, v124, v50
v_mfma_f32_16x16x32_bf16 v[20:23], a[216:219], a[148:151], v[20:23]
v_exp_f32 v51, v51
v_mfma_f32_16x16x32_bf16 v[20:23], a[220:223], a[180:183], v[20:23]
v_add_f32 v124, v124, v51
v_cvt_pk_bf16_f32 v83, v50, v51
v_mfma_f32_16x16x32_bf16 v[16:19], a[220:223], a[176:179], v[96:99]
v_exp_f32 v58, v58
v_mfma_f32_16x16x32_bf16 v[16:19], a[216:219], a[144:147], v[16:19]
v_mfma_f32_16x16x32_bf16 v[16:19], a[212:215], a[112:115], v[16:19]
v_exp_f32 v59, v59
v_mfma_f32_16x16x32_bf16 v[16:19], a[208:211], a[80:83], v[16:19]
s_waitcnt lgkmcnt(0)
v_cvt_pk_bf16_f32 v91, v58, v59
v_mfma_f32_16x16x32_bf16 a[0:3], v[152:155], v[152:155], 0
v_exp_f32 v36, v36
v_mfma_f32_16x16x32_bf16 a[4:7], v[152:155], v[152:155], 0
ds_read_b128 a[192:195], v235 offset:24576
v_add_f32 v125, v125, v36
v_mfma_f32_16x16x32_bf16 a[8:11], v[152:155], v[152:155], 0
s_add_u32 m0, s65, 98304
v_exp_f32 v37, v37
v_mfma_f32_16x16x32_bf16 a[12:15], v[152:155], v[152:155], 0
buffer_load_dwordx4 v228, s[24:27], s64 offen offset:0 lds
v_mfma_f32_16x16x32_bf16 a[16:19], v[152:155], v[152:155], 0
v_exp_f32 v44, v44
v_mfma_f32_16x16x32_bf16 a[20:23], v[152:155], v[152:155], 0
ds_read_b128 a[196:199], v236 offset:24576
v_add_f32 v125, v125, v37
v_mfma_f32_16x16x32_bf16 a[24:27], v[152:155], v[152:155], 0
v_exp_f32 v45, v45
v_mfma_f32_16x16x32_bf16 a[28:31], v[152:155], v[152:155], 0
v_cvt_pk_bf16_f32 v84, v36, v37
v_cvt_pk_bf16_f32 v92, v44, v45
v_mfma_f32_16x16x32_bf16 a[32:35], v[152:155], v[152:155], 0
v_exp_f32 v38, v38
v_mfma_f32_16x16x32_bf16 a[36:39], v[152:155], v[152:155], 0
ds_read_b128 a[200:203], v237 offset:24576
v_add_f32 v125, v125, v38
v_mfma_f32_16x16x32_bf16 a[40:43], v[152:155], v[152:155], 0
v_exp_f32 v39, v39
v_mfma_f32_16x16x32_bf16 a[44:47], v[152:155], v[152:155], 0
buffer_load_dwordx4 v229, s[24:27], s64 offen offset:1024 lds
v_mfma_f32_16x16x32_bf16 a[48:51], v[152:155], v[152:155], 0
v_exp_f32 v46, v46
v_mfma_f32_16x16x32_bf16 a[52:55], v[152:155], v[152:155], 0
ds_read_b128 a[204:207], v238 offset:24576
v_add_f32 v125, v125, v39
v_mfma_f32_16x16x32_bf16 a[56:59], v[152:155], v[152:155], 0
v_exp_f32 v47, v47
v_mfma_f32_16x16x32_bf16 a[60:63], v[152:155], v[152:155], 0
s_waitcnt lgkmcnt(4)
v_cvt_pk_bf16_f32 v85, v38, v39
v_cvt_pk_bf16_f32 v93, v46, v47
v_mfma_f32_16x16x32_bf16 a[64:67], v[152:155], v[152:155], 0
v_exp_f32 v52, v52
v_mfma_f32_16x16x32_bf16 a[68:71], v[152:155], v[152:155], 0
ds_read_b128 a[208:211], v235 offset:28672
v_add_f32 v125, v125, v52
v_mfma_f32_16x16x32_bf16 a[72:75], v[152:155], v[152:155], 0
v_exp_f32 v53, v53
v_mfma_f32_16x16x32_bf16 a[76:79], v[152:155], v[152:155], 0
buffer_load_dwordx4 v228, s[24:27], s64 offen offset:2048 lds
v_mfma_f32_16x16x32_bf16 a[96:99], v[152:155], v[152:155], 0
v_exp_f32 v60, v60
v_mfma_f32_16x16x32_bf16 a[100:103], v[152:155], v[152:155], 0
ds_read_b128 a[212:215], v236 offset:28672
v_add_f32 v125, v125, v53
v_mfma_f32_16x16x32_bf16 a[104:107], v[152:155], v[152:155], 0
v_exp_f32 v61, v61
v_mfma_f32_16x16x32_bf16 a[108:111], v[152:155], v[152:155], 0
v_cvt_pk_bf16_f32 v86, v52, v53
v_cvt_pk_bf16_f32 v94, v60, v61
v_mfma_f32_16x16x32_bf16 a[128:131], v[152:155], v[152:155], 0
s_waitcnt vmcnt(23)
v_exp_f32 v54, v54
v_mfma_f32_16x16x32_bf16 a[132:135], v[152:155], v[152:155], 0
ds_read_b128 a[216:219], v237 offset:28672
ds_add_u32 v132, v134
v_mfma_f32_16x16x32_bf16 a[136:139], v[152:155], v[152:155], 0
v_exp_f32 v55, v55
v_mfma_f32_16x16x32_bf16 a[140:143], v[152:155], v[152:155], 0
buffer_load_dwordx4 v229, s[24:27], s64 offen offset:3072 lds
v_mfma_f32_16x16x32_bf16 a[160:163], v[152:155], v[152:155], 0
s_add_u32 s64, s64, 16384
v_exp_f32 v62, v62
v_mfma_f32_16x16x32_bf16 a[164:167], v[152:155], v[152:155], 0
ds_read_b128 a[220:223], v238 offset:28672
v_add_f32 v125, v125, v54
v_mfma_f32_16x16x32_bf16 a[168:171], v[152:155], v[152:155], 0
s_add_u32 s47, s47, 1
v_exp_f32 v63, v63
v_mfma_f32_16x16x32_bf16 a[172:175], v[152:155], v[152:155], 0
v_add_f32 v125, v125, v55
v_cvt_pk_bf16_f32 v87, v54, v55
v_mfma_f32_16x16x32_bf16 v[112:115], v[152:155], v[152:155], 0
v_cvt_pk_bf16_f32 v95, v62, v63
v_mfma_f32_16x16x32_bf16 v[116:119], v[152:155], v[152:155], 0
s_waitcnt lgkmcnt(5)
.p2align 6
k1_al:
v_mfma_f32_16x16x32_bf16 v[32:35], a[192:195], a[80:83], v[96:99]
v_exp_f32 v0, v0
v_mfma_f32_16x16x32_bf16 v[32:35], a[196:199], a[112:115], v[32:35]
ds_read_b64_tr_b16 a[224:225], v239 offset:0
v_add_f32 v124, v124, v0
v_mfma_f32_16x16x32_bf16 v[32:35], a[200:203], a[144:147], v[32:35]
v_exp_f32 v1, v1
v_mfma_f32_16x16x32_bf16 v[32:35], a[204:207], a[176:179], v[32:35]
ds_read_b64_tr_b16 a[226:227], v239 offset:4096
v_add_f32 v124, v124, v1
v_mfma_f32_16x16x32_bf16 v[36:39], a[204:207], a[180:183], v[100:103]
v_exp_f32 v8, v8
v_mfma_f32_16x16x32_bf16 v[36:39], a[200:203], a[148:151], v[36:39]
ds_read_b64_tr_b16 a[228:229], v239 offset:8192
v_cvt_pk_bf16_f32 v136, v0, v1
v_mfma_f32_16x16x32_bf16 v[36:39], a[196:199], a[116:119], v[36:39]
v_exp_f32 v9, v9
v_mfma_f32_16x16x32_bf16 v[36:39], a[192:195], a[84:87], v[36:39]
ds_read_b64_tr_b16 a[230:231], v239 offset:12288
v_cvt_pk_bf16_f32 v144, v8, v9
v_mfma_f32_16x16x32_bf16 v[40:43], a[192:195], a[88:91], v[104:107]
v_exp_f32 v2, v2
v_mfma_f32_16x16x32_bf16 v[40:43], a[196:199], a[120:123], v[40:43]
ds_read_b64_tr_b16 a[232:233], v240 offset:0
v_add_f32 v124, v124, v2
v_mfma_f32_16x16x32_bf16 v[40:43], a[200:203], a[152:155], v[40:43]
v_exp_f32 v3, v3
v_mfma_f32_16x16x32_bf16 v[40:43], a[204:207], a[184:187], v[40:43]
ds_read_b64_tr_b16 a[234:235], v240 offset:4096
v_add_f32 v124, v124, v3
v_mfma_f32_16x16x32_bf16 v[44:47], a[204:207], a[188:191], v[108:111]
v_exp_f32 v10, v10
v_mfma_f32_16x16x32_bf16 v[44:47], a[200:203], a[156:159], v[44:47]
ds_read_b64_tr_b16 a[236:237], v240 offset:8192
ds_read_b32 v135, v133
v_mfma_f32_16x16x32_bf16 v[44:47], a[196:199], a[124:127], v[44:47]
v_exp_f32 v11, v11
v_mfma_f32_16x16x32_bf16 v[44:47], a[192:195], a[92:95], v[44:47]
s_waitcnt lgkmcnt(8)
ds_read_b64_tr_b16 a[238:239], v240 offset:12288
v_cvt_pk_bf16_f32 v137, v2, v3
v_mfma_f32_16x16x32_bf16 v[60:63], a[208:211], a[92:95], v[108:111]
s_min_u32 s74, s68, 13
v_exp_f32 v16, v16
v_mfma_f32_16x16x32_bf16 v[60:63], a[212:215], a[124:127], v[60:63]
s_add_u32 s74, s74, s69
ds_read_b64_tr_b16 a[240:241], v241 offset:0
v_cvt_pk_bf16_f32 v145, v10, v11
v_mfma_f32_16x16x32_bf16 v[60:63], a[216:219], a[156:159], v[60:63]
s_add_u32 s76, s68, s70
v_exp_f32 v17, v17
v_mfma_f32_16x16x32_bf16 v[60:63], a[220:223], a[188:191], v[60:63]
s_cmp_lt_u32 s68, 18
ds_read_b64_tr_b16 a[242:243], v241 offset:4096
v_add_f32 v124, v124, v16
v_mfma_f32_16x16x32_bf16 v[56:59], a[220:223], a[184:187], v[104:107]
s_cselect_b32 s32, s4, s6
v_exp_f32 v24, v24
v_mfma_f32_16x16x32_bf16 v[56:59], a[216:219], a[152:155], v[56:59]
s_cselect_b32 s33, s5, s7
ds_read_b64_tr_b16 a[244:245], v241 offset:8192
v_add_f32 v124, v124, v17
v_mfma_f32_16x16x32_bf16 v[56:59], a[212:215], a[120:123], v[56:59]
s_cselect_b32 s74, s74, s76
v_exp_f32 v25, v25
v_mfma_f32_16x16x32_bf16 v[56:59], a[208:211], a[88:91], v[56:59]
s_cselect_b32 s76, 0, 4096
ds_read_b64_tr_b16 a[246:247], v241 offset:12288
v_cvt_pk_bf16_f32 v138, v16, v17
v_mfma_f32_16x16x32_bf16 v[52:55], a[208:211], a[84:87], v[100:103]
s_add_u32 s76, s76, s74
v_exp_f32 v18, v18
v_mfma_f32_16x16x32_bf16 v[52:55], a[212:215], a[116:119], v[52:55]
s_mul_i32 s74, s74, 1152
ds_read_b64_tr_b16 a[248:249], v242 offset:0
v_cvt_pk_bf16_f32 v146, v24, v25
v_mfma_f32_16x16x32_bf16 v[52:55], a[216:219], a[148:151], v[52:55]
s_add_u32 s74, s74, s71
v_exp_f32 v19, v19
v_mfma_f32_16x16x32_bf16 v[52:55], a[220:223], a[180:183], v[52:55]
ds_read_b64_tr_b16 a[250:251], v242 offset:4096
v_add_f32 v124, v124, v18
v_mfma_f32_16x16x32_bf16 v[48:51], a[220:223], a[176:179], v[96:99]
v_exp_f32 v26, v26
v_mfma_f32_16x16x32_bf16 v[48:51], a[216:219], a[144:147], v[48:51]
s_waitcnt lgkmcnt(7)
ds_read_b64_tr_b16 a[252:253], v242 offset:8192
v_cmp_gt_u32 vcc, s47, v135
v_mfma_f32_16x16x32_bf16 v[48:51], a[212:215], a[112:115], v[48:51]
v_exp_f32 v27, v27
v_mfma_f32_16x16x32_bf16 v[48:51], a[208:211], a[80:83], v[48:51]
s_waitcnt lgkmcnt(7)
ds_read_b64_tr_b16 a[254:255], v242 offset:12288
v_add_f32 v124, v124, v19
v_mfma_f32_16x16x32_bf16 a[12:15], a[224:227], v[76:79], a[12:15]
s_cbranch_vccnz k1_y02_s
k1_y02_b:
v_exp_f32 v4, v4
v_mfma_f32_16x16x32_bf16 a[12:15], a[228:231], v[92:95], a[12:15]
ds_read_b128 a[192:195], v235 offset:32768
v_cvt_pk_bf16_f32 v139, v18, v19
v_mfma_f32_16x16x32_bf16 a[8:11], a[228:231], v[88:91], a[8:11]
s_add_u32 m0, s65, 0
v_exp_f32 v5, v5
v_mfma_f32_16x16x32_bf16 a[8:11], a[224:227], v[72:75], a[8:11]
buffer_load_dwordx4 v224, s[20:23], s63 offen offset:0 lds
v_mfma_f32_16x16x32_bf16 a[4:7], a[224:227], v[68:71], a[4:7]
v_exp_f32 v12, v12
v_mfma_f32_16x16x32_bf16 a[4:7], a[228:231], v[84:87], a[4:7]
ds_read_b128 a[196:199], v236 offset:32768
v_cvt_pk_bf16_f32 v147, v26, v27
v_mfma_f32_16x16x32_bf16 a[0:3], a[228:231], v[80:83], a[0:3]
v_exp_f32 v13, v13
v_mfma_f32_16x16x32_bf16 a[0:3], a[224:227], v[64:67], a[0:3]
buffer_load_dwordx4 v[192:195], v230, s[32:35], s74 offen
v_mfma_f32_16x16x32_bf16 a[16:19], a[232:235], v[64:67], a[16:19]
s_mul_i32 s76, s76, 288
v_exp_f32 v6, v6
v_mfma_f32_16x16x32_bf16 a[16:19], a[236:239], v[80:83], a[16:19]
s_add_u32 s54, s76, s57
ds_read_b128 a[200:203], v237 offset:32768
v_add_f32 v125, v125, v4
v_mfma_f32_16x16x32_bf16 a[20:23], a[236:239], v[84:87], a[20:23]
v_exp_f32 v7, v7
v_mfma_f32_16x16x32_bf16 a[20:23], a[232:235], v[68:71], a[20:23]
buffer_load_dwordx4 v225, s[20:23], s63 offen offset:1024 lds
v_mfma_f32_16x16x32_bf16 a[24:27], a[232:235], v[72:75], a[24:27]
s_add_u32 s68, s68, 3
v_exp_f32 v14, v14
v_mfma_f32_16x16x32_bf16 a[24:27], a[236:239], v[88:91], a[24:27]
ds_read_b128 a[204:207], v238 offset:32768
v_add_f32 v125, v125, v5
v_mfma_f32_16x16x32_bf16 a[28:31], a[236:239], v[92:95], a[28:31]
v_exp_f32 v15, v15
v_mfma_f32_16x16x32_bf16 a[28:31], a[232:235], v[76:79], a[28:31]
s_waitcnt lgkmcnt(4)
v_cvt_pk_bf16_f32 v140, v4, v5
v_cvt_pk_bf16_f32 v148, v12, v13
v_mfma_f32_16x16x32_bf16 a[44:47], a[240:243], v[76:79], a[44:47]
v_exp_f32 v20, v20
v_mfma_f32_16x16x32_bf16 a[44:47], a[244:247], v[92:95], a[44:47]
ds_read_b128 a[208:211], v235 offset:36864
v_add_f32 v125, v125, v6
v_mfma_f32_16x16x32_bf16 a[40:43], a[244:247], v[88:91], a[40:43]
v_exp_f32 v21, v21
v_mfma_f32_16x16x32_bf16 a[40:43], a[240:243], v[72:75], a[40:43]
buffer_load_dwordx4 v226, s[20:23], s63 offen offset:2048 lds
v_mfma_f32_16x16x32_bf16 a[36:39], a[240:243], v[68:71], a[36:39]
v_exp_f32 v28, v28
v_mfma_f32_16x16x32_bf16 a[36:39], a[244:247], v[84:87], a[36:39]
ds_read_b128 a[212:215], v236 offset:36864
v_add_f32 v125, v125, v7
v_mfma_f32_16x16x32_bf16 a[32:35], a[244:247], v[80:83], a[32:35]
v_exp_f32 v29, v29
v_mfma_f32_16x16x32_bf16 a[32:35], a[240:243], v[64:67], a[32:35]
v_cvt_pk_bf16_f32 v141, v6, v7
v_cvt_pk_bf16_f32 v149, v14, v15
v_mfma_f32_16x16x32_bf16 a[48:51], a[248:251], v[64:67], a[48:51]
v_exp_f32 v22, v22
v_mfma_f32_16x16x32_bf16 a[48:51], a[252:255], v[80:83], a[48:51]
ds_read_b128 a[216:219], v237 offset:36864
v_add_f32 v125, v125, v20
v_mfma_f32_16x16x32_bf16 a[52:55], a[252:255], v[84:87], a[52:55]
v_exp_f32 v23, v23
v_mfma_f32_16x16x32_bf16 a[52:55], a[248:251], v[68:71], a[52:55]
buffer_load_dwordx4 v227, s[20:23], s63 offen offset:3072 lds
v_mfma_f32_16x16x32_bf16 a[56:59], a[248:251], v[72:75], a[56:59]
s_add_u32 s63, s63, 16384
v_exp_f32 v30, v30
v_mfma_f32_16x16x32_bf16 a[56:59], a[252:255], v[88:91], a[56:59]
ds_read_b128 a[220:223], v238 offset:36864
v_add_f32 v125, v125, v21
v_mfma_f32_16x16x32_bf16 a[60:63], a[252:255], v[92:95], a[60:63]
v_exp_f32 v31, v31
v_mfma_f32_16x16x32_bf16 a[60:63], a[248:251], v[76:79], a[60:63]
v_cvt_pk_bf16_f32 v142, v20, v21
v_cvt_pk_bf16_f32 v150, v28, v29
v_mfma_f32_16x16x32_bf16 v[112:115], v[120:123], v[72:75], v[112:115]
v_add_f32 v125, v125, v22
v_add_f32 v125, v125, v23
v_mfma_f32_16x16x32_bf16 v[112:115], v[120:123], v[88:91], v[112:115]
s_waitcnt lgkmcnt(4)
v_cvt_pk_bf16_f32 v143, v22, v23
v_cvt_pk_bf16_f32 v151, v30, v31
v_mfma_f32_16x16x32_bf16 v[0:3], a[192:195], a[80:83], v[96:99]
v_exp_f32 v32, v32
v_mfma_f32_16x16x32_bf16 v[0:3], a[196:199], a[112:115], v[0:3]
ds_read_b64_tr_b16 a[224:225], v243 offset:0
v_add_f32 v124, v124, v32
v_mfma_f32_16x16x32_bf16 v[0:3], a[200:203], a[144:147], v[0:3]
v_exp_f32 v33, v33
v_mfma_f32_16x16x32_bf16 v[0:3], a[204:207], a[176:179], v[0:3]
ds_read_b64_tr_b16 a[226:227], v243 offset:4096
v_add_f32 v124, v124, v33
v_mfma_f32_16x16x32_bf16 v[4:7], a[204:207], a[180:183], v[100:103]
v_exp_f32 v40, v40
v_mfma_f32_16x16x32_bf16 v[4:7], a[200:203], a[148:151], v[4:7]
ds_read_b64_tr_b16 a[228:229], v243 offset:8192
v_cvt_pk_bf16_f32 v152, v32, v33
v_mfma_f32_16x16x32_bf16 v[4:7], a[196:199], a[116:119], v[4:7]
v_exp_f32 v41, v41
v_mfma_f32_16x16x32_bf16 v[4:7], a[192:195], a[84:87], v[4:7]
ds_read_b64_tr_b16 a[230:231], v243 offset:12288
v_cvt_pk_bf16_f32 v160, v40, v41
v_mfma_f32_16x16x32_bf16 v[8:11], a[192:195], a[88:91], v[104:107]
v_exp_f32 v34, v34
v_mfma_f32_16x16x32_bf16 v[8:11], a[196:199], a[120:123], v[8:11]
ds_read_b64_tr_b16 a[232:233], v244 offset:0
v_add_f32 v124, v124, v34
v_mfma_f32_16x16x32_bf16 v[8:11], a[200:203], a[152:155], v[8:11]
v_exp_f32 v35, v35
v_mfma_f32_16x16x32_bf16 v[8:11], a[204:207], a[184:187], v[8:11]
ds_read_b64_tr_b16 a[234:235], v244 offset:4096
v_add_f32 v124, v124, v35
v_mfma_f32_16x16x32_bf16 v[12:15], a[204:207], a[188:191], v[108:111]
v_exp_f32 v42, v42
v_mfma_f32_16x16x32_bf16 v[12:15], a[200:203], a[156:159], v[12:15]
ds_read_b64_tr_b16 a[236:237], v244 offset:8192
v_cvt_pk_bf16_f32 v153, v34, v35
v_mfma_f32_16x16x32_bf16 v[12:15], a[196:199], a[124:127], v[12:15]
v_exp_f32 v43, v43
v_mfma_f32_16x16x32_bf16 v[12:15], a[192:195], a[92:95], v[12:15]
s_waitcnt lgkmcnt(7)
ds_read_b64_tr_b16 a[238:239], v244 offset:12288
v_cvt_pk_bf16_f32 v161, v42, v43
v_mfma_f32_16x16x32_bf16 v[28:31], a[208:211], a[92:95], v[108:111]
s_min_u32 s74, s68, 13
v_exp_f32 v48, v48
v_mfma_f32_16x16x32_bf16 v[28:31], a[212:215], a[124:127], v[28:31]
s_add_u32 s74, s74, s69
ds_read_b64_tr_b16 a[240:241], v245 offset:0
v_add_f32 v124, v124, v48
v_mfma_f32_16x16x32_bf16 v[28:31], a[216:219], a[156:159], v[28:31]
s_add_u32 s76, s68, s70
v_exp_f32 v49, v49
v_mfma_f32_16x16x32_bf16 v[28:31], a[220:223], a[188:191], v[28:31]
s_cmp_lt_u32 s68, 18
ds_read_b64_tr_b16 a[242:243], v245 offset:4096
v_add_f32 v124, v124, v49
v_mfma_f32_16x16x32_bf16 v[24:27], a[220:223], a[184:187], v[104:107]
s_cselect_b32 s32, s4, s6
v_exp_f32 v56, v56
v_mfma_f32_16x16x32_bf16 v[24:27], a[216:219], a[152:155], v[24:27]
s_cselect_b32 s33, s5, s7
ds_read_b64_tr_b16 a[244:245], v245 offset:8192
v_cvt_pk_bf16_f32 v154, v48, v49
v_mfma_f32_16x16x32_bf16 v[24:27], a[212:215], a[120:123], v[24:27]
s_cselect_b32 s74, s74, s76
v_exp_f32 v57, v57
v_mfma_f32_16x16x32_bf16 v[24:27], a[208:211], a[88:91], v[24:27]
s_cselect_b32 s76, 0, 4096
ds_read_b64_tr_b16 a[246:247], v245 offset:12288
v_cvt_pk_bf16_f32 v162, v56, v57
v_mfma_f32_16x16x32_bf16 v[20:23], a[208:211], a[84:87], v[100:103]
s_add_u32 s76, s76, s74
v_exp_f32 v50, v50
v_mfma_f32_16x16x32_bf16 v[20:23], a[212:215], a[116:119], v[20:23]
s_mul_i32 s74, s74, 1152
ds_read_b64_tr_b16 a[248:249], v246 offset:0
v_add_f32 v124, v124, v50
v_mfma_f32_16x16x32_bf16 v[20:23], a[216:219], a[148:151], v[20:23]
s_add_u32 s74, s74, s71
v_exp_f32 v51, v51
v_mfma_f32_16x16x32_bf16 v[20:23], a[220:223], a[180:183], v[20:23]
ds_read_b64_tr_b16 a[250:251], v246 offset:4096
v_add_f32 v124, v124, v51
v_mfma_f32_16x16x32_bf16 v[16:19], a[220:223], a[176:179], v[96:99]
v_exp_f32 v58, v58
v_mfma_f32_16x16x32_bf16 v[16:19], a[216:219], a[144:147], v[16:19]
ds_read_b64_tr_b16 a[252:253], v246 offset:8192
v_cvt_pk_bf16_f32 v155, v50, v51
v_mfma_f32_16x16x32_bf16 v[16:19], a[212:215], a[112:115], v[16:19]
v_exp_f32 v59, v59
v_mfma_f32_16x16x32_bf16 v[16:19], a[208:211], a[80:83], v[16:19]
s_waitcnt lgkmcnt(7)
ds_read_b64_tr_b16 a[254:255], v246 offset:12288
v_cvt_pk_bf16_f32 v163, v58, v59
v_mfma_f32_16x16x32_bf16 a[76:79], a[224:227], v[76:79], a[76:79]
v_exp_f32 v36, v36
v_mfma_f32_16x16x32_bf16 a[76:79], a[228:231], v[92:95], a[76:79]
ds_read_b128 a[192:195], v235 offset:40960
v_add_f32 v125, v125, v36
v_mfma_f32_16x16x32_bf16 a[72:75], a[228:231], v[88:91], a[72:75]
s_add_u32 m0, s65, 114688
v_exp_f32 v37, v37
v_mfma_f32_16x16x32_bf16 a[72:75], a[224:227], v[72:75], a[72:75]
buffer_load_dwordx4 v228, s[24:27], s64 offen offset:0 lds
v_mfma_f32_16x16x32_bf16 a[68:71], a[224:227], v[68:71], a[68:71]
v_exp_f32 v44, v44
v_mfma_f32_16x16x32_bf16 a[68:71], a[228:231], v[84:87], a[68:71]
ds_read_b128 a[196:199], v236 offset:40960
v_add_f32 v125, v125, v37
v_mfma_f32_16x16x32_bf16 a[64:67], a[228:231], v[80:83], a[64:67]
v_exp_f32 v45, v45
v_mfma_f32_16x16x32_bf16 a[64:67], a[224:227], v[64:67], a[64:67]
buffer_load_dwordx4 v[196:199], v230, s[32:35], s74 offen
v_mfma_f32_16x16x32_bf16 a[96:99], a[232:235], v[64:67], a[96:99]
s_mul_i32 s76, s76, 288
v_exp_f32 v38, v38
v_mfma_f32_16x16x32_bf16 a[96:99], a[236:239], v[80:83], a[96:99]
s_add_u32 s55, s76, s57
ds_read_b128 a[200:203], v237 offset:40960
v_cvt_pk_bf16_f32 v156, v36, v37
v_mfma_f32_16x16x32_bf16 a[100:103], a[236:239], v[84:87], a[100:103]
v_exp_f32 v39, v39
v_mfma_f32_16x16x32_bf16 a[100:103], a[232:235], v[68:71], a[100:103]
buffer_load_dwordx4 v229, s[24:27], s64 offen offset:1024 lds
v_mfma_f32_16x16x32_bf16 a[104:107], a[232:235], v[72:75], a[104:107]
s_add_u32 s68, s68, 3
v_exp_f32 v46, v46
v_mfma_f32_16x16x32_bf16 a[104:107], a[236:239], v[88:91], a[104:107]
ds_read_b128 a[204:207], v238 offset:40960
v_cvt_pk_bf16_f32 v164, v44, v45
v_mfma_f32_16x16x32_bf16 a[108:111], a[236:239], v[92:95], a[108:111]
v_exp_f32 v47, v47
v_mfma_f32_16x16x32_bf16 a[108:111], a[232:235], v[76:79], a[108:111]
s_waitcnt lgkmcnt(4)
v_add_f32 v125, v125, v38
v_add_f32 v125, v125, v39
v_mfma_f32_16x16x32_bf16 a[140:143], a[240:243], v[76:79], a[140:143]
v_exp_f32 v52, v52
v_mfma_f32_16x16x32_bf16 a[140:143], a[244:247], v[92:95], a[140:143]
ds_read_b128 a[208:211], v235 offset:45056
v_cvt_pk_bf16_f32 v157, v38, v39
v_mfma_f32_16x16x32_bf16 a[136:139], a[244:247], v[88:91], a[136:139]
v_exp_f32 v53, v53
v_mfma_f32_16x16x32_bf16 a[136:139], a[240:243], v[72:75], a[136:139]
buffer_load_dwordx4 v228, s[24:27], s64 offen offset:2048 lds
v_mfma_f32_16x16x32_bf16 a[132:135], a[240:243], v[68:71], a[132:135]
v_exp_f32 v60, v60
v_mfma_f32_16x16x32_bf16 a[132:135], a[244:247], v[84:87], a[132:135]
ds_read_b128 a[212:215], v236 offset:45056
v_cvt_pk_bf16_f32 v165, v46, v47
v_mfma_f32_16x16x32_bf16 a[128:131], a[244:247], v[80:83], a[128:131]
v_exp_f32 v61, v61
v_mfma_f32_16x16x32_bf16 a[128:131], a[240:243], v[64:67], a[128:131]
v_add_f32 v125, v125, v52
v_add_f32 v125, v125, v53
v_mfma_f32_16x16x32_bf16 a[160:163], a[248:251], v[64:67], a[160:163]
s_waitcnt vmcnt(9)
v_exp_f32 v54, v54
v_mfma_f32_16x16x32_bf16 a[160:163], a[252:255], v[80:83], a[160:163]
ds_read_b128 a[216:219], v237 offset:45056
ds_add_u32 v132, v134
v_mfma_f32_16x16x32_bf16 a[164:167], a[252:255], v[84:87], a[164:167]
v_exp_f32 v55, v55
v_mfma_f32_16x16x32_bf16 a[164:167], a[248:251], v[68:71], a[164:167]
buffer_load_dwordx4 v229, s[24:27], s64 offen offset:3072 lds
v_mfma_f32_16x16x32_bf16 a[168:171], a[248:251], v[72:75], a[168:171]
s_add_u32 s64, s64, 16384
v_exp_f32 v62, v62
v_mfma_f32_16x16x32_bf16 a[168:171], a[252:255], v[88:91], a[168:171]
ds_read_b128 a[220:223], v238 offset:45056
v_cvt_pk_bf16_f32 v158, v52, v53
v_mfma_f32_16x16x32_bf16 a[172:175], a[252:255], v[92:95], a[172:175]
s_add_u32 s47, s47, 1
v_exp_f32 v63, v63
v_mfma_f32_16x16x32_bf16 a[172:175], a[248:251], v[76:79], a[172:175]
v_cvt_pk_bf16_f32 v166, v60, v61
v_add_f32 v125, v125, v54
v_mfma_f32_16x16x32_bf16 v[116:119], v[120:123], v[76:79], v[116:119]
v_add_f32 v125, v125, v55
v_cvt_pk_bf16_f32 v159, v54, v55
v_mfma_f32_16x16x32_bf16 v[116:119], v[120:123], v[92:95], v[116:119]
s_waitcnt lgkmcnt(5)
v_cvt_pk_bf16_f32 v167, v62, v63
v_mfma_f32_16x16x32_bf16 v[32:35], a[192:195], a[80:83], v[96:99]
v_exp_f32 v0, v0
v_mfma_f32_16x16x32_bf16 v[32:35], a[196:199], a[112:115], v[32:35]
ds_read_b64_tr_b16 a[224:225], v239 offset:16384
v_add_f32 v124, v124, v0
v_mfma_f32_16x16x32_bf16 v[32:35], a[200:203], a[144:147], v[32:35]
v_exp_f32 v1, v1
v_mfma_f32_16x16x32_bf16 v[32:35], a[204:207], a[176:179], v[32:35]
ds_read_b64_tr_b16 a[226:227], v239 offset:20480
v_add_f32 v124, v124, v1
v_mfma_f32_16x16x32_bf16 v[36:39], a[204:207], a[180:183], v[100:103]
v_exp_f32 v8, v8
v_mfma_f32_16x16x32_bf16 v[36:39], a[200:203], a[148:151], v[36:39]
ds_read_b64_tr_b16 a[228:229], v239 offset:24576
v_cvt_pk_bf16_f32 v64, v0, v1
v_mfma_f32_16x16x32_bf16 v[36:39], a[196:199], a[116:119], v[36:39]
v_exp_f32 v9, v9
v_mfma_f32_16x16x32_bf16 v[36:39], a[192:195], a[84:87], v[36:39]
ds_read_b64_tr_b16 a[230:231], v239 offset:28672
v_cvt_pk_bf16_f32 v72, v8, v9
v_mfma_f32_16x16x32_bf16 v[40:43], a[192:195], a[88:91], v[104:107]
v_exp_f32 v2, v2
v_mfma_f32_16x16x32_bf16 v[40:43], a[196:199], a[120:123], v[40:43]
ds_read_b64_tr_b16 a[232:233], v240 offset:16384
v_add_f32 v124, v124, v2
v_mfma_f32_16x16x32_bf16 v[40:43], a[200:203], a[152:155], v[40:43]
v_exp_f32 v3, v3
v_mfma_f32_16x16x32_bf16 v[40:43], a[204:207], a[184:187], v[40:43]
ds_read_b64_tr_b16 a[234:235], v240 offset:20480
v_add_f32 v124, v124, v3
v_mfma_f32_16x16x32_bf16 v[44:47], a[204:207], a[188:191], v[108:111]
v_exp_f32 v10, v10
v_mfma_f32_16x16x32_bf16 v[44:47], a[200:203], a[156:159], v[44:47]
ds_read_b64_tr_b16 a[236:237], v240 offset:24576
ds_read_b32 v135, v133
v_mfma_f32_16x16x32_bf16 v[44:47], a[196:199], a[124:127], v[44:47]
v_exp_f32 v11, v11
v_mfma_f32_16x16x32_bf16 v[44:47], a[192:195], a[92:95], v[44:47]
s_waitcnt lgkmcnt(8)
ds_read_b64_tr_b16 a[238:239], v240 offset:28672
v_cvt_pk_bf16_f32 v65, v2, v3
v_mfma_f32_16x16x32_bf16 v[60:63], a[208:211], a[92:95], v[108:111]
s_min_u32 s74, s68, 13
v_exp_f32 v16, v16
v_mfma_f32_16x16x32_bf16 v[60:63], a[212:215], a[124:127], v[60:63]
s_add_u32 s74, s74, s69
ds_read_b64_tr_b16 a[240:241], v241 offset:16384
v_cvt_pk_bf16_f32 v73, v10, v11
v_mfma_f32_16x16x32_bf16 v[60:63], a[216:219], a[156:159], v[60:63]
s_add_u32 s76, s68, s70
v_exp_f32 v17, v17
v_mfma_f32_16x16x32_bf16 v[60:63], a[220:223], a[188:191], v[60:63]
s_cmp_lt_u32 s68, 18
ds_read_b64_tr_b16 a[242:243], v241 offset:20480
v_add_f32 v124, v124, v16
v_mfma_f32_16x16x32_bf16 v[56:59], a[220:223], a[184:187], v[104:107]
s_cselect_b32 s32, s4, s6
v_exp_f32 v24, v24
v_mfma_f32_16x16x32_bf16 v[56:59], a[216:219], a[152:155], v[56:59]
s_cselect_b32 s33, s5, s7
ds_read_b64_tr_b16 a[244:245], v241 offset:24576
v_add_f32 v124, v124, v17
v_mfma_f32_16x16x32_bf16 v[56:59], a[212:215], a[120:123], v[56:59]
s_cselect_b32 s74, s74, s76
v_exp_f32 v25, v25
v_mfma_f32_16x16x32_bf16 v[56:59], a[208:211], a[88:91], v[56:59]
s_cselect_b32 s76, 0, 4096
ds_read_b64_tr_b16 a[246:247], v241 offset:28672
v_cvt_pk_bf16_f32 v66, v16, v17
v_mfma_f32_16x16x32_bf16 v[52:55], a[208:211], a[84:87], v[100:103]
s_add_u32 s76, s76, s74
v_exp_f32 v18, v18
v_mfma_f32_16x16x32_bf16 v[52:55], a[212:215], a[116:119], v[52:55]
s_mul_i32 s74, s74, 1152
ds_read_b64_tr_b16 a[248:249], v242 offset:16384
v_cvt_pk_bf16_f32 v74, v24, v25
v_mfma_f32_16x16x32_bf16 v[52:55], a[216:219], a[148:151], v[52:55]
s_add_u32 s74, s74, s71
v_exp_f32 v19, v19
v_mfma_f32_16x16x32_bf16 v[52:55], a[220:223], a[180:183], v[52:55]
ds_read_b64_tr_b16 a[250:251], v242 offset:20480
v_add_f32 v124, v124, v18
v_mfma_f32_16x16x32_bf16 v[48:51], a[220:223], a[176:179], v[96:99]
v_exp_f32 v26, v26
v_mfma_f32_16x16x32_bf16 v[48:51], a[216:219], a[144:147], v[48:51]
s_waitcnt lgkmcnt(7)
ds_read_b64_tr_b16 a[252:253], v242 offset:24576
v_cmp_gt_u32 vcc, s47, v135
v_mfma_f32_16x16x32_bf16 v[48:51], a[212:215], a[112:115], v[48:51]
v_exp_f32 v27, v27
v_mfma_f32_16x16x32_bf16 v[48:51], a[208:211], a[80:83], v[48:51]
s_waitcnt lgkmcnt(7)
ds_read_b64_tr_b16 a[254:255], v242 offset:28672
v_add_f32 v124, v124, v19
v_mfma_f32_16x16x32_bf16 a[12:15], a[224:227], v[148:151], a[12:15]
s_cbranch_vccnz k1_y04_s
k1_y04_b:
v_exp_f32 v4, v4
v_mfma_f32_16x16x32_bf16 a[12:15], a[228:231], v[164:167], a[12:15]
ds_read_b128 a[192:195], v235 offset:49152
v_cvt_pk_bf16_f32 v67, v18, v19
v_mfma_f32_16x16x32_bf16 a[8:11], a[228:231], v[160:163], a[8:11]
s_add_u32 m0, s65, 16384
v_exp_f32 v5, v5
v_mfma_f32_16x16x32_bf16 a[8:11], a[224:227], v[144:147], a[8:11]
buffer_load_dwordx4 v224, s[20:23], s63 offen offset:0 lds
v_mfma_f32_16x16x32_bf16 a[4:7], a[224:227], v[140:143], a[4:7]
v_exp_f32 v12, v12
v_mfma_f32_16x16x32_bf16 a[4:7], a[228:231], v[156:159], a[4:7]
ds_read_b128 a[196:199], v236 offset:49152
v_cvt_pk_bf16_f32 v75, v26, v27
v_mfma_f32_16x16x32_bf16 a[0:3], a[228:231], v[152:155], a[0:3]
v_exp_f32 v13, v13
v_mfma_f32_16x16x32_bf16 a[0:3], a[224:227], v[136:139], a[0:3]
buffer_load_dwordx4 v[200:203], v230, s[32:35], s74 offen
v_mfma_f32_16x16x32_bf16 a[16:19], a[232:235], v[136:139], a[16:19]
s_mul_i32 s76, s76, 288
v_exp_f32 v6, v6
v_mfma_f32_16x16x32_bf16 a[16:19], a[236:239], v[152:155], a[16:19]
s_add_u32 s56, s76, s57
ds_read_b128 a[200:203], v237 offset:49152
v_add_f32 v125, v125, v4
v_mfma_f32_16x16x32_bf16 a[20:23], a[236:239], v[156:159], a[20:23]
v_exp_f32 v7, v7
v_mfma_f32_16x16x32_bf16 a[20:23], a[232:235], v[140:143], a[20:23]
buffer_load_dwordx4 v225, s[20:23], s63 offen offset:1024 lds
v_mfma_f32_16x16x32_bf16 a[24:27], a[232:235], v[144:147], a[24:27]
s_add_u32 s68, s68, 3
v_exp_f32 v14, v14
v_mfma_f32_16x16x32_bf16 a[24:27], a[236:239], v[160:163], a[24:27]
ds_read_b128 a[204:207], v238 offset:49152
v_add_f32 v125, v125, v5
v_mfma_f32_16x16x32_bf16 a[28:31], a[236:239], v[164:167], a[28:31]
v_exp_f32 v15, v15
v_mfma_f32_16x16x32_bf16 a[28:31], a[232:235], v[148:151], a[28:31]
s_waitcnt lgkmcnt(4)
v_cvt_pk_bf16_f32 v68, v4, v5
v_cvt_pk_bf16_f32 v76, v12, v13
v_mfma_f32_16x16x32_bf16 a[44:47], a[240:243], v[148:151], a[44:47]
v_exp_f32 v20, v20
v_mfma_f32_16x16x32_bf16 a[44:47], a[244:247], v[164:167], a[44:47]
ds_read_b128 a[208:211], v235 offset:53248
v_add_f32 v125, v125, v6
v_mfma_f32_16x16x32_bf16 a[40:43], a[244:247], v[160:163], a[40:43]
v_exp_f32 v21, v21
v_mfma_f32_16x16x32_bf16 a[40:43], a[240:243], v[144:147], a[40:43]
buffer_load_dwordx4 v226, s[20:23], s63 offen offset:2048 lds
v_mfma_f32_16x16x32_bf16 a[36:39], a[240:243], v[140:143], a[36:39]
v_exp_f32 v28, v28
v_mfma_f32_16x16x32_bf16 a[36:39], a[244:247], v[156:159], a[36:39]
ds_read_b128 a[212:215], v236 offset:53248
v_add_f32 v125, v125, v7
v_mfma_f32_16x16x32_bf16 a[32:35], a[244:247], v[152:155], a[32:35]
v_exp_f32 v29, v29
v_mfma_f32_16x16x32_bf16 a[32:35], a[240:243], v[136:139], a[32:35]
v_cvt_pk_bf16_f32 v69, v6, v7
v_cvt_pk_bf16_f32 v77, v14, v15
v_mfma_f32_16x16x32_bf16 a[48:51], a[248:251], v[136:139], a[48:51]
v_exp_f32 v22, v22
v_mfma_f32_16x16x32_bf16 a[48:51], a[252:255], v[152:155], a[48:51]
ds_read_b128 a[216:219], v237 offset:53248
v_add_f32 v125, v125, v20
v_mfma_f32_16x16x32_bf16 a[52:55], a[252:255], v[156:159], a[52:55]
v_exp_f32 v23, v23
v_mfma_f32_16x16x32_bf16 a[52:55], a[248:251], v[140:143], a[52:55]
buffer_load_dwordx4 v227, s[20:23], s63 offen offset:3072 lds
v_mfma_f32_16x16x32_bf16 a[56:59], a[248:251], v[144:147], a[56:59]
s_add_u32 s63, s63, 16384
v_exp_f32 v30, v30
v_mfma_f32_16x16x32_bf16 a[56:59], a[252:255], v[160:163], a[56:59]
ds_read_b128 a[220:223], v238 offset:53248
v_add_f32 v125, v125, v21
v_mfma_f32_16x16x32_bf16 a[60:63], a[252:255], v[164:167], a[60:63]
v_exp_f32 v31, v31
v_mfma_f32_16x16x32_bf16 a[60:63], a[248:251], v[148:151], a[60:63]
v_cvt_pk_bf16_f32 v70, v20, v21
v_cvt_pk_bf16_f32 v78, v28, v29
v_mfma_f32_16x16x32_bf16 v[112:115], v[120:123], v[144:147], v[112:115]
v_add_f32 v125, v125, v22
v_add_f32 v125, v125, v23
v_mfma_f32_16x16x32_bf16 v[112:115], v[120:123], v[160:163], v[112:115]
s_waitcnt lgkmcnt(4)
v_cvt_pk_bf16_f32 v71, v22, v23
v_cvt_pk_bf16_f32 v79, v30, v31
v_mfma_f32_16x16x32_bf16 v[0:3], a[192:195], a[80:83], v[96:99]
v_exp_f32 v32, v32
v_mfma_f32_16x16x32_bf16 v[0:3], a[196:199], a[112:115], v[0:3]
ds_read_b64_tr_b16 a[224:225], v243 offset:16384
v_add_f32 v124, v124, v32
v_mfma_f32_16x16x32_bf16 v[0:3], a[200:203], a[144:147], v[0:3]
v_exp_f32 v33, v33
v_mfma_f32_16x16x32_bf16 v[0:3], a[204:207], a[176:179], v[0:3]
ds_read_b64_tr_b16 a[226:227], v243 offset:20480
v_add_f32 v124, v124, v33
v_mfma_f32_16x16x32_bf16 v[4:7], a[204:207], a[180:183], v[100:103]
v_exp_f32 v40, v40
v_mfma_f32_16x16x32_bf16 v[4:7], a[200:203], a[148:151], v[4:7]
ds_read_b64_tr_b16 a[228:229], v243 offset:24576
v_cvt_pk_bf16_f32 v80, v32, v33
v_mfma_f32_16x16x32_bf16 v[4:7], a[196:199], a[116:119], v[4:7]
v_exp_f32 v41, v41
v_mfma_f32_16x16x32_bf16 v[4:7], a[192:195], a[84:87], v[4:7]
ds_read_b64_tr_b16 a[230:231], v243 offset:28672
v_cvt_pk_bf16_f32 v88, v40, v41
v_mfma_f32_16x16x32_bf16 v[8:11], a[192:195], a[88:91], v[104:107]
v_exp_f32 v34, v34
v_mfma_f32_16x16x32_bf16 v[8:11], a[196:199], a[120:123], v[8:11]
ds_read_b64_tr_b16 a[232:233], v244 offset:16384
v_add_f32 v124, v124, v34
v_mfma_f32_16x16x32_bf16 v[8:11], a[200:203], a[152:155], v[8:11]
v_exp_f32 v35, v35
v_mfma_f32_16x16x32_bf16 v[8:11], a[204:207], a[184:187], v[8:11]
ds_read_b64_tr_b16 a[234:235], v244 offset:20480
v_add_f32 v124, v124, v35
v_mfma_f32_16x16x32_bf16 v[12:15], a[204:207], a[188:191], v[108:111]
v_exp_f32 v42, v42
v_mfma_f32_16x16x32_bf16 v[12:15], a[200:203], a[156:159], v[12:15]
ds_read_b64_tr_b16 a[236:237], v244 offset:24576
v_cvt_pk_bf16_f32 v81, v34, v35
v_mfma_f32_16x16x32_bf16 v[12:15], a[196:199], a[124:127], v[12:15]
v_exp_f32 v43, v43
v_mfma_f32_16x16x32_bf16 v[12:15], a[192:195], a[92:95], v[12:15]
s_waitcnt lgkmcnt(7)
ds_read_b64_tr_b16 a[238:239], v244 offset:28672
v_cvt_pk_bf16_f32 v89, v42, v43
v_mfma_f32_16x16x32_bf16 v[28:31], a[208:211], a[92:95], v[108:111]
s_cmp_eq_u32 s59, s58
v_exp_f32 v48, v48
v_mfma_f32_16x16x32_bf16 v[28:31], a[212:215], a[124:127], v[28:31]
s_cselect_b32 s74, 2048, 0
ds_read_b64_tr_b16 a[240:241], v245 offset:16384
v_add_f32 v124, v124, v48
v_mfma_f32_16x16x32_bf16 v[28:31], a[216:219], a[156:159], v[28:31]
s_add_u32 s59, s59, s74
v_exp_f32 v49, v49
v_mfma_f32_16x16x32_bf16 v[28:31], a[220:223], a[188:191], v[28:31]
ds_read_b64_tr_b16 a[242:243], v245 offset:20480
v_add_f32 v124, v124, v49
v_mfma_f32_16x16x32_bf16 v[24:27], a[220:223], a[184:187], v[104:107]
v_exp_f32 v56, v56
v_mfma_f32_16x16x32_bf16 v[24:27], a[216:219], a[152:155], v[24:27]
ds_read_b64_tr_b16 a[244:245], v245 offset:24576
v_cvt_pk_bf16_f32 v82, v48, v49
v_mfma_f32_16x16x32_bf16 v[24:27], a[212:215], a[120:123], v[24:27]
v_exp_f32 v57, v57
v_mfma_f32_16x16x32_bf16 v[24:27], a[208:211], a[88:91], v[24:27]
ds_read_b64_tr_b16 a[246:247], v245 offset:28672
v_cvt_pk_bf16_f32 v90, v56, v57
v_mfma_f32_16x16x32_bf16 v[20:23], a[208:211], a[84:87], v[100:103]
v_exp_f32 v50, v50
v_mfma_f32_16x16x32_bf16 v[20:23], a[212:215], a[116:119], v[20:23]
ds_read_b64_tr_b16 a[248:249], v246 offset:16384
v_add_f32 v124, v124, v50
v_mfma_f32_16x16x32_bf16 v[20:23], a[216:219], a[148:151], v[20:23]
v_exp_f32 v51, v51
v_mfma_f32_16x16x32_bf16 v[20:23], a[220:223], a[180:183], v[20:23]
ds_read_b64_tr_b16 a[250:251], v246 offset:20480
v_add_f32 v124, v124, v51
v_mfma_f32_16x16x32_bf16 v[16:19], a[220:223], a[176:179], v[96:99]
v_exp_f32 v58, v58
v_mfma_f32_16x16x32_bf16 v[16:19], a[216:219], a[144:147], v[16:19]
ds_read_b64_tr_b16 a[252:253], v246 offset:24576
v_cvt_pk_bf16_f32 v83, v50, v51
v_mfma_f32_16x16x32_bf16 v[16:19], a[212:215], a[112:115], v[16:19]
v_exp_f32 v59, v59
v_mfma_f32_16x16x32_bf16 v[16:19], a[208:211], a[80:83], v[16:19]
s_waitcnt lgkmcnt(7)
ds_read_b64_tr_b16 a[254:255], v246 offset:28672
v_cvt_pk_bf16_f32 v91, v58, v59
v_mfma_f32_16x16x32_bf16 a[76:79], a[224:227], v[148:151], a[76:79]
v_exp_f32 v36, v36
v_mfma_f32_16x16x32_bf16 a[76:79], a[228:231], v[164:167], a[76:79]
ds_read_b128 a[192:195], v235 offset:57344
v_add_f32 v125, v125, v36
v_mfma_f32_16x16x32_bf16 a[72:75], a[228:231], v[160:163], a[72:75]
s_add_u32 m0, s65, 65536
v_exp_f32 v37, v37
v_mfma_f32_16x16x32_bf16 a[72:75], a[224:227], v[144:147], a[72:75]
buffer_load_dwordx4 v228, s[24:27], s64 offen offset:0 lds
v_mfma_f32_16x16x32_bf16 a[68:71], a[224:227], v[140:143], a[68:71]
v_exp_f32 v44, v44
v_mfma_f32_16x16x32_bf16 a[68:71], a[228:231], v[156:159], a[68:71]
ds_read_b128 a[196:199], v236 offset:57344
v_add_f32 v125, v125, v37
v_mfma_f32_16x16x32_bf16 a[64:67], a[228:231], v[152:155], a[64:67]
v_exp_f32 v45, v45
v_mfma_f32_16x16x32_bf16 a[64:67], a[224:227], v[136:139], a[64:67]
buffer_store_dwordx4 v[128:131], v234, s[36:39], s59 offen sc1
v_mfma_f32_16x16x32_bf16 a[96:99], a[232:235], v[136:139], a[96:99]
s_add_u32 s59, s59, 1024
v_exp_f32 v38, v38
v_mfma_f32_16x16x32_bf16 a[96:99], a[236:239], v[152:155], a[96:99]
ds_read_b128 a[200:203], v237 offset:57344
v_cvt_pk_bf16_f32 v84, v36, v37
v_mfma_f32_16x16x32_bf16 a[100:103], a[236:239], v[156:159], a[100:103]
v_exp_f32 v39, v39
v_mfma_f32_16x16x32_bf16 a[100:103], a[232:235], v[140:143], a[100:103]
buffer_load_dwordx4 v229, s[24:27], s64 offen offset:1024 lds
v_mfma_f32_16x16x32_bf16 a[104:107], a[232:235], v[144:147], a[104:107]
v_exp_f32 v46, v46
v_mfma_f32_16x16x32_bf16 a[104:107], a[236:239], v[160:163], a[104:107]
ds_read_b128 a[204:207], v238 offset:57344
v_cvt_pk_bf16_f32 v92, v44, v45
v_mfma_f32_16x16x32_bf16 a[108:111], a[236:239], v[164:167], a[108:111]
v_exp_f32 v47, v47
v_mfma_f32_16x16x32_bf16 a[108:111], a[232:235], v[148:151], a[108:111]
s_waitcnt lgkmcnt(4)
v_add_f32 v125, v125, v38
v_add_f32 v125, v125, v39
v_mfma_f32_16x16x32_bf16 a[140:143], a[240:243], v[148:151], a[140:143]
v_exp_f32 v52, v52
v_mfma_f32_16x16x32_bf16 a[140:143], a[244:247], v[164:167], a[140:143]
ds_read_b128 a[208:211], v235 offset:61440
v_cvt_pk_bf16_f32 v85, v38, v39
v_mfma_f32_16x16x32_bf16 a[136:139], a[244:247], v[160:163], a[136:139]
v_exp_f32 v53, v53
v_mfma_f32_16x16x32_bf16 a[136:139], a[240:243], v[144:147], a[136:139]
buffer_load_dwordx4 v228, s[24:27], s64 offen offset:2048 lds
v_mfma_f32_16x16x32_bf16 a[132:135], a[240:243], v[140:143], a[132:135]
v_exp_f32 v60, v60
v_mfma_f32_16x16x32_bf16 a[132:135], a[244:247], v[156:159], a[132:135]
ds_read_b128 a[212:215], v236 offset:61440
v_cvt_pk_bf16_f32 v93, v46, v47
v_mfma_f32_16x16x32_bf16 a[128:131], a[244:247], v[152:155], a[128:131]
v_exp_f32 v61, v61
v_mfma_f32_16x16x32_bf16 a[128:131], a[240:243], v[136:139], a[128:131]
v_add_f32 v125, v125, v52
v_add_f32 v125, v125, v53
v_mfma_f32_16x16x32_bf16 a[160:163], a[248:251], v[136:139], a[160:163]
s_waitcnt vmcnt(9)
v_exp_f32 v54, v54
v_mfma_f32_16x16x32_bf16 a[160:163], a[252:255], v[152:155], a[160:163]
ds_read_b128 a[216:219], v237 offset:61440
ds_add_u32 v132, v134
v_mfma_f32_16x16x32_bf16 a[164:167], a[252:255], v[156:159], a[164:167]
v_exp_f32 v55, v55
v_mfma_f32_16x16x32_bf16 a[164:167], a[248:251], v[140:143], a[164:167]
buffer_load_dwordx4 v229, s[24:27], s64 offen offset:3072 lds
v_mfma_f32_16x16x32_bf16 a[168:171], a[248:251], v[144:147], a[168:171]
s_add_u32 s64, s64, 16384
v_exp_f32 v62, v62
v_mfma_f32_16x16x32_bf16 a[168:171], a[252:255], v[160:163], a[168:171]
ds_read_b128 a[220:223], v238 offset:61440
v_cvt_pk_bf16_f32 v86, v52, v53
v_mfma_f32_16x16x32_bf16 a[172:175], a[252:255], v[164:167], a[172:175]
s_add_u32 s47, s47, 1
v_exp_f32 v63, v63
v_mfma_f32_16x16x32_bf16 a[172:175], a[248:251], v[148:151], a[172:175]
v_cvt_pk_bf16_f32 v94, v60, v61
v_add_f32 v125, v125, v54
v_mfma_f32_16x16x32_bf16 v[116:119], v[120:123], v[148:151], v[116:119]
v_add_f32 v125, v125, v55
v_cvt_pk_bf16_f32 v87, v54, v55
v_mfma_f32_16x16x32_bf16 v[116:119], v[120:123], v[164:167], v[116:119]
s_waitcnt lgkmcnt(5)
v_cvt_pk_bf16_f32 v95, v62, v63
v_mfma_f32_16x16x32_bf16 v[32:35], a[192:195], a[80:83], v[96:99]
v_exp_f32 v0, v0
v_mfma_f32_16x16x32_bf16 v[32:35], a[196:199], a[112:115], v[32:35]
ds_read_b64_tr_b16 a[224:225], v239 offset:32768
v_add_f32 v124, v124, v0
v_mfma_f32_16x16x32_bf16 v[32:35], a[200:203], a[144:147], v[32:35]
v_exp_f32 v1, v1
v_mfma_f32_16x16x32_bf16 v[32:35], a[204:207], a[176:179], v[32:35]
ds_read_b64_tr_b16 a[226:227], v239 offset:36864
v_add_f32 v124, v124, v1
v_mfma_f32_16x16x32_bf16 v[36:39], a[204:207], a[180:183], v[100:103]
v_exp_f32 v8, v8
v_mfma_f32_16x16x32_bf16 v[36:39], a[200:203], a[148:151], v[36:39]
ds_read_b64_tr_b16 a[228:229], v239 offset:40960
v_cvt_pk_bf16_f32 v136, v0, v1
v_mfma_f32_16x16x32_bf16 v[36:39], a[196:199], a[116:119], v[36:39]
v_exp_f32 v9, v9
v_mfma_f32_16x16x32_bf16 v[36:39], a[192:195], a[84:87], v[36:39]
ds_read_b64_tr_b16 a[230:231], v239 offset:45056
v_cvt_pk_bf16_f32 v144, v8, v9
v_mfma_f32_16x16x32_bf16 v[40:43], a[192:195], a[88:91], v[104:107]
v_exp_f32 v2, v2
v_mfma_f32_16x16x32_bf16 v[40:43], a[196:199], a[120:123], v[40:43]
ds_read_b64_tr_b16 a[232:233], v240 offset:32768
v_add_f32 v124, v124, v2
v_mfma_f32_16x16x32_bf16 v[40:43], a[200:203], a[152:155], v[40:43]
v_exp_f32 v3, v3
v_mfma_f32_16x16x32_bf16 v[40:43], a[204:207], a[184:187], v[40:43]
ds_read_b64_tr_b16 a[234:235], v240 offset:36864
v_add_f32 v124, v124, v3
v_mfma_f32_16x16x32_bf16 v[44:47], a[204:207], a[188:191], v[108:111]
v_exp_f32 v10, v10
v_mfma_f32_16x16x32_bf16 v[44:47], a[200:203], a[156:159], v[44:47]
ds_read_b64_tr_b16 a[236:237], v240 offset:40960
ds_read_b32 v135, v133
v_mfma_f32_16x16x32_bf16 v[44:47], a[196:199], a[124:127], v[44:47]
v_exp_f32 v11, v11
v_mfma_f32_16x16x32_bf16 v[44:47], a[192:195], a[92:95], v[44:47]
s_waitcnt lgkmcnt(8)
ds_read_b64_tr_b16 a[238:239], v240 offset:45056
v_cvt_pk_bf16_f32 v137, v2, v3
v_mfma_f32_16x16x32_bf16 v[60:63], a[208:211], a[92:95], v[108:111]
s_cmp_eq_u32 s59, s58
v_exp_f32 v16, v16
v_mfma_f32_16x16x32_bf16 v[60:63], a[212:215], a[124:127], v[60:63]
s_cselect_b32 s74, 2048, 0
ds_read_b64_tr_b16 a[240:241], v241 offset:32768
v_cvt_pk_bf16_f32 v145, v10, v11
v_mfma_f32_16x16x32_bf16 v[60:63], a[216:219], a[156:159], v[60:63]
s_add_u32 s59, s59, s74
v_exp_f32 v17, v17
v_mfma_f32_16x16x32_bf16 v[60:63], a[220:223], a[188:191], v[60:63]
ds_read_b64_tr_b16 a[242:243], v241 offset:36864
v_add_f32 v124, v124, v16
v_mfma_f32_16x16x32_bf16 v[56:59], a[220:223], a[184:187], v[104:107]
v_exp_f32 v24, v24
v_mfma_f32_16x16x32_bf16 v[56:59], a[216:219], a[152:155], v[56:59]
ds_read_b64_tr_b16 a[244:245], v241 offset:40960
v_add_f32 v124, v124, v17
v_mfma_f32_16x16x32_bf16 v[56:59], a[212:215], a[120:123], v[56:59]
v_exp_f32 v25, v25
v_mfma_f32_16x16x32_bf16 v[56:59], a[208:211], a[88:91], v[56:59]
ds_read_b64_tr_b16 a[246:247], v241 offset:45056
v_cvt_pk_bf16_f32 v138, v16, v17
v_mfma_f32_16x16x32_bf16 v[52:55], a[208:211], a[84:87], v[100:103]
v_exp_f32 v18, v18
v_mfma_f32_16x16x32_bf16 v[52:55], a[212:215], a[116:119], v[52:55]
ds_read_b64_tr_b16 a[248:249], v242 offset:32768
v_cvt_pk_bf16_f32 v146, v24, v25
v_mfma_f32_16x16x32_bf16 v[52:55], a[216:219], a[148:151], v[52:55]
v_exp_f32 v19, v19
v_mfma_f32_16x16x32_bf16 v[52:55], a[220:223], a[180:183], v[52:55]
ds_read_b64_tr_b16 a[250:251], v242 offset:36864
v_add_f32 v124, v124, v18
v_mfma_f32_16x16x32_bf16 v[48:51], a[220:223], a[176:179], v[96:99]
v_exp_f32 v26, v26
v_mfma_f32_16x16x32_bf16 v[48:51], a[216:219], a[144:147], v[48:51]
s_waitcnt lgkmcnt(7)
ds_read_b64_tr_b16 a[252:253], v242 offset:40960
v_cmp_gt_u32 vcc, s47, v135
v_mfma_f32_16x16x32_bf16 v[48:51], a[212:215], a[112:115], v[48:51]
v_exp_f32 v27, v27
v_mfma_f32_16x16x32_bf16 v[48:51], a[208:211], a[80:83], v[48:51]
s_waitcnt lgkmcnt(7)
ds_read_b64_tr_b16 a[254:255], v242 offset:45056
v_add_f32 v124, v124, v19
v_mfma_f32_16x16x32_bf16 a[12:15], a[224:227], v[76:79], a[12:15]
s_cbranch_vccnz k1_y06_s
k1_y06_b:
v_exp_f32 v4, v4
v_mfma_f32_16x16x32_bf16 a[12:15], a[228:231], v[92:95], a[12:15]
ds_read_b128 a[192:195], v235 offset:0
v_cvt_pk_bf16_f32 v139, v18, v19
v_mfma_f32_16x16x32_bf16 a[8:11], a[228:231], v[88:91], a[8:11]
s_add_u32 m0, s65, 32768
v_exp_f32 v5, v5
v_mfma_f32_16x16x32_bf16 a[8:11], a[224:227], v[72:75], a[8:11]
buffer_load_dwordx4 v224, s[20:23], s63 offen offset:0 lds
v_mfma_f32_16x16x32_bf16 a[4:7], a[224:227], v[68:71], a[4:7]
v_exp_f32 v12, v12
v_mfma_f32_16x16x32_bf16 a[4:7], a[228:231], v[84:87], a[4:7]
ds_read_b128 a[196:199], v236 offset:0
v_cvt_pk_bf16_f32 v147, v26, v27
v_mfma_f32_16x16x32_bf16 a[0:3], a[228:231], v[80:83], a[0:3]
v_exp_f32 v13, v13
v_mfma_f32_16x16x32_bf16 a[0:3], a[224:227], v[64:67], a[0:3]
buffer_store_dwordx4 v[128:131], v234, s[36:39], s59 offen sc1
v_mfma_f32_16x16x32_bf16 a[16:19], a[232:235], v[64:67], a[16:19]
s_add_u32 s59, s59, 1024
v_exp_f32 v6, v6
v_mfma_f32_16x16x32_bf16 a[16:19], a[236:239], v[80:83], a[16:19]
ds_read_b128 a[200:203], v237 offset:0
v_add_f32 v125, v125, v4
v_mfma_f32_16x16x32_bf16 a[20:23], a[236:239], v[84:87], a[20:23]
v_exp_f32 v7, v7
v_mfma_f32_16x16x32_bf16 a[20:23], a[232:235], v[68:71], a[20:23]
buffer_load_dwordx4 v225, s[20:23], s63 offen offset:1024 lds
v_mfma_f32_16x16x32_bf16 a[24:27], a[232:235], v[72:75], a[24:27]
v_exp_f32 v14, v14
v_mfma_f32_16x16x32_bf16 a[24:27], a[236:239], v[88:91], a[24:27]
ds_read_b128 a[204:207], v238 offset:0
v_add_f32 v125, v125, v5
v_mfma_f32_16x16x32_bf16 a[28:31], a[236:239], v[92:95], a[28:31]
v_exp_f32 v15, v15
v_mfma_f32_16x16x32_bf16 a[28:31], a[232:235], v[76:79], a[28:31]
s_waitcnt lgkmcnt(4)
v_cvt_pk_bf16_f32 v140, v4, v5
v_cvt_pk_bf16_f32 v148, v12, v13
v_mfma_f32_16x16x32_bf16 a[44:47], a[240:243], v[76:79], a[44:47]
v_exp_f32 v20, v20
v_mfma_f32_16x16x32_bf16 a[44:47], a[244:247], v[92:95], a[44:47]
ds_read_b128 a[208:211], v235 offset:4096
v_add_f32 v125, v125, v6
v_mfma_f32_16x16x32_bf16 a[40:43], a[244:247], v[88:91], a[40:43]
v_exp_f32 v21, v21
v_mfma_f32_16x16x32_bf16 a[40:43], a[240:243], v[72:75], a[40:43]
buffer_load_dwordx4 v226, s[20:23], s63 offen offset:2048 lds
v_mfma_f32_16x16x32_bf16 a[36:39], a[240:243], v[68:71], a[36:39]
v_exp_f32 v28, v28
v_mfma_f32_16x16x32_bf16 a[36:39], a[244:247], v[84:87], a[36:39]
ds_read_b128 a[212:215], v236 offset:4096
v_add_f32 v125, v125, v7
v_mfma_f32_16x16x32_bf16 a[32:35], a[244:247], v[80:83], a[32:35]
v_exp_f32 v29, v29
v_mfma_f32_16x16x32_bf16 a[32:35], a[240:243], v[64:67], a[32:35]
v_cvt_pk_bf16_f32 v141, v6, v7
v_cvt_pk_bf16_f32 v149, v14, v15
v_mfma_f32_16x16x32_bf16 a[48:51], a[248:251], v[64:67], a[48:51]
v_exp_f32 v22, v22
v_mfma_f32_16x16x32_bf16 a[48:51], a[252:255], v[80:83], a[48:51]
ds_read_b128 a[216:219], v237 offset:4096
v_add_f32 v125, v125, v20
v_mfma_f32_16x16x32_bf16 a[52:55], a[252:255], v[84:87], a[52:55]
v_exp_f32 v23, v23
v_mfma_f32_16x16x32_bf16 a[52:55], a[248:251], v[68:71], a[52:55]
buffer_load_dwordx4 v227, s[20:23], s63 offen offset:3072 lds
v_mfma_f32_16x16x32_bf16 a[56:59], a[248:251], v[72:75], a[56:59]
s_add_u32 s63, s63, 16384
v_exp_f32 v30, v30
v_mfma_f32_16x16x32_bf16 a[56:59], a[252:255], v[88:91], a[56:59]
ds_read_b128 a[220:223], v238 offset:4096
v_add_f32 v125, v125, v21
v_mfma_f32_16x16x32_bf16 a[60:63], a[252:255], v[92:95], a[60:63]
v_exp_f32 v31, v31
v_mfma_f32_16x16x32_bf16 a[60:63], a[248:251], v[76:79], a[60:63]
v_cvt_pk_bf16_f32 v142, v20, v21
v_cvt_pk_bf16_f32 v150, v28, v29
v_mfma_f32_16x16x32_bf16 v[112:115], v[120:123], v[72:75], v[112:115]
v_add_f32 v125, v125, v22
v_add_f32 v125, v125, v23
v_mfma_f32_16x16x32_bf16 v[112:115], v[120:123], v[88:91], v[112:115]
s_waitcnt lgkmcnt(4)
v_cvt_pk_bf16_f32 v143, v22, v23
v_cvt_pk_bf16_f32 v151, v30, v31
v_mfma_f32_16x16x32_bf16 v[0:3], a[192:195], a[80:83], v[96:99]
v_exp_f32 v32, v32
v_mfma_f32_16x16x32_bf16 v[0:3], a[196:199], a[112:115], v[0:3]
ds_read_b64_tr_b16 a[224:225], v243 offset:32768
v_add_f32 v124, v124, v32
v_mfma_f32_16x16x32_bf16 v[0:3], a[200:203], a[144:147], v[0:3]
v_exp_f32 v33, v33
v_mfma_f32_16x16x32_bf16 v[0:3], a[204:207], a[176:179], v[0:3]
ds_read_b64_tr_b16 a[226:227], v243 offset:36864
v_add_f32 v124, v124, v33
v_mfma_f32_16x16x32_bf16 v[4:7], a[204:207], a[180:183], v[100:103]
v_exp_f32 v40, v40
v_mfma_f32_16x16x32_bf16 v[4:7], a[200:203], a[148:151], v[4:7]
ds_read_b64_tr_b16 a[228:229], v243 offset:40960
v_cvt_pk_bf16_f32 v152, v32, v33
v_mfma_f32_16x16x32_bf16 v[4:7], a[196:199], a[116:119], v[4:7]
v_exp_f32 v41, v41
v_mfma_f32_16x16x32_bf16 v[4:7], a[192:195], a[84:87], v[4:7]
ds_read_b64_tr_b16 a[230:231], v243 offset:45056
v_cvt_pk_bf16_f32 v160, v40, v41
v_mfma_f32_16x16x32_bf16 v[8:11], a[192:195], a[88:91], v[104:107]
v_exp_f32 v34, v34
v_mfma_f32_16x16x32_bf16 v[8:11], a[196:199], a[120:123], v[8:11]
ds_read_b64_tr_b16 a[232:233], v244 offset:32768
v_add_f32 v124, v124, v34
v_mfma_f32_16x16x32_bf16 v[8:11], a[200:203], a[152:155], v[8:11]
v_exp_f32 v35, v35
v_mfma_f32_16x16x32_bf16 v[8:11], a[204:207], a[184:187], v[8:11]
ds_read_b64_tr_b16 a[234:235], v244 offset:36864
v_add_f32 v124, v124, v35
v_mfma_f32_16x16x32_bf16 v[12:15], a[204:207], a[188:191], v[108:111]
v_exp_f32 v42, v42
v_mfma_f32_16x16x32_bf16 v[12:15], a[200:203], a[156:159], v[12:15]
ds_read_b64_tr_b16 a[236:237], v244 offset:40960
v_cvt_pk_bf16_f32 v153, v34, v35
v_mfma_f32_16x16x32_bf16 v[12:15], a[196:199], a[124:127], v[12:15]
v_exp_f32 v43, v43
v_mfma_f32_16x16x32_bf16 v[12:15], a[192:195], a[92:95], v[12:15]
s_waitcnt lgkmcnt(7)
ds_read_b64_tr_b16 a[238:239], v244 offset:45056
v_cvt_pk_bf16_f32 v161, v42, v43
v_mfma_f32_16x16x32_bf16 v[28:31], a[208:211], a[92:95], v[108:111]
v_exp_f32 v48, v48
v_mfma_f32_16x16x32_bf16 v[28:31], a[212:215], a[124:127], v[28:31]
ds_read_b64_tr_b16 a[240:241], v245 offset:32768
v_add_f32 v124, v124, v48
v_mfma_f32_16x16x32_bf16 v[28:31], a[216:219], a[156:159], v[28:31]
v_exp_f32 v49, v49
v_mfma_f32_16x16x32_bf16 v[28:31], a[220:223], a[188:191], v[28:31]
ds_read_b64_tr_b16 a[242:243], v245 offset:36864
v_add_f32 v124, v124, v49
v_mfma_f32_16x16x32_bf16 v[24:27], a[220:223], a[184:187], v[104:107]
v_exp_f32 v56, v56
v_mfma_f32_16x16x32_bf16 v[24:27], a[216:219], a[152:155], v[24:27]
ds_read_b64_tr_b16 a[244:245], v245 offset:40960
v_cvt_pk_bf16_f32 v154, v48, v49
v_mfma_f32_16x16x32_bf16 v[24:27], a[212:215], a[120:123], v[24:27]
v_exp_f32 v57, v57
v_mfma_f32_16x16x32_bf16 v[24:27], a[208:211], a[88:91], v[24:27]
ds_read_b64_tr_b16 a[246:247], v245 offset:45056
v_cvt_pk_bf16_f32 v162, v56, v57
v_mfma_f32_16x16x32_bf16 v[20:23], a[208:211], a[84:87], v[100:103]
v_exp_f32 v50, v50
v_mfma_f32_16x16x32_bf16 v[20:23], a[212:215], a[116:119], v[20:23]
ds_read_b64_tr_b16 a[248:249], v246 offset:32768
v_add_f32 v124, v124, v50
v_mfma_f32_16x16x32_bf16 v[20:23], a[216:219], a[148:151], v[20:23]
v_exp_f32 v51, v51
v_mfma_f32_16x16x32_bf16 v[20:23], a[220:223], a[180:183], v[20:23]
ds_read_b64_tr_b16 a[250:251], v246 offset:36864
v_add_f32 v124, v124, v51
v_mfma_f32_16x16x32_bf16 v[16:19], a[220:223], a[176:179], v[96:99]
v_exp_f32 v58, v58
v_mfma_f32_16x16x32_bf16 v[16:19], a[216:219], a[144:147], v[16:19]
ds_read_b64_tr_b16 a[252:253], v246 offset:40960
v_cvt_pk_bf16_f32 v155, v50, v51
v_mfma_f32_16x16x32_bf16 v[16:19], a[212:215], a[112:115], v[16:19]
v_exp_f32 v59, v59
v_mfma_f32_16x16x32_bf16 v[16:19], a[208:211], a[80:83], v[16:19]
s_waitcnt lgkmcnt(7)
ds_read_b64_tr_b16 a[254:255], v246 offset:45056
v_cvt_pk_bf16_f32 v163, v58, v59
v_mfma_f32_16x16x32_bf16 a[76:79], a[224:227], v[76:79], a[76:79]
v_exp_f32 v36, v36
v_mfma_f32_16x16x32_bf16 a[76:79], a[228:231], v[92:95], a[76:79]
ds_read_b128 a[192:195], v235 offset:8192
v_add_f32 v125, v125, v36
v_mfma_f32_16x16x32_bf16 a[72:75], a[228:231], v[88:91], a[72:75]
s_add_u32 m0, s65, 81920
v_exp_f32 v37, v37
v_mfma_f32_16x16x32_bf16 a[72:75], a[224:227], v[72:75], a[72:75]
buffer_load_dwordx4 v228, s[24:27], s64 offen offset:0 lds
v_mfma_f32_16x16x32_bf16 a[68:71], a[224:227], v[68:71], a[68:71]
v_exp_f32 v44, v44
v_mfma_f32_16x16x32_bf16 a[68:71], a[228:231], v[84:87], a[68:71]
ds_read_b128 a[196:199], v236 offset:8192
v_add_f32 v125, v125, v37
v_mfma_f32_16x16x32_bf16 a[64:67], a[228:231], v[80:83], a[64:67]
v_exp_f32 v45, v45
v_mfma_f32_16x16x32_bf16 a[64:67], a[224:227], v[64:67], a[64:67]
buffer_store_dwordx4 v[192:195], v231, s[12:15], s54 offen sc1
v_mfma_f32_16x16x32_bf16 a[96:99], a[232:235], v[64:67], a[96:99]
v_exp_f32 v38, v38
v_mfma_f32_16x16x32_bf16 a[96:99], a[236:239], v[80:83], a[96:99]
ds_read_b128 a[200:203], v237 offset:8192
v_cvt_pk_bf16_f32 v156, v36, v37
v_mfma_f32_16x16x32_bf16 a[100:103], a[236:239], v[84:87], a[100:103]
v_exp_f32 v39, v39
v_mfma_f32_16x16x32_bf16 a[100:103], a[232:235], v[68:71], a[100:103]
buffer_load_dwordx4 v229, s[24:27], s64 offen offset:1024 lds
v_mfma_f32_16x16x32_bf16 a[104:107], a[232:235], v[72:75], a[104:107]
v_exp_f32 v46, v46
v_mfma_f32_16x16x32_bf16 a[104:107], a[236:239], v[88:91], a[104:107]
ds_read_b128 a[204:207], v238 offset:8192
v_cvt_pk_bf16_f32 v164, v44, v45
v_mfma_f32_16x16x32_bf16 a[108:111], a[236:239], v[92:95], a[108:111]
v_exp_f32 v47, v47
v_mfma_f32_16x16x32_bf16 a[108:111], a[232:235], v[76:79], a[108:111]
s_waitcnt lgkmcnt(4)
v_add_f32 v125, v125, v38
v_add_f32 v125, v125, v39
v_mfma_f32_16x16x32_bf16 a[140:143], a[240:243], v[76:79], a[140:143]
v_exp_f32 v52, v52
v_mfma_f32_16x16x32_bf16 a[140:143], a[244:247], v[92:95], a[140:143]
ds_read_b128 a[208:211], v235 offset:12288
v_cvt_pk_bf16_f32 v157, v38, v39
v_mfma_f32_16x16x32_bf16 a[136:139], a[244:247], v[88:91], a[136:139]
v_exp_f32 v53, v53
v_mfma_f32_16x16x32_bf16 a[136:139], a[240:243], v[72:75], a[136:139]
buffer_load_dwordx4 v228, s[24:27], s64 offen offset:2048 lds
v_mfma_f32_16x16x32_bf16 a[132:135], a[240:243], v[68:71], a[132:135]
v_exp_f32 v60, v60
v_mfma_f32_16x16x32_bf16 a[132:135], a[244:247], v[84:87], a[132:135]
ds_read_b128 a[212:215], v236 offset:12288
v_cvt_pk_bf16_f32 v165, v46, v47
v_mfma_f32_16x16x32_bf16 a[128:131], a[244:247], v[80:83], a[128:131]
v_exp_f32 v61, v61
v_mfma_f32_16x16x32_bf16 a[128:131], a[240:243], v[64:67], a[128:131]
v_add_f32 v125, v125, v52
v_add_f32 v125, v125, v53
v_mfma_f32_16x16x32_bf16 a[160:163], a[248:251], v[64:67], a[160:163]
s_waitcnt vmcnt(9)
v_exp_f32 v54, v54
v_mfma_f32_16x16x32_bf16 a[160:163], a[252:255], v[80:83], a[160:163]
ds_read_b128 a[216:219], v237 offset:12288
ds_add_u32 v132, v134
v_mfma_f32_16x16x32_bf16 a[164:167], a[252:255], v[84:87], a[164:167]
v_exp_f32 v55, v55
v_mfma_f32_16x16x32_bf16 a[164:167], a[248:251], v[68:71], a[164:167]
buffer_load_dwordx4 v229, s[24:27], s64 offen offset:3072 lds
v_mfma_f32_16x16x32_bf16 a[168:171], a[248:251], v[72:75], a[168:171]
s_add_u32 s64, s64, 16384
v_exp_f32 v62, v62
v_mfma_f32_16x16x32_bf16 a[168:171], a[252:255], v[88:91], a[168:171]
ds_read_b128 a[220:223], v238 offset:12288
v_cvt_pk_bf16_f32 v158, v52, v53
v_mfma_f32_16x16x32_bf16 a[172:175], a[252:255], v[92:95], a[172:175]
s_add_u32 s47, s47, 1
v_exp_f32 v63, v63
v_mfma_f32_16x16x32_bf16 a[172:175], a[248:251], v[76:79], a[172:175]
v_cvt_pk_bf16_f32 v166, v60, v61
v_add_f32 v125, v125, v54
v_mfma_f32_16x16x32_bf16 v[116:119], v[120:123], v[76:79], v[116:119]
v_add_f32 v125, v125, v55
v_cvt_pk_bf16_f32 v159, v54, v55
v_mfma_f32_16x16x32_bf16 v[116:119], v[120:123], v[92:95], v[116:119]
s_waitcnt lgkmcnt(5)
v_cvt_pk_bf16_f32 v167, v62, v63
v_mfma_f32_16x16x32_bf16 v[32:35], a[192:195], a[80:83], v[96:99]
v_exp_f32 v0, v0
v_mfma_f32_16x16x32_bf16 v[32:35], a[196:199], a[112:115], v[32:35]
ds_read_b64_tr_b16 a[224:225], v239 offset:49152
v_add_f32 v124, v124, v0
v_mfma_f32_16x16x32_bf16 v[32:35], a[200:203], a[144:147], v[32:35]
v_exp_f32 v1, v1
v_mfma_f32_16x16x32_bf16 v[32:35], a[204:207], a[176:179], v[32:35]
ds_read_b64_tr_b16 a[226:227], v239 offset:53248
v_add_f32 v124, v124, v1
v_mfma_f32_16x16x32_bf16 v[36:39], a[204:207], a[180:183], v[100:103]
v_exp_f32 v8, v8
v_mfma_f32_16x16x32_bf16 v[36:39], a[200:203], a[148:151], v[36:39]
ds_read_b64_tr_b16 a[228:229], v239 offset:57344
v_cvt_pk_bf16_f32 v64, v0, v1
v_mfma_f32_16x16x32_bf16 v[36:39], a[196:199], a[116:119], v[36:39]
v_exp_f32 v9, v9
v_mfma_f32_16x16x32_bf16 v[36:39], a[192:195], a[84:87], v[36:39]
ds_read_b64_tr_b16 a[230:231], v239 offset:61440
v_cvt_pk_bf16_f32 v72, v8, v9
v_mfma_f32_16x16x32_bf16 v[40:43], a[192:195], a[88:91], v[104:107]
v_exp_f32 v2, v2
v_mfma_f32_16x16x32_bf16 v[40:43], a[196:199], a[120:123], v[40:43]
ds_read_b64_tr_b16 a[232:233], v240 offset:49152
v_add_f32 v124, v124, v2
v_mfma_f32_16x16x32_bf16 v[40:43], a[200:203], a[152:155], v[40:43]
v_exp_f32 v3, v3
v_mfma_f32_16x16x32_bf16 v[40:43], a[204:207], a[184:187], v[40:43]
ds_read_b64_tr_b16 a[234:235], v240 offset:53248
v_add_f32 v124, v124, v3
v_mfma_f32_16x16x32_bf16 v[44:47], a[204:207], a[188:191], v[108:111]
v_exp_f32 v10, v10
v_mfma_f32_16x16x32_bf16 v[44:47], a[200:203], a[156:159], v[44:47]
ds_read_b64_tr_b16 a[236:237], v240 offset:57344
ds_read_b32 v135, v133
v_mfma_f32_16x16x32_bf16 v[44:47], a[196:199], a[124:127], v[44:47]
v_exp_f32 v11, v11
v_mfma_f32_16x16x32_bf16 v[44:47], a[192:195], a[92:95], v[44:47]
s_waitcnt lgkmcnt(8)
ds_read_b64_tr_b16 a[238:239], v240 offset:61440
v_cvt_pk_bf16_f32 v65, v2, v3
v_mfma_f32_16x16x32_bf16 v[60:63], a[208:211], a[92:95], v[108:111]
v_exp_f32 v16, v16
v_mfma_f32_16x16x32_bf16 v[60:63], a[212:215], a[124:127], v[60:63]
ds_read_b64_tr_b16 a[240:241], v241 offset:49152
v_cvt_pk_bf16_f32 v73, v10, v11
v_mfma_f32_16x16x32_bf16 v[60:63], a[216:219], a[156:159], v[60:63]
v_exp_f32 v17, v17
v_mfma_f32_16x16x32_bf16 v[60:63], a[220:223], a[188:191], v[60:63]
ds_read_b64_tr_b16 a[242:243], v241 offset:53248
v_add_f32 v124, v124, v16
v_mfma_f32_16x16x32_bf16 v[56:59], a[220:223], a[184:187], v[104:107]
v_exp_f32 v24, v24
v_mfma_f32_16x16x32_bf16 v[56:59], a[216:219], a[152:155], v[56:59]
ds_read_b64_tr_b16 a[244:245], v241 offset:57344
v_add_f32 v124, v124, v17
v_mfma_f32_16x16x32_bf16 v[56:59], a[212:215], a[120:123], v[56:59]
v_exp_f32 v25, v25
v_mfma_f32_16x16x32_bf16 v[56:59], a[208:211], a[88:91], v[56:59]
ds_read_b64_tr_b16 a[246:247], v241 offset:61440
v_cvt_pk_bf16_f32 v66, v16, v17
v_mfma_f32_16x16x32_bf16 v[52:55], a[208:211], a[84:87], v[100:103]
v_exp_f32 v18, v18
v_mfma_f32_16x16x32_bf16 v[52:55], a[212:215], a[116:119], v[52:55]
ds_read_b64_tr_b16 a[248:249], v242 offset:49152
v_cvt_pk_bf16_f32 v74, v24, v25
v_mfma_f32_16x16x32_bf16 v[52:55], a[216:219], a[148:151], v[52:55]
v_exp_f32 v19, v19
v_mfma_f32_16x16x32_bf16 v[52:55], a[220:223], a[180:183], v[52:55]
ds_read_b64_tr_b16 a[250:251], v242 offset:53248
v_add_f32 v124, v124, v18
v_mfma_f32_16x16x32_bf16 v[48:51], a[220:223], a[176:179], v[96:99]
v_exp_f32 v26, v26
v_mfma_f32_16x16x32_bf16 v[48:51], a[216:219], a[144:147], v[48:51]
s_waitcnt lgkmcnt(7)
ds_read_b64_tr_b16 a[252:253], v242 offset:57344
v_cmp_gt_u32 vcc, s47, v135
v_mfma_f32_16x16x32_bf16 v[48:51], a[212:215], a[112:115], v[48:51]
v_exp_f32 v27, v27
v_mfma_f32_16x16x32_bf16 v[48:51], a[208:211], a[80:83], v[48:51]
s_waitcnt lgkmcnt(7)
ds_read_b64_tr_b16 a[254:255], v242 offset:61440
v_add_f32 v124, v124, v19
v_mfma_f32_16x16x32_bf16 a[12:15], a[224:227], v[148:151], a[12:15]
s_cbranch_vccnz k1_y00_s
k1_y00_b:
v_exp_f32 v4, v4
v_mfma_f32_16x16x32_bf16 a[12:15], a[228:231], v[164:167], a[12:15]
ds_read_b128 a[192:195], v235 offset:16384
v_cvt_pk_bf16_f32 v67, v18, v19
v_mfma_f32_16x16x32_bf16 a[8:11], a[228:231], v[160:163], a[8:11]
s_add_u32 m0, s65, 49152
v_exp_f32 v5, v5
v_mfma_f32_16x16x32_bf16 a[8:11], a[224:227], v[144:147], a[8:11]
buffer_load_dwordx4 v224, s[20:23], s63 offen offset:0 lds
v_mfma_f32_16x16x32_bf16 a[4:7], a[224:227], v[140:143], a[4:7]
v_exp_f32 v12, v12
v_mfma_f32_16x16x32_bf16 a[4:7], a[228:231], v[156:159], a[4:7]
ds_read_b128 a[196:199], v236 offset:16384
v_cvt_pk_bf16_f32 v75, v26, v27
v_mfma_f32_16x16x32_bf16 a[0:3], a[228:231], v[152:155], a[0:3]
v_exp_f32 v13, v13
v_mfma_f32_16x16x32_bf16 a[0:3], a[224:227], v[136:139], a[0:3]
buffer_store_dwordx4 v[196:199], v231, s[12:15], s55 offen sc1
v_mfma_f32_16x16x32_bf16 a[16:19], a[232:235], v[136:139], a[16:19]
v_exp_f32 v6, v6
v_mfma_f32_16x16x32_bf16 a[16:19], a[236:239], v[152:155], a[16:19]
ds_read_b128 a[200:203], v237 offset:16384
v_add_f32 v125, v125, v4
v_mfma_f32_16x16x32_bf16 a[20:23], a[236:239], v[156:159], a[20:23]
v_exp_f32 v7, v7
v_mfma_f32_16x16x32_bf16 a[20:23], a[232:235], v[140:143], a[20:23]
buffer_load_dwordx4 v225, s[20:23], s63 offen offset:1024 lds
v_mfma_f32_16x16x32_bf16 a[24:27], a[232:235], v[144:147], a[24:27]
v_exp_f32 v14, v14
v_mfma_f32_16x16x32_bf16 a[24:27], a[236:239], v[160:163], a[24:27]
ds_read_b128 a[204:207], v238 offset:16384
v_add_f32 v125, v125, v5
v_mfma_f32_16x16x32_bf16 a[28:31], a[236:239], v[164:167], a[28:31]
v_exp_f32 v15, v15
v_mfma_f32_16x16x32_bf16 a[28:31], a[232:235], v[148:151], a[28:31]
s_waitcnt lgkmcnt(4)
v_cvt_pk_bf16_f32 v68, v4, v5
v_cvt_pk_bf16_f32 v76, v12, v13
v_mfma_f32_16x16x32_bf16 a[44:47], a[240:243], v[148:151], a[44:47]
v_exp_f32 v20, v20
v_mfma_f32_16x16x32_bf16 a[44:47], a[244:247], v[164:167], a[44:47]
ds_read_b128 a[208:211], v235 offset:20480
v_add_f32 v125, v125, v6
v_mfma_f32_16x16x32_bf16 a[40:43], a[244:247], v[160:163], a[40:43]
v_exp_f32 v21, v21
v_mfma_f32_16x16x32_bf16 a[40:43], a[240:243], v[144:147], a[40:43]
buffer_load_dwordx4 v226, s[20:23], s63 offen offset:2048 lds
v_mfma_f32_16x16x32_bf16 a[36:39], a[240:243], v[140:143], a[36:39]
v_exp_f32 v28, v28
v_mfma_f32_16x16x32_bf16 a[36:39], a[244:247], v[156:159], a[36:39]
ds_read_b128 a[212:215], v236 offset:20480
v_add_f32 v125, v125, v7
v_mfma_f32_16x16x32_bf16 a[32:35], a[244:247], v[152:155], a[32:35]
v_exp_f32 v29, v29
v_mfma_f32_16x16x32_bf16 a[32:35], a[240:243], v[136:139], a[32:35]
v_cvt_pk_bf16_f32 v69, v6, v7
v_cvt_pk_bf16_f32 v77, v14, v15
v_mfma_f32_16x16x32_bf16 a[48:51], a[248:251], v[136:139], a[48:51]
v_exp_f32 v22, v22
v_mfma_f32_16x16x32_bf16 a[48:51], a[252:255], v[152:155], a[48:51]
ds_read_b128 a[216:219], v237 offset:20480
v_add_f32 v125, v125, v20
v_mfma_f32_16x16x32_bf16 a[52:55], a[252:255], v[156:159], a[52:55]
v_exp_f32 v23, v23
v_mfma_f32_16x16x32_bf16 a[52:55], a[248:251], v[140:143], a[52:55]
buffer_load_dwordx4 v227, s[20:23], s63 offen offset:3072 lds
v_mfma_f32_16x16x32_bf16 a[56:59], a[248:251], v[144:147], a[56:59]
s_add_u32 s63, s63, 16384
v_exp_f32 v30, v30
v_mfma_f32_16x16x32_bf16 a[56:59], a[252:255], v[160:163], a[56:59]
ds_read_b128 a[220:223], v238 offset:20480
v_add_f32 v125, v125, v21
v_mfma_f32_16x16x32_bf16 a[60:63], a[252:255], v[164:167], a[60:63]
v_exp_f32 v31, v31
v_mfma_f32_16x16x32_bf16 a[60:63], a[248:251], v[148:151], a[60:63]
v_cvt_pk_bf16_f32 v70, v20, v21
v_cvt_pk_bf16_f32 v78, v28, v29
v_mfma_f32_16x16x32_bf16 v[112:115], v[120:123], v[144:147], v[112:115]
v_add_f32 v125, v125, v22
v_add_f32 v125, v125, v23
v_mfma_f32_16x16x32_bf16 v[112:115], v[120:123], v[160:163], v[112:115]
s_waitcnt lgkmcnt(4)
v_cvt_pk_bf16_f32 v71, v22, v23
v_cvt_pk_bf16_f32 v79, v30, v31
v_mfma_f32_16x16x32_bf16 v[0:3], a[192:195], a[80:83], v[96:99]
v_exp_f32 v32, v32
v_mfma_f32_16x16x32_bf16 v[0:3], a[196:199], a[112:115], v[0:3]
ds_read_b64_tr_b16 a[224:225], v243 offset:49152
v_add_f32 v124, v124, v32
v_mfma_f32_16x16x32_bf16 v[0:3], a[200:203], a[144:147], v[0:3]
v_exp_f32 v33, v33
v_mfma_f32_16x16x32_bf16 v[0:3], a[204:207], a[176:179], v[0:3]
ds_read_b64_tr_b16 a[226:227], v243 offset:53248
v_add_f32 v124, v124, v33
v_mfma_f32_16x16x32_bf16 v[4:7], a[204:207], a[180:183], v[100:103]
v_exp_f32 v40, v40
v_mfma_f32_16x16x32_bf16 v[4:7], a[200:203], a[148:151], v[4:7]
ds_read_b64_tr_b16 a[228:229], v243 offset:57344
v_cvt_pk_bf16_f32 v80, v32, v33
v_mfma_f32_16x16x32_bf16 v[4:7], a[196:199], a[116:119], v[4:7]
v_exp_f32 v41, v41
v_mfma_f32_16x16x32_bf16 v[4:7], a[192:195], a[84:87], v[4:7]
ds_read_b64_tr_b16 a[230:231], v243 offset:61440
v_cvt_pk_bf16_f32 v88, v40, v41
v_mfma_f32_16x16x32_bf16 v[8:11], a[192:195], a[88:91], v[104:107]
v_exp_f32 v34, v34
v_mfma_f32_16x16x32_bf16 v[8:11], a[196:199], a[120:123], v[8:11]
ds_read_b64_tr_b16 a[232:233], v244 offset:49152
v_add_f32 v124, v124, v34
v_mfma_f32_16x16x32_bf16 v[8:11], a[200:203], a[152:155], v[8:11]
v_exp_f32 v35, v35
v_mfma_f32_16x16x32_bf16 v[8:11], a[204:207], a[184:187], v[8:11]
ds_read_b64_tr_b16 a[234:235], v244 offset:53248
v_add_f32 v124, v124, v35
v_mfma_f32_16x16x32_bf16 v[12:15], a[204:207], a[188:191], v[108:111]
v_exp_f32 v42, v42
v_mfma_f32_16x16x32_bf16 v[12:15], a[200:203], a[156:159], v[12:15]
ds_read_b64_tr_b16 a[236:237], v244 offset:57344
v_cvt_pk_bf16_f32 v81, v34, v35
v_mfma_f32_16x16x32_bf16 v[12:15], a[196:199], a[124:127], v[12:15]
v_exp_f32 v43, v43
v_mfma_f32_16x16x32_bf16 v[12:15], a[192:195], a[92:95], v[12:15]
s_waitcnt lgkmcnt(7)
ds_read_b64_tr_b16 a[238:239], v244 offset:61440
v_cvt_pk_bf16_f32 v89, v42, v43
v_mfma_f32_16x16x32_bf16 v[28:31], a[208:211], a[92:95], v[108:111]
v_exp_f32 v48, v48
v_mfma_f32_16x16x32_bf16 v[28:31], a[212:215], a[124:127], v[28:31]
ds_read_b64_tr_b16 a[240:241], v245 offset:49152
v_add_f32 v124, v124, v48
v_mfma_f32_16x16x32_bf16 v[28:31], a[216:219], a[156:159], v[28:31]
v_exp_f32 v49, v49
v_mfma_f32_16x16x32_bf16 v[28:31], a[220:223], a[188:191], v[28:31]
ds_read_b64_tr_b16 a[242:243], v245 offset:53248
v_add_f32 v124, v124, v49
v_mfma_f32_16x16x32_bf16 v[24:27], a[220:223], a[184:187], v[104:107]
v_exp_f32 v56, v56
v_mfma_f32_16x16x32_bf16 v[24:27], a[216:219], a[152:155], v[24:27]
ds_read_b64_tr_b16 a[244:245], v245 offset:57344
v_cvt_pk_bf16_f32 v82, v48, v49
v_mfma_f32_16x16x32_bf16 v[24:27], a[212:215], a[120:123], v[24:27]
v_exp_f32 v57, v57
v_mfma_f32_16x16x32_bf16 v[24:27], a[208:211], a[88:91], v[24:27]
ds_read_b64_tr_b16 a[246:247], v245 offset:61440
v_cvt_pk_bf16_f32 v90, v56, v57
v_mfma_f32_16x16x32_bf16 v[20:23], a[208:211], a[84:87], v[100:103]
v_exp_f32 v50, v50
v_mfma_f32_16x16x32_bf16 v[20:23], a[212:215], a[116:119], v[20:23]
ds_read_b64_tr_b16 a[248:249], v246 offset:49152
v_add_f32 v124, v124, v50
v_mfma_f32_16x16x32_bf16 v[20:23], a[216:219], a[148:151], v[20:23]
v_exp_f32 v51, v51
v_mfma_f32_16x16x32_bf16 v[20:23], a[220:223], a[180:183], v[20:23]
ds_read_b64_tr_b16 a[250:251], v246 offset:53248
v_add_f32 v124, v124, v51
v_mfma_f32_16x16x32_bf16 v[16:19], a[220:223], a[176:179], v[96:99]
v_exp_f32 v58, v58
v_mfma_f32_16x16x32_bf16 v[16:19], a[216:219], a[144:147], v[16:19]
ds_read_b64_tr_b16 a[252:253], v246 offset:57344
v_cvt_pk_bf16_f32 v83, v50, v51
v_mfma_f32_16x16x32_bf16 v[16:19], a[212:215], a[112:115], v[16:19]
v_exp_f32 v59, v59
v_mfma_f32_16x16x32_bf16 v[16:19], a[208:211], a[80:83], v[16:19]
s_waitcnt lgkmcnt(7)
ds_read_b64_tr_b16 a[254:255], v246 offset:61440
v_cvt_pk_bf16_f32 v91, v58, v59
v_mfma_f32_16x16x32_bf16 a[76:79], a[224:227], v[148:151], a[76:79]
v_exp_f32 v36, v36
v_mfma_f32_16x16x32_bf16 a[76:79], a[228:231], v[164:167], a[76:79]
ds_read_b128 a[192:195], v235 offset:24576
v_add_f32 v125, v125, v36
v_mfma_f32_16x16x32_bf16 a[72:75], a[228:231], v[160:163], a[72:75]
s_add_u32 m0, s65, 98304
v_exp_f32 v37, v37
v_mfma_f32_16x16x32_bf16 a[72:75], a[224:227], v[144:147], a[72:75]
buffer_load_dwordx4 v228, s[24:27], s64 offen offset:0 lds
v_mfma_f32_16x16x32_bf16 a[68:71], a[224:227], v[140:143], a[68:71]
v_exp_f32 v44, v44
v_mfma_f32_16x16x32_bf16 a[68:71], a[228:231], v[156:159], a[68:71]
ds_read_b128 a[196:199], v236 offset:24576
v_add_f32 v125, v125, v37
v_mfma_f32_16x16x32_bf16 a[64:67], a[228:231], v[152:155], a[64:67]
v_exp_f32 v45, v45
v_mfma_f32_16x16x32_bf16 a[64:67], a[224:227], v[136:139], a[64:67]
buffer_store_dwordx4 v[200:203], v231, s[12:15], s56 offen sc1
v_mfma_f32_16x16x32_bf16 a[96:99], a[232:235], v[136:139], a[96:99]
v_exp_f32 v38, v38
v_mfma_f32_16x16x32_bf16 a[96:99], a[236:239], v[152:155], a[96:99]
ds_read_b128 a[200:203], v237 offset:24576
v_cvt_pk_bf16_f32 v84, v36, v37
v_mfma_f32_16x16x32_bf16 a[100:103], a[236:239], v[156:159], a[100:103]
v_exp_f32 v39, v39
v_mfma_f32_16x16x32_bf16 a[100:103], a[232:235], v[140:143], a[100:103]
buffer_load_dwordx4 v229, s[24:27], s64 offen offset:1024 lds
v_mfma_f32_16x16x32_bf16 a[104:107], a[232:235], v[144:147], a[104:107]
v_exp_f32 v46, v46
v_mfma_f32_16x16x32_bf16 a[104:107], a[236:239], v[160:163], a[104:107]
ds_read_b128 a[204:207], v238 offset:24576
v_cvt_pk_bf16_f32 v92, v44, v45
v_mfma_f32_16x16x32_bf16 a[108:111], a[236:239], v[164:167], a[108:111]
v_exp_f32 v47, v47
v_mfma_f32_16x16x32_bf16 a[108:111], a[232:235], v[148:151], a[108:111]
s_waitcnt lgkmcnt(4)
v_add_f32 v125, v125, v38
v_add_f32 v125, v125, v39
v_mfma_f32_16x16x32_bf16 a[140:143], a[240:243], v[148:151], a[140:143]
v_exp_f32 v52, v52
v_mfma_f32_16x16x32_bf16 a[140:143], a[244:247], v[164:167], a[140:143]
ds_read_b128 a[208:211], v235 offset:28672
v_cvt_pk_bf16_f32 v85, v38, v39
v_mfma_f32_16x16x32_bf16 a[136:139], a[244:247], v[160:163], a[136:139]
v_exp_f32 v53, v53
v_mfma_f32_16x16x32_bf16 a[136:139], a[240:243], v[144:147], a[136:139]
buffer_load_dwordx4 v228, s[24:27], s64 offen offset:2048 lds
v_mfma_f32_16x16x32_bf16 a[132:135], a[240:243], v[140:143], a[132:135]
v_exp_f32 v60, v60
v_mfma_f32_16x16x32_bf16 a[132:135], a[244:247], v[156:159], a[132:135]
ds_read_b128 a[212:215], v236 offset:28672
v_cvt_pk_bf16_f32 v93, v46, v47
v_mfma_f32_16x16x32_bf16 a[128:131], a[244:247], v[152:155], a[128:131]
v_exp_f32 v61, v61
v_mfma_f32_16x16x32_bf16 a[128:131], a[240:243], v[136:139], a[128:131]
v_add_f32 v125, v125, v52
v_add_f32 v125, v125, v53
v_mfma_f32_16x16x32_bf16 a[160:163], a[248:251], v[136:139], a[160:163]
s_waitcnt vmcnt(9)
v_exp_f32 v54, v54
v_mfma_f32_16x16x32_bf16 a[160:163], a[252:255], v[152:155], a[160:163]
ds_read_b128 a[216:219], v237 offset:28672
ds_add_u32 v132, v134
v_mfma_f32_16x16x32_bf16 a[164:167], a[252:255], v[156:159], a[164:167]
v_exp_f32 v55, v55
v_mfma_f32_16x16x32_bf16 a[164:167], a[248:251], v[140:143], a[164:167]
buffer_load_dwordx4 v229, s[24:27], s64 offen offset:3072 lds
v_mfma_f32_16x16x32_bf16 a[168:171], a[248:251], v[144:147], a[168:171]
s_add_u32 s64, s64, 16384
v_exp_f32 v62, v62
v_mfma_f32_16x16x32_bf16 a[168:171], a[252:255], v[160:163], a[168:171]
ds_read_b128 a[220:223], v238 offset:28672
v_cvt_pk_bf16_f32 v86, v52, v53
v_mfma_f32_16x16x32_bf16 a[172:175], a[252:255], v[164:167], a[172:175]
s_add_u32 s47, s47, 1
v_exp_f32 v63, v63
v_mfma_f32_16x16x32_bf16 a[172:175], a[248:251], v[148:151], a[172:175]
v_cvt_pk_bf16_f32 v94, v60, v61
v_add_f32 v125, v125, v54
v_mfma_f32_16x16x32_bf16 v[116:119], v[120:123], v[148:151], v[116:119]
v_add_f32 v125, v125, v55
v_cvt_pk_bf16_f32 v87, v54, v55
v_mfma_f32_16x16x32_bf16 v[116:119], v[120:123], v[164:167], v[116:119]
s_waitcnt lgkmcnt(5)
v_cvt_pk_bf16_f32 v95, v62, v63
s_add_u32 s62, s62, 1
s_cmp_lt_u32 s62, 4
s_cbranch_scc1 k1_al
s_getpc_b64 s[74:75]
ct2:
s_add_u32 s74, s74, k1_tail-ct2
s_addc_u32 s75, s75, 0
s_lshr_b32 s76, s2, 3
s_lshl_b32 s76, s76, 2
s_add_u32 s76, s76, s3
s_lshl_b32 s76, s76, 9
v_bfe_u32 v249, v234, 4, 2
v_lshlrev_b32 v249, 7, v249
v_add_u32 v249, s76, v249
v_min_u32 v249, k1_last-k1_tail, v249
global_load_dword v255, v249, s[74:75]
.p2align 6
k1_bl:
v_mfma_f32_16x16x32_bf16 v[32:35], a[192:195], a[80:83], v[96:99]
v_exp_f32 v0, v0
v_mfma_f32_16x16x32_bf16 v[32:35], a[196:199], a[112:115], v[32:35]
ds_read_b64_tr_b16 a[224:225], v239 offset:0
v_add_f32 v124, v124, v0
v_mfma_f32_16x16x32_bf16 v[32:35], a[200:203], a[144:147], v[32:35]
v_exp_f32 v1, v1
v_mfma_f32_16x16x32_bf16 v[32:35], a[204:207], a[176:179], v[32:35]
ds_read_b64_tr_b16 a[226:227], v239 offset:4096
v_add_f32 v124, v124, v1
v_mfma_f32_16x16x32_bf16 v[36:39], a[204:207], a[180:183], v[100:103]
v_exp_f32 v8, v8
v_mfma_f32_16x16x32_bf16 v[36:39], a[200:203], a[148:151], v[36:39]
ds_read_b64_tr_b16 a[228:229], v239 offset:8192
v_cvt_pk_bf16_f32 v136, v0, v1
v_mfma_f32_16x16x32_bf16 v[36:39], a[196:199], a[116:119], v[36:39]
v_exp_f32 v9, v9
v_mfma_f32_16x16x32_bf16 v[36:39], a[192:195], a[84:87], v[36:39]
ds_read_b64_tr_b16 a[230:231], v239 offset:12288
v_cvt_pk_bf16_f32 v144, v8, v9
v_mfma_f32_16x16x32_bf16 v[40:43], a[192:195], a[88:91], v[104:107]
v_exp_f32 v2, v2
v_mfma_f32_16x16x32_bf16 v[40:43], a[196:199], a[120:123], v[40:43]
ds_read_b64_tr_b16 a[232:233], v240 offset:0
v_add_f32 v124, v124, v2
v_mfma_f32_16x16x32_bf16 v[40:43], a[200:203], a[152:155], v[40:43]
v_exp_f32 v3, v3
v_mfma_f32_16x16x32_bf16 v[40:43], a[204:207], a[184:187], v[40:43]
ds_read_b64_tr_b16 a[234:235], v240 offset:4096
v_add_f32 v124, v124, v3
v_mfma_f32_16x16x32_bf16 v[44:47], a[204:207], a[188:191], v[108:111]
v_exp_f32 v10, v10
v_mfma_f32_16x16x32_bf16 v[44:47], a[200:203], a[156:159], v[44:47]
ds_read_b64_tr_b16 a[236:237], v240 offset:8192
ds_read_b32 v135, v133
v_mfma_f32_16x16x32_bf16 v[44:47], a[196:199], a[124:127], v[44:47]
v_exp_f32 v11, v11
v_mfma_f32_16x16x32_bf16 v[44:47], a[192:195], a[92:95], v[44:47]
s_waitcnt lgkmcnt(8)
ds_read_b64_tr_b16 a[238:239], v240 offset:12288
v_cvt_pk_bf16_f32 v137, v2, v3
v_mfma_f32_16x16x32_bf16 v[60:63], a[208:211], a[92:95], v[108:111]
v_exp_f32 v16, v16
v_mfma_f32_16x16x32_bf16 v[60:63], a[212:215], a[124:127], v[60:63]
ds_read_b64_tr_b16 a[240:241], v241 offset:0
v_cvt_pk_bf16_f32 v145, v10, v11
v_mfma_f32_16x16x32_bf16 v[60:63], a[216:219], a[156:159], v[60:63]
v_exp_f32 v17, v17
v_mfma_f32_16x16x32_bf16 v[60:63], a[220:223], a[188:191], v[60:63]
ds_read_b64_tr_b16 a[242:243], v241 offset:4096
v_add_f32 v124, v124, v16
v_mfma_f32_16x16x32_bf16 v[56:59], a[220:223], a[184:187], v[104:107]
v_exp_f32 v24, v24
v_mfma_f32_16x16x32_bf16 v[56:59], a[216:219], a[152:155], v[56:59]
ds_read_b64_tr_b16 a[244:245], v241 offset:8192
v_add_f32 v124, v124, v17
v_mfma_f32_16x16x32_bf16 v[56:59], a[212:215], a[120:123], v[56:59]
v_exp_f32 v25, v25
v_mfma_f32_16x16x32_bf16 v[56:59], a[208:211], a[88:91], v[56:59]
ds_read_b64_tr_b16 a[246:247], v241 offset:12288
v_cvt_pk_bf16_f32 v138, v16, v17
v_mfma_f32_16x16x32_bf16 v[52:55], a[208:211], a[84:87], v[100:103]
v_exp_f32 v18, v18
v_mfma_f32_16x16x32_bf16 v[52:55], a[212:215], a[116:119], v[52:55]
ds_read_b64_tr_b16 a[248:249], v242 offset:0
v_cvt_pk_bf16_f32 v146, v24, v25
v_mfma_f32_16x16x32_bf16 v[52:55], a[216:219], a[148:151], v[52:55]
v_exp_f32 v19, v19
v_mfma_f32_16x16x32_bf16 v[52:55], a[220:223], a[180:183], v[52:55]
ds_read_b64_tr_b16 a[250:251], v242 offset:4096
v_add_f32 v124, v124, v18
v_mfma_f32_16x16x32_bf16 v[48:51], a[220:223], a[176:179], v[96:99]
v_exp_f32 v26, v26
v_mfma_f32_16x16x32_bf16 v[48:51], a[216:219], a[144:147], v[48:51]
s_waitcnt lgkmcnt(7)
ds_read_b64_tr_b16 a[252:253], v242 offset:8192
v_cmp_gt_u32 vcc, s47, v135
v_mfma_f32_16x16x32_bf16 v[48:51], a[212:215], a[112:115], v[48:51]
v_exp_f32 v27, v27
v_mfma_f32_16x16x32_bf16 v[48:51], a[208:211], a[80:83], v[48:51]
s_waitcnt lgkmcnt(7)
ds_read_b64_tr_b16 a[254:255], v242 offset:12288
v_add_f32 v124, v124, v19
v_mfma_f32_16x16x32_bf16 a[12:15], a[224:227], v[76:79], a[12:15]
s_cbranch_vccnz k1_y12_s
k1_y12_b:
v_exp_f32 v4, v4
v_mfma_f32_16x16x32_bf16 a[12:15], a[228:231], v[92:95], a[12:15]
ds_read_b128 a[192:195], v235 offset:32768
v_cvt_pk_bf16_f32 v139, v18, v19
v_mfma_f32_16x16x32_bf16 a[8:11], a[228:231], v[88:91], a[8:11]
s_add_u32 m0, s65, 0
v_exp_f32 v5, v5
v_mfma_f32_16x16x32_bf16 a[8:11], a[224:227], v[72:75], a[8:11]
buffer_load_dwordx4 v224, s[20:23], s63 offen offset:0 lds
v_mfma_f32_16x16x32_bf16 a[4:7], a[224:227], v[68:71], a[4:7]
v_exp_f32 v12, v12
v_mfma_f32_16x16x32_bf16 a[4:7], a[228:231], v[84:87], a[4:7]
ds_read_b128 a[196:199], v236 offset:32768
v_cvt_pk_bf16_f32 v147, v26, v27
v_mfma_f32_16x16x32_bf16 a[0:3], a[228:231], v[80:83], a[0:3]
v_exp_f32 v13, v13
v_mfma_f32_16x16x32_bf16 a[0:3], a[224:227], v[64:67], a[0:3]
v_add_f32 v125, v125, v4
v_add_f32 v125, v125, v5
v_mfma_f32_16x16x32_bf16 a[16:19], a[232:235], v[64:67], a[16:19]
v_exp_f32 v6, v6
v_mfma_f32_16x16x32_bf16 a[16:19], a[236:239], v[80:83], a[16:19]
ds_read_b128 a[200:203], v237 offset:32768
v_cvt_pk_bf16_f32 v140, v4, v5
v_mfma_f32_16x16x32_bf16 a[20:23], a[236:239], v[84:87], a[20:23]
v_exp_f32 v7, v7
v_mfma_f32_16x16x32_bf16 a[20:23], a[232:235], v[68:71], a[20:23]
buffer_load_dwordx4 v225, s[20:23], s63 offen offset:1024 lds
v_mfma_f32_16x16x32_bf16 a[24:27], a[232:235], v[72:75], a[24:27]
v_exp_f32 v14, v14
v_mfma_f32_16x16x32_bf16 a[24:27], a[236:239], v[88:91], a[24:27]
ds_read_b128 a[204:207], v238 offset:32768
v_cvt_pk_bf16_f32 v148, v12, v13
v_mfma_f32_16x16x32_bf16 a[28:31], a[236:239], v[92:95], a[28:31]
v_exp_f32 v15, v15
v_mfma_f32_16x16x32_bf16 a[28:31], a[232:235], v[76:79], a[28:31]
s_waitcnt lgkmcnt(4)
v_add_f32 v125, v125, v6
v_add_f32 v125, v125, v7
v_mfma_f32_16x16x32_bf16 a[44:47], a[240:243], v[76:79], a[44:47]
v_exp_f32 v20, v20
v_mfma_f32_16x16x32_bf16 a[44:47], a[244:247], v[92:95], a[44:47]
ds_read_b128 a[208:211], v235 offset:36864
v_cvt_pk_bf16_f32 v141, v6, v7
v_mfma_f32_16x16x32_bf16 a[40:43], a[244:247], v[88:91], a[40:43]
v_exp_f32 v21, v21
v_mfma_f32_16x16x32_bf16 a[40:43], a[240:243], v[72:75], a[40:43]
buffer_load_dwordx4 v226, s[20:23], s63 offen offset:2048 lds
v_mfma_f32_16x16x32_bf16 a[36:39], a[240:243], v[68:71], a[36:39]
v_exp_f32 v28, v28
v_mfma_f32_16x16x32_bf16 a[36:39], a[244:247], v[84:87], a[36:39]
ds_read_b128 a[212:215], v236 offset:36864
v_cvt_pk_bf16_f32 v149, v14, v15
v_mfma_f32_16x16x32_bf16 a[32:35], a[244:247], v[80:83], a[32:35]
v_exp_f32 v29, v29
v_mfma_f32_16x16x32_bf16 a[32:35], a[240:243], v[64:67], a[32:35]
v_add_f32 v125, v125, v20
v_add_f32 v125, v125, v21
v_mfma_f32_16x16x32_bf16 a[48:51], a[248:251], v[64:67], a[48:51]
v_exp_f32 v22, v22
v_mfma_f32_16x16x32_bf16 a[48:51], a[252:255], v[80:83], a[48:51]
ds_read_b128 a[216:219], v237 offset:36864
v_cvt_pk_bf16_f32 v142, v20, v21
v_mfma_f32_16x16x32_bf16 a[52:55], a[252:255], v[84:87], a[52:55]
v_exp_f32 v23, v23
v_mfma_f32_16x16x32_bf16 a[52:55], a[248:251], v[68:71], a[52:55]
buffer_load_dwordx4 v227, s[20:23], s63 offen offset:3072 lds
v_mfma_f32_16x16x32_bf16 a[56:59], a[248:251], v[72:75], a[56:59]
s_add_u32 s63, s63, 16384
v_exp_f32 v30, v30
v_mfma_f32_16x16x32_bf16 a[56:59], a[252:255], v[88:91], a[56:59]
ds_read_b128 a[220:223], v238 offset:36864
v_cvt_pk_bf16_f32 v150, v28, v29
v_mfma_f32_16x16x32_bf16 a[60:63], a[252:255], v[92:95], a[60:63]
v_exp_f32 v31, v31
v_mfma_f32_16x16x32_bf16 a[60:63], a[248:251], v[76:79], a[60:63]
v_add_f32 v125, v125, v22
v_add_f32 v125, v125, v23
v_mfma_f32_16x16x32_bf16 v[112:115], v[120:123], v[72:75], v[112:115]
v_cvt_pk_bf16_f32 v143, v22, v23
v_cvt_pk_bf16_f32 v151, v30, v31
v_mfma_f32_16x16x32_bf16 v[112:115], v[120:123], v[88:91], v[112:115]
s_waitcnt lgkmcnt(4)
v_mfma_f32_16x16x32_bf16 v[0:3], a[192:195], a[80:83], v[96:99]
v_exp_f32 v32, v32
v_mfma_f32_16x16x32_bf16 v[0:3], a[196:199], a[112:115], v[0:3]
ds_read_b64_tr_b16 a[224:225], v243 offset:0
v_add_f32 v124, v124, v32
v_mfma_f32_16x16x32_bf16 v[0:3], a[200:203], a[144:147], v[0:3]
v_exp_f32 v33, v33
v_mfma_f32_16x16x32_bf16 v[0:3], a[204:207], a[176:179], v[0:3]
ds_read_b64_tr_b16 a[226:227], v243 offset:4096
v_add_f32 v124, v124, v33
v_mfma_f32_16x16x32_bf16 v[4:7], a[204:207], a[180:183], v[100:103]
v_exp_f32 v40, v40
v_mfma_f32_16x16x32_bf16 v[4:7], a[200:203], a[148:151], v[4:7]
ds_read_b64_tr_b16 a[228:229], v243 offset:8192
v_cvt_pk_bf16_f32 v152, v32, v33
v_mfma_f32_16x16x32_bf16 v[4:7], a[196:199], a[116:119], v[4:7]
v_exp_f32 v41, v41
v_mfma_f32_16x16x32_bf16 v[4:7], a[192:195], a[84:87], v[4:7]
ds_read_b64_tr_b16 a[230:231], v243 offset:12288
v_cvt_pk_bf16_f32 v160, v40, v41
v_mfma_f32_16x16x32_bf16 v[8:11], a[192:195], a[88:91], v[104:107]
v_exp_f32 v34, v34
v_mfma_f32_16x16x32_bf16 v[8:11], a[196:199], a[120:123], v[8:11]
ds_read_b64_tr_b16 a[232:233], v244 offset:0
v_add_f32 v124, v124, v34
v_mfma_f32_16x16x32_bf16 v[8:11], a[200:203], a[152:155], v[8:11]
v_exp_f32 v35, v35
v_mfma_f32_16x16x32_bf16 v[8:11], a[204:207], a[184:187], v[8:11]
ds_read_b64_tr_b16 a[234:235], v244 offset:4096
v_add_f32 v124, v124, v35
v_mfma_f32_16x16x32_bf16 v[12:15], a[204:207], a[188:191], v[108:111]
v_exp_f32 v42, v42
v_mfma_f32_16x16x32_bf16 v[12:15], a[200:203], a[156:159], v[12:15]
ds_read_b64_tr_b16 a[236:237], v244 offset:8192
v_cvt_pk_bf16_f32 v153, v34, v35
v_mfma_f32_16x16x32_bf16 v[12:15], a[196:199], a[124:127], v[12:15]
v_exp_f32 v43, v43
v_mfma_f32_16x16x32_bf16 v[12:15], a[192:195], a[92:95], v[12:15]
s_waitcnt lgkmcnt(7)
ds_read_b64_tr_b16 a[238:239], v244 offset:12288
v_cvt_pk_bf16_f32 v161, v42, v43
v_mfma_f32_16x16x32_bf16 v[28:31], a[208:211], a[92:95], v[108:111]
v_exp_f32 v48, v48
v_mfma_f32_16x16x32_bf16 v[28:31], a[212:215], a[124:127], v[28:31]
ds_read_b64_tr_b16 a[240:241], v245 offset:0
v_add_f32 v124, v124, v48
v_mfma_f32_16x16x32_bf16 v[28:31], a[216:219], a[156:159], v[28:31]
v_exp_f32 v49, v49
v_mfma_f32_16x16x32_bf16 v[28:31], a[220:223], a[188:191], v[28:31]
ds_read_b64_tr_b16 a[242:243], v245 offset:4096
v_add_f32 v124, v124, v49
v_mfma_f32_16x16x32_bf16 v[24:27], a[220:223], a[184:187], v[104:107]
v_exp_f32 v56, v56
v_mfma_f32_16x16x32_bf16 v[24:27], a[216:219], a[152:155], v[24:27]
ds_read_b64_tr_b16 a[244:245], v245 offset:8192
v_cvt_pk_bf16_f32 v154, v48, v49
v_mfma_f32_16x16x32_bf16 v[24:27], a[212:215], a[120:123], v[24:27]
v_exp_f32 v57, v57
v_mfma_f32_16x16x32_bf16 v[24:27], a[208:211], a[88:91], v[24:27]
ds_read_b64_tr_b16 a[246:247], v245 offset:12288
v_cvt_pk_bf16_f32 v162, v56, v57
v_mfma_f32_16x16x32_bf16 v[20:23], a[208:211], a[84:87], v[100:103]
v_exp_f32 v50, v50
v_mfma_f32_16x16x32_bf16 v[20:23], a[212:215], a[116:119], v[20:23]
ds_read_b64_tr_b16 a[248:249], v246 offset:0
v_add_f32 v124, v124, v50
v_mfma_f32_16x16x32_bf16 v[20:23], a[216:219], a[148:151], v[20:23]
v_exp_f32 v51, v51
v_mfma_f32_16x16x32_bf16 v[20:23], a[220:223], a[180:183], v[20:23]
ds_read_b64_tr_b16 a[250:251], v246 offset:4096
v_add_f32 v124, v124, v51
v_mfma_f32_16x16x32_bf16 v[16:19], a[220:223], a[176:179], v[96:99]
v_exp_f32 v58, v58
v_mfma_f32_16x16x32_bf16 v[16:19], a[216:219], a[144:147], v[16:19]
ds_read_b64_tr_b16 a[252:253], v246 offset:8192
v_cvt_pk_bf16_f32 v155, v50, v51
v_mfma_f32_16x16x32_bf16 v[16:19], a[212:215], a[112:115], v[16:19]
v_exp_f32 v59, v59
v_mfma_f32_16x16x32_bf16 v[16:19], a[208:211], a[80:83], v[16:19]
s_waitcnt lgkmcnt(7)
ds_read_b64_tr_b16 a[254:255], v246 offset:12288
v_cvt_pk_bf16_f32 v163, v58, v59
v_mfma_f32_16x16x32_bf16 a[76:79], a[224:227], v[76:79], a[76:79]
v_exp_f32 v36, v36
v_mfma_f32_16x16x32_bf16 a[76:79], a[228:231], v[92:95], a[76:79]
ds_read_b128 a[192:195], v235 offset:40960
v_add_f32 v125, v125, v36
v_mfma_f32_16x16x32_bf16 a[72:75], a[228:231], v[88:91], a[72:75]
s_add_u32 m0, s65, 114688
v_exp_f32 v37, v37
v_mfma_f32_16x16x32_bf16 a[72:75], a[224:227], v[72:75], a[72:75]
buffer_load_dwordx4 v228, s[24:27], s64 offen offset:0 lds
v_mfma_f32_16x16x32_bf16 a[68:71], a[224:227], v[68:71], a[68:71]
v_exp_f32 v44, v44
v_mfma_f32_16x16x32_bf16 a[68:71], a[228:231], v[84:87], a[68:71]
ds_read_b128 a[196:199], v236 offset:40960
v_add_f32 v125, v125, v37
v_mfma_f32_16x16x32_bf16 a[64:67], a[228:231], v[80:83], a[64:67]
v_exp_f32 v45, v45
v_mfma_f32_16x16x32_bf16 a[64:67], a[224:227], v[64:67], a[64:67]
v_cvt_pk_bf16_f32 v156, v36, v37
v_cvt_pk_bf16_f32 v164, v44, v45
v_mfma_f32_16x16x32_bf16 a[96:99], a[232:235], v[64:67], a[96:99]
v_exp_f32 v38, v38
v_mfma_f32_16x16x32_bf16 a[96:99], a[236:239], v[80:83], a[96:99]
ds_read_b128 a[200:203], v237 offset:40960
v_add_f32 v125, v125, v38
v_mfma_f32_16x16x32_bf16 a[100:103], a[236:239], v[84:87], a[100:103]
v_exp_f32 v39, v39
v_mfma_f32_16x16x32_bf16 a[100:103], a[232:235], v[68:71], a[100:103]
buffer_load_dwordx4 v229, s[24:27], s64 offen offset:1024 lds
v_mfma_f32_16x16x32_bf16 a[104:107], a[232:235], v[72:75], a[104:107]
v_exp_f32 v46, v46
v_mfma_f32_16x16x32_bf16 a[104:107], a[236:239], v[88:91], a[104:107]
ds_read_b128 a[204:207], v238 offset:40960
v_add_f32 v125, v125, v39
v_mfma_f32_16x16x32_bf16 a[108:111], a[236:239], v[92:95], a[108:111]
v_exp_f32 v47, v47
v_mfma_f32_16x16x32_bf16 a[108:111], a[232:235], v[76:79], a[108:111]
s_waitcnt lgkmcnt(4)
v_cvt_pk_bf16_f32 v157, v38, v39
v_cvt_pk_bf16_f32 v165, v46, v47
v_mfma_f32_16x16x32_bf16 a[140:143], a[240:243], v[76:79], a[140:143]
v_exp_f32 v52, v52
v_mfma_f32_16x16x32_bf16 a[140:143], a[244:247], v[92:95], a[140:143]
ds_read_b128 a[208:211], v235 offset:45056
v_add_f32 v125, v125, v52
v_mfma_f32_16x16x32_bf16 a[136:139], a[244:247], v[88:91], a[136:139]
v_exp_f32 v53, v53
v_mfma_f32_16x16x32_bf16 a[136:139], a[240:243], v[72:75], a[136:139]
buffer_load_dwordx4 v228, s[24:27], s64 offen offset:2048 lds
v_mfma_f32_16x16x32_bf16 a[132:135], a[240:243], v[68:71], a[132:135]
v_exp_f32 v60, v60
v_mfma_f32_16x16x32_bf16 a[132:135], a[244:247], v[84:87], a[132:135]
ds_read_b128 a[212:215], v236 offset:45056
v_add_f32 v125, v125, v53
v_mfma_f32_16x16x32_bf16 a[128:131], a[244:247], v[80:83], a[128:131]
v_exp_f32 v61, v61
v_mfma_f32_16x16x32_bf16 a[128:131], a[240:243], v[64:67], a[128:131]
v_cvt_pk_bf16_f32 v158, v52, v53
v_cvt_pk_bf16_f32 v166, v60, v61
v_mfma_f32_16x16x32_bf16 a[160:163], a[248:251], v[64:67], a[160:163]
s_waitcnt vmcnt(7)
v_exp_f32 v54, v54
v_mfma_f32_16x16x32_bf16 a[160:163], a[252:255], v[80:83], a[160:163]
ds_read_b128 a[216:219], v237 offset:45056
ds_add_u32 v132, v134
v_mfma_f32_16x16x32_bf16 a[164:167], a[252:255], v[84:87], a[164:167]
v_exp_f32 v55, v55
v_mfma_f32_16x16x32_bf16 a[164:167], a[248:251], v[68:71], a[164:167]
buffer_load_dwordx4 v229, s[24:27], s64 offen offset:3072 lds
v_mfma_f32_16x16x32_bf16 a[168:171], a[248:251], v[72:75], a[168:171]
s_add_u32 s64, s64, 16384
v_exp_f32 v62, v62
v_mfma_f32_16x16x32_bf16 a[168:171], a[252:255], v[88:91], a[168:171]
ds_read_b128 a[220:223], v238 offset:45056
v_add_f32 v125, v125, v54
v_mfma_f32_16x16x32_bf16 a[172:175], a[252:255], v[92:95], a[172:175]
s_add_u32 s47, s47, 1
v_exp_f32 v63, v63
v_mfma_f32_16x16x32_bf16 a[172:175], a[248:251], v[76:79], a[172:175]
v_add_f32 v125, v125, v55
v_cvt_pk_bf16_f32 v159, v54, v55
v_mfma_f32_16x16x32_bf16 v[116:119], v[120:123], v[76:79], v[116:119]
v_cvt_pk_bf16_f32 v167, v62, v63
v_mfma_f32_16x16x32_bf16 v[116:119], v[120:123], v[92:95], v[116:119]
s_waitcnt lgkmcnt(5)
v_mfma_f32_16x16x32_bf16 v[32:35], a[192:195], a[80:83], v[96:99]
v_exp_f32 v0, v0
v_mfma_f32_16x16x32_bf16 v[32:35], a[196:199], a[112:115], v[32:35]
ds_read_b64_tr_b16 a[224:225], v239 offset:16384
v_add_f32 v124, v124, v0
v_mfma_f32_16x16x32_bf16 v[32:35], a[200:203], a[144:147], v[32:35]
v_exp_f32 v1, v1
v_mfma_f32_16x16x32_bf16 v[32:35], a[204:207], a[176:179], v[32:35]
ds_read_b64_tr_b16 a[226:227], v239 offset:20480
v_add_f32 v124, v124, v1
v_mfma_f32_16x16x32_bf16 v[36:39], a[204:207], a[180:183], v[100:103]
v_exp_f32 v8, v8
v_mfma_f32_16x16x32_bf16 v[36:39], a[200:203], a[148:151], v[36:39]
ds_read_b64_tr_b16 a[228:229], v239 offset:24576
v_cvt_pk_bf16_f32 v64, v0, v1
v_mfma_f32_16x16x32_bf16 v[36:39], a[196:199], a[116:119], v[36:39]
v_exp_f32 v9, v9
v_mfma_f32_16x16x32_bf16 v[36:39], a[192:195], a[84:87], v[36:39]
ds_read_b64_tr_b16 a[230:231], v239 offset:28672
v_cvt_pk_bf16_f32 v72, v8, v9
v_mfma_f32_16x16x32_bf16 v[40:43], a[192:195], a[88:91], v[104:107]
v_exp_f32 v2, v2
v_mfma_f32_16x16x32_bf16 v[40:43], a[196:199], a[120:123], v[40:43]
ds_read_b64_tr_b16 a[232:233], v240 offset:16384
v_add_f32 v124, v124, v2
v_mfma_f32_16x16x32_bf16 v[40:43], a[200:203], a[152:155], v[40:43]
v_exp_f32 v3, v3
v_mfma_f32_16x16x32_bf16 v[40:43], a[204:207], a[184:187], v[40:43]
ds_read_b64_tr_b16 a[234:235], v240 offset:20480
v_add_f32 v124, v124, v3
v_mfma_f32_16x16x32_bf16 v[44:47], a[204:207], a[188:191], v[108:111]
v_exp_f32 v10, v10
v_mfma_f32_16x16x32_bf16 v[44:47], a[200:203], a[156:159], v[44:47]
ds_read_b64_tr_b16 a[236:237], v240 offset:24576
ds_read_b32 v135, v133
v_mfma_f32_16x16x32_bf16 v[44:47], a[196:199], a[124:127], v[44:47]
v_exp_f32 v11, v11
v_mfma_f32_16x16x32_bf16 v[44:47], a[192:195], a[92:95], v[44:47]
s_waitcnt lgkmcnt(8)
ds_read_b64_tr_b16 a[238:239], v240 offset:28672
v_cvt_pk_bf16_f32 v65, v2, v3
v_mfma_f32_16x16x32_bf16 v[60:63], a[208:211], a[92:95], v[108:111]
v_exp_f32 v16, v16
v_mfma_f32_16x16x32_bf16 v[60:63], a[212:215], a[124:127], v[60:63]
ds_read_b64_tr_b16 a[240:241], v241 offset:16384
v_cvt_pk_bf16_f32 v73, v10, v11
v_mfma_f32_16x16x32_bf16 v[60:63], a[216:219], a[156:159], v[60:63]
v_exp_f32 v17, v17
v_mfma_f32_16x16x32_bf16 v[60:63], a[220:223], a[188:191], v[60:63]
ds_read_b64_tr_b16 a[242:243], v241 offset:20480
v_add_f32 v124, v124, v16
v_mfma_f32_16x16x32_bf16 v[56:59], a[220:223], a[184:187], v[104:107]
v_exp_f32 v24, v24
v_mfma_f32_16x16x32_bf16 v[56:59], a[216:219], a[152:155], v[56:59]
ds_read_b64_tr_b16 a[244:245], v241 offset:24576
v_add_f32 v124, v124, v17
v_mfma_f32_16x16x32_bf16 v[56:59], a[212:215], a[120:123], v[56:59]
v_exp_f32 v25, v25
v_mfma_f32_16x16x32_bf16 v[56:59], a[208:211], a[88:91], v[56:59]
ds_read_b64_tr_b16 a[246:247], v241 offset:28672
v_cvt_pk_bf16_f32 v66, v16, v17
v_mfma_f32_16x16x32_bf16 v[52:55], a[208:211], a[84:87], v[100:103]
v_exp_f32 v18, v18
v_mfma_f32_16x16x32_bf16 v[52:55], a[212:215], a[116:119], v[52:55]
ds_read_b64_tr_b16 a[248:249], v242 offset:16384
v_cvt_pk_bf16_f32 v74, v24, v25
v_mfma_f32_16x16x32_bf16 v[52:55], a[216:219], a[148:151], v[52:55]
v_exp_f32 v19, v19
v_mfma_f32_16x16x32_bf16 v[52:55], a[220:223], a[180:183], v[52:55]
ds_read_b64_tr_b16 a[250:251], v242 offset:20480
v_add_f32 v124, v124, v18
v_mfma_f32_16x16x32_bf16 v[48:51], a[220:223], a[176:179], v[96:99]
v_exp_f32 v26, v26
v_mfma_f32_16x16x32_bf16 v[48:51], a[216:219], a[144:147], v[48:51]
s_waitcnt lgkmcnt(7)
ds_read_b64_tr_b16 a[252:253], v242 offset:24576
v_cmp_gt_u32 vcc, s47, v135
v_mfma_f32_16x16x32_bf16 v[48:51], a[212:215], a[112:115], v[48:51]
v_exp_f32 v27, v27
v_mfma_f32_16x16x32_bf16 v[48:51], a[208:211], a[80:83], v[48:51]
s_waitcnt lgkmcnt(7)
ds_read_b64_tr_b16 a[254:255], v242 offset:28672
v_add_f32 v124, v124, v19
v_mfma_f32_16x16x32_bf16 a[12:15], a[224:227], v[148:151], a[12:15]
s_cbranch_vccnz k1_y14_s
k1_y14_b:
v_exp_f32 v4, v4
v_mfma_f32_16x16x32_bf16 a[12:15], a[228:231], v[164:167], a[12:15]
ds_read_b128 a[192:195], v235 offset:49152
v_cvt_pk_bf16_f32 v67, v18, v19
v_mfma_f32_16x16x32_bf16 a[8:11], a[228:231], v[160:163], a[8:11]
s_add_u32 m0, s65, 16384
v_exp_f32 v5, v5
v_mfma_f32_16x16x32_bf16 a[8:11], a[224:227], v[144:147], a[8:11]
buffer_load_dwordx4 v224, s[20:23], s63 offen offset:0 lds
v_mfma_f32_16x16x32_bf16 a[4:7], a[224:227], v[140:143], a[4:7]
v_exp_f32 v12, v12
v_mfma_f32_16x16x32_bf16 a[4:7], a[228:231], v[156:159], a[4:7]
ds_read_b128 a[196:199], v236 offset:49152
v_cvt_pk_bf16_f32 v75, v26, v27
v_mfma_f32_16x16x32_bf16 a[0:3], a[228:231], v[152:155], a[0:3]
v_exp_f32 v13, v13
v_mfma_f32_16x16x32_bf16 a[0:3], a[224:227], v[136:139], a[0:3]
v_add_f32 v125, v125, v4
v_add_f32 v125, v125, v5
v_mfma_f32_16x16x32_bf16 a[16:19], a[232:235], v[136:139], a[16:19]
v_exp_f32 v6, v6
v_mfma_f32_16x16x32_bf16 a[16:19], a[236:239], v[152:155], a[16:19]
ds_read_b128 a[200:203], v237 offset:49152
v_cvt_pk_bf16_f32 v68, v4, v5
v_mfma_f32_16x16x32_bf16 a[20:23], a[236:239], v[156:159], a[20:23]
v_exp_f32 v7, v7
v_mfma_f32_16x16x32_bf16 a[20:23], a[232:235], v[140:143], a[20:23]
buffer_load_dwordx4 v225, s[20:23], s63 offen offset:1024 lds
v_mfma_f32_16x16x32_bf16 a[24:27], a[232:235], v[144:147], a[24:27]
v_exp_f32 v14, v14
v_mfma_f32_16x16x32_bf16 a[24:27], a[236:239], v[160:163], a[24:27]
ds_read_b128 a[204:207], v238 offset:49152
v_cvt_pk_bf16_f32 v76, v12, v13
v_mfma_f32_16x16x32_bf16 a[28:31], a[236:239], v[164:167], a[28:31]
v_exp_f32 v15, v15
v_mfma_f32_16x16x32_bf16 a[28:31], a[232:235], v[148:151], a[28:31]
s_waitcnt lgkmcnt(4)
v_add_f32 v125, v125, v6
v_add_f32 v125, v125, v7
v_mfma_f32_16x16x32_bf16 a[44:47], a[240:243], v[148:151], a[44:47]
v_exp_f32 v20, v20
v_mfma_f32_16x16x32_bf16 a[44:47], a[244:247], v[164:167], a[44:47]
ds_read_b128 a[208:211], v235 offset:53248
v_cvt_pk_bf16_f32 v69, v6, v7
v_mfma_f32_16x16x32_bf16 a[40:43], a[244:247], v[160:163], a[40:43]
v_exp_f32 v21, v21
v_mfma_f32_16x16x32_bf16 a[40:43], a[240:243], v[144:147], a[40:43]
buffer_load_dwordx4 v226, s[20:23], s63 offen offset:2048 lds
v_mfma_f32_16x16x32_bf16 a[36:39], a[240:243], v[140:143], a[36:39]
v_exp_f32 v28, v28
v_mfma_f32_16x16x32_bf16 a[36:39], a[244:247], v[156:159], a[36:39]
ds_read_b128 a[212:215], v236 offset:53248
v_cvt_pk_bf16_f32 v77, v14, v15
v_mfma_f32_16x16x32_bf16 a[32:35], a[244:247], v[152:155], a[32:35]
v_exp_f32 v29, v29
v_mfma_f32_16x16x32_bf16 a[32:35], a[240:243], v[136:139], a[32:35]
v_add_f32 v125, v125, v20
v_add_f32 v125, v125, v21
v_mfma_f32_16x16x32_bf16 a[48:51], a[248:251], v[136:139], a[48:51]
v_exp_f32 v22, v22
v_mfma_f32_16x16x32_bf16 a[48:51], a[252:255], v[152:155], a[48:51]
ds_read_b128 a[216:219], v237 offset:53248
v_cvt_pk_bf16_f32 v70, v20, v21
v_mfma_f32_16x16x32_bf16 a[52:55], a[252:255], v[156:159], a[52:55]
v_exp_f32 v23, v23
v_mfma_f32_16x16x32_bf16 a[52:55], a[248:251], v[140:143], a[52:55]
buffer_load_dwordx4 v227, s[20:23], s63 offen offset:3072 lds
v_mfma_f32_16x16x32_bf16 a[56:59], a[248:251], v[144:147], a[56:59]
s_add_u32 s63, s63, 16384
v_exp_f32 v30, v30
v_mfma_f32_16x16x32_bf16 a[56:59], a[252:255], v[160:163], a[56:59]
ds_read_b128 a[220:223], v238 offset:53248
v_cvt_pk_bf16_f32 v78, v28, v29
v_mfma_f32_16x16x32_bf16 a[60:63], a[252:255], v[164:167], a[60:63]
v_exp_f32 v31, v31
v_mfma_f32_16x16x32_bf16 a[60:63], a[248:251], v[148:151], a[60:63]
v_add_f32 v125, v125, v22
v_add_f32 v125, v125, v23
v_mfma_f32_16x16x32_bf16 v[112:115], v[120:123], v[144:147], v[112:115]
v_cvt_pk_bf16_f32 v71, v22, v23
v_cvt_pk_bf16_f32 v79, v30, v31
v_mfma_f32_16x16x32_bf16 v[112:115], v[120:123], v[160:163], v[112:115]
s_waitcnt lgkmcnt(4)
v_mfma_f32_16x16x32_bf16 v[0:3], a[192:195], a[80:83], v[96:99]
v_exp_f32 v32, v32
v_mfma_f32_16x16x32_bf16 v[0:3], a[196:199], a[112:115], v[0:3]
ds_read_b64_tr_b16 a[224:225], v243 offset:16384
v_add_f32 v124, v124, v32
v_mfma_f32_16x16x32_bf16 v[0:3], a[200:203], a[144:147], v[0:3]
v_exp_f32 v33, v33
v_mfma_f32_16x16x32_bf16 v[0:3], a[204:207], a[176:179], v[0:3]
ds_read_b64_tr_b16 a[226:227], v243 offset:20480
v_add_f32 v124, v124, v33
v_mfma_f32_16x16x32_bf16 v[4:7], a[204:207], a[180:183], v[100:103]
v_exp_f32 v40, v40
v_mfma_f32_16x16x32_bf16 v[4:7], a[200:203], a[148:151], v[4:7]
ds_read_b64_tr_b16 a[228:229], v243 offset:24576
v_cvt_pk_bf16_f32 v80, v32, v33
v_mfma_f32_16x16x32_bf16 v[4:7], a[196:199], a[116:119], v[4:7]
v_exp_f32 v41, v41
v_mfma_f32_16x16x32_bf16 v[4:7], a[192:195], a[84:87], v[4:7]
ds_read_b64_tr_b16 a[230:231], v243 offset:28672
v_cvt_pk_bf16_f32 v88, v40, v41
v_mfma_f32_16x16x32_bf16 v[8:11], a[192:195], a[88:91], v[104:107]
v_exp_f32 v34, v34
v_mfma_f32_16x16x32_bf16 v[8:11], a[196:199], a[120:123], v[8:11]
ds_read_b64_tr_b16 a[232:233], v244 offset:16384
v_add_f32 v124, v124, v34
v_mfma_f32_16x16x32_bf16 v[8:11], a[200:203], a[152:155], v[8:11]
v_exp_f32 v35, v35
v_mfma_f32_16x16x32_bf16 v[8:11], a[204:207], a[184:187], v[8:11]
ds_read_b64_tr_b16 a[234:235], v244 offset:20480
v_add_f32 v124, v124, v35
v_mfma_f32_16x16x32_bf16 v[12:15], a[204:207], a[188:191], v[108:111]
v_exp_f32 v42, v42
v_mfma_f32_16x16x32_bf16 v[12:15], a[200:203], a[156:159], v[12:15]
ds_read_b64_tr_b16 a[236:237], v244 offset:24576
v_cvt_pk_bf16_f32 v81, v34, v35
v_mfma_f32_16x16x32_bf16 v[12:15], a[196:199], a[124:127], v[12:15]
v_exp_f32 v43, v43
v_mfma_f32_16x16x32_bf16 v[12:15], a[192:195], a[92:95], v[12:15]
s_waitcnt lgkmcnt(7)
ds_read_b64_tr_b16 a[238:239], v244 offset:28672
v_cvt_pk_bf16_f32 v89, v42, v43
v_mfma_f32_16x16x32_bf16 v[28:31], a[208:211], a[92:95], v[108:111]
v_exp_f32 v48, v48
v_mfma_f32_16x16x32_bf16 v[28:31], a[212:215], a[124:127], v[28:31]
ds_read_b64_tr_b16 a[240:241], v245 offset:16384
v_add_f32 v124, v124, v48
v_mfma_f32_16x16x32_bf16 v[28:31], a[216:219], a[156:159], v[28:31]
v_exp_f32 v49, v49
v_mfma_f32_16x16x32_bf16 v[28:31], a[220:223], a[188:191], v[28:31]
ds_read_b64_tr_b16 a[242:243], v245 offset:20480
v_add_f32 v124, v124, v49
v_mfma_f32_16x16x32_bf16 v[24:27], a[220:223], a[184:187], v[104:107]
v_exp_f32 v56, v56
v_mfma_f32_16x16x32_bf16 v[24:27], a[216:219], a[152:155], v[24:27]
ds_read_b64_tr_b16 a[244:245], v245 offset:24576
v_cvt_pk_bf16_f32 v82, v48, v49
v_mfma_f32_16x16x32_bf16 v[24:27], a[212:215], a[120:123], v[24:27]
v_exp_f32 v57, v57
v_mfma_f32_16x16x32_bf16 v[24:27], a[208:211], a[88:91], v[24:27]
ds_read_b64_tr_b16 a[246:247], v245 offset:28672
v_cvt_pk_bf16_f32 v90, v56, v57
v_mfma_f32_16x16x32_bf16 v[20:23], a[208:211], a[84:87], v[100:103]
v_exp_f32 v50, v50
v_mfma_f32_16x16x32_bf16 v[20:23], a[212:215], a[116:119], v[20:23]
ds_read_b64_tr_b16 a[248:249], v246 offset:16384
v_add_f32 v124, v124, v50
v_mfma_f32_16x16x32_bf16 v[20:23], a[216:219], a[148:151], v[20:23]
v_exp_f32 v51, v51
v_mfma_f32_16x16x32_bf16 v[20:23], a[220:223], a[180:183], v[20:23]
ds_read_b64_tr_b16 a[250:251], v246 offset:20480
v_add_f32 v124, v124, v51
v_mfma_f32_16x16x32_bf16 v[16:19], a[220:223], a[176:179], v[96:99]
v_exp_f32 v58, v58
v_mfma_f32_16x16x32_bf16 v[16:19], a[216:219], a[144:147], v[16:19]
ds_read_b64_tr_b16 a[252:253], v246 offset:24576
v_cvt_pk_bf16_f32 v83, v50, v51
v_mfma_f32_16x16x32_bf16 v[16:19], a[212:215], a[112:115], v[16:19]
v_exp_f32 v59, v59
v_mfma_f32_16x16x32_bf16 v[16:19], a[208:211], a[80:83], v[16:19]
s_waitcnt lgkmcnt(7)
ds_read_b64_tr_b16 a[254:255], v246 offset:28672
v_cvt_pk_bf16_f32 v91, v58, v59
v_mfma_f32_16x16x32_bf16 a[76:79], a[224:227], v[148:151], a[76:79]
v_exp_f32 v36, v36
v_mfma_f32_16x16x32_bf16 a[76:79], a[228:231], v[164:167], a[76:79]
ds_read_b128 a[192:195], v235 offset:57344
v_add_f32 v125, v125, v36
v_mfma_f32_16x16x32_bf16 a[72:75], a[228:231], v[160:163], a[72:75]
s_add_u32 m0, s65, 65536
v_exp_f32 v37, v37
v_mfma_f32_16x16x32_bf16 a[72:75], a[224:227], v[144:147], a[72:75]
buffer_load_dwordx4 v228, s[24:27], s64 offen offset:0 lds
v_mfma_f32_16x16x32_bf16 a[68:71], a[224:227], v[140:143], a[68:71]
v_exp_f32 v44, v44
v_mfma_f32_16x16x32_bf16 a[68:71], a[228:231], v[156:159], a[68:71]
ds_read_b128 a[196:199], v236 offset:57344
v_add_f32 v125, v125, v37
v_mfma_f32_16x16x32_bf16 a[64:67], a[228:231], v[152:155], a[64:67]
v_exp_f32 v45, v45
v_mfma_f32_16x16x32_bf16 a[64:67], a[224:227], v[136:139], a[64:67]
v_cvt_pk_bf16_f32 v84, v36, v37
v_cvt_pk_bf16_f32 v92, v44, v45
v_mfma_f32_16x16x32_bf16 a[96:99], a[232:235], v[136:139], a[96:99]
v_exp_f32 v38, v38
v_mfma_f32_16x16x32_bf16 a[96:99], a[236:239], v[152:155], a[96:99]
ds_read_b128 a[200:203], v237 offset:57344
v_add_f32 v125, v125, v38
v_mfma_f32_16x16x32_bf16 a[100:103], a[236:239], v[156:159], a[100:103]
v_exp_f32 v39, v39
v_mfma_f32_16x16x32_bf16 a[100:103], a[232:235], v[140:143], a[100:103]
buffer_load_dwordx4 v229, s[24:27], s64 offen offset:1024 lds
v_mfma_f32_16x16x32_bf16 a[104:107], a[232:235], v[144:147], a[104:107]
v_exp_f32 v46, v46
v_mfma_f32_16x16x32_bf16 a[104:107], a[236:239], v[160:163], a[104:107]
ds_read_b128 a[204:207], v238 offset:57344
v_add_f32 v125, v125, v39
v_mfma_f32_16x16x32_bf16 a[108:111], a[236:239], v[164:167], a[108:111]
v_exp_f32 v47, v47
v_mfma_f32_16x16x32_bf16 a[108:111], a[232:235], v[148:151], a[108:111]
s_waitcnt lgkmcnt(4)
v_cvt_pk_bf16_f32 v85, v38, v39
v_cvt_pk_bf16_f32 v93, v46, v47
v_mfma_f32_16x16x32_bf16 a[140:143], a[240:243], v[148:151], a[140:143]
v_exp_f32 v52, v52
v_mfma_f32_16x16x32_bf16 a[140:143], a[244:247], v[164:167], a[140:143]
ds_read_b128 a[208:211], v235 offset:61440
v_add_f32 v125, v125, v52
v_mfma_f32_16x16x32_bf16 a[136:139], a[244:247], v[160:163], a[136:139]
v_exp_f32 v53, v53
v_mfma_f32_16x16x32_bf16 a[136:139], a[240:243], v[144:147], a[136:139]
buffer_load_dwordx4 v228, s[24:27], s64 offen offset:2048 lds
v_mfma_f32_16x16x32_bf16 a[132:135], a[240:243], v[140:143], a[132:135]
v_exp_f32 v60, v60
v_mfma_f32_16x16x32_bf16 a[132:135], a[244:247], v[156:159], a[132:135]
ds_read_b128 a[212:215], v236 offset:61440
v_add_f32 v125, v125, v53
v_mfma_f32_16x16x32_bf16 a[128:131], a[244:247], v[152:155], a[128:131]
v_exp_f32 v61, v61
v_mfma_f32_16x16x32_bf16 a[128:131], a[240:243], v[136:139], a[128:131]
v_cvt_pk_bf16_f32 v86, v52, v53
v_cvt_pk_bf16_f32 v94, v60, v61
v_mfma_f32_16x16x32_bf16 a[160:163], a[248:251], v[136:139], a[160:163]
s_waitcnt vmcnt(7)
v_exp_f32 v54, v54
v_mfma_f32_16x16x32_bf16 a[160:163], a[252:255], v[152:155], a[160:163]
ds_read_b128 a[216:219], v237 offset:61440
ds_add_u32 v132, v134
v_mfma_f32_16x16x32_bf16 a[164:167], a[252:255], v[156:159], a[164:167]
v_exp_f32 v55, v55
v_mfma_f32_16x16x32_bf16 a[164:167], a[248:251], v[140:143], a[164:167]
buffer_load_dwordx4 v229, s[24:27], s64 offen offset:3072 lds
v_mfma_f32_16x16x32_bf16 a[168:171], a[248:251], v[144:147], a[168:171]
s_add_u32 s64, s64, 16384
v_exp_f32 v62, v62
v_mfma_f32_16x16x32_bf16 a[168:171], a[252:255], v[160:163], a[168:171]
ds_read_b128 a[220:223], v238 offset:61440
v_add_f32 v125, v125, v54
v_mfma_f32_16x16x32_bf16 a[172:175], a[252:255], v[164:167], a[172:175]
s_add_u32 s47, s47, 1
v_exp_f32 v63, v63
v_mfma_f32_16x16x32_bf16 a[172:175], a[248:251], v[148:151], a[172:175]
v_add_f32 v125, v125, v55
v_cvt_pk_bf16_f32 v87, v54, v55
v_mfma_f32_16x16x32_bf16 v[116:119], v[120:123], v[148:151], v[116:119]
v_cvt_pk_bf16_f32 v95, v62, v63
v_mfma_f32_16x16x32_bf16 v[116:119], v[120:123], v[164:167], v[116:119]
s_waitcnt lgkmcnt(5)
v_mfma_f32_16x16x32_bf16 v[32:35], a[192:195], a[80:83], v[96:99]
v_exp_f32 v0, v0
v_mfma_f32_16x16x32_bf16 v[32:35], a[196:199], a[112:115], v[32:35]
ds_read_b64_tr_b16 a[224:225], v239 offset:32768
v_add_f32 v124, v124, v0
v_mfma_f32_16x16x32_bf16 v[32:35], a[200:203], a[144:147], v[32:35]
v_exp_f32 v1, v1
v_mfma_f32_16x16x32_bf16 v[32:35], a[204:207], a[176:179], v[32:35]
ds_read_b64_tr_b16 a[226:227], v239 offset:36864
v_add_f32 v124, v124, v1
v_mfma_f32_16x16x32_bf16 v[36:39], a[204:207], a[180:183], v[100:103]
v_exp_f32 v8, v8
v_mfma_f32_16x16x32_bf16 v[36:39], a[200:203], a[148:151], v[36:39]
ds_read_b64_tr_b16 a[228:229], v239 offset:40960
v_cvt_pk_bf16_f32 v136, v0, v1
v_mfma_f32_16x16x32_bf16 v[36:39], a[196:199], a[116:119], v[36:39]
v_exp_f32 v9, v9
v_mfma_f32_16x16x32_bf16 v[36:39], a[192:195], a[84:87], v[36:39]
ds_read_b64_tr_b16 a[230:231], v239 offset:45056
v_cvt_pk_bf16_f32 v144, v8, v9
v_mfma_f32_16x16x32_bf16 v[40:43], a[192:195], a[88:91], v[104:107]
v_exp_f32 v2, v2
v_mfma_f32_16x16x32_bf16 v[40:43], a[196:199], a[120:123], v[40:43]
ds_read_b64_tr_b16 a[232:233], v240 offset:32768
v_add_f32 v124, v124, v2
v_mfma_f32_16x16x32_bf16 v[40:43], a[200:203], a[152:155], v[40:43]
v_exp_f32 v3, v3
v_mfma_f32_16x16x32_bf16 v[40:43], a[204:207], a[184:187], v[40:43]
ds_read_b64_tr_b16 a[234:235], v240 offset:36864
v_add_f32 v124, v124, v3
v_mfma_f32_16x16x32_bf16 v[44:47], a[204:207], a[188:191], v[108:111]
v_exp_f32 v10, v10
v_mfma_f32_16x16x32_bf16 v[44:47], a[200:203], a[156:159], v[44:47]
ds_read_b64_tr_b16 a[236:237], v240 offset:40960
ds_read_b32 v135, v133
v_mfma_f32_16x16x32_bf16 v[44:47], a[196:199], a[124:127], v[44:47]
v_exp_f32 v11, v11
v_mfma_f32_16x16x32_bf16 v[44:47], a[192:195], a[92:95], v[44:47]
s_waitcnt lgkmcnt(8)
ds_read_b64_tr_b16 a[238:239], v240 offset:45056
v_cvt_pk_bf16_f32 v137, v2, v3
v_mfma_f32_16x16x32_bf16 v[60:63], a[208:211], a[92:95], v[108:111]
s_cmp_eq_u32 s62, s79
v_exp_f32 v16, v16
v_mfma_f32_16x16x32_bf16 v[60:63], a[212:215], a[124:127], v[60:63]
s_cselect_b32 s75, s52, 0x40000000
ds_read_b64_tr_b16 a[240:241], v241 offset:32768
v_cvt_pk_bf16_f32 v145, v10, v11
v_mfma_f32_16x16x32_bf16 v[60:63], a[216:219], a[156:159], v[60:63]
v_exp_f32 v17, v17
v_mfma_f32_16x16x32_bf16 v[60:63], a[220:223], a[188:191], v[60:63]
ds_read_b64_tr_b16 a[242:243], v241 offset:36864
v_add_f32 v124, v124, v16
v_mfma_f32_16x16x32_bf16 v[56:59], a[220:223], a[184:187], v[104:107]
v_exp_f32 v24, v24
v_mfma_f32_16x16x32_bf16 v[56:59], a[216:219], a[152:155], v[56:59]
ds_read_b64_tr_b16 a[244:245], v241 offset:40960
v_add_f32 v124, v124, v17
v_mfma_f32_16x16x32_bf16 v[56:59], a[212:215], a[120:123], v[56:59]
v_exp_f32 v25, v25
v_mfma_f32_16x16x32_bf16 v[56:59], a[208:211], a[88:91], v[56:59]
ds_read_b64_tr_b16 a[246:247], v241 offset:45056
v_cvt_pk_bf16_f32 v138, v16, v17
v_mfma_f32_16x16x32_bf16 v[52:55], a[208:211], a[84:87], v[100:103]
v_exp_f32 v18, v18
v_mfma_f32_16x16x32_bf16 v[52:55], a[212:215], a[116:119], v[52:55]
ds_read_b64_tr_b16 a[248:249], v242 offset:32768
v_cvt_pk_bf16_f32 v146, v24, v25
v_mfma_f32_16x16x32_bf16 v[52:55], a[216:219], a[148:151], v[52:55]
v_exp_f32 v19, v19
v_mfma_f32_16x16x32_bf16 v[52:55], a[220:223], a[180:183], v[52:55]
ds_read_b64_tr_b16 a[250:251], v242 offset:36864
v_add_f32 v124, v124, v18
v_mfma_f32_16x16x32_bf16 v[48:51], a[220:223], a[176:179], v[96:99]
v_exp_f32 v26, v26
v_mfma_f32_16x16x32_bf16 v[48:51], a[216:219], a[144:147], v[48:51]
s_waitcnt lgkmcnt(7)
ds_read_b64_tr_b16 a[252:253], v242 offset:40960
v_cmp_gt_u32 vcc, s47, v135
v_mfma_f32_16x16x32_bf16 v[48:51], a[212:215], a[112:115], v[48:51]
v_exp_f32 v27, v27
v_mfma_f32_16x16x32_bf16 v[48:51], a[208:211], a[80:83], v[48:51]
s_waitcnt lgkmcnt(7)
ds_read_b64_tr_b16 a[254:255], v242 offset:45056
v_add_f32 v124, v124, v19
v_mfma_f32_16x16x32_bf16 a[12:15], a[224:227], v[76:79], a[12:15]
s_cbranch_vccnz k1_y16_s
k1_y16_b:
v_exp_f32 v4, v4
v_mfma_f32_16x16x32_bf16 a[12:15], a[228:231], v[92:95], a[12:15]
ds_read_b128 a[192:195], v235 offset:0
v_cvt_pk_bf16_f32 v139, v18, v19
v_mfma_f32_16x16x32_bf16 a[8:11], a[228:231], v[88:91], a[8:11]
s_add_u32 m0, s65, 32768
v_exp_f32 v5, v5
v_mfma_f32_16x16x32_bf16 a[8:11], a[224:227], v[72:75], a[8:11]
buffer_load_dwordx4 v224, s[20:23], s63 offen offset:0 lds
v_mfma_f32_16x16x32_bf16 a[4:7], a[224:227], v[68:71], a[4:7]
v_exp_f32 v12, v12
v_mfma_f32_16x16x32_bf16 a[4:7], a[228:231], v[84:87], a[4:7]
ds_read_b128 a[196:199], v236 offset:0
v_cvt_pk_bf16_f32 v147, v26, v27
v_mfma_f32_16x16x32_bf16 a[0:3], a[228:231], v[80:83], a[0:3]
v_exp_f32 v13, v13
v_mfma_f32_16x16x32_bf16 a[0:3], a[224:227], v[64:67], a[0:3]
buffer_store_dword v186, v232, s[36:39], s75 offen sc1
v_mfma_f32_16x16x32_bf16 a[16:19], a[232:235], v[64:67], a[16:19]
v_exp_f32 v6, v6
v_mfma_f32_16x16x32_bf16 a[16:19], a[236:239], v[80:83], a[16:19]
ds_read_b128 a[200:203], v237 offset:0
v_add_f32 v125, v125, v4
v_mfma_f32_16x16x32_bf16 a[20:23], a[236:239], v[84:87], a[20:23]
v_exp_f32 v7, v7
v_mfma_f32_16x16x32_bf16 a[20:23], a[232:235], v[68:71], a[20:23]
buffer_load_dwordx4 v225, s[20:23], s63 offen offset:1024 lds
v_mfma_f32_16x16x32_bf16 a[24:27], a[232:235], v[72:75], a[24:27]
v_exp_f32 v14, v14
v_mfma_f32_16x16x32_bf16 a[24:27], a[236:239], v[88:91], a[24:27]
ds_read_b128 a[204:207], v238 offset:0
v_add_f32 v125, v125, v5
v_mfma_f32_16x16x32_bf16 a[28:31], a[236:239], v[92:95], a[28:31]
v_exp_f32 v15, v15
v_mfma_f32_16x16x32_bf16 a[28:31], a[232:235], v[76:79], a[28:31]
s_waitcnt lgkmcnt(4)
v_cvt_pk_bf16_f32 v140, v4, v5
v_cvt_pk_bf16_f32 v148, v12, v13
v_mfma_f32_16x16x32_bf16 a[44:47], a[240:243], v[76:79], a[44:47]
v_exp_f32 v20, v20
v_mfma_f32_16x16x32_bf16 a[44:47], a[244:247], v[92:95], a[44:47]
ds_read_b128 a[208:211], v235 offset:4096
v_add_f32 v125, v125, v6
v_mfma_f32_16x16x32_bf16 a[40:43], a[244:247], v[88:91], a[40:43]
v_exp_f32 v21, v21
v_mfma_f32_16x16x32_bf16 a[40:43], a[240:243], v[72:75], a[40:43]
buffer_load_dwordx4 v226, s[20:23], s63 offen offset:2048 lds
v_mfma_f32_16x16x32_bf16 a[36:39], a[240:243], v[68:71], a[36:39]
v_exp_f32 v28, v28
v_mfma_f32_16x16x32_bf16 a[36:39], a[244:247], v[84:87], a[36:39]
ds_read_b128 a[212:215], v236 offset:4096
v_add_f32 v125, v125, v7
v_mfma_f32_16x16x32_bf16 a[32:35], a[244:247], v[80:83], a[32:35]
v_exp_f32 v29, v29
v_mfma_f32_16x16x32_bf16 a[32:35], a[240:243], v[64:67], a[32:35]
v_cvt_pk_bf16_f32 v141, v6, v7
v_cvt_pk_bf16_f32 v149, v14, v15
v_mfma_f32_16x16x32_bf16 a[48:51], a[248:251], v[64:67], a[48:51]
v_exp_f32 v22, v22
v_mfma_f32_16x16x32_bf16 a[48:51], a[252:255], v[80:83], a[48:51]
ds_read_b128 a[216:219], v237 offset:4096
v_add_f32 v125, v125, v20
v_mfma_f32_16x16x32_bf16 a[52:55], a[252:255], v[84:87], a[52:55]
v_exp_f32 v23, v23
v_mfma_f32_16x16x32_bf16 a[52:55], a[248:251], v[68:71], a[52:55]
buffer_load_dwordx4 v227, s[20:23], s63 offen offset:3072 lds
v_mfma_f32_16x16x32_bf16 a[56:59], a[248:251], v[72:75], a[56:59]
s_add_u32 s63, s63, 16384
v_exp_f32 v30, v30
v_mfma_f32_16x16x32_bf16 a[56:59], a[252:255], v[88:91], a[56:59]
ds_read_b128 a[220:223], v238 offset:4096
v_add_f32 v125, v125, v21
v_mfma_f32_16x16x32_bf16 a[60:63], a[252:255], v[92:95], a[60:63]
v_exp_f32 v31, v31
v_mfma_f32_16x16x32_bf16 a[60:63], a[248:251], v[76:79], a[60:63]
v_cvt_pk_bf16_f32 v142, v20, v21
v_cvt_pk_bf16_f32 v150, v28, v29
v_mfma_f32_16x16x32_bf16 v[112:115], v[120:123], v[72:75], v[112:115]
v_add_f32 v125, v125, v22
v_add_f32 v125, v125, v23
v_mfma_f32_16x16x32_bf16 v[112:115], v[120:123], v[88:91], v[112:115]
s_waitcnt lgkmcnt(4)
v_cvt_pk_bf16_f32 v143, v22, v23
v_cvt_pk_bf16_f32 v151, v30, v31
v_mfma_f32_16x16x32_bf16 v[0:3], a[192:195], a[80:83], v[96:99]
v_exp_f32 v32, v32
v_mfma_f32_16x16x32_bf16 v[0:3], a[196:199], a[112:115], v[0:3]
ds_read_b64_tr_b16 a[224:225], v243 offset:32768
v_add_f32 v124, v124, v32
v_mfma_f32_16x16x32_bf16 v[0:3], a[200:203], a[144:147], v[0:3]
v_exp_f32 v33, v33
v_mfma_f32_16x16x32_bf16 v[0:3], a[204:207], a[176:179], v[0:3]
ds_read_b64_tr_b16 a[226:227], v243 offset:36864
v_add_f32 v124, v124, v33
v_mfma_f32_16x16x32_bf16 v[4:7], a[204:207], a[180:183], v[100:103]
v_exp_f32 v40, v40
v_mfma_f32_16x16x32_bf16 v[4:7], a[200:203], a[148:151], v[4:7]
ds_read_b64_tr_b16 a[228:229], v243 offset:40960
v_cvt_pk_bf16_f32 v152, v32, v33
v_mfma_f32_16x16x32_bf16 v[4:7], a[196:199], a[116:119], v[4:7]
v_exp_f32 v41, v41
v_mfma_f32_16x16x32_bf16 v[4:7], a[192:195], a[84:87], v[4:7]
ds_read_b64_tr_b16 a[230:231], v243 offset:45056
v_cvt_pk_bf16_f32 v160, v40, v41
v_mfma_f32_16x16x32_bf16 v[8:11], a[192:195], a[88:91], v[104:107]
v_exp_f32 v34, v34
v_mfma_f32_16x16x32_bf16 v[8:11], a[196:199], a[120:123], v[8:11]
ds_read_b64_tr_b16 a[232:233], v244 offset:32768
v_add_f32 v124, v124, v34
v_mfma_f32_16x16x32_bf16 v[8:11], a[200:203], a[152:155], v[8:11]
v_exp_f32 v35, v35
v_mfma_f32_16x16x32_bf16 v[8:11], a[204:207], a[184:187], v[8:11]
ds_read_b64_tr_b16 a[234:235], v244 offset:36864
v_add_f32 v124, v124, v35
v_mfma_f32_16x16x32_bf16 v[12:15], a[204:207], a[188:191], v[108:111]
v_exp_f32 v42, v42
v_mfma_f32_16x16x32_bf16 v[12:15], a[200:203], a[156:159], v[12:15]
ds_read_b64_tr_b16 a[236:237], v244 offset:40960
v_cvt_pk_bf16_f32 v153, v34, v35
v_mfma_f32_16x16x32_bf16 v[12:15], a[196:199], a[124:127], v[12:15]
v_exp_f32 v43, v43
v_mfma_f32_16x16x32_bf16 v[12:15], a[192:195], a[92:95], v[12:15]
s_waitcnt lgkmcnt(7)
ds_read_b64_tr_b16 a[238:239], v244 offset:45056
v_cvt_pk_bf16_f32 v161, v42, v43
v_mfma_f32_16x16x32_bf16 v[28:31], a[208:211], a[92:95], v[108:111]
v_exp_f32 v48, v48
v_mfma_f32_16x16x32_bf16 v[28:31], a[212:215], a[124:127], v[28:31]
ds_read_b64_tr_b16 a[240:241], v245 offset:32768
v_add_f32 v124, v124, v48
v_mfma_f32_16x16x32_bf16 v[28:31], a[216:219], a[156:159], v[28:31]
v_exp_f32 v49, v49
v_mfma_f32_16x16x32_bf16 v[28:31], a[220:223], a[188:191], v[28:31]
ds_read_b64_tr_b16 a[242:243], v245 offset:36864
v_add_f32 v124, v124, v49
v_mfma_f32_16x16x32_bf16 v[24:27], a[220:223], a[184:187], v[104:107]
v_exp_f32 v56, v56
v_mfma_f32_16x16x32_bf16 v[24:27], a[216:219], a[152:155], v[24:27]
ds_read_b64_tr_b16 a[244:245], v245 offset:40960
v_cvt_pk_bf16_f32 v154, v48, v49
v_mfma_f32_16x16x32_bf16 v[24:27], a[212:215], a[120:123], v[24:27]
v_exp_f32 v57, v57
v_mfma_f32_16x16x32_bf16 v[24:27], a[208:211], a[88:91], v[24:27]
ds_read_b64_tr_b16 a[246:247], v245 offset:45056
v_cvt_pk_bf16_f32 v162, v56, v57
v_mfma_f32_16x16x32_bf16 v[20:23], a[208:211], a[84:87], v[100:103]
v_exp_f32 v50, v50
v_mfma_f32_16x16x32_bf16 v[20:23], a[212:215], a[116:119], v[20:23]
ds_read_b64_tr_b16 a[248:249], v246 offset:32768
v_add_f32 v124, v124, v50
v_mfma_f32_16x16x32_bf16 v[20:23], a[216:219], a[148:151], v[20:23]
v_exp_f32 v51, v51
v_mfma_f32_16x16x32_bf16 v[20:23], a[220:223], a[180:183], v[20:23]
ds_read_b64_tr_b16 a[250:251], v246 offset:36864
v_add_f32 v124, v124, v51
v_mfma_f32_16x16x32_bf16 v[16:19], a[220:223], a[176:179], v[96:99]
v_exp_f32 v58, v58
v_mfma_f32_16x16x32_bf16 v[16:19], a[216:219], a[144:147], v[16:19]
ds_read_b64_tr_b16 a[252:253], v246 offset:40960
v_cvt_pk_bf16_f32 v155, v50, v51
v_mfma_f32_16x16x32_bf16 v[16:19], a[212:215], a[112:115], v[16:19]
v_exp_f32 v59, v59
v_mfma_f32_16x16x32_bf16 v[16:19], a[208:211], a[80:83], v[16:19]
s_waitcnt lgkmcnt(7)
ds_read_b64_tr_b16 a[254:255], v246 offset:45056
v_cvt_pk_bf16_f32 v163, v58, v59
v_mfma_f32_16x16x32_bf16 a[76:79], a[224:227], v[76:79], a[76:79]
v_exp_f32 v36, v36
v_mfma_f32_16x16x32_bf16 a[76:79], a[228:231], v[92:95], a[76:79]
ds_read_b128 a[192:195], v235 offset:8192
v_add_f32 v125, v125, v36
v_mfma_f32_16x16x32_bf16 a[72:75], a[228:231], v[88:91], a[72:75]
s_add_u32 m0, s65, 81920
v_exp_f32 v37, v37
v_mfma_f32_16x16x32_bf16 a[72:75], a[224:227], v[72:75], a[72:75]
buffer_load_dwordx4 v228, s[24:27], s64 offen offset:0 lds
v_mfma_f32_16x16x32_bf16 a[68:71], a[224:227], v[68:71], a[68:71]
v_exp_f32 v44, v44
v_mfma_f32_16x16x32_bf16 a[68:71], a[228:231], v[84:87], a[68:71]
ds_read_b128 a[196:199], v236 offset:8192
v_add_f32 v125, v125, v37
v_mfma_f32_16x16x32_bf16 a[64:67], a[228:231], v[80:83], a[64:67]
v_exp_f32 v45, v45
v_mfma_f32_16x16x32_bf16 a[64:67], a[224:227], v[64:67], a[64:67]
v_cvt_pk_bf16_f32 v156, v36, v37
v_cvt_pk_bf16_f32 v164, v44, v45
v_mfma_f32_16x16x32_bf16 a[96:99], a[232:235], v[64:67], a[96:99]
v_exp_f32 v38, v38
v_mfma_f32_16x16x32_bf16 a[96:99], a[236:239], v[80:83], a[96:99]
ds_read_b128 a[200:203], v237 offset:8192
v_add_f32 v125, v125, v38
v_mfma_f32_16x16x32_bf16 a[100:103], a[236:239], v[84:87], a[100:103]
v_exp_f32 v39, v39
v_mfma_f32_16x16x32_bf16 a[100:103], a[232:235], v[68:71], a[100:103]
buffer_load_dwordx4 v229, s[24:27], s64 offen offset:1024 lds
v_mfma_f32_16x16x32_bf16 a[104:107], a[232:235], v[72:75], a[104:107]
v_exp_f32 v46, v46
v_mfma_f32_16x16x32_bf16 a[104:107], a[236:239], v[88:91], a[104:107]
ds_read_b128 a[204:207], v238 offset:8192
v_add_f32 v125, v125, v39
v_mfma_f32_16x16x32_bf16 a[108:111], a[236:239], v[92:95], a[108:111]
v_exp_f32 v47, v47
v_mfma_f32_16x16x32_bf16 a[108:111], a[232:235], v[76:79], a[108:111]
s_waitcnt lgkmcnt(4)
v_cvt_pk_bf16_f32 v157, v38, v39
v_cvt_pk_bf16_f32 v165, v46, v47
v_mfma_f32_16x16x32_bf16 a[140:143], a[240:243], v[76:79], a[140:143]
v_exp_f32 v52, v52
v_mfma_f32_16x16x32_bf16 a[140:143], a[244:247], v[92:95], a[140:143]
ds_read_b128 a[208:211], v235 offset:12288
v_add_f32 v125, v125, v52
v_mfma_f32_16x16x32_bf16 a[136:139], a[244:247], v[88:91], a[136:139]
v_exp_f32 v53, v53
v_mfma_f32_16x16x32_bf16 a[136:139], a[240:243], v[72:75], a[136:139]
buffer_load_dwordx4 v228, s[24:27], s64 offen offset:2048 lds
v_mfma_f32_16x16x32_bf16 a[132:135], a[240:243], v[68:71], a[132:135]
v_exp_f32 v60, v60
v_mfma_f32_16x16x32_bf16 a[132:135], a[244:247], v[84:87], a[132:135]
ds_read_b128 a[212:215], v236 offset:12288
v_add_f32 v125, v125, v53
v_mfma_f32_16x16x32_bf16 a[128:131], a[244:247], v[80:83], a[128:131]
v_exp_f32 v61, v61
v_mfma_f32_16x16x32_bf16 a[128:131], a[240:243], v[64:67], a[128:131]
v_cvt_pk_bf16_f32 v158, v52, v53
v_cvt_pk_bf16_f32 v166, v60, v61
v_mfma_f32_16x16x32_bf16 a[160:163], a[248:251], v[64:67], a[160:163]
s_waitcnt vmcnt(8)
v_exp_f32 v54, v54
v_mfma_f32_16x16x32_bf16 a[160:163], a[252:255], v[80:83], a[160:163]
ds_read_b128 a[216:219], v237 offset:12288
ds_add_u32 v132, v134
v_mfma_f32_16x16x32_bf16 a[164:167], a[252:255], v[84:87], a[164:167]
v_exp_f32 v55, v55
v_mfma_f32_16x16x32_bf16 a[164:167], a[248:251], v[68:71], a[164:167]
buffer_load_dwordx4 v229, s[24:27], s64 offen offset:3072 lds
v_mfma_f32_16x16x32_bf16 a[168:171], a[248:251], v[72:75], a[168:171]
s_add_u32 s64, s64, 16384
v_exp_f32 v62, v62
v_mfma_f32_16x16x32_bf16 a[168:171], a[252:255], v[88:91], a[168:171]
ds_read_b128 a[220:223], v238 offset:12288
v_add_f32 v125, v125, v54
v_mfma_f32_16x16x32_bf16 a[172:175], a[252:255], v[92:95], a[172:175]
s_add_u32 s47, s47, 1
v_exp_f32 v63, v63
v_mfma_f32_16x16x32_bf16 a[172:175], a[248:251], v[76:79], a[172:175]
v_add_f32 v125, v125, v55
v_cvt_pk_bf16_f32 v159, v54, v55
v_mfma_f32_16x16x32_bf16 v[116:119], v[120:123], v[76:79], v[116:119]
v_cvt_pk_bf16_f32 v167, v62, v63
v_mfma_f32_16x16x32_bf16 v[116:119], v[120:123], v[92:95], v[116:119]
s_waitcnt lgkmcnt(5)
v_mfma_f32_16x16x32_bf16 v[32:35], a[192:195], a[80:83], v[96:99]
v_exp_f32 v0, v0
v_mfma_f32_16x16x32_bf16 v[32:35], a[196:199], a[112:115], v[32:35]
ds_read_b64_tr_b16 a[224:225], v239 offset:49152
v_add_f32 v124, v124, v0
v_mfma_f32_16x16x32_bf16 v[32:35], a[200:203], a[144:147], v[32:35]
v_exp_f32 v1, v1
v_mfma_f32_16x16x32_bf16 v[32:35], a[204:207], a[176:179], v[32:35]
ds_read_b64_tr_b16 a[226:227], v239 offset:53248
v_add_f32 v124, v124, v1
v_mfma_f32_16x16x32_bf16 v[36:39], a[204:207], a[180:183], v[100:103]
v_exp_f32 v8, v8
v_mfma_f32_16x16x32_bf16 v[36:39], a[200:203], a[148:151], v[36:39]
ds_read_b64_tr_b16 a[228:229], v239 offset:57344
v_cvt_pk_bf16_f32 v64, v0, v1
v_mfma_f32_16x16x32_bf16 v[36:39], a[196:199], a[116:119], v[36:39]
v_exp_f32 v9, v9
v_mfma_f32_16x16x32_bf16 v[36:39], a[192:195], a[84:87], v[36:39]
ds_read_b64_tr_b16 a[230:231], v239 offset:61440
v_cvt_pk_bf16_f32 v72, v8, v9
v_mfma_f32_16x16x32_bf16 v[40:43], a[192:195], a[88:91], v[104:107]
v_exp_f32 v2, v2
v_mfma_f32_16x16x32_bf16 v[40:43], a[196:199], a[120:123], v[40:43]
ds_read_b64_tr_b16 a[232:233], v240 offset:49152
v_add_f32 v124, v124, v2
v_mfma_f32_16x16x32_bf16 v[40:43], a[200:203], a[152:155], v[40:43]
v_exp_f32 v3, v3
v_mfma_f32_16x16x32_bf16 v[40:43], a[204:207], a[184:187], v[40:43]
ds_read_b64_tr_b16 a[234:235], v240 offset:53248
v_add_f32 v124, v124, v3
v_mfma_f32_16x16x32_bf16 v[44:47], a[204:207], a[188:191], v[108:111]
v_exp_f32 v10, v10
v_mfma_f32_16x16x32_bf16 v[44:47], a[200:203], a[156:159], v[44:47]
ds_read_b64_tr_b16 a[236:237], v240 offset:57344
ds_read_b32 v135, v133
v_mfma_f32_16x16x32_bf16 v[44:47], a[196:199], a[124:127], v[44:47]
v_exp_f32 v11, v11
v_mfma_f32_16x16x32_bf16 v[44:47], a[192:195], a[92:95], v[44:47]
s_waitcnt lgkmcnt(8)
ds_read_b64_tr_b16 a[238:239], v240 offset:61440
v_cvt_pk_bf16_f32 v65, v2, v3
v_mfma_f32_16x16x32_bf16 v[60:63], a[208:211], a[92:95], v[108:111]
v_exp_f32 v16, v16
v_mfma_f32_16x16x32_bf16 v[60:63], a[212:215], a[124:127], v[60:63]
ds_read_b64_tr_b16 a[240:241], v241 offset:49152
v_cvt_pk_bf16_f32 v73, v10, v11
v_mfma_f32_16x16x32_bf16 v[60:63], a[216:219], a[156:159], v[60:63]
v_exp_f32 v17, v17
v_mfma_f32_16x16x32_bf16 v[60:63], a[220:223], a[188:191], v[60:63]
ds_read_b64_tr_b16 a[242:243], v241 offset:53248
v_add_f32 v124, v124, v16
v_mfma_f32_16x16x32_bf16 v[56:59], a[220:223], a[184:187], v[104:107]
v_exp_f32 v24, v24
v_mfma_f32_16x16x32_bf16 v[56:59], a[216:219], a[152:155], v[56:59]
ds_read_b64_tr_b16 a[244:245], v241 offset:57344
v_add_f32 v124, v124, v17
v_mfma_f32_16x16x32_bf16 v[56:59], a[212:215], a[120:123], v[56:59]
v_exp_f32 v25, v25
v_mfma_f32_16x16x32_bf16 v[56:59], a[208:211], a[88:91], v[56:59]
ds_read_b64_tr_b16 a[246:247], v241 offset:61440
v_cvt_pk_bf16_f32 v66, v16, v17
v_mfma_f32_16x16x32_bf16 v[52:55], a[208:211], a[84:87], v[100:103]
v_exp_f32 v18, v18
v_mfma_f32_16x16x32_bf16 v[52:55], a[212:215], a[116:119], v[52:55]
ds_read_b64_tr_b16 a[248:249], v242 offset:49152
v_cvt_pk_bf16_f32 v74, v24, v25
v_mfma_f32_16x16x32_bf16 v[52:55], a[216:219], a[148:151], v[52:55]
v_exp_f32 v19, v19
v_mfma_f32_16x16x32_bf16 v[52:55], a[220:223], a[180:183], v[52:55]
ds_read_b64_tr_b16 a[250:251], v242 offset:53248
v_add_f32 v124, v124, v18
v_mfma_f32_16x16x32_bf16 v[48:51], a[220:223], a[176:179], v[96:99]
v_exp_f32 v26, v26
v_mfma_f32_16x16x32_bf16 v[48:51], a[216:219], a[144:147], v[48:51]
s_waitcnt lgkmcnt(7)
ds_read_b64_tr_b16 a[252:253], v242 offset:57344
v_cmp_gt_u32 vcc, s47, v135
v_mfma_f32_16x16x32_bf16 v[48:51], a[212:215], a[112:115], v[48:51]
v_exp_f32 v27, v27
v_mfma_f32_16x16x32_bf16 v[48:51], a[208:211], a[80:83], v[48:51]
s_waitcnt lgkmcnt(7)
ds_read_b64_tr_b16 a[254:255], v242 offset:61440
v_add_f32 v124, v124, v19
v_mfma_f32_16x16x32_bf16 a[12:15], a[224:227], v[148:151], a[12:15]
s_cbranch_vccnz k1_y10_s
k1_y10_b:
v_exp_f32 v4, v4
v_mfma_f32_16x16x32_bf16 a[12:15], a[228:231], v[164:167], a[12:15]
ds_read_b128 a[192:195], v235 offset:16384
v_cvt_pk_bf16_f32 v67, v18, v19
v_mfma_f32_16x16x32_bf16 a[8:11], a[228:231], v[160:163], a[8:11]
s_add_u32 m0, s65, 49152
v_exp_f32 v5, v5
v_mfma_f32_16x16x32_bf16 a[8:11], a[224:227], v[144:147], a[8:11]
buffer_load_dwordx4 v224, s[20:23], s63 offen offset:0 lds
v_mfma_f32_16x16x32_bf16 a[4:7], a[224:227], v[140:143], a[4:7]
v_exp_f32 v12, v12
v_mfma_f32_16x16x32_bf16 a[4:7], a[228:231], v[156:159], a[4:7]
ds_read_b128 a[196:199], v236 offset:16384
v_cvt_pk_bf16_f32 v75, v26, v27
v_mfma_f32_16x16x32_bf16 a[0:3], a[228:231], v[152:155], a[0:3]
v_exp_f32 v13, v13
v_mfma_f32_16x16x32_bf16 a[0:3], a[224:227], v[136:139], a[0:3]
v_add_f32 v125, v125, v4
v_add_f32 v125, v125, v5
v_mfma_f32_16x16x32_bf16 a[16:19], a[232:235], v[136:139], a[16:19]
v_exp_f32 v6, v6
v_mfma_f32_16x16x32_bf16 a[16:19], a[236:239], v[152:155], a[16:19]
ds_read_b128 a[200:203], v237 offset:16384
v_cvt_pk_bf16_f32 v68, v4, v5
v_mfma_f32_16x16x32_bf16 a[20:23], a[236:239], v[156:159], a[20:23]
v_exp_f32 v7, v7
v_mfma_f32_16x16x32_bf16 a[20:23], a[232:235], v[140:143], a[20:23]
buffer_load_dwordx4 v225, s[20:23], s63 offen offset:1024 lds
v_mfma_f32_16x16x32_bf16 a[24:27], a[232:235], v[144:147], a[24:27]
v_exp_f32 v14, v14
v_mfma_f32_16x16x32_bf16 a[24:27], a[236:239], v[160:163], a[24:27]
ds_read_b128 a[204:207], v238 offset:16384
v_cvt_pk_bf16_f32 v76, v12, v13
v_mfma_f32_16x16x32_bf16 a[28:31], a[236:239], v[164:167], a[28:31]
v_exp_f32 v15, v15
v_mfma_f32_16x16x32_bf16 a[28:31], a[232:235], v[148:151], a[28:31]
s_waitcnt lgkmcnt(4)
v_add_f32 v125, v125, v6
v_add_f32 v125, v125, v7
v_mfma_f32_16x16x32_bf16 a[44:47], a[240:243], v[148:151], a[44:47]
v_exp_f32 v20, v20
v_mfma_f32_16x16x32_bf16 a[44:47], a[244:247], v[164:167], a[44:47]
ds_read_b128 a[208:211], v235 offset:20480
v_cvt_pk_bf16_f32 v69, v6, v7
v_mfma_f32_16x16x32_bf16 a[40:43], a[244:247], v[160:163], a[40:43]
v_exp_f32 v21, v21
v_mfma_f32_16x16x32_bf16 a[40:43], a[240:243], v[144:147], a[40:43]
buffer_load_dwordx4 v226, s[20:23], s63 offen offset:2048 lds
v_mfma_f32_16x16x32_bf16 a[36:39], a[240:243], v[140:143], a[36:39]
v_exp_f32 v28, v28
v_mfma_f32_16x16x32_bf16 a[36:39], a[244:247], v[156:159], a[36:39]
ds_read_b128 a[212:215], v236 offset:20480
v_cvt_pk_bf16_f32 v77, v14, v15
v_mfma_f32_16x16x32_bf16 a[32:35], a[244:247], v[152:155], a[32:35]
v_exp_f32 v29, v29
v_mfma_f32_16x16x32_bf16 a[32:35], a[240:243], v[136:139], a[32:35]
v_add_f32 v125, v125, v20
v_add_f32 v125, v125, v21
v_mfma_f32_16x16x32_bf16 a[48:51], a[248:251], v[136:139], a[48:51]
v_exp_f32 v22, v22
v_mfma_f32_16x16x32_bf16 a[48:51], a[252:255], v[152:155], a[48:51]
ds_read_b128 a[216:219], v237 offset:20480
v_cvt_pk_bf16_f32 v70, v20, v21
v_mfma_f32_16x16x32_bf16 a[52:55], a[252:255], v[156:159], a[52:55]
v_exp_f32 v23, v23
v_mfma_f32_16x16x32_bf16 a[52:55], a[248:251], v[140:143], a[52:55]
buffer_load_dwordx4 v227, s[20:23], s63 offen offset:3072 lds
v_mfma_f32_16x16x32_bf16 a[56:59], a[248:251], v[144:147], a[56:59]
s_add_u32 s63, s63, 16384
v_exp_f32 v30, v30
v_mfma_f32_16x16x32_bf16 a[56:59], a[252:255], v[160:163], a[56:59]
ds_read_b128 a[220:223], v238 offset:20480
v_cvt_pk_bf16_f32 v78, v28, v29
v_mfma_f32_16x16x32_bf16 a[60:63], a[252:255], v[164:167], a[60:63]
v_exp_f32 v31, v31
v_mfma_f32_16x16x32_bf16 a[60:63], a[248:251], v[148:151], a[60:63]
v_add_f32 v125, v125, v22
v_add_f32 v125, v125, v23
v_mfma_f32_16x16x32_bf16 v[112:115], v[120:123], v[144:147], v[112:115]
v_cvt_pk_bf16_f32 v71, v22, v23
v_cvt_pk_bf16_f32 v79, v30, v31
v_mfma_f32_16x16x32_bf16 v[112:115], v[120:123], v[160:163], v[112:115]
s_waitcnt lgkmcnt(4)
v_mfma_f32_16x16x32_bf16 v[0:3], a[192:195], a[80:83], v[96:99]
v_exp_f32 v32, v32
v_mfma_f32_16x16x32_bf16 v[0:3], a[196:199], a[112:115], v[0:3]
ds_read_b64_tr_b16 a[224:225], v243 offset:49152
v_add_f32 v124, v124, v32
v_mfma_f32_16x16x32_bf16 v[0:3], a[200:203], a[144:147], v[0:3]
v_exp_f32 v33, v33
v_mfma_f32_16x16x32_bf16 v[0:3], a[204:207], a[176:179], v[0:3]
ds_read_b64_tr_b16 a[226:227], v243 offset:53248
v_add_f32 v124, v124, v33
v_mfma_f32_16x16x32_bf16 v[4:7], a[204:207], a[180:183], v[100:103]
v_exp_f32 v40, v40
v_mfma_f32_16x16x32_bf16 v[4:7], a[200:203], a[148:151], v[4:7]
ds_read_b64_tr_b16 a[228:229], v243 offset:57344
v_cvt_pk_bf16_f32 v80, v32, v33
v_mfma_f32_16x16x32_bf16 v[4:7], a[196:199], a[116:119], v[4:7]
v_exp_f32 v41, v41
v_mfma_f32_16x16x32_bf16 v[4:7], a[192:195], a[84:87], v[4:7]
ds_read_b64_tr_b16 a[230:231], v243 offset:61440
v_cvt_pk_bf16_f32 v88, v40, v41
v_mfma_f32_16x16x32_bf16 v[8:11], a[192:195], a[88:91], v[104:107]
v_exp_f32 v34, v34
v_mfma_f32_16x16x32_bf16 v[8:11], a[196:199], a[120:123], v[8:11]
ds_read_b64_tr_b16 a[232:233], v244 offset:49152
v_add_f32 v124, v124, v34
v_mfma_f32_16x16x32_bf16 v[8:11], a[200:203], a[152:155], v[8:11]
v_exp_f32 v35, v35
v_mfma_f32_16x16x32_bf16 v[8:11], a[204:207], a[184:187], v[8:11]
ds_read_b64_tr_b16 a[234:235], v244 offset:53248
v_add_f32 v124, v124, v35
v_mfma_f32_16x16x32_bf16 v[12:15], a[204:207], a[188:191], v[108:111]
v_exp_f32 v42, v42
v_mfma_f32_16x16x32_bf16 v[12:15], a[200:203], a[156:159], v[12:15]
ds_read_b64_tr_b16 a[236:237], v244 offset:57344
v_cvt_pk_bf16_f32 v81, v34, v35
v_mfma_f32_16x16x32_bf16 v[12:15], a[196:199], a[124:127], v[12:15]
v_exp_f32 v43, v43
v_mfma_f32_16x16x32_bf16 v[12:15], a[192:195], a[92:95], v[12:15]
s_waitcnt lgkmcnt(7)
ds_read_b64_tr_b16 a[238:239], v244 offset:61440
v_cvt_pk_bf16_f32 v89, v42, v43
v_mfma_f32_16x16x32_bf16 v[28:31], a[208:211], a[92:95], v[108:111]
v_exp_f32 v48, v48
v_mfma_f32_16x16x32_bf16 v[28:31], a[212:215], a[124:127], v[28:31]
ds_read_b64_tr_b16 a[240:241], v245 offset:49152
v_add_f32 v124, v124, v48
v_mfma_f32_16x16x32_bf16 v[28:31], a[216:219], a[156:159], v[28:31]
v_exp_f32 v49, v49
v_mfma_f32_16x16x32_bf16 v[28:31], a[220:223], a[188:191], v[28:31]
ds_read_b64_tr_b16 a[242:243], v245 offset:53248
v_add_f32 v124, v124, v49
v_mfma_f32_16x16x32_bf16 v[24:27], a[220:223], a[184:187], v[104:107]
v_exp_f32 v56, v56
v_mfma_f32_16x16x32_bf16 v[24:27], a[216:219], a[152:155], v[24:27]
ds_read_b64_tr_b16 a[244:245], v245 offset:57344
v_cvt_pk_bf16_f32 v82, v48, v49
v_mfma_f32_16x16x32_bf16 v[24:27], a[212:215], a[120:123], v[24:27]
v_exp_f32 v57, v57
v_mfma_f32_16x16x32_bf16 v[24:27], a[208:211], a[88:91], v[24:27]
ds_read_b64_tr_b16 a[246:247], v245 offset:61440
v_cvt_pk_bf16_f32 v90, v56, v57
v_mfma_f32_16x16x32_bf16 v[20:23], a[208:211], a[84:87], v[100:103]
v_exp_f32 v50, v50
v_mfma_f32_16x16x32_bf16 v[20:23], a[212:215], a[116:119], v[20:23]
ds_read_b64_tr_b16 a[248:249], v246 offset:49152
v_add_f32 v124, v124, v50
v_mfma_f32_16x16x32_bf16 v[20:23], a[216:219], a[148:151], v[20:23]
v_exp_f32 v51, v51
v_mfma_f32_16x16x32_bf16 v[20:23], a[220:223], a[180:183], v[20:23]
ds_read_b64_tr_b16 a[250:251], v246 offset:53248
v_add_f32 v124, v124, v51
v_mfma_f32_16x16x32_bf16 v[16:19], a[220:223], a[176:179], v[96:99]
v_exp_f32 v58, v58
v_mfma_f32_16x16x32_bf16 v[16:19], a[216:219], a[144:147], v[16:19]
ds_read_b64_tr_b16 a[252:253], v246 offset:57344
v_cvt_pk_bf16_f32 v83, v50, v51
v_mfma_f32_16x16x32_bf16 v[16:19], a[212:215], a[112:115], v[16:19]
v_exp_f32 v59, v59
v_mfma_f32_16x16x32_bf16 v[16:19], a[208:211], a[80:83], v[16:19]
s_waitcnt lgkmcnt(7)
ds_read_b64_tr_b16 a[254:255], v246 offset:61440
v_cvt_pk_bf16_f32 v91, v58, v59
v_mfma_f32_16x16x32_bf16 a[76:79], a[224:227], v[148:151], a[76:79]
v_exp_f32 v36, v36
v_mfma_f32_16x16x32_bf16 a[76:79], a[228:231], v[164:167], a[76:79]
ds_read_b128 a[192:195], v235 offset:24576
v_add_f32 v125, v125, v36
v_mfma_f32_16x16x32_bf16 a[72:75], a[228:231], v[160:163], a[72:75]
s_add_u32 m0, s65, 98304
v_exp_f32 v37, v37
v_mfma_f32_16x16x32_bf16 a[72:75], a[224:227], v[144:147], a[72:75]
buffer_load_dwordx4 v228, s[24:27], s64 offen offset:0 lds
v_mfma_f32_16x16x32_bf16 a[68:71], a[224:227], v[140:143], a[68:71]
v_exp_f32 v44, v44
v_mfma_f32_16x16x32_bf16 a[68:71], a[228:231], v[156:159], a[68:71]
ds_read_b128 a[196:199], v236 offset:24576
v_add_f32 v125, v125, v37
v_mfma_f32_16x16x32_bf16 a[64:67], a[228:231], v[152:155], a[64:67]
v_exp_f32 v45, v45
v_mfma_f32_16x16x32_bf16 a[64:67], a[224:227], v[136:139], a[64:67]
v_cvt_pk_bf16_f32 v84, v36, v37
v_cvt_pk_bf16_f32 v92, v44, v45
v_mfma_f32_16x16x32_bf16 a[96:99], a[232:235], v[136:139], a[96:99]
v_exp_f32 v38, v38
v_mfma_f32_16x16x32_bf16 a[96:99], a[236:239], v[152:155], a[96:99]
ds_read_b128 a[200:203], v237 offset:24576
v_add_f32 v125, v125, v38
v_mfma_f32_16x16x32_bf16 a[100:103], a[236:239], v[156:159], a[100:103]
v_exp_f32 v39, v39
v_mfma_f32_16x16x32_bf16 a[100:103], a[232:235], v[140:143], a[100:103]
buffer_load_dwordx4 v229, s[24:27], s64 offen offset:1024 lds
v_mfma_f32_16x16x32_bf16 a[104:107], a[232:235], v[144:147], a[104:107]
v_exp_f32 v46, v46
v_mfma_f32_16x16x32_bf16 a[104:107], a[236:239], v[160:163], a[104:107]
ds_read_b128 a[204:207], v238 offset:24576
v_add_f32 v125, v125, v39
v_mfma_f32_16x16x32_bf16 a[108:111], a[236:239], v[164:167], a[108:111]
v_exp_f32 v47, v47
v_mfma_f32_16x16x32_bf16 a[108:111], a[232:235], v[148:151], a[108:111]
s_waitcnt lgkmcnt(4)
v_cvt_pk_bf16_f32 v85, v38, v39
v_cvt_pk_bf16_f32 v93, v46, v47
v_mfma_f32_16x16x32_bf16 a[140:143], a[240:243], v[148:151], a[140:143]
v_exp_f32 v52, v52
v_mfma_f32_16x16x32_bf16 a[140:143], a[244:247], v[164:167], a[140:143]
ds_read_b128 a[208:211], v235 offset:28672
v_add_f32 v125, v125, v52
v_mfma_f32_16x16x32_bf16 a[136:139], a[244:247], v[160:163], a[136:139]
v_exp_f32 v53, v53
v_mfma_f32_16x16x32_bf16 a[136:139], a[240:243], v[144:147], a[136:139]
buffer_load_dwordx4 v228, s[24:27], s64 offen offset:2048 lds
v_mfma_f32_16x16x32_bf16 a[132:135], a[240:243], v[140:143], a[132:135]
v_exp_f32 v60, v60
v_mfma_f32_16x16x32_bf16 a[132:135], a[244:247], v[156:159], a[132:135]
ds_read_b128 a[212:215], v236 offset:28672
v_add_f32 v125, v125, v53
v_mfma_f32_16x16x32_bf16 a[128:131], a[244:247], v[152:155], a[128:131]
v_exp_f32 v61, v61
v_mfma_f32_16x16x32_bf16 a[128:131], a[240:243], v[136:139], a[128:131]
v_cvt_pk_bf16_f32 v86, v52, v53
v_cvt_pk_bf16_f32 v94, v60, v61
v_mfma_f32_16x16x32_bf16 a[160:163], a[248:251], v[136:139], a[160:163]
s_waitcnt vmcnt(7)
v_exp_f32 v54, v54
v_mfma_f32_16x16x32_bf16 a[160:163], a[252:255], v[152:155], a[160:163]
ds_read_b128 a[216:219], v237 offset:28672
ds_add_u32 v132, v134
v_mfma_f32_16x16x32_bf16 a[164:167], a[252:255], v[156:159], a[164:167]
v_exp_f32 v55, v55
v_mfma_f32_16x16x32_bf16 a[164:167], a[248:251], v[140:143], a[164:167]
buffer_load_dwordx4 v229, s[24:27], s64 offen offset:3072 lds
v_mfma_f32_16x16x32_bf16 a[168:171], a[248:251], v[144:147], a[168:171]
s_add_u32 s64, s64, 16384
v_exp_f32 v62, v62
v_mfma_f32_16x16x32_bf16 a[168:171], a[252:255], v[160:163], a[168:171]
ds_read_b128 a[220:223], v238 offset:28672
v_add_f32 v125, v125, v54
v_mfma_f32_16x16x32_bf16 a[172:175], a[252:255], v[164:167], a[172:175]
s_add_u32 s47, s47, 1
v_exp_f32 v63, v63
v_mfma_f32_16x16x32_bf16 a[172:175], a[248:251], v[148:151], a[172:175]
v_add_f32 v125, v125, v55
v_cvt_pk_bf16_f32 v87, v54, v55
v_mfma_f32_16x16x32_bf16 v[116:119], v[120:123], v[148:151], v[116:119]
v_cvt_pk_bf16_f32 v95, v62, v63
v_mfma_f32_16x16x32_bf16 v[116:119], v[120:123], v[164:167], v[116:119]
s_waitcnt lgkmcnt(5)
s_add_u32 s62, s62, 1
s_cmp_lt_u32 s62, 7
s_cbranch_scc1 k1_bl
k1_tail:
v_mfma_f32_16x16x32_bf16 v[32:35], a[192:195], a[80:83], v[96:99]
s_bfe_u32 s54, s2, 0x20001
v_exp_f32 v0, v0
v_mfma_f32_16x16x32_bf16 v[32:35], a[196:199], a[112:115], v[32:35]
s_bfe_u32 s56, s2, 0x10000
ds_read_b64_tr_b16 a[224:225], v239 offset:0
v_add_f32 v124, v124, v0
v_mfma_f32_16x16x32_bf16 v[32:35], a[200:203], a[144:147], v[32:35]
s_lshl_b32 s56, s56, 3
v_exp_f32 v1, v1
v_mfma_f32_16x16x32_bf16 v[32:35], a[204:207], a[176:179], v[32:35]
s_lshr_b32 s74, s2, 5
ds_read_b64_tr_b16 a[226:227], v239 offset:4096
v_add_f32 v124, v124, v1
v_mfma_f32_16x16x32_bf16 v[36:39], a[204:207], a[180:183], v[100:103]
s_add_u32 s56, s56, s74
v_exp_f32 v8, v8
v_mfma_f32_16x16x32_bf16 v[36:39], a[200:203], a[148:151], v[36:39]
s_bfe_u32 s55, s2, 0x20003
ds_read_b64_tr_b16 a[228:229], v239 offset:8192
v_cvt_pk_bf16_f32 v136, v0, v1
v_mfma_f32_16x16x32_bf16 v[36:39], a[196:199], a[116:119], v[36:39]
s_lshl_b32 s57, s56, 2
v_exp_f32 v9, v9
v_mfma_f32_16x16x32_bf16 v[36:39], a[192:195], a[84:87], v[36:39]
s_add_u32 s57, s57, s55
ds_read_b64_tr_b16 a[230:231], v239 offset:12288
v_cvt_pk_bf16_f32 v144, v8, v9
v_mfma_f32_16x16x32_bf16 v[40:43], a[192:195], a[88:91], v[104:107]
s_lshl_b32 s56, s56, 1
v_exp_f32 v2, v2
v_mfma_f32_16x16x32_bf16 v[40:43], a[196:199], a[120:123], v[40:43]
s_lshr_b32 s74, s3, 1
ds_read_b64_tr_b16 a[232:233], v240 offset:0
v_add_f32 v124, v124, v2
v_mfma_f32_16x16x32_bf16 v[40:43], a[200:203], a[152:155], v[40:43]
s_add_u32 s56, s56, s74
v_exp_f32 v3, v3
v_mfma_f32_16x16x32_bf16 v[40:43], a[204:207], a[184:187], v[40:43]
s_mul_i32 s61, s56, 1114112
ds_read_b64_tr_b16 a[234:235], v240 offset:4096
v_add_f32 v124, v124, v3
v_mfma_f32_16x16x32_bf16 v[44:47], a[204:207], a[188:191], v[108:111]
s_and_b32 s74, s3, 1
v_exp_f32 v10, v10
v_mfma_f32_16x16x32_bf16 v[44:47], a[200:203], a[156:159], v[44:47]
s_lshl_b32 s74, s74, 11
ds_read_b64_tr_b16 a[236:237], v240 offset:8192
v_cvt_pk_bf16_f32 v137, v2, v3
v_mfma_f32_16x16x32_bf16 v[44:47], a[196:199], a[124:127], v[44:47]
s_add_u32 s61, s61, s74
v_exp_f32 v11, v11
v_mfma_f32_16x16x32_bf16 v[44:47], a[192:195], a[92:95], v[44:47]
s_waitcnt lgkmcnt(7)
ds_read_b64_tr_b16 a[238:239], v240 offset:12288
v_cvt_pk_bf16_f32 v145, v10, v11
v_mfma_f32_16x16x32_bf16 v[60:63], a[208:211], a[92:95], v[108:111]
s_lshl_b32 s70, s54, 17
v_exp_f32 v16, v16
v_mfma_f32_16x16x32_bf16 v[60:63], a[212:215], a[124:127], v[60:63]
s_add_u32 s70, s70, s61
ds_read_b64_tr_b16 a[240:241], v241 offset:0
v_add_f32 v124, v124, v16
v_mfma_f32_16x16x32_bf16 v[60:63], a[216:219], a[156:159], v[60:63]
s_mul_i32 s58, s55, 272
v_exp_f32 v17, v17
v_mfma_f32_16x16x32_bf16 v[60:63], a[220:223], a[188:191], v[60:63]
s_add_u32 s58, s58, s3
ds_read_b64_tr_b16 a[242:243], v241 offset:4096
v_add_f32 v124, v124, v17
v_mfma_f32_16x16x32_bf16 v[56:59], a[220:223], a[184:187], v[104:107]
s_mul_i32 s58, s58, 9216
v_exp_f32 v24, v24
v_mfma_f32_16x16x32_bf16 v[56:59], a[216:219], a[152:155], v[56:59]
s_mul_i32 s71, s54, 294912
ds_read_b64_tr_b16 a[244:245], v241 offset:8192
v_cvt_pk_bf16_f32 v138, v16, v17
v_mfma_f32_16x16x32_bf16 v[56:59], a[212:215], a[120:123], v[56:59]
s_add_u32 s71, s71, s58
v_exp_f32 v25, v25
v_mfma_f32_16x16x32_bf16 v[56:59], a[208:211], a[88:91], v[56:59]
s_lshl_b32 s40, s57, 4
ds_read_b64_tr_b16 a[246:247], v241 offset:12288
v_cvt_pk_bf16_f32 v146, v24, v25
v_mfma_f32_16x16x32_bf16 v[52:55], a[208:211], a[84:87], v[100:103]
s_add_u32 s40, s40, s3
v_exp_f32 v18, v18
v_mfma_f32_16x16x32_bf16 v[52:55], a[212:215], a[116:119], v[52:55]
s_mul_i32 s40, s40, 10240
ds_read_b64_tr_b16 a[248:249], v242 offset:0
v_add_f32 v124, v124, v18
v_mfma_f32_16x16x32_bf16 v[52:55], a[216:219], a[148:151], v[52:55]
s_add_u32 s40, s40, 65536
v_exp_f32 v19, v19
v_mfma_f32_16x16x32_bf16 v[52:55], a[220:223], a[180:183], v[52:55]
s_lshr_b32 s73, s54, 1
ds_read_b64_tr_b16 a[250:251], v242 offset:4096
v_add_f32 v124, v124, v19
v_mfma_f32_16x16x32_bf16 v[48:51], a[220:223], a[176:179], v[96:99]
s_mov_b32 s14, 10027008
v_exp_f32 v26, v26
v_mfma_f32_16x16x32_bf16 v[48:51], a[216:219], a[144:147], v[48:51]
s_lshl_b32 s41, s56, 2
ds_read_b64_tr_b16 a[252:253], v242 offset:8192
v_cvt_pk_bf16_f32 v139, v18, v19
v_mfma_f32_16x16x32_bf16 v[48:51], a[212:215], a[112:115], v[48:51]
s_waitcnt vmcnt(8)
v_exp_f32 v27, v27
v_mfma_f32_16x16x32_bf16 v[48:51], a[208:211], a[80:83], v[48:51]
s_waitcnt lgkmcnt(7)
ds_read_b64_tr_b16 a[254:255], v242 offset:12288
v_cvt_pk_bf16_f32 v147, v26, v27
v_mfma_f32_16x16x32_bf16 a[12:15], a[224:227], v[76:79], a[12:15]
s_barrier
v_exp_f32 v4, v4
v_mfma_f32_16x16x32_bf16 a[12:15], a[228:231], v[92:95], a[12:15]
s_and_b32 s74, s3, 1
ds_read_b128 a[192:195], v235 offset:32768
v_add_f32 v125, v125, v4
v_mfma_f32_16x16x32_bf16 a[8:11], a[228:231], v[88:91], a[8:11]
s_lshl_b32 s74, s74, 1
v_exp_f32 v5, v5
v_mfma_f32_16x16x32_bf16 a[8:11], a[224:227], v[72:75], a[8:11]
s_add_u32 s41, s41, s74
v_add_f32 v125, v125, v5
v_cvt_pk_bf16_f32 v140, v4, v5
v_mfma_f32_16x16x32_bf16 a[4:7], a[224:227], v[68:71], a[4:7]
s_and_b32 s74, s54, 1
v_exp_f32 v12, v12
v_mfma_f32_16x16x32_bf16 a[4:7], a[228:231], v[84:87], a[4:7]
s_add_u32 s41, s41, s74
ds_read_b128 a[196:199], v236 offset:32768
v_mfma_f32_16x16x32_bf16 a[0:3], a[228:231], v[80:83], a[0:3]
s_mul_i32 s41, s41, 18432
v_exp_f32 v13, v13
v_mfma_f32_16x16x32_bf16 a[0:3], a[224:227], v[64:67], a[0:3]
s_mul_i32 s74, s55, 288
buffer_load_dwordx4 v[188:191], v234, s[36:39], 0 offen sc1
v_mfma_f32_16x16x32_bf16 a[16:19], a[232:235], v[64:67], a[16:19]
s_add_u32 s41, s41, s74
v_exp_f32 v6, v6
v_mfma_f32_16x16x32_bf16 a[16:19], a[236:239], v[80:83], a[16:19]
s_lshl_b32 s78, s73, 30
ds_read_b128 a[200:203], v237 offset:32768
v_cvt_pk_bf16_f32 v148, v12, v13
v_mfma_f32_16x16x32_bf16 a[20:23], a[236:239], v[84:87], a[20:23]
s_add_u32 s78, s78, s41
v_exp_f32 v7, v7
v_mfma_f32_16x16x32_bf16 a[20:23], a[232:235], v[68:71], a[20:23]
s_mul_i32 s74, s73, 160
v_add_f32 v125, v125, v6
v_add_f32 v125, v125, v7
v_mfma_f32_16x16x32_bf16 a[24:27], a[232:235], v[72:75], a[24:27]
s_add_u32 s41, s41, s74
v_exp_f32 v14, v14
v_mfma_f32_16x16x32_bf16 a[24:27], a[236:239], v[88:91], a[24:27]
s_lshl_b32 s68, s56, 2
ds_read_b128 a[204:207], v238 offset:32768
v_cvt_pk_bf16_f32 v141, v6, v7
v_mfma_f32_16x16x32_bf16 a[28:31], a[236:239], v[92:95], a[28:31]
s_add_u32 s68, s68, s54
v_exp_f32 v15, v15
v_mfma_f32_16x16x32_bf16 a[28:31], a[232:235], v[76:79], a[28:31]
s_waitcnt lgkmcnt(4)
v_cvt_pk_bf16_f32 v149, v14, v15
v_mfma_f32_16x16x32_bf16 a[44:47], a[240:243], v[76:79], a[44:47]
s_add_u32 s68, s68, 64
v_exp_f32 v20, v20
v_mfma_f32_16x16x32_bf16 a[44:47], a[244:247], v[92:95], a[44:47]
s_lshl_b32 s68, s68, 6
ds_read_b128 a[208:211], v235 offset:36864
v_add_f32 v125, v125, v20
v_mfma_f32_16x16x32_bf16 a[40:43], a[244:247], v[88:91], a[40:43]
s_lshl_b32 s69, s57, 2
v_exp_f32 v21, v21
v_mfma_f32_16x16x32_bf16 a[40:43], a[240:243], v[72:75], a[40:43]
s_add_u32 s69, s69, s3
v_add_f32 v125, v125, v21
v_cvt_pk_bf16_f32 v142, v20, v21
v_mfma_f32_16x16x32_bf16 a[36:39], a[240:243], v[68:71], a[36:39]
s_add_u32 s69, s69, 192
v_exp_f32 v28, v28
v_mfma_f32_16x16x32_bf16 a[36:39], a[244:247], v[84:87], a[36:39]
s_lshl_b32 s69, s69, 6
ds_read_b128 a[212:215], v236 offset:36864
v_mfma_f32_16x16x32_bf16 a[32:35], a[244:247], v[80:83], a[32:35]
v_exp_f32 v29, v29
v_mfma_f32_16x16x32_bf16 a[32:35], a[240:243], v[64:67], a[32:35]
v_cvt_pk_bf16_f32 v150, v28, v29
v_mfma_f32_16x16x32_bf16 a[48:51], a[248:251], v[64:67], a[48:51]
v_exp_f32 v22, v22
v_mfma_f32_16x16x32_bf16 a[48:51], a[252:255], v[80:83], a[48:51]
ds_read_b128 a[216:219], v237 offset:36864
v_add_f32 v125, v125, v22
v_mfma_f32_16x16x32_bf16 a[52:55], a[252:255], v[84:87], a[52:55]
v_exp_f32 v23, v23
v_mfma_f32_16x16x32_bf16 a[52:55], a[248:251], v[68:71], a[52:55]
v_add_f32 v125, v125, v23
v_cvt_pk_bf16_f32 v143, v22, v23
v_mfma_f32_16x16x32_bf16 a[56:59], a[248:251], v[72:75], a[56:59]
v_exp_f32 v30, v30
v_mfma_f32_16x16x32_bf16 a[56:59], a[252:255], v[88:91], a[56:59]
ds_read_b128 a[220:223], v238 offset:36864
v_mfma_f32_16x16x32_bf16 a[60:63], a[252:255], v[92:95], a[60:63]
v_exp_f32 v31, v31
v_mfma_f32_16x16x32_bf16 a[60:63], a[248:251], v[76:79], a[60:63]
v_cvt_pk_bf16_f32 v151, v30, v31
v_mfma_f32_16x16x32_bf16 v[112:115], v[120:123], v[72:75], v[112:115]
v_mfma_f32_16x16x32_bf16 v[112:115], v[120:123], v[88:91], v[112:115]
s_waitcnt lgkmcnt(4)
v_mfma_f32_16x16x32_bf16 v[0:3], a[192:195], a[80:83], v[96:99]
v_exp_f32 v32, v32
v_mfma_f32_16x16x32_bf16 v[0:3], a[196:199], a[112:115], v[0:3]
ds_read_b64_tr_b16 a[224:225], v243 offset:0
v_add_f32 v124, v124, v32
v_mfma_f32_16x16x32_bf16 v[0:3], a[200:203], a[144:147], v[0:3]
v_exp_f32 v33, v33
v_mfma_f32_16x16x32_bf16 v[0:3], a[204:207], a[176:179], v[0:3]
ds_read_b64_tr_b16 a[226:227], v243 offset:4096
v_add_f32 v124, v124, v33
v_mfma_f32_16x16x32_bf16 v[4:7], a[204:207], a[180:183], v[100:103]
v_exp_f32 v40, v40
v_mfma_f32_16x16x32_bf16 v[4:7], a[200:203], a[148:151], v[4:7]
ds_read_b64_tr_b16 a[228:229], v243 offset:8192
v_cvt_pk_bf16_f32 v152, v32, v33
v_mfma_f32_16x16x32_bf16 v[4:7], a[196:199], a[116:119], v[4:7]
v_exp_f32 v41, v41
v_mfma_f32_16x16x32_bf16 v[4:7], a[192:195], a[84:87], v[4:7]
ds_read_b64_tr_b16 a[230:231], v243 offset:12288
v_cvt_pk_bf16_f32 v160, v40, v41
v_mfma_f32_16x16x32_bf16 v[8:11], a[192:195], a[88:91], v[104:107]
v_exp_f32 v34, v34
v_mfma_f32_16x16x32_bf16 v[8:11], a[196:199], a[120:123], v[8:11]
ds_read_b64_tr_b16 a[232:233], v244 offset:0
v_add_f32 v124, v124, v34
v_mfma_f32_16x16x32_bf16 v[8:11], a[200:203], a[152:155], v[8:11]
v_exp_f32 v35, v35
v_mfma_f32_16x16x32_bf16 v[8:11], a[204:207], a[184:187], v[8:11]
ds_read_b64_tr_b16 a[234:235], v244 offset:4096
v_add_f32 v124, v124, v35
v_mfma_f32_16x16x32_bf16 v[12:15], a[204:207], a[188:191], v[108:111]
v_exp_f32 v42, v42
v_mfma_f32_16x16x32_bf16 v[12:15], a[200:203], a[156:159], v[12:15]
ds_read_b64_tr_b16 a[236:237], v244 offset:8192
v_cvt_pk_bf16_f32 v153, v34, v35
v_mfma_f32_16x16x32_bf16 v[12:15], a[196:199], a[124:127], v[12:15]
v_exp_f32 v43, v43
v_mfma_f32_16x16x32_bf16 v[12:15], a[192:195], a[92:95], v[12:15]
s_waitcnt lgkmcnt(7)
ds_read_b64_tr_b16 a[238:239], v244 offset:12288
v_cvt_pk_bf16_f32 v161, v42, v43
v_mfma_f32_16x16x32_bf16 v[28:31], a[208:211], a[92:95], v[108:111]
v_exp_f32 v48, v48
v_mfma_f32_16x16x32_bf16 v[28:31], a[212:215], a[124:127], v[28:31]
ds_read_b64_tr_b16 a[240:241], v245 offset:0
v_add_f32 v124, v124, v48
v_mfma_f32_16x16x32_bf16 v[28:31], a[216:219], a[156:159], v[28:31]
v_exp_f32 v49, v49
v_mfma_f32_16x16x32_bf16 v[28:31], a[220:223], a[188:191], v[28:31]
ds_read_b64_tr_b16 a[242:243], v245 offset:4096
v_add_f32 v124, v124, v49
v_mfma_f32_16x16x32_bf16 v[24:27], a[220:223], a[184:187], v[104:107]
v_exp_f32 v56, v56
v_mfma_f32_16x16x32_bf16 v[24:27], a[216:219], a[152:155], v[24:27]
ds_read_b64_tr_b16 a[244:245], v245 offset:8192
v_cvt_pk_bf16_f32 v154, v48, v49
v_mfma_f32_16x16x32_bf16 v[24:27], a[212:215], a[120:123], v[24:27]
v_exp_f32 v57, v57
v_mfma_f32_16x16x32_bf16 v[24:27], a[208:211], a[88:91], v[24:27]
ds_read_b64_tr_b16 a[246:247], v245 offset:12288
v_cvt_pk_bf16_f32 v162, v56, v57
v_mfma_f32_16x16x32_bf16 v[20:23], a[208:211], a[84:87], v[100:103]
v_exp_f32 v50, v50
v_mfma_f32_16x16x32_bf16 v[20:23], a[212:215], a[116:119], v[20:23]
ds_read_b64_tr_b16 a[248:249], v246 offset:0
v_add_f32 v124, v124, v50
v_mfma_f32_16x16x32_bf16 v[20:23], a[216:219], a[148:151], v[20:23]
v_exp_f32 v51, v51
v_mfma_f32_16x16x32_bf16 v[20:23], a[220:223], a[180:183], v[20:23]
ds_read_b64_tr_b16 a[250:251], v246 offset:4096
v_add_f32 v124, v124, v51
v_mfma_f32_16x16x32_bf16 v[16:19], a[220:223], a[176:179], v[96:99]
v_exp_f32 v58, v58
v_mfma_f32_16x16x32_bf16 v[16:19], a[216:219], a[144:147], v[16:19]
ds_read_b64_tr_b16 a[252:253], v246 offset:8192
v_cvt_pk_bf16_f32 v155, v50, v51
v_mfma_f32_16x16x32_bf16 v[16:19], a[212:215], a[112:115], v[16:19]
v_exp_f32 v59, v59
v_mfma_f32_16x16x32_bf16 v[16:19], a[208:211], a[80:83], v[16:19]
s_waitcnt lgkmcnt(7)
ds_read_b64_tr_b16 a[254:255], v246 offset:12288
v_cvt_pk_bf16_f32 v163, v58, v59
v_mfma_f32_16x16x32_bf16 a[76:79], a[224:227], v[76:79], a[76:79]
v_exp_f32 v36, v36
v_mfma_f32_16x16x32_bf16 a[76:79], a[228:231], v[92:95], a[76:79]
ds_read_b128 a[192:195], v235 offset:40960
v_add_f32 v125, v125, v36
v_mfma_f32_16x16x32_bf16 a[72:75], a[228:231], v[88:91], a[72:75]
s_add_u32 m0, s65, 114688
v_exp_f32 v37, v37
v_mfma_f32_16x16x32_bf16 a[72:75], a[224:227], v[72:75], a[72:75]
buffer_load_dwordx4 v228, s[24:27], s64 offen offset:0 lds
v_mfma_f32_16x16x32_bf16 a[68:71], a[224:227], v[68:71], a[68:71]
v_exp_f32 v44, v44
v_mfma_f32_16x16x32_bf16 a[68:71], a[228:231], v[84:87], a[68:71]
ds_read_b128 a[196:199], v236 offset:40960
v_add_f32 v125, v125, v37
v_mfma_f32_16x16x32_bf16 a[64:67], a[228:231], v[80:83], a[64:67]
v_exp_f32 v45, v45
v_mfma_f32_16x16x32_bf16 a[64:67], a[224:227], v[64:67], a[64:67]
v_cvt_pk_bf16_f32 v156, v36, v37
v_cvt_pk_bf16_f32 v164, v44, v45
v_mfma_f32_16x16x32_bf16 a[96:99], a[232:235], v[64:67], a[96:99]
v_exp_f32 v38, v38
v_mfma_f32_16x16x32_bf16 a[96:99], a[236:239], v[80:83], a[96:99]
ds_read_b128 a[200:203], v237 offset:40960
v_add_f32 v125, v125, v38
v_mfma_f32_16x16x32_bf16 a[100:103], a[236:239], v[84:87], a[100:103]
v_exp_f32 v39, v39
v_mfma_f32_16x16x32_bf16 a[100:103], a[232:235], v[68:71], a[100:103]
buffer_load_dwordx4 v229, s[24:27], s64 offen offset:1024 lds
v_mfma_f32_16x16x32_bf16 a[104:107], a[232:235], v[72:75], a[104:107]
v_exp_f32 v46, v46
v_mfma_f32_16x16x32_bf16 a[104:107], a[236:239], v[88:91], a[104:107]
ds_read_b128 a[204:207], v238 offset:40960
v_add_f32 v125, v125, v39
v_mfma_f32_16x16x32_bf16 a[108:111], a[236:239], v[92:95], a[108:111]
v_exp_f32 v47, v47
v_mfma_f32_16x16x32_bf16 a[108:111], a[232:235], v[76:79], a[108:111]
s_waitcnt lgkmcnt(4)
v_cvt_pk_bf16_f32 v157, v38, v39
v_cvt_pk_bf16_f32 v165, v46, v47
v_mfma_f32_16x16x32_bf16 a[140:143], a[240:243], v[76:79], a[140:143]
v_exp_f32 v52, v52
v_mfma_f32_16x16x32_bf16 a[140:143], a[244:247], v[92:95], a[140:143]
ds_read_b128 a[208:211], v235 offset:45056
v_add_f32 v125, v125, v52
v_mfma_f32_16x16x32_bf16 a[136:139], a[244:247], v[88:91], a[136:139]
v_exp_f32 v53, v53
v_mfma_f32_16x16x32_bf16 a[136:139], a[240:243], v[72:75], a[136:139]
buffer_load_dwordx4 v228, s[24:27], s64 offen offset:2048 lds
v_mfma_f32_16x16x32_bf16 a[132:135], a[240:243], v[68:71], a[132:135]
v_exp_f32 v60, v60
v_mfma_f32_16x16x32_bf16 a[132:135], a[244:247], v[84:87], a[132:135]
ds_read_b128 a[212:215], v236 offset:45056
v_add_f32 v125, v125, v53
v_mfma_f32_16x16x32_bf16 a[128:131], a[244:247], v[80:83], a[128:131]
v_exp_f32 v61, v61
v_mfma_f32_16x16x32_bf16 a[128:131], a[240:243], v[64:67], a[128:131]
v_cvt_pk_bf16_f32 v158, v52, v53
v_cvt_pk_bf16_f32 v166, v60, v61
v_mfma_f32_16x16x32_bf16 a[160:163], a[248:251], v[64:67], a[160:163]
v_exp_f32 v54, v54
v_mfma_f32_16x16x32_bf16 a[160:163], a[252:255], v[80:83], a[160:163]
ds_read_b128 a[216:219], v237 offset:45056
v_add_f32 v125, v125, v54
v_mfma_f32_16x16x32_bf16 a[164:167], a[252:255], v[84:87], a[164:167]
v_exp_f32 v55, v55
v_mfma_f32_16x16x32_bf16 a[164:167], a[248:251], v[68:71], a[164:167]
buffer_load_dwordx4 v229, s[24:27], s64 offen offset:3072 lds
v_mfma_f32_16x16x32_bf16 a[168:171], a[248:251], v[72:75], a[168:171]
s_add_u32 s64, s64, 16384
v_exp_f32 v62, v62
v_mfma_f32_16x16x32_bf16 a[168:171], a[252:255], v[88:91], a[168:171]
ds_read_b128 a[220:223], v238 offset:45056
v_add_f32 v125, v125, v55
v_mfma_f32_16x16x32_bf16 a[172:175], a[252:255], v[92:95], a[172:175]
v_exp_f32 v63, v63
v_mfma_f32_16x16x32_bf16 a[172:175], a[248:251], v[76:79], a[172:175]
v_cvt_pk_bf16_f32 v159, v54, v55
v_cvt_pk_bf16_f32 v167, v62, v63
v_mfma_f32_16x16x32_bf16 v[116:119], v[120:123], v[76:79], v[116:119]
v_mfma_f32_16x16x32_bf16 v[116:119], v[120:123], v[92:95], v[116:119]
s_waitcnt lgkmcnt(4)
v_mfma_f32_16x16x32_bf16 v[32:35], a[192:195], a[80:83], v[96:99]
s_mul_i32 s74, s54, 9
v_exp_f32 v0, v0
v_mfma_f32_16x16x32_bf16 v[32:35], a[196:199], a[112:115], v[32:35]
s_add_u32 s74, s74, 32
ds_read_b64_tr_b16 a[224:225], v239 offset:16384
v_add_f32 v124, v124, v0
v_mfma_f32_16x16x32_bf16 v[32:35], a[200:203], a[144:147], v[32:35]
s_lshl_b32 s75, s74, 14
v_exp_f32 v1, v1
v_mfma_f32_16x16x32_bf16 v[32:35], a[204:207], a[176:179], v[32:35]
s_add_u32 s61, s61, s75
ds_read_b64_tr_b16 a[226:227], v239 offset:20480
v_add_f32 v124, v124, v1
v_mfma_f32_16x16x32_bf16 v[36:39], a[204:207], a[180:183], v[100:103]
s_mul_i32 s75, s74, 36864
v_exp_f32 v8, v8
v_mfma_f32_16x16x32_bf16 v[36:39], a[200:203], a[148:151], v[36:39]
s_add_u32 s58, s58, s75
ds_read_b64_tr_b16 a[228:229], v239 offset:24576
v_cvt_pk_bf16_f32 v64, v0, v1
v_mfma_f32_16x16x32_bf16 v[36:39], a[196:199], a[116:119], v[36:39]
s_add_u32 s59, s58, 4096
v_exp_f32 v9, v9
v_mfma_f32_16x16x32_bf16 v[36:39], a[192:195], a[84:87], v[36:39]
s_add_u32 s72, s58, 8192
ds_read_b64_tr_b16 a[230:231], v239 offset:28672
v_cvt_pk_bf16_f32 v72, v8, v9
v_mfma_f32_16x16x32_bf16 v[40:43], a[192:195], a[88:91], v[104:107]
s_mov_b32 s64, s60
v_exp_f32 v2, v2
v_mfma_f32_16x16x32_bf16 v[40:43], a[196:199], a[120:123], v[40:43]
ds_read_b64_tr_b16 a[232:233], v240 offset:16384
v_add_f32 v124, v124, v2
v_mfma_f32_16x16x32_bf16 v[40:43], a[200:203], a[152:155], v[40:43]
v_exp_f32 v3, v3
v_mfma_f32_16x16x32_bf16 v[40:43], a[204:207], a[184:187], v[40:43]
ds_read_b64_tr_b16 a[234:235], v240 offset:20480
v_add_f32 v124, v124, v3
v_mfma_f32_16x16x32_bf16 v[44:47], a[204:207], a[188:191], v[108:111]
v_exp_f32 v10, v10
v_mfma_f32_16x16x32_bf16 v[44:47], a[200:203], a[156:159], v[44:47]
ds_read_b64_tr_b16 a[236:237], v240 offset:24576
v_cvt_pk_bf16_f32 v65, v2, v3
v_mfma_f32_16x16x32_bf16 v[44:47], a[196:199], a[124:127], v[44:47]
v_exp_f32 v11, v11
v_mfma_f32_16x16x32_bf16 v[44:47], a[192:195], a[92:95], v[44:47]
s_waitcnt lgkmcnt(7)
ds_read_b64_tr_b16 a[238:239], v240 offset:28672
v_cvt_pk_bf16_f32 v73, v10, v11
v_mfma_f32_16x16x32_bf16 v[60:63], a[208:211], a[92:95], v[108:111]
v_exp_f32 v16, v16
v_mfma_f32_16x16x32_bf16 v[60:63], a[212:215], a[124:127], v[60:63]
ds_read_b64_tr_b16 a[240:241], v241 offset:16384
v_add_f32 v124, v124, v16
v_mfma_f32_16x16x32_bf16 v[60:63], a[216:219], a[156:159], v[60:63]
v_exp_f32 v17, v17
v_mfma_f32_16x16x32_bf16 v[60:63], a[220:223], a[188:191], v[60:63]
ds_read_b64_tr_b16 a[242:243], v241 offset:20480
v_add_f32 v124, v124, v17
v_mfma_f32_16x16x32_bf16 v[56:59], a[220:223], a[184:187], v[104:107]
v_exp_f32 v24, v24
v_mfma_f32_16x16x32_bf16 v[56:59], a[216:219], a[152:155], v[56:59]
ds_read_b64_tr_b16 a[244:245], v241 offset:24576
v_cvt_pk_bf16_f32 v66, v16, v17
v_mfma_f32_16x16x32_bf16 v[56:59], a[212:215], a[120:123], v[56:59]
v_exp_f32 v25, v25
v_mfma_f32_16x16x32_bf16 v[56:59], a[208:211], a[88:91], v[56:59]
ds_read_b64_tr_b16 a[246:247], v241 offset:28672
v_cvt_pk_bf16_f32 v74, v24, v25
v_mfma_f32_16x16x32_bf16 v[52:55], a[208:211], a[84:87], v[100:103]
v_exp_f32 v18, v18
v_mfma_f32_16x16x32_bf16 v[52:55], a[212:215], a[116:119], v[52:55]
ds_read_b64_tr_b16 a[248:249], v242 offset:16384
v_add_f32 v124, v124, v18
v_mfma_f32_16x16x32_bf16 v[52:55], a[216:219], a[148:151], v[52:55]
v_exp_f32 v19, v19
v_mfma_f32_16x16x32_bf16 v[52:55], a[220:223], a[180:183], v[52:55]
ds_read_b64_tr_b16 a[250:251], v242 offset:20480
v_add_f32 v124, v124, v19
v_mfma_f32_16x16x32_bf16 v[48:51], a[220:223], a[176:179], v[96:99]
v_exp_f32 v26, v26
v_mfma_f32_16x16x32_bf16 v[48:51], a[216:219], a[144:147], v[48:51]
ds_read_b64_tr_b16 a[252:253], v242 offset:24576
v_cvt_pk_bf16_f32 v67, v18, v19
v_mfma_f32_16x16x32_bf16 v[48:51], a[212:215], a[112:115], v[48:51]
s_waitcnt vmcnt(4)
v_exp_f32 v27, v27
v_mfma_f32_16x16x32_bf16 v[48:51], a[208:211], a[80:83], v[48:51]
s_waitcnt lgkmcnt(7)
ds_read_b64_tr_b16 a[254:255], v242 offset:28672
v_cvt_pk_bf16_f32 v75, v26, v27
v_mfma_f32_16x16x32_bf16 a[12:15], a[224:227], v[148:151], a[12:15]
s_barrier
v_exp_f32 v4, v4
v_mfma_f32_16x16x32_bf16 a[12:15], a[228:231], v[164:167], a[12:15]
ds_read_b128 a[192:195], v235 offset:49152
v_add_f32 v125, v125, v4
v_xor_b32 v188, v188, v186
v_xor_b32 v189, v189, v186
v_xor_b32 v190, v190, v186
v_xor_b32 v191, v191, v186
v_or3_b32 v188, v188, v189, v190
v_or_b32 v188, v188, v191
v_cmp_ne_u32 vcc, 0, v188
s_nop 4
s_cbranch_vccnz k1_pa_s
k1_pa_b:
s_cmp_eq_u32 s52, 0
s_cselect_b32 s74, 2048, s52
s_cselect_b32 s74, s74, 0x40000000
buffer_store_dword v186, v232, s[36:39], s74 offen sc1
s_and_b32 s74, s54, 1
s_lshl_b32 s74, s74, 10
s_mul_i32 s75, s73, 160
v_add_u32 v183, s74, v234
v_xor_b32 v184, 0x400, v183
v_lshrrev_b32 v254, 6, v234
v_bfe_u32 v255, v234, 4, 2
v_mul_u32_u24 v254, 288, v254
v_lshl_add_u32 v181, v255, 3, v254
v_add_u32 v180, s75, v181
v_add_u32 v182, 160, v181
v_subrev_u32 v182, s75, v182
v_bfe_u32 v254, v234, 4, 4
v_lshrrev_b32 v255, 8, v234
v_mul_u32_u24 v254, 1152, v254
v_lshl_add_u32 v185, v255, 3, v254
v_mfma_f32_16x16x32_bf16 a[8:11], a[228:231], v[160:163], a[8:11]
s_add_u32 m0, s64, 0
v_exp_f32 v5, v5
v_mfma_f32_16x16x32_bf16 a[8:11], a[224:227], v[144:147], a[8:11]
buffer_load_dwordx4 v234, s[12:15], s58 offen offset:0 sc1 lds
v_mfma_f32_16x16x32_bf16 a[4:7], a[224:227], v[140:143], a[4:7]
v_exp_f32 v12, v12
v_mfma_f32_16x16x32_bf16 a[4:7], a[228:231], v[156:159], a[4:7]
ds_read_b128 a[196:199], v236 offset:49152
v_add_f32 v125, v125, v5
v_mfma_f32_16x16x32_bf16 a[0:3], a[228:231], v[152:155], a[0:3]
v_exp_f32 v13, v13
v_mfma_f32_16x16x32_bf16 a[0:3], a[224:227], v[136:139], a[0:3]
buffer_load_dwordx4 v234, s[12:15], s58 offen offset:1024 sc1 lds
v_mfma_f32_16x16x32_bf16 a[16:19], a[232:235], v[136:139], a[16:19]
v_exp_f32 v6, v6
v_mfma_f32_16x16x32_bf16 a[16:19], a[236:239], v[152:155], a[16:19]
ds_read_b128 a[200:203], v237 offset:49152
v_cvt_pk_bf16_f32 v68, v4, v5
v_mfma_f32_16x16x32_bf16 a[20:23], a[236:239], v[156:159], a[20:23]
v_exp_f32 v7, v7
v_mfma_f32_16x16x32_bf16 a[20:23], a[232:235], v[140:143], a[20:23]
buffer_load_dwordx4 v234, s[12:15], s58 offen offset:2048 sc1 lds
v_mfma_f32_16x16x32_bf16 a[24:27], a[232:235], v[144:147], a[24:27]
v_exp_f32 v14, v14
v_mfma_f32_16x16x32_bf16 a[24:27], a[236:239], v[160:163], a[24:27]
ds_read_b128 a[204:207], v238 offset:49152
v_cvt_pk_bf16_f32 v76, v12, v13
v_mfma_f32_16x16x32_bf16 a[28:31], a[236:239], v[164:167], a[28:31]
v_exp_f32 v15, v15
v_mfma_f32_16x16x32_bf16 a[28:31], a[232:235], v[148:151], a[28:31]
s_waitcnt lgkmcnt(4)
v_add_f32 v125, v125, v6
v_add_f32 v125, v125, v7
v_mfma_f32_16x16x32_bf16 a[44:47], a[240:243], v[148:151], a[44:47]
v_exp_f32 v20, v20
v_mfma_f32_16x16x32_bf16 a[44:47], a[244:247], v[164:167], a[44:47]
ds_read_b128 a[208:211], v235 offset:53248
v_cvt_pk_bf16_f32 v69, v6, v7
v_mfma_f32_16x16x32_bf16 a[40:43], a[244:247], v[160:163], a[40:43]
v_exp_f32 v21, v21
v_mfma_f32_16x16x32_bf16 a[40:43], a[240:243], v[144:147], a[40:43]
buffer_load_dwordx4 v234, s[12:15], s58 offen offset:3072 sc1 lds
v_mfma_f32_16x16x32_bf16 a[36:39], a[240:243], v[140:143], a[36:39]
s_add_u32 s58, s58, 36864
v_exp_f32 v28, v28
v_mfma_f32_16x16x32_bf16 a[36:39], a[244:247], v[156:159], a[36:39]
ds_read_b128 a[212:215], v236 offset:53248
v_cvt_pk_bf16_f32 v77, v14, v15
v_mfma_f32_16x16x32_bf16 a[32:35], a[244:247], v[152:155], a[32:35]
v_exp_f32 v29, v29
v_mfma_f32_16x16x32_bf16 a[32:35], a[240:243], v[136:139], a[32:35]
v_add_f32 v125, v125, v20
v_add_f32 v125, v125, v21
v_mfma_f32_16x16x32_bf16 a[48:51], a[248:251], v[136:139], a[48:51]
v_exp_f32 v22, v22
v_mfma_f32_16x16x32_bf16 a[48:51], a[252:255], v[152:155], a[48:51]
ds_read_b128 a[216:219], v237 offset:53248
v_cvt_pk_bf16_f32 v70, v20, v21
v_mfma_f32_16x16x32_bf16 a[52:55], a[252:255], v[156:159], a[52:55]
s_add_u32 m0, s64, 4096
v_exp_f32 v23, v23
v_mfma_f32_16x16x32_bf16 a[52:55], a[248:251], v[140:143], a[52:55]
buffer_load_dwordx4 v234, s[12:15], s59 offen offset:0 sc1 lds
v_mfma_f32_16x16x32_bf16 a[56:59], a[248:251], v[144:147], a[56:59]
v_exp_f32 v30, v30
v_mfma_f32_16x16x32_bf16 a[56:59], a[252:255], v[160:163], a[56:59]
ds_read_b128 a[220:223], v238 offset:53248
v_cvt_pk_bf16_f32 v78, v28, v29
v_mfma_f32_16x16x32_bf16 a[60:63], a[252:255], v[164:167], a[60:63]
v_exp_f32 v31, v31
v_mfma_f32_16x16x32_bf16 a[60:63], a[248:251], v[148:151], a[60:63]
v_add_f32 v125, v125, v22
v_add_f32 v125, v125, v23
v_mfma_f32_16x16x32_bf16 v[112:115], v[120:123], v[144:147], v[112:115]
v_cvt_pk_bf16_f32 v71, v22, v23
v_cvt_pk_bf16_f32 v79, v30, v31
v_mfma_f32_16x16x32_bf16 v[112:115], v[120:123], v[160:163], v[112:115]
s_waitcnt lgkmcnt(4)
v_mfma_f32_16x16x32_bf16 v[0:3], a[192:195], a[80:83], v[96:99]
v_exp_f32 v32, v32
v_mfma_f32_16x16x32_bf16 v[0:3], a[196:199], a[112:115], v[0:3]
ds_read_b64_tr_b16 a[224:225], v243 offset:16384
v_add_f32 v124, v124, v32
v_mfma_f32_16x16x32_bf16 v[0:3], a[200:203], a[144:147], v[0:3]
v_exp_f32 v33, v33
v_mfma_f32_16x16x32_bf16 v[0:3], a[204:207], a[176:179], v[0:3]
ds_read_b64_tr_b16 a[226:227], v243 offset:20480
v_add_f32 v124, v124, v33
v_mfma_f32_16x16x32_bf16 v[4:7], a[204:207], a[180:183], v[100:103]
v_exp_f32 v40, v40
v_mfma_f32_16x16x32_bf16 v[4:7], a[200:203], a[148:151], v[4:7]
ds_read_b64_tr_b16 a[228:229], v243 offset:24576
v_cvt_pk_bf16_f32 v80, v32, v33
v_mfma_f32_16x16x32_bf16 v[4:7], a[196:199], a[116:119], v[4:7]
v_exp_f32 v41, v41
v_mfma_f32_16x16x32_bf16 v[4:7], a[192:195], a[84:87], v[4:7]
ds_read_b64_tr_b16 a[230:231], v243 offset:28672
v_cvt_pk_bf16_f32 v88, v40, v41
v_mfma_f32_16x16x32_bf16 v[8:11], a[192:195], a[88:91], v[104:107]
v_exp_f32 v34, v34
v_mfma_f32_16x16x32_bf16 v[8:11], a[196:199], a[120:123], v[8:11]
ds_read_b64_tr_b16 a[232:233], v244 offset:16384
v_add_f32 v124, v124, v34
v_mfma_f32_16x16x32_bf16 v[8:11], a[200:203], a[152:155], v[8:11]
v_exp_f32 v35, v35
v_mfma_f32_16x16x32_bf16 v[8:11], a[204:207], a[184:187], v[8:11]
ds_read_b64_tr_b16 a[234:235], v244 offset:20480
v_add_f32 v124, v124, v35
v_mfma_f32_16x16x32_bf16 v[12:15], a[204:207], a[188:191], v[108:111]
v_exp_f32 v42, v42
v_mfma_f32_16x16x32_bf16 v[12:15], a[200:203], a[156:159], v[12:15]
ds_read_b64_tr_b16 a[236:237], v244 offset:24576
v_cvt_pk_bf16_f32 v81, v34, v35
v_mfma_f32_16x16x32_bf16 v[12:15], a[196:199], a[124:127], v[12:15]
v_exp_f32 v43, v43
v_mfma_f32_16x16x32_bf16 v[12:15], a[192:195], a[92:95], v[12:15]
s_waitcnt lgkmcnt(7)
ds_read_b64_tr_b16 a[238:239], v244 offset:28672
v_cvt_pk_bf16_f32 v89, v42, v43
v_mfma_f32_16x16x32_bf16 v[28:31], a[208:211], a[92:95], v[108:111]
v_exp_f32 v48, v48
v_mfma_f32_16x16x32_bf16 v[28:31], a[212:215], a[124:127], v[28:31]
ds_read_b64_tr_b16 a[240:241], v245 offset:16384
v_add_f32 v124, v124, v48
v_mfma_f32_16x16x32_bf16 v[28:31], a[216:219], a[156:159], v[28:31]
v_exp_f32 v49, v49
v_mfma_f32_16x16x32_bf16 v[28:31], a[220:223], a[188:191], v[28:31]
ds_read_b64_tr_b16 a[242:243], v245 offset:20480
v_add_f32 v124, v124, v49
v_mfma_f32_16x16x32_bf16 v[24:27], a[220:223], a[184:187], v[104:107]
v_exp_f32 v56, v56
v_mfma_f32_16x16x32_bf16 v[24:27], a[216:219], a[152:155], v[24:27]
ds_read_b64_tr_b16 a[244:245], v245 offset:24576
v_cvt_pk_bf16_f32 v82, v48, v49
v_mfma_f32_16x16x32_bf16 v[24:27], a[212:215], a[120:123], v[24:27]
v_exp_f32 v57, v57
v_mfma_f32_16x16x32_bf16 v[24:27], a[208:211], a[88:91], v[24:27]
ds_read_b64_tr_b16 a[246:247], v245 offset:28672
v_cvt_pk_bf16_f32 v90, v56, v57
v_mfma_f32_16x16x32_bf16 v[20:23], a[208:211], a[84:87], v[100:103]
v_exp_f32 v50, v50
v_mfma_f32_16x16x32_bf16 v[20:23], a[212:215], a[116:119], v[20:23]
ds_read_b64_tr_b16 a[248:249], v246 offset:16384
v_add_f32 v124, v124, v50
v_mfma_f32_16x16x32_bf16 v[20:23], a[216:219], a[148:151], v[20:23]
v_exp_f32 v51, v51
v_mfma_f32_16x16x32_bf16 v[20:23], a[220:223], a[180:183], v[20:23]
ds_read_b64_tr_b16 a[250:251], v246 offset:20480
v_add_f32 v124, v124, v51
v_mfma_f32_16x16x32_bf16 v[16:19], a[220:223], a[176:179], v[96:99]
v_exp_f32 v58, v58
v_mfma_f32_16x16x32_bf16 v[16:19], a[216:219], a[144:147], v[16:19]
ds_read_b64_tr_b16 a[252:253], v246 offset:24576
v_cvt_pk_bf16_f32 v83, v50, v51
v_mfma_f32_16x16x32_bf16 v[16:19], a[212:215], a[112:115], v[16:19]
v_exp_f32 v59, v59
v_mfma_f32_16x16x32_bf16 v[16:19], a[208:211], a[80:83], v[16:19]
s_waitcnt lgkmcnt(7)
ds_read_b64_tr_b16 a[254:255], v246 offset:28672
v_cvt_pk_bf16_f32 v91, v58, v59
v_mfma_f32_16x16x32_bf16 a[76:79], a[224:227], v[148:151], a[76:79]
v_exp_f32 v36, v36
v_mfma_f32_16x16x32_bf16 a[76:79], a[228:231], v[164:167], a[76:79]
ds_read_b128 a[192:195], v235 offset:57344
v_add_f32 v125, v125, v36
v_mfma_f32_16x16x32_bf16 a[72:75], a[228:231], v[160:163], a[72:75]
v_exp_f32 v37, v37
v_mfma_f32_16x16x32_bf16 a[72:75], a[224:227], v[144:147], a[72:75]
buffer_load_dwordx4 v234, s[12:15], s59 offen offset:1024 sc1 lds
v_mfma_f32_16x16x32_bf16 a[68:71], a[224:227], v[140:143], a[68:71]
v_exp_f32 v44, v44
v_mfma_f32_16x16x32_bf16 a[68:71], a[228:231], v[156:159], a[68:71]
ds_read_b128 a[196:199], v236 offset:57344
v_add_f32 v125, v125, v37
v_mfma_f32_16x16x32_bf16 a[64:67], a[228:231], v[152:155], a[64:67]
v_exp_f32 v45, v45
v_mfma_f32_16x16x32_bf16 a[64:67], a[224:227], v[136:139], a[64:67]
buffer_load_dwordx4 v234, s[12:15], s59 offen offset:2048 sc1 lds
v_mfma_f32_16x16x32_bf16 a[96:99], a[232:235], v[136:139], a[96:99]
v_exp_f32 v38, v38
v_mfma_f32_16x16x32_bf16 a[96:99], a[236:239], v[152:155], a[96:99]
ds_read_b128 a[200:203], v237 offset:57344
v_cvt_pk_bf16_f32 v84, v36, v37
v_mfma_f32_16x16x32_bf16 a[100:103], a[236:239], v[156:159], a[100:103]
v_exp_f32 v39, v39
v_mfma_f32_16x16x32_bf16 a[100:103], a[232:235], v[140:143], a[100:103]
buffer_load_dwordx4 v234, s[12:15], s59 offen offset:3072 sc1 lds
v_mfma_f32_16x16x32_bf16 a[104:107], a[232:235], v[144:147], a[104:107]
s_add_u32 s59, s59, 36864
v_exp_f32 v46, v46
v_mfma_f32_16x16x32_bf16 a[104:107], a[236:239], v[160:163], a[104:107]
ds_read_b128 a[204:207], v238 offset:57344
v_cvt_pk_bf16_f32 v92, v44, v45
v_mfma_f32_16x16x32_bf16 a[108:111], a[236:239], v[164:167], a[108:111]
v_exp_f32 v47, v47
v_mfma_f32_16x16x32_bf16 a[108:111], a[232:235], v[148:151], a[108:111]
s_waitcnt lgkmcnt(4)
v_add_f32 v125, v125, v38
v_add_f32 v125, v125, v39
v_mfma_f32_16x16x32_bf16 a[140:143], a[240:243], v[148:151], a[140:143]
v_exp_f32 v52, v52
v_mfma_f32_16x16x32_bf16 a[140:143], a[244:247], v[164:167], a[140:143]
ds_read_b128 a[208:211], v235 offset:61440
v_cvt_pk_bf16_f32 v85, v38, v39
v_mfma_f32_16x16x32_bf16 a[136:139], a[244:247], v[160:163], a[136:139]
s_add_u32 m0, s64, 8192
v_exp_f32 v53, v53
v_mfma_f32_16x16x32_bf16 a[136:139], a[240:243], v[144:147], a[136:139]
buffer_load_dwordx4 v234, s[12:15], s72 offen offset:0 sc1 lds
v_mfma_f32_16x16x32_bf16 a[132:135], a[240:243], v[140:143], a[132:135]
s_add_u32 s72, s72, 36864
s_add_u32 s64, s64, 36864
s_cmp_ge_u32 s64, 147456
s_cselect_b32 s64, s60, s64
v_exp_f32 v60, v60
v_mfma_f32_16x16x32_bf16 a[132:135], a[244:247], v[156:159], a[132:135]
ds_read_b128 a[212:215], v236 offset:61440
v_cvt_pk_bf16_f32 v93, v46, v47
v_mfma_f32_16x16x32_bf16 a[128:131], a[244:247], v[152:155], a[128:131]
v_exp_f32 v61, v61
v_mfma_f32_16x16x32_bf16 a[128:131], a[240:243], v[136:139], a[128:131]
v_add_f32 v125, v125, v52
v_add_f32 v125, v125, v53
v_mfma_f32_16x16x32_bf16 a[160:163], a[248:251], v[136:139], a[160:163]
v_exp_f32 v54, v54
v_mfma_f32_16x16x32_bf16 a[160:163], a[252:255], v[152:155], a[160:163]
ds_read_b128 a[216:219], v237 offset:61440
v_cvt_pk_bf16_f32 v86, v52, v53
v_mfma_f32_16x16x32_bf16 a[164:167], a[252:255], v[156:159], a[164:167]
v_exp_f32 v55, v55
v_mfma_f32_16x16x32_bf16 a[164:167], a[248:251], v[140:143], a[164:167]
v_cvt_pk_bf16_f32 v94, v60, v61
v_add_f32 v125, v125, v54
v_mfma_f32_16x16x32_bf16 a[168:171], a[248:251], v[144:147], a[168:171]
v_exp_f32 v62, v62
v_mfma_f32_16x16x32_bf16 a[168:171], a[252:255], v[160:163], a[168:171]
ds_read_b128 a[220:223], v238 offset:61440
v_add_f32 v125, v125, v55
v_mfma_f32_16x16x32_bf16 a[172:175], a[252:255], v[164:167], a[172:175]
v_exp_f32 v63, v63
v_mfma_f32_16x16x32_bf16 a[172:175], a[248:251], v[148:151], a[172:175]
v_cvt_pk_bf16_f32 v87, v54, v55
v_cvt_pk_bf16_f32 v95, v62, v63
v_mfma_f32_16x16x32_bf16 v[116:119], v[120:123], v[148:151], v[116:119]
v_mfma_f32_16x16x32_bf16 v[116:119], v[120:123], v[164:167], v[116:119]
s_waitcnt lgkmcnt(4)
v_mfma_f32_16x16x32_bf16 v[32:35], a[192:195], a[80:83], v[96:99]
v_exp_f32 v0, v0
v_mfma_f32_16x16x32_bf16 v[32:35], a[196:199], a[112:115], v[32:35]
ds_read_b64_tr_b16 a[224:225], v239 offset:32768
v_add_f32 v124, v124, v0
v_mfma_f32_16x16x32_bf16 v[32:35], a[200:203], a[144:147], v[32:35]
v_exp_f32 v1, v1
v_mfma_f32_16x16x32_bf16 v[32:35], a[204:207], a[176:179], v[32:35]
ds_read_b64_tr_b16 a[226:227], v239 offset:36864
v_add_f32 v124, v124, v1
v_mfma_f32_16x16x32_bf16 v[36:39], a[204:207], a[180:183], v[100:103]
v_exp_f32 v8, v8
v_mfma_f32_16x16x32_bf16 v[36:39], a[200:203], a[148:151], v[36:39]
ds_read_b64_tr_b16 a[228:229], v239 offset:40960
v_cvt_pk_bf16_f32 v136, v0, v1
v_mfma_f32_16x16x32_bf16 v[36:39], a[196:199], a[116:119], v[36:39]
v_exp_f32 v9, v9
v_mfma_f32_16x16x32_bf16 v[36:39], a[192:195], a[84:87], v[36:39]
ds_read_b64_tr_b16 a[230:231], v239 offset:45056
v_cvt_pk_bf16_f32 v144, v8, v9
v_mfma_f32_16x16x32_bf16 v[40:43], a[192:195], a[88:91], v[104:107]
v_exp_f32 v2, v2
v_mfma_f32_16x16x32_bf16 v[40:43], a[196:199], a[120:123], v[40:43]
ds_read_b64_tr_b16 a[232:233], v240 offset:32768
v_add_f32 v124, v124, v2
v_mfma_f32_16x16x32_bf16 v[40:43], a[200:203], a[152:155], v[40:43]
v_exp_f32 v3, v3
v_mfma_f32_16x16x32_bf16 v[40:43], a[204:207], a[184:187], v[40:43]
ds_read_b64_tr_b16 a[234:235], v240 offset:36864
v_add_f32 v124, v124, v3
v_mfma_f32_16x16x32_bf16 v[44:47], a[204:207], a[188:191], v[108:111]
v_exp_f32 v10, v10
v_mfma_f32_16x16x32_bf16 v[44:47], a[200:203], a[156:159], v[44:47]
ds_read_b64_tr_b16 a[236:237], v240 offset:40960
v_cvt_pk_bf16_f32 v137, v2, v3
v_mfma_f32_16x16x32_bf16 v[44:47], a[196:199], a[124:127], v[44:47]
v_exp_f32 v11, v11
v_mfma_f32_16x16x32_bf16 v[44:47], a[192:195], a[92:95], v[44:47]
s_waitcnt lgkmcnt(7)
ds_read_b64_tr_b16 a[238:239], v240 offset:45056
v_cvt_pk_bf16_f32 v145, v10, v11
v_mfma_f32_16x16x32_bf16 v[60:63], a[208:211], a[92:95], v[108:111]
v_exp_f32 v16, v16
v_mfma_f32_16x16x32_bf16 v[60:63], a[212:215], a[124:127], v[60:63]
ds_read_b64_tr_b16 a[240:241], v241 offset:32768
v_add_f32 v124, v124, v16
v_mfma_f32_16x16x32_bf16 v[60:63], a[216:219], a[156:159], v[60:63]
v_exp_f32 v17, v17
v_mfma_f32_16x16x32_bf16 v[60:63], a[220:223], a[188:191], v[60:63]
ds_read_b64_tr_b16 a[242:243], v241 offset:36864
v_add_f32 v124, v124, v17
v_mfma_f32_16x16x32_bf16 v[56:59], a[220:223], a[184:187], v[104:107]
v_exp_f32 v24, v24
v_mfma_f32_16x16x32_bf16 v[56:59], a[216:219], a[152:155], v[56:59]
ds_read_b64_tr_b16 a[244:245], v241 offset:40960
v_cvt_pk_bf16_f32 v138, v16, v17
v_mfma_f32_16x16x32_bf16 v[56:59], a[212:215], a[120:123], v[56:59]
v_exp_f32 v25, v25
v_mfma_f32_16x16x32_bf16 v[56:59], a[208:211], a[88:91], v[56:59]
ds_read_b64_tr_b16 a[246:247], v241 offset:45056
v_cvt_pk_bf16_f32 v146, v24, v25
v_mfma_f32_16x16x32_bf16 v[52:55], a[208:211], a[84:87], v[100:103]
v_exp_f32 v18, v18
v_mfma_f32_16x16x32_bf16 v[52:55], a[212:215], a[116:119], v[52:55]
ds_read_b64_tr_b16 a[248:249], v242 offset:32768
v_add_f32 v124, v124, v18
v_mfma_f32_16x16x32_bf16 v[52:55], a[216:219], a[148:151], v[52:55]
v_exp_f32 v19, v19
v_mfma_f32_16x16x32_bf16 v[52:55], a[220:223], a[180:183], v[52:55]
ds_read_b64_tr_b16 a[250:251], v242 offset:36864
v_add_f32 v124, v124, v19
v_mfma_f32_16x16x32_bf16 v[48:51], a[220:223], a[176:179], v[96:99]
v_exp_f32 v26, v26
v_mfma_f32_16x16x32_bf16 v[48:51], a[216:219], a[144:147], v[48:51]
ds_read_b64_tr_b16 a[252:253], v242 offset:40960
v_cvt_pk_bf16_f32 v139, v18, v19
v_mfma_f32_16x16x32_bf16 v[48:51], a[212:215], a[112:115], v[48:51]
s_waitcnt vmcnt(10)
v_exp_f32 v27, v27
v_mfma_f32_16x16x32_bf16 v[48:51], a[208:211], a[80:83], v[48:51]
s_waitcnt lgkmcnt(7)
ds_read_b64_tr_b16 a[254:255], v242 offset:45056
v_cvt_pk_bf16_f32 v147, v26, v27
v_mfma_f32_16x16x32_bf16 a[12:15], a[224:227], v[76:79], a[12:15]
s_barrier
v_exp_f32 v4, v4
v_mfma_f32_16x16x32_bf16 a[12:15], a[228:231], v[92:95], a[12:15]
ds_read_b64_tr_b16 v[168:169], v243 offset:32768
ds_read_b64_tr_b16 v[170:171], v243 offset:36864
v_add_f32 v125, v125, v4
v_mfma_f32_16x16x32_bf16 a[8:11], a[228:231], v[88:91], a[8:11]
v_exp_f32 v5, v5
v_mfma_f32_16x16x32_bf16 a[8:11], a[224:227], v[72:75], a[8:11]
buffer_load_dwordx4 a[192:195], v183, s[28:31], s61 offen sc1
v_mfma_f32_16x16x32_bf16 a[4:7], a[224:227], v[68:71], a[4:7]
v_exp_f32 v12, v12
v_mfma_f32_16x16x32_bf16 a[4:7], a[228:231], v[84:87], a[4:7]
ds_read_b64_tr_b16 v[172:173], v243 offset:40960
ds_read_b64_tr_b16 v[174:175], v243 offset:45056
v_add_f32 v125, v125, v5
v_mfma_f32_16x16x32_bf16 a[0:3], a[228:231], v[80:83], a[0:3]
v_exp_f32 v13, v13
v_mfma_f32_16x16x32_bf16 a[0:3], a[224:227], v[64:67], a[0:3]
buffer_load_dwordx4 a[196:199], v184, s[28:31], s61 offen sc1
v_mfma_f32_16x16x32_bf16 a[16:19], a[232:235], v[64:67], a[16:19]
s_add_u32 s61, s61, 4096
v_exp_f32 v6, v6
v_mfma_f32_16x16x32_bf16 a[16:19], a[236:239], v[80:83], a[16:19]
ds_read_b64_tr_b16 v[176:177], v244 offset:32768
ds_read_b64_tr_b16 v[178:179], v244 offset:36864
v_cvt_pk_bf16_f32 v140, v4, v5
v_mfma_f32_16x16x32_bf16 a[20:23], a[236:239], v[84:87], a[20:23]
v_exp_f32 v7, v7
v_mfma_f32_16x16x32_bf16 a[20:23], a[232:235], v[68:71], a[20:23]
buffer_load_dwordx4 a[200:203], v183, s[28:31], s61 offen sc1
v_mfma_f32_16x16x32_bf16 a[24:27], a[232:235], v[72:75], a[24:27]
v_exp_f32 v14, v14
v_mfma_f32_16x16x32_bf16 a[24:27], a[236:239], v[88:91], a[24:27]
ds_read_b64_tr_b16 v[192:193], v244 offset:40960
ds_read_b64_tr_b16 v[194:195], v244 offset:45056
v_cvt_pk_bf16_f32 v148, v12, v13
v_mfma_f32_16x16x32_bf16 a[28:31], a[236:239], v[92:95], a[28:31]
v_exp_f32 v15, v15
v_mfma_f32_16x16x32_bf16 a[28:31], a[232:235], v[76:79], a[28:31]
s_waitcnt lgkmcnt(8)
v_add_f32 v125, v125, v6
v_add_f32 v125, v125, v7
v_mfma_f32_16x16x32_bf16 a[44:47], a[240:243], v[76:79], a[44:47]
v_exp_f32 v20, v20
v_mfma_f32_16x16x32_bf16 a[44:47], a[244:247], v[92:95], a[44:47]
ds_read_b64_tr_b16 v[196:197], v245 offset:32768
ds_read_b64_tr_b16 v[198:199], v245 offset:36864
v_cvt_pk_bf16_f32 v141, v6, v7
v_mfma_f32_16x16x32_bf16 a[40:43], a[244:247], v[88:91], a[40:43]
v_exp_f32 v21, v21
v_mfma_f32_16x16x32_bf16 a[40:43], a[240:243], v[72:75], a[40:43]
buffer_load_dwordx4 a[204:207], v184, s[28:31], s61 offen sc1
v_mfma_f32_16x16x32_bf16 a[36:39], a[240:243], v[68:71], a[36:39]
s_add_u32 s61, s61, 4096
v_exp_f32 v28, v28
v_mfma_f32_16x16x32_bf16 a[36:39], a[244:247], v[84:87], a[36:39]
ds_read_b64_tr_b16 v[200:201], v245 offset:40960
ds_read_b64_tr_b16 v[202:203], v245 offset:45056
v_cvt_pk_bf16_f32 v149, v14, v15
v_mfma_f32_16x16x32_bf16 a[32:35], a[244:247], v[80:83], a[32:35]
v_exp_f32 v29, v29
v_mfma_f32_16x16x32_bf16 a[32:35], a[240:243], v[64:67], a[32:35]
v_add_f32 v125, v125, v20
v_add_f32 v125, v125, v21
v_mfma_f32_16x16x32_bf16 a[48:51], a[248:251], v[64:67], a[48:51]
v_exp_f32 v22, v22
v_mfma_f32_16x16x32_bf16 a[48:51], a[252:255], v[80:83], a[48:51]
ds_read_b64_tr_b16 v[204:205], v246 offset:32768
ds_read_b64_tr_b16 v[206:207], v246 offset:36864
v_cvt_pk_bf16_f32 v142, v20, v21
v_mfma_f32_16x16x32_bf16 a[52:55], a[252:255], v[84:87], a[52:55]
s_add_u32 m0, s64, 0
v_exp_f32 v23, v23
v_mfma_f32_16x16x32_bf16 a[52:55], a[248:251], v[68:71], a[52:55]
buffer_load_dwordx4 v234, s[12:15], s58 offen offset:0 sc1 lds
v_mfma_f32_16x16x32_bf16 a[56:59], a[248:251], v[72:75], a[56:59]
v_exp_f32 v30, v30
v_mfma_f32_16x16x32_bf16 a[56:59], a[252:255], v[88:91], a[56:59]
ds_read_b64_tr_b16 v[220:221], v246 offset:40960
ds_read_b64_tr_b16 v[222:223], v246 offset:45056
v_cvt_pk_bf16_f32 v150, v28, v29
v_mfma_f32_16x16x32_bf16 a[60:63], a[252:255], v[92:95], a[60:63]
v_exp_f32 v31, v31
v_mfma_f32_16x16x32_bf16 a[60:63], a[248:251], v[76:79], a[60:63]
v_add_f32 v125, v125, v22
v_add_f32 v125, v125, v23
v_mfma_f32_16x16x32_bf16 v[112:115], v[120:123], v[72:75], v[112:115]
v_cvt_pk_bf16_f32 v143, v22, v23
v_cvt_pk_bf16_f32 v151, v30, v31
v_mfma_f32_16x16x32_bf16 v[112:115], v[120:123], v[88:91], v[112:115]
s_waitcnt lgkmcnt(8)
v_mfma_f32_16x16x32_bf16 a[76:79], v[168:171], v[76:79], a[76:79]
v_exp_f32 v40, v40
v_exp_f32 v41, v41
v_mfma_f32_16x16x32_bf16 a[76:79], v[172:175], v[92:95], a[76:79]
ds_read_b64_tr_b16 a[224:225], v239 offset:49152
v_exp_f32 v42, v42
v_exp_f32 v43, v43
v_mfma_f32_16x16x32_bf16 a[72:75], v[172:175], v[88:91], a[72:75]
buffer_load_dwordx4 v234, s[12:15], s58 offen offset:1024 sc1 lds
v_mfma_f32_16x16x32_bf16 a[72:75], v[168:171], v[72:75], a[72:75]
ds_read_b64_tr_b16 a[226:227], v239 offset:53248
v_cvt_pk_bf16_f32 v160, v40, v41
v_cvt_pk_bf16_f32 v161, v42, v43
v_exp_f32 v56, v56
v_mfma_f32_16x16x32_bf16 a[68:71], v[168:171], v[68:71], a[68:71]
v_exp_f32 v57, v57
v_exp_f32 v58, v58
v_mfma_f32_16x16x32_bf16 a[68:71], v[172:175], v[84:87], a[68:71]
ds_read_b64_tr_b16 a[228:229], v239 offset:57344
v_exp_f32 v59, v59
v_cvt_pk_bf16_f32 v162, v56, v57
v_cvt_pk_bf16_f32 v163, v58, v59
v_mfma_f32_16x16x32_bf16 a[64:67], v[172:175], v[80:83], a[64:67]
buffer_load_dwordx4 v234, s[12:15], s58 offen offset:2048 sc1 lds
v_mfma_f32_16x16x32_bf16 a[64:67], v[168:171], v[64:67], a[64:67]
ds_read_b64_tr_b16 a[230:231], v239 offset:61440
v_exp_f32 v44, v44
v_exp_f32 v45, v45
v_mfma_f32_16x16x32_bf16 a[96:99], v[176:179], v[64:67], a[96:99]
v_exp_f32 v46, v46
v_exp_f32 v47, v47
v_cvt_pk_bf16_f32 v164, v44, v45
v_mfma_f32_16x16x32_bf16 a[96:99], v[192:195], v[80:83], a[96:99]
ds_read_b64_tr_b16 a[232:233], v240 offset:49152
v_cvt_pk_bf16_f32 v165, v46, v47
v_exp_f32 v60, v60
v_mfma_f32_16x16x32_bf16 a[100:103], v[192:195], v[84:87], a[100:103]
buffer_load_dwordx4 v234, s[12:15], s58 offen offset:3072 sc1 lds
s_add_u32 s58, s58, 36864
v_mfma_f32_16x16x32_bf16 a[100:103], v[176:179], v[68:71], a[100:103]
ds_read_b64_tr_b16 a[234:235], v240 offset:53248
v_exp_f32 v61, v61
v_exp_f32 v62, v62
v_mfma_f32_16x16x32_bf16 a[104:107], v[176:179], v[72:75], a[104:107]
v_exp_f32 v63, v63
v_cvt_pk_bf16_f32 v166, v60, v61
v_cvt_pk_bf16_f32 v167, v62, v63
v_mfma_f32_16x16x32_bf16 a[104:107], v[192:195], v[88:91], a[104:107]
ds_read_b64_tr_b16 a[236:237], v240 offset:57344
v_exp_f32 v32, v32
v_exp_f32 v33, v33
s_add_u32 m0, s64, 4096
v_mfma_f32_16x16x32_bf16 a[108:111], v[192:195], v[92:95], a[108:111]
buffer_load_dwordx4 v234, s[12:15], s59 offen offset:0 sc1 lds
v_mfma_f32_16x16x32_bf16 a[108:111], v[176:179], v[76:79], a[108:111]
s_waitcnt lgkmcnt(7)
ds_read_b64_tr_b16 a[238:239], v240 offset:61440
v_exp_f32 v34, v34
v_exp_f32 v35, v35
v_mfma_f32_16x16x32_bf16 a[140:143], v[196:199], v[76:79], a[140:143]
v_add_f32 v124, v124, v32
v_add_f32 v124, v124, v33
v_add_f32 v124, v124, v34
v_add_f32 v124, v124, v35
v_cvt_pk_bf16_f32 v152, v32, v33
v_mfma_f32_16x16x32_bf16 a[140:143], v[200:203], v[92:95], a[140:143]
ds_read_b64_tr_b16 a[240:241], v241 offset:49152
v_cvt_pk_bf16_f32 v153, v34, v35
v_exp_f32 v48, v48
v_mfma_f32_16x16x32_bf16 a[136:139], v[200:203], v[88:91], a[136:139]
buffer_load_dwordx4 v234, s[12:15], s59 offen offset:1024 sc1 lds
v_mfma_f32_16x16x32_bf16 a[136:139], v[196:199], v[72:75], a[136:139]
ds_read_b64_tr_b16 a[242:243], v241 offset:53248
v_exp_f32 v49, v49
v_exp_f32 v50, v50
v_mfma_f32_16x16x32_bf16 a[132:135], v[196:199], v[68:71], a[132:135]
v_exp_f32 v51, v51
v_add_f32 v124, v124, v48
v_add_f32 v124, v124, v49
v_add_f32 v124, v124, v50
v_mfma_f32_16x16x32_bf16 a[132:135], v[200:203], v[84:87], a[132:135]
ds_read_b64_tr_b16 a[244:245], v241 offset:57344
v_add_f32 v124, v124, v51
v_cvt_pk_bf16_f32 v154, v48, v49
v_cvt_pk_bf16_f32 v155, v50, v51
v_mfma_f32_16x16x32_bf16 a[128:131], v[200:203], v[80:83], a[128:131]
buffer_load_dwordx4 v234, s[12:15], s59 offen offset:2048 sc1 lds
v_mfma_f32_16x16x32_bf16 a[128:131], v[196:199], v[64:67], a[128:131]
ds_read_b64_tr_b16 a[246:247], v241 offset:61440
v_exp_f32 v36, v36
v_exp_f32 v37, v37
v_mfma_f32_16x16x32_bf16 a[160:163], v[204:207], v[64:67], a[160:163]
v_exp_f32 v38, v38
v_exp_f32 v39, v39
v_add_f32 v125, v125, v36
v_mfma_f32_16x16x32_bf16 a[160:163], v[220:223], v[80:83], a[160:163]
ds_read_b64_tr_b16 a[248:249], v242 offset:49152
v_add_f32 v125, v125, v37
v_add_f32 v125, v125, v38
v_add_f32 v125, v125, v39
v_cvt_pk_bf16_f32 v156, v36, v37
v_mfma_f32_16x16x32_bf16 a[164:167], v[220:223], v[84:87], a[164:167]
buffer_load_dwordx4 v234, s[12:15], s59 offen offset:3072 sc1 lds
s_add_u32 s59, s59, 36864
v_mfma_f32_16x16x32_bf16 a[164:167], v[204:207], v[68:71], a[164:167]
ds_read_b64_tr_b16 a[250:251], v242 offset:53248
v_cvt_pk_bf16_f32 v157, v38, v39
v_exp_f32 v52, v52
v_mfma_f32_16x16x32_bf16 a[168:171], v[204:207], v[72:75], a[168:171]
v_exp_f32 v53, v53
v_exp_f32 v54, v54
v_mfma_f32_16x16x32_bf16 a[168:171], v[220:223], v[88:91], a[168:171]
ds_read_b64_tr_b16 a[252:253], v242 offset:57344
v_exp_f32 v55, v55
v_add_f32 v125, v125, v52
v_add_f32 v125, v125, v53
s_add_u32 m0, s64, 8192
v_mfma_f32_16x16x32_bf16 a[172:175], v[220:223], v[92:95], a[172:175]
buffer_load_dwordx4 v234, s[12:15], s72 offen offset:0 sc1 lds
s_add_u32 s72, s72, 36864
s_add_u32 s64, s64, 36864
s_cmp_ge_u32 s64, 147456
s_cselect_b32 s64, s60, s64
v_mfma_f32_16x16x32_bf16 a[172:175], v[204:207], v[76:79], a[172:175]
ds_read_b64_tr_b16 a[254:255], v242 offset:61440
v_add_f32 v125, v125, v54
v_add_f32 v125, v125, v55
v_cvt_pk_bf16_f32 v158, v52, v53
v_cvt_pk_bf16_f32 v159, v54, v55
v_mfma_f32_16x16x32_bf16 v[116:119], v[120:123], v[76:79], v[116:119]
v_mfma_f32_16x16x32_bf16 v[116:119], v[120:123], v[92:95], v[116:119]
v_mfma_f32_16x16x32_bf16 v[112:115], v[120:123], v[144:147], v[112:115]
buffer_load_dwordx4 a[208:211], v183, s[28:31], s61 offen sc1
v_mfma_f32_16x16x32_bf16 v[112:115], v[120:123], v[160:163], v[112:115]
ds_read_b64_tr_b16 v[168:169], v243 offset:49152
v_mfma_f32_16x16x32_bf16 v[116:119], v[120:123], v[148:151], v[116:119]
v_mfma_f32_16x16x32_bf16 v[116:119], v[120:123], v[164:167], v[116:119]
s_waitcnt lgkmcnt(9)
ds_read_b64_tr_b16 v[170:171], v243 offset:53248
v_mfma_f32_16x16x32_bf16 a[12:15], a[224:227], v[148:151], a[12:15]
buffer_load_dwordx4 a[212:215], v184, s[28:31], s61 offen sc1
s_add_u32 s61, s61, 4096
v_mfma_f32_16x16x32_bf16 a[12:15], a[228:231], v[164:167], a[12:15]
ds_read_b64_tr_b16 v[172:173], v243 offset:57344
v_mfma_f32_16x16x32_bf16 a[8:11], a[228:231], v[160:163], a[8:11]
v_mov_b32 v248, v124
v_mov_b32 v249, v125
v_mfma_f32_16x16x32_bf16 a[8:11], a[224:227], v[144:147], a[8:11]
ds_read_b64_tr_b16 v[174:175], v243 offset:61440
s_nop 1
v_mfma_f32_16x16x32_bf16 a[4:7], a[224:227], v[140:143], a[4:7]
buffer_load_dwordx4 a[216:219], v183, s[28:31], s61 offen sc1
v_mfma_f32_16x16x32_bf16 a[4:7], a[228:231], v[156:159], a[4:7]
ds_read_b64_tr_b16 v[176:177], v244 offset:49152
v_permlane16_swap_b32 v124, v248
v_mfma_f32_16x16x32_bf16 a[0:3], a[228:231], v[152:155], a[0:3]
v_permlane16_swap_b32 v125, v249
v_add_f32 v124, v124, v248
v_mfma_f32_16x16x32_bf16 a[0:3], a[224:227], v[136:139], a[0:3]
ds_read_b64_tr_b16 v[178:179], v244 offset:53248
v_add_f32 v125, v125, v249
v_mfma_f32_16x16x32_bf16 a[16:19], a[232:235], v[136:139], a[16:19]
buffer_load_dwordx4 a[220:223], v184, s[28:31], s61 offen sc1
s_add_u32 s61, s61, 4096
v_mfma_f32_16x16x32_bf16 a[16:19], a[236:239], v[152:155], a[16:19]
ds_read_b64_tr_b16 v[192:193], v244 offset:57344
v_mov_b32 v248, v124
v_mfma_f32_16x16x32_bf16 a[20:23], a[236:239], v[156:159], a[20:23]
v_mov_b32 v249, v125
s_nop 1
v_mfma_f32_16x16x32_bf16 a[20:23], a[232:235], v[140:143], a[20:23]
ds_read_b64_tr_b16 v[194:195], v244 offset:61440
v_permlane32_swap_b32 v124, v248
v_mfma_f32_16x16x32_bf16 a[24:27], a[232:235], v[144:147], a[24:27]
buffer_load_dwordx2 v[208:209], v185, s[8:11], s41 offen offset:0
v_mfma_f32_16x16x32_bf16 a[24:27], a[236:239], v[160:163], a[24:27]
ds_read_b64_tr_b16 v[196:197], v245 offset:49152
v_permlane32_swap_b32 v125, v249
v_mfma_f32_16x16x32_bf16 a[28:31], a[236:239], v[164:167], a[28:31]
v_add_f32 v124, v124, v248
v_add_f32 v125, v125, v249
v_mfma_f32_16x16x32_bf16 a[28:31], a[232:235], v[148:151], a[28:31]
s_waitcnt lgkmcnt(9)
ds_read_b64_tr_b16 v[198:199], v245 offset:53248
v_mov_b32 v126, v112
v_mfma_f32_16x16x32_bf16 a[44:47], a[240:243], v[148:151], a[44:47]
buffer_load_dwordx2 v[210:211], v185, s[8:11], s41 offen offset:32
v_mfma_f32_16x16x32_bf16 a[44:47], a[244:247], v[164:167], a[44:47]
ds_read_b64_tr_b16 v[200:201], v245 offset:57344
v_mov_b32 v127, v116
v_mfma_f32_16x16x32_bf16 a[40:43], a[244:247], v[160:163], a[40:43]
v_add_f32 v249, v124, v125
v_add_f32 v249, v249, v126
v_mfma_f32_16x16x32_bf16 a[40:43], a[240:243], v[144:147], a[40:43]
ds_read_b64_tr_b16 v[202:203], v245 offset:61440
v_add_f32 v249, v249, v127
v_mfma_f32_16x16x32_bf16 a[36:39], a[240:243], v[140:143], a[36:39]
buffer_load_dwordx2 v[212:213], v185, s[8:11], s41 offen offset:64
v_mfma_f32_16x16x32_bf16 a[36:39], a[244:247], v[156:159], a[36:39]
ds_read_b64_tr_b16 v[204:205], v246 offset:49152
s_mov_b32 s74, 0x4f800000
v_mfma_f32_16x16x32_bf16 a[32:35], a[244:247], v[152:155], a[32:35]
v_cmp_ngt_f32 vcc, s74, v249
v_mfma_f32_16x16x32_bf16 a[32:35], a[240:243], v[136:139], a[32:35]
ds_read_b64_tr_b16 v[206:207], v246 offset:53248
v_mfma_f32_16x16x32_bf16 a[48:51], a[248:251], v[136:139], a[48:51]
buffer_load_dwordx2 v[214:215], v185, s[8:11], s41 offen offset:96
v_mfma_f32_16x16x32_bf16 a[48:51], a[252:255], v[152:155], a[48:51]
ds_read_b64_tr_b16 v[220:221], v246 offset:57344
v_mfma_f32_16x16x32_bf16 a[52:55], a[252:255], v[156:159], a[52:55]
v_rcp_f32 v124, v124
v_mfma_f32_16x16x32_bf16 a[52:55], a[248:251], v[140:143], a[52:55]
ds_read_b64_tr_b16 v[222:223], v246 offset:61440
v_mfma_f32_16x16x32_bf16 a[56:59], a[248:251], v[144:147], a[56:59]
buffer_load_dwordx2 v[216:217], v185, s[8:11], s78 offen offset:128
v_mfma_f32_16x16x32_bf16 a[56:59], a[252:255], v[160:163], a[56:59]
v_rcp_f32 v125, v125
v_mfma_f32_16x16x32_bf16 a[60:63], a[252:255], v[164:167], a[60:63]
v_rcp_f32 v126, v126
v_mfma_f32_16x16x32_bf16 a[60:63], a[248:251], v[148:151], a[60:63]
s_waitcnt lgkmcnt(8)
v_rcp_f32 v127, v127
v_mfma_f32_16x16x32_bf16 a[76:79], v[168:171], v[148:151], a[76:79]
v_mov_b32 v249, 159744
v_mov_b32 v250, 1
v_mfma_f32_16x16x32_bf16 a[76:79], v[172:175], v[164:167], a[76:79]
v_mfma_f32_16x16x32_bf16 a[72:75], v[172:175], v[160:163], a[72:75]
buffer_load_dwordx4 a[224:227], v183, s[28:31], s61 offen sc1
v_mfma_f32_16x16x32_bf16 a[72:75], v[168:171], v[144:147], a[72:75]
v_mfma_f32_16x16x32_bf16 a[68:71], v[168:171], v[140:143], a[68:71]
v_mfma_f32_16x16x32_bf16 a[68:71], v[172:175], v[156:159], a[68:71]
v_mfma_f32_16x16x32_bf16 a[64:67], v[172:175], v[152:155], a[64:67]
buffer_load_dwordx4 a[228:231], v184, s[28:31], s61 offen sc1
s_add_u32 s61, s61, 4096
v_mfma_f32_16x16x32_bf16 a[64:67], v[168:171], v[136:139], a[64:67]
v_mfma_f32_16x16x32_bf16 a[96:99], v[176:179], v[136:139], a[96:99]
v_mfma_f32_16x16x32_bf16 a[96:99], v[192:195], v[152:155], a[96:99]
v_mfma_f32_16x16x32_bf16 a[100:103], v[192:195], v[156:159], a[100:103]
buffer_load_dwordx4 a[232:235], v183, s[28:31], s61 offen sc1
v_mfma_f32_16x16x32_bf16 a[100:103], v[176:179], v[140:143], a[100:103]
v_mfma_f32_16x16x32_bf16 a[104:107], v[176:179], v[144:147], a[104:107]
v_mfma_f32_16x16x32_bf16 a[104:107], v[192:195], v[160:163], a[104:107]
v_mfma_f32_16x16x32_bf16 a[108:111], v[192:195], v[164:167], a[108:111]
buffer_load_dwordx4 a[236:239], v184, s[28:31], s61 offen sc1
s_add_u32 s61, s61, 4096
v_mfma_f32_16x16x32_bf16 a[108:111], v[176:179], v[148:151], a[108:111]
s_waitcnt lgkmcnt(0)
v_mfma_f32_16x16x32_bf16 a[140:143], v[196:199], v[148:151], a[140:143]
s_mov_b32 s45, 0
v_mfma_f32_16x16x32_bf16 a[140:143], v[200:203], v[164:167], a[140:143]
s_mov_b32 s42, 0xfffe5000
v_mfma_f32_16x16x32_bf16 a[136:139], v[200:203], v[160:163], a[136:139]
s_mul_i32 s63, s53, 272
buffer_load_dwordx4 a[240:243], v183, s[28:31], s61 offen sc1
v_mfma_f32_16x16x32_bf16 a[136:139], v[196:199], v[144:147], a[136:139]
s_lshl_b32 s75, s50, 2
v_mfma_f32_16x16x32_bf16 a[132:135], v[196:199], v[140:143], a[132:135]
s_add_u32 s63, s63, s75
v_mfma_f32_16x16x32_bf16 a[132:135], v[200:203], v[156:159], a[132:135]
s_lshl_b32 s63, s63, 12
s_cbranch_vccz k1_ok
ds_write_b32 v249, v250
k1_ok:
v_mfma_f32_16x16x32_bf16 a[128:131], v[200:203], v[152:155], a[128:131]
buffer_load_dwordx4 a[244:247], v184, s[28:31], s61 offen sc1
s_add_u32 s61, s61, 4096
v_mfma_f32_16x16x32_bf16 a[128:131], v[196:199], v[136:139], a[128:131]
v_mfma_f32_16x16x32_bf16 a[160:163], v[204:207], v[136:139], a[160:163]
v_mfma_f32_16x16x32_bf16 a[160:163], v[220:223], v[152:155], a[160:163]
s_waitcnt vmcnt(24)
v_mfma_f32_16x16x32_bf16 a[164:167], v[220:223], v[156:159], a[164:167]
s_waitcnt lgkmcnt(0)
buffer_load_dwordx4 a[248:251], v183, s[28:31], s61 offen sc1
v_mfma_f32_16x16x32_bf16 a[164:167], v[204:207], v[140:143], a[164:167]
s_barrier
v_mfma_f32_16x16x32_bf16 a[168:171], v[204:207], v[144:147], a[168:171]
ds_read_b32 v251, v249
v_mfma_f32_16x16x32_bf16 a[168:171], v[220:223], v[160:163], a[168:171]
v_mfma_f32_16x16x32_bf16 a[172:175], v[220:223], v[164:167], a[172:175]
buffer_load_dwordx4 a[252:255], v184, s[28:31], s61 offen sc1
s_add_u32 s61, s61, 4096
v_mfma_f32_16x16x32_bf16 a[172:175], v[204:207], v[148:151], a[172:175]
ds_read_b64_tr_b16 v[144:145], v180 offset:0
ds_read_b64_tr_b16 v[146:147], v180 offset:4608
ds_read_b64_tr_b16 v[148:149], v180 offset:9216
ds_read_b64_tr_b16 v[150:151], v180 offset:13824
ds_read_b64_tr_b16 v[152:153], v180 offset:32
ds_read_b64_tr_b16 v[154:155], v180 offset:4640
ds_read_b64_tr_b16 v[156:157], v180 offset:9248
ds_read_b64_tr_b16 v[158:159], v180 offset:13856
ds_read_b64_tr_b16 v[160:161], v180 offset:64
ds_read_b64_tr_b16 v[162:163], v180 offset:4672
ds_read_b64_tr_b16 v[164:165], v180 offset:9280
ds_read_b64_tr_b16 v[166:167], v180 offset:13888
s_waitcnt lgkmcnt(4)
v_readfirstlane_b32 s74, v251
s_nop 1
s_andn2_b32 s74, s74, s66
s_cbranch_scc1 k1_fb
s_lshl_b32 s53, s53, 2
s_lshr_b32 s74, s50, 3
s_add_u32 s53, s53, s74
s_add_u32 s53, s53, 64
s_lshl_b32 s53, s53, 6
s_and_b32 s74, s50, 7
s_lshl_b32 s74, s74, 2
s_add_u32 s53, s53, s74
v_mov_b32 v188, v132
v_mov_b32 v189, v133
v_mov_b32 v190, 1
v_mfma_f32_16x16x32_bf16 v[0:3], v[144:147], a[192:195], 0
ds_read_b64_tr_b16 v[168:169], v180 offset:96
v_accvgpr_read_b32 v72, a0
v_accvgpr_read_b32 v73, a1
v_accvgpr_read_b32 v74, a2
v_mfma_f32_16x16x32_bf16 v[0:3], v[148:151], a[200:203], v[0:3]
s_add_u32 m0, s64, 0
ds_read_b64_tr_b16 v[170:171], v180 offset:4704
v_accvgpr_read_b32 v75, a3
v_accvgpr_read_b32 v76, a16
v_accvgpr_read_b32 v77, a17
v_mfma_f32_16x16x32_bf16 v[4:7], v[148:151], a[204:207], 0
buffer_load_dwordx4 v234, s[12:15], s58 offen offset:0 sc1 lds
v_mfma_f32_16x16x32_bf16 v[4:7], v[144:147], a[196:199], v[4:7]
ds_read_b64_tr_b16 v[172:173], v180 offset:9312
ds_read_b64_tr_b16 v[174:175], v180 offset:13920
v_accvgpr_read_b32 v78, a18
v_accvgpr_read_b32 v79, a19
v_mfma_f32_16x16x32_bf16 v[12:15], v[152:155], a[196:199], 0
ds_read_b64_tr_b16 v[176:177], v181 offset:128
v_mul_f32 v72, v124, v72
v_mul_f32 v73, v124, v73
v_mul_f32 v74, v124, v74
v_mfma_f32_16x16x32_bf16 v[12:15], v[156:159], a[204:207], v[12:15]
s_waitcnt lgkmcnt(5)
buffer_load_dwordx4 v234, s[12:15], s58 offen offset:1024 sc1 lds
v_mfma_f32_16x16x32_bf16 v[8:11], v[156:159], a[200:203], 0
ds_read_b64_tr_b16 v[178:179], v181 offset:4736
v_mul_f32 v75, v124, v75
v_mul_f32 v76, v124, v76
v_mul_f32 v77, v124, v77
v_mfma_f32_16x16x32_bf16 v[8:11], v[152:155], a[192:195], v[8:11]
ds_read_b64_tr_b16 v[144:145], v181 offset:9344
ds_read_b64_tr_b16 v[146:147], v181 offset:13952
v_mul_f32 v78, v124, v78
v_mul_f32 v79, v124, v79
v_mfma_f32_16x16x32_bf16 v[16:19], v[160:163], a[192:195], 0
buffer_load_dwordx4 v234, s[12:15], s58 offen offset:2048 sc1 lds
v_mfma_f32_16x16x32_bf16 v[16:19], v[164:167], a[200:203], v[16:19]
ds_read_b64_tr_b16 v[148:149], v182 offset:0
v_cvt_pk_bf16_f32 v80, v72, v73
v_cvt_pk_bf16_f32 v81, v74, v75
v_cvt_pk_bf16_f32 v82, v76, v77
v_mfma_f32_16x16x32_bf16 v[20:23], v[164:167], a[204:207], 0
ds_read_b64_tr_b16 v[150:151], v182 offset:4608
v_cvt_pk_bf16_f32 v83, v78, v79
v_mfma_f32_16x16x32_bf16 v[20:23], v[160:163], a[196:199], v[20:23]
s_waitcnt lgkmcnt(2)
buffer_store_dwordx4 v[80:83], v234, s[28:31], s63 offen offset:0 sc1
v_mfma_f32_16x16x32_bf16 v[28:31], v[168:171], a[196:199], 0
ds_read_b64_tr_b16 v[152:153], v182 offset:9216
ds_read_b64_tr_b16 v[154:155], v182 offset:13824
v_accvgpr_read_b32 v84, a4
v_accvgpr_read_b32 v85, a5
v_mfma_f32_16x16x32_bf16 v[28:31], v[172:175], a[204:207], v[28:31]
ds_read_b64_tr_b16 v[156:157], v182 offset:32
v_accvgpr_read_b32 v86, a6
v_accvgpr_read_b32 v87, a7
v_accvgpr_read_b32 v88, a20
v_mfma_f32_16x16x32_bf16 v[24:27], v[172:175], a[200:203], 0
buffer_load_dwordx4 v234, s[12:15], s58 offen offset:3072 sc1 lds
v_mfma_f32_16x16x32_bf16 v[24:27], v[168:171], a[192:195], v[24:27]
s_add_u32 s58, s58, 36864
ds_read_b64_tr_b16 v[158:159], v182 offset:4640
ds_read_b64_tr_b16 v[160:161], v182 offset:9248
v_accvgpr_read_b32 v89, a21
v_accvgpr_read_b32 v90, a22
v_mfma_f32_16x16x32_bf16 v[32:35], v[176:179], a[192:195], 0
s_waitcnt vmcnt(31)
ds_read_b64_tr_b16 v[162:163], v182 offset:13856
v_accvgpr_read_b32 v91, a23
v_mul_f32 v84, v125, v84
v_mul_f32 v85, v125, v85
s_add_u32 m0, s64, 4096
v_mfma_f32_16x16x32_bf16 v[32:35], v[144:147], a[200:203], v[32:35]
s_waitcnt lgkmcnt(4)
buffer_load_dwordx4 v234, s[12:15], s59 offen offset:0 sc1 lds
v_mfma_f32_16x16x32_bf16 v[36:39], v[144:147], a[204:207], 0
ds_read_b64_tr_b16 v[164:165], v182 offset:64
ds_read_b64_tr_b16 v[166:167], v182 offset:4672
v_mul_f32 v86, v125, v86
v_mul_f32 v87, v125, v87
v_mfma_f32_16x16x32_bf16 v[36:39], v[176:179], a[196:199], v[36:39]
ds_read_b64_tr_b16 v[168:169], v182 offset:9280
ds_read_b64_tr_b16 v[170:171], v182 offset:13888
v_mul_f32 v88, v125, v88
v_mul_f32 v89, v125, v89
v_mfma_f32_16x16x32_bf16 v[44:47], v[148:151], a[196:199], 0
buffer_load_dwordx4 v234, s[12:15], s59 offen offset:1024 sc1 lds
v_mfma_f32_16x16x32_bf16 v[44:47], v[152:155], a[204:207], v[44:47]
ds_read_b64_tr_b16 v[172:173], v182 offset:96
v_mul_f32 v90, v125, v90
v_mul_f32 v91, v125, v91
v_cvt_pk_bf16_f32 v92, v84, v85
v_mfma_f32_16x16x32_bf16 v[40:43], v[152:155], a[200:203], 0
ds_read_b64_tr_b16 v[174:175], v182 offset:4704
v_cvt_pk_bf16_f32 v93, v86, v87
v_cvt_pk_bf16_f32 v94, v88, v89
v_cvt_pk_bf16_f32 v95, v90, v91
v_mfma_f32_16x16x32_bf16 v[40:43], v[148:151], a[192:195], v[40:43]
s_waitcnt lgkmcnt(2)
buffer_store_dwordx4 v[92:95], v234, s[28:31], s63 offen offset:1024 sc1
v_mfma_f32_16x16x32_bf16 v[48:51], v[156:159], a[192:195], 0
ds_read_b64_tr_b16 v[176:177], v182 offset:9312
ds_read_b64_tr_b16 v[178:179], v182 offset:13920
v_accvgpr_read_b32 v96, a8
v_accvgpr_read_b32 v97, a9
v_mfma_f32_16x16x32_bf16 v[48:51], v[160:163], a[200:203], v[48:51]
ds_read_b64_tr_b16 v[144:145], v180 offset:18432
v_accvgpr_read_b32 v98, a10
v_accvgpr_read_b32 v99, a11
v_accvgpr_read_b32 v100, a24
v_mfma_f32_16x16x32_bf16 v[52:55], v[160:163], a[204:207], 0
buffer_load_dwordx4 v234, s[12:15], s59 offen offset:2048 sc1 lds
v_mfma_f32_16x16x32_bf16 v[52:55], v[156:159], a[196:199], v[52:55]
ds_read_b64_tr_b16 v[146:147], v180 offset:23040
ds_read_b64_tr_b16 v[148:149], v180 offset:27648
v_accvgpr_read_b32 v101, a25
v_accvgpr_read_b32 v102, a26
v_mfma_f32_16x16x32_bf16 v[60:63], v[164:167], a[196:199], 0
ds_read_b64_tr_b16 v[150:151], v180 offset:32256
v_accvgpr_read_b32 v103, a27
v_mul_f32 v96, v126, v96
v_mul_f32 v97, v126, v97
v_mfma_f32_16x16x32_bf16 v[60:63], v[168:171], a[204:207], v[60:63]
s_waitcnt lgkmcnt(4)
buffer_load_dwordx4 v234, s[12:15], s59 offen offset:3072 sc1 lds
v_mfma_f32_16x16x32_bf16 v[56:59], v[168:171], a[200:203], 0
s_add_u32 s59, s59, 36864
ds_read_b64_tr_b16 v[152:153], v180 offset:18464
ds_read_b64_tr_b16 v[154:155], v180 offset:23072
v_mul_f32 v98, v126, v98
v_mul_f32 v99, v126, v99
v_mfma_f32_16x16x32_bf16 v[56:59], v[164:167], a[192:195], v[56:59]
s_add_u32 m0, s64, 8192
ds_read_b64_tr_b16 v[156:157], v180 offset:27680
ds_read_b64_tr_b16 v[158:159], v180 offset:32288
v_mul_f32 v100, v126, v100
v_mul_f32 v101, v126, v101
v_mfma_f32_16x16x32_bf16 v[64:67], v[172:175], a[192:195], 0
buffer_load_dwordx4 v234, s[12:15], s72 offen offset:0 sc1 lds
s_add_u32 s72, s72, 36864
s_add_u32 s64, s64, 36864
s_cmp_ge_u32 s64, 147456
s_cselect_b32 s64, s60, s64
v_mfma_f32_16x16x32_bf16 v[64:67], v[176:179], a[200:203], v[64:67]
ds_read_b64_tr_b16 v[160:161], v180 offset:18496
v_mul_f32 v102, v126, v102
v_mul_f32 v103, v126, v103
v_cvt_pk_bf16_f32 v104, v96, v97
v_mfma_f32_16x16x32_bf16 v[68:71], v[176:179], a[204:207], 0
s_waitcnt vmcnt(24)
ds_read_b64_tr_b16 v[162:163], v180 offset:23104
v_cvt_pk_bf16_f32 v105, v98, v99
v_cvt_pk_bf16_f32 v106, v100, v101
v_cvt_pk_bf16_f32 v107, v102, v103
v_mfma_f32_16x16x32_bf16 v[68:71], v[172:175], a[196:199], v[68:71]
s_waitcnt lgkmcnt(2)
buffer_store_dwordx4 v[104:107], v234, s[28:31], s63 offen offset:2048 sc1
v_mfma_f32_16x16x32_bf16 v[4:7], v[144:147], a[212:215], v[4:7]
ds_read_b64_tr_b16 v[164:165], v180 offset:27712
ds_read_b64_tr_b16 v[166:167], v180 offset:32320
v_accvgpr_read_b32 v72, a12
v_accvgpr_read_b32 v73, a13
v_mfma_f32_16x16x32_bf16 v[4:7], v[148:151], a[220:223], v[4:7]
ds_read_b64_tr_b16 v[168:169], v180 offset:18528
v_accvgpr_read_b32 v74, a14
v_accvgpr_read_b32 v75, a15
v_accvgpr_read_b32 v76, a28
v_mfma_f32_16x16x32_bf16 v[0:3], v[148:151], a[216:219], v[0:3]
buffer_load_dwordx4 a[192:195], v183, s[28:31], s61 offen sc1
v_mfma_f32_16x16x32_bf16 v[0:3], v[144:147], a[208:211], v[0:3]
ds_read_b64_tr_b16 v[170:171], v180 offset:23136
ds_read_b64_tr_b16 v[172:173], v180 offset:27744
v_accvgpr_read_b32 v77, a29
v_accvgpr_read_b32 v78, a30
v_mfma_f32_16x16x32_bf16 v[8:11], v[152:155], a[208:211], v[8:11]
s_waitcnt vmcnt(26)
ds_add_u32 v188, v190
ds_read_b64_tr_b16 v[174:175], v180 offset:32352
v_accvgpr_read_b32 v79, a31
v_mul_f32 v72, v127, v72
v_mfma_f32_16x16x32_bf16 v[8:11], v[156:159], a[216:219], v[8:11]
s_waitcnt lgkmcnt(5)
buffer_load_dwordx4 a[196:199], v184, s[28:31], s61 offen sc1
s_add_u32 s61, s61, 4096
v_mfma_f32_16x16x32_bf16 v[12:15], v[156:159], a[220:223], v[12:15]
s_add_u32 s47, s47, 1
ds_read_b64_tr_b16 v[176:177], v181 offset:18560
ds_read_b64_tr_b16 v[178:179], v181 offset:23168
v_mul_f32 v73, v127, v73
v_mul_f32 v74, v127, v74
v_mfma_f32_16x16x32_bf16 v[12:15], v[152:155], a[212:215], v[12:15]
ds_read_b64_tr_b16 v[144:145], v181 offset:27776
ds_read_b64_tr_b16 v[146:147], v181 offset:32384
v_mul_f32 v75, v127, v75
v_mul_f32 v76, v127, v76
v_mfma_f32_16x16x32_bf16 v[20:23], v[160:163], a[212:215], v[20:23]
s_add_u32 s45, s45, 1
buffer_load_dwordx4 a[200:203], v183, s[28:31], s61 offen sc1
v_mfma_f32_16x16x32_bf16 v[20:23], v[164:167], a[220:223], v[20:23]
ds_read_b64_tr_b16 v[148:149], v182 offset:18432
v_mul_f32 v77, v127, v77
v_mul_f32 v78, v127, v78
v_mul_f32 v79, v127, v79
v_mfma_f32_16x16x32_bf16 v[16:19], v[164:167], a[216:219], v[16:19]
s_and_b32 s45, s45, 3
s_cselect_b32 s46, 36864, s42
ds_read_b64_tr_b16 v[150:151], v182 offset:23040
v_cvt_pk_bf16_f32 v80, v72, v73
v_cvt_pk_bf16_f32 v81, v74, v75
v_cvt_pk_bf16_f32 v82, v76, v77
v_mfma_f32_16x16x32_bf16 v[16:19], v[160:163], a[208:211], v[16:19]
s_waitcnt lgkmcnt(2)
buffer_load_dwordx4 a[204:207], v184, s[28:31], s61 offen sc1
v_mfma_f32_16x16x32_bf16 v[24:27], v[168:171], a[208:211], v[24:27]
s_add_u32 s61, s61, 4096
ds_read_b32 v191, v189
v_cvt_pk_bf16_f32 v83, v78, v79
v_mfma_f32_16x16x32_bf16 v[24:27], v[172:175], a[216:219], v[24:27]
ds_read_b64_tr_b16 v[152:153], v182 offset:27648
ds_read_b64_tr_b16 v[154:155], v182 offset:32256
v_mfma_f32_16x16x32_bf16 v[28:31], v[172:175], a[220:223], v[28:31]
buffer_store_dwordx4 v[80:83], v234, s[28:31], s63 offen offset:3072 sc1
v_mfma_f32_16x16x32_bf16 v[28:31], v[168:171], a[212:215], v[28:31]
ds_read_b64_tr_b16 v[156:157], v182 offset:18464
ds_read_b64_tr_b16 v[158:159], v182 offset:23072
v_add_u32 v180, s46, v180
s_add_u32 s63, s63, 4096
v_mfma_f32_16x16x32_bf16 v[36:39], v[176:179], a[212:215], v[36:39]
s_waitcnt vmcnt(30)
ds_read_b64_tr_b16 v[160:161], v182 offset:27680
ds_read_b64_tr_b16 v[162:163], v182 offset:32288
v_add_u32 v181, s46, v181
v_accvgpr_read_b32 v84, a32
v_mfma_f32_16x16x32_bf16 v[36:39], v[144:147], a[220:223], v[36:39]
s_waitcnt lgkmcnt(4)
v_mfma_f32_16x16x32_bf16 v[32:35], v[144:147], a[216:219], v[32:35]
ds_read_b64_tr_b16 v[164:165], v182 offset:18496
v_cmp_gt_u32 vcc, s47, v191
v_accvgpr_read_b32 v85, a33
v_accvgpr_read_b32 v86, a34
v_mfma_f32_16x16x32_bf16 v[32:35], v[176:179], a[208:211], v[32:35]
ds_read_b64_tr_b16 v[166:167], v182 offset:23104
ds_read_b64_tr_b16 v[168:169], v182 offset:27712
v_accvgpr_read_b32 v87, a35
v_accvgpr_read_b32 v88, a48
v_mfma_f32_16x16x32_bf16 v[40:43], v[148:151], a[208:211], v[40:43]
v_mfma_f32_16x16x32_bf16 v[40:43], v[152:155], a[216:219], v[40:43]
s_cbranch_vccnz k1_f0_s
k1_f0_b:
ds_read_b64_tr_b16 v[170:171], v182 offset:32320
v_accvgpr_read_b32 v89, a49
v_accvgpr_read_b32 v90, a50
v_accvgpr_read_b32 v91, a51
v_mfma_f32_16x16x32_bf16 v[44:47], v[152:155], a[220:223], v[44:47]
ds_read_b64_tr_b16 v[172:173], v182 offset:18528
ds_read_b64_tr_b16 v[174:175], v182 offset:23136
v_mul_f32 v84, v124, v84
v_mul_f32 v85, v124, v85
v_mfma_f32_16x16x32_bf16 v[44:47], v[148:151], a[212:215], v[44:47]
s_waitcnt lgkmcnt(2)
v_mfma_f32_16x16x32_bf16 v[52:55], v[156:159], a[212:215], v[52:55]
ds_read_b64_tr_b16 v[176:177], v182 offset:27744
ds_read_b64_tr_b16 v[178:179], v182 offset:32352
v_add_u32 v182, s46, v182
v_mul_f32 v86, v124, v86
v_mfma_f32_16x16x32_bf16 v[52:55], v[160:163], a[220:223], v[52:55]
ds_read_b64_tr_b16 v[144:145], v180 offset:0
v_mul_f32 v87, v124, v87
v_mul_f32 v88, v124, v88
v_mul_f32 v89, v124, v89
v_mfma_f32_16x16x32_bf16 v[48:51], v[160:163], a[216:219], v[48:51]
v_mfma_f32_16x16x32_bf16 v[48:51], v[156:159], a[208:211], v[48:51]
ds_read_b64_tr_b16 v[146:147], v180 offset:4608
ds_read_b64_tr_b16 v[148:149], v180 offset:9216
v_mul_f32 v90, v124, v90
v_mul_f32 v91, v124, v91
v_mfma_f32_16x16x32_bf16 v[56:59], v[164:167], a[208:211], v[56:59]
ds_read_b64_tr_b16 v[150:151], v180 offset:13824
v_cvt_pk_bf16_f32 v92, v84, v85
v_cvt_pk_bf16_f32 v93, v86, v87
v_cvt_pk_bf16_f32 v94, v88, v89
v_mfma_f32_16x16x32_bf16 v[56:59], v[168:171], a[216:219], v[56:59]
s_waitcnt lgkmcnt(4)
v_mfma_f32_16x16x32_bf16 v[60:63], v[168:171], a[220:223], v[60:63]
ds_read_b64_tr_b16 v[152:153], v180 offset:32
ds_read_b64_tr_b16 v[154:155], v180 offset:4640
v_cvt_pk_bf16_f32 v95, v90, v91
v_mfma_f32_16x16x32_bf16 v[60:63], v[164:167], a[212:215], v[60:63]
ds_read_b64_tr_b16 v[156:157], v180 offset:9248
ds_read_b64_tr_b16 v[158:159], v180 offset:13856
v_mfma_f32_16x16x32_bf16 v[68:71], v[172:175], a[212:215], v[68:71]
buffer_store_dwordx4 v[92:95], v234, s[28:31], s63 offen offset:0 sc1
v_mfma_f32_16x16x32_bf16 v[68:71], v[176:179], a[220:223], v[68:71]
ds_read_b64_tr_b16 v[160:161], v180 offset:64
v_accvgpr_read_b32 v96, a36
v_accvgpr_read_b32 v97, a37
v_accvgpr_read_b32 v98, a38
v_mfma_f32_16x16x32_bf16 v[64:67], v[176:179], a[216:219], v[64:67]
s_waitcnt vmcnt(22)
ds_read_b64_tr_b16 v[162:163], v180 offset:4672
v_accvgpr_read_b32 v99, a39
v_accvgpr_read_b32 v100, a52
v_accvgpr_read_b32 v101, a53
v_mfma_f32_16x16x32_bf16 v[64:67], v[172:175], a[208:211], v[64:67]
s_waitcnt lgkmcnt(2)
ds_read_b64_tr_b16 v[164:165], v180 offset:9280
ds_read_b64_tr_b16 v[166:167], v180 offset:13888
v_accvgpr_read_b32 v102, a54
v_accvgpr_read_b32 v103, a55
v_mfma_f32_16x16x32_bf16 v[0:3], v[144:147], a[224:227], v[0:3]
ds_read_b64_tr_b16 v[168:169], v180 offset:96
v_mul_f32 v96, v125, v96
v_mul_f32 v97, v125, v97
v_mul_f32 v98, v125, v98
v_mfma_f32_16x16x32_bf16 v[0:3], v[148:151], a[232:235], v[0:3]
ds_read_b64_tr_b16 v[170:171], v180 offset:4704
v_mul_f32 v99, v125, v99
v_mul_f32 v100, v125, v100
v_mul_f32 v101, v125, v101
v_mfma_f32_16x16x32_bf16 v[4:7], v[148:151], a[236:239], v[4:7]
buffer_load_dwordx4 a[208:211], v183, s[28:31], s61 offen sc1
v_mfma_f32_16x16x32_bf16 v[4:7], v[144:147], a[228:231], v[4:7]
ds_read_b64_tr_b16 v[172:173], v180 offset:9312
ds_read_b64_tr_b16 v[174:175], v180 offset:13920
v_mul_f32 v102, v125, v102
v_mul_f32 v103, v125, v103
v_mfma_f32_16x16x32_bf16 v[12:15], v[152:155], a[228:231], v[12:15]
ds_read_b64_tr_b16 v[176:177], v181 offset:128
v_cvt_pk_bf16_f32 v104, v96, v97
v_cvt_pk_bf16_f32 v105, v98, v99
v_cvt_pk_bf16_f32 v106, v100, v101
v_mfma_f32_16x16x32_bf16 v[12:15], v[156:159], a[236:239], v[12:15]
s_waitcnt lgkmcnt(5)
buffer_load_dwordx4 a[212:215], v184, s[28:31], s61 offen sc1
v_mfma_f32_16x16x32_bf16 v[8:11], v[156:159], a[232:235], v[8:11]
s_add_u32 s61, s61, 4096
ds_read_b64_tr_b16 v[178:179], v181 offset:4736
v_cvt_pk_bf16_f32 v107, v102, v103
v_mfma_f32_16x16x32_bf16 v[8:11], v[152:155], a[224:227], v[8:11]
ds_read_b64_tr_b16 v[144:145], v181 offset:9344
ds_read_b64_tr_b16 v[146:147], v181 offset:13952
v_mfma_f32_16x16x32_bf16 v[16:19], v[160:163], a[224:227], v[16:19]
buffer_store_dwordx4 v[104:107], v234, s[28:31], s63 offen offset:1024 sc1
v_mfma_f32_16x16x32_bf16 v[16:19], v[164:167], a[232:235], v[16:19]
ds_read_b64_tr_b16 v[148:149], v182 offset:0
v_accvgpr_read_b32 v72, a40
v_accvgpr_read_b32 v73, a41
v_accvgpr_read_b32 v74, a42
v_mfma_f32_16x16x32_bf16 v[20:23], v[164:167], a[236:239], v[20:23]
ds_read_b64_tr_b16 v[150:151], v182 offset:4608
v_accvgpr_read_b32 v75, a43
v_accvgpr_read_b32 v76, a56
v_accvgpr_read_b32 v77, a57
v_mfma_f32_16x16x32_bf16 v[20:23], v[160:163], a[228:231], v[20:23]
s_waitcnt lgkmcnt(2)
buffer_load_dwordx4 a[216:219], v183, s[28:31], s61 offen sc1
v_mfma_f32_16x16x32_bf16 v[28:31], v[168:171], a[228:231], v[28:31]
ds_read_b64_tr_b16 v[152:153], v182 offset:9216
ds_read_b64_tr_b16 v[154:155], v182 offset:13824
v_accvgpr_read_b32 v78, a58
v_accvgpr_read_b32 v79, a59
v_mfma_f32_16x16x32_bf16 v[28:31], v[172:175], a[236:239], v[28:31]
ds_read_b64_tr_b16 v[156:157], v182 offset:32
v_mul_f32 v72, v126, v72
v_mul_f32 v73, v126, v73
v_mul_f32 v74, v126, v74
v_mfma_f32_16x16x32_bf16 v[24:27], v[172:175], a[232:235], v[24:27]
buffer_load_dwordx4 a[220:223], v184, s[28:31], s61 offen sc1
v_mfma_f32_16x16x32_bf16 v[24:27], v[168:171], a[224:227], v[24:27]
s_add_u32 s61, s61, 4096
ds_read_b64_tr_b16 v[158:159], v182 offset:4640
ds_read_b64_tr_b16 v[160:161], v182 offset:9248
v_mul_f32 v75, v126, v75
v_mul_f32 v76, v126, v76
v_mfma_f32_16x16x32_bf16 v[32:35], v[176:179], a[224:227], v[32:35]
s_waitcnt vmcnt(27)
ds_read_b64_tr_b16 v[162:163], v182 offset:13856
v_mul_f32 v77, v126, v77
v_mul_f32 v78, v126, v78
v_mul_f32 v79, v126, v79
s_add_u32 m0, s64, 0
v_mfma_f32_16x16x32_bf16 v[32:35], v[144:147], a[232:235], v[32:35]
s_waitcnt lgkmcnt(4)
buffer_load_dwordx4 v234, s[12:15], s58 offen offset:0 sc1 lds
v_mfma_f32_16x16x32_bf16 v[36:39], v[144:147], a[236:239], v[36:39]
ds_read_b64_tr_b16 v[164:165], v182 offset:64
ds_read_b64_tr_b16 v[166:167], v182 offset:4672
v_cvt_pk_bf16_f32 v80, v72, v73
v_cvt_pk_bf16_f32 v81, v74, v75
v_mfma_f32_16x16x32_bf16 v[36:39], v[176:179], a[228:231], v[36:39]
ds_read_b64_tr_b16 v[168:169], v182 offset:9280
ds_read_b64_tr_b16 v[170:171], v182 offset:13888
v_cvt_pk_bf16_f32 v82, v76, v77
v_cvt_pk_bf16_f32 v83, v78, v79
v_mfma_f32_16x16x32_bf16 v[44:47], v[148:151], a[228:231], v[44:47]
buffer_store_dwordx4 v[80:83], v234, s[28:31], s63 offen offset:2048 sc1
v_mfma_f32_16x16x32_bf16 v[44:47], v[152:155], a[236:239], v[44:47]
ds_read_b64_tr_b16 v[172:173], v182 offset:96
v_accvgpr_read_b32 v84, a44
v_accvgpr_read_b32 v85, a45
v_accvgpr_read_b32 v86, a46
v_mfma_f32_16x16x32_bf16 v[40:43], v[152:155], a[232:235], v[40:43]
ds_read_b64_tr_b16 v[174:175], v182 offset:4704
v_accvgpr_read_b32 v87, a47
v_accvgpr_read_b32 v88, a60
v_accvgpr_read_b32 v89, a61
v_mfma_f32_16x16x32_bf16 v[40:43], v[148:151], a[224:227], v[40:43]
s_waitcnt lgkmcnt(2)
buffer_load_dwordx4 v234, s[12:15], s58 offen offset:1024 sc1 lds
v_mfma_f32_16x16x32_bf16 v[48:51], v[156:159], a[224:227], v[48:51]
ds_read_b64_tr_b16 v[176:177], v182 offset:9312
ds_read_b64_tr_b16 v[178:179], v182 offset:13920
v_accvgpr_read_b32 v90, a62
v_accvgpr_read_b32 v91, a63
v_mfma_f32_16x16x32_bf16 v[48:51], v[160:163], a[232:235], v[48:51]
ds_read_b64_tr_b16 v[144:145], v180 offset:18432
v_mul_f32 v84, v127, v84
v_mul_f32 v85, v127, v85
v_mul_f32 v86, v127, v86
v_mfma_f32_16x16x32_bf16 v[52:55], v[160:163], a[236:239], v[52:55]
buffer_load_dwordx4 v234, s[12:15], s58 offen offset:2048 sc1 lds
v_mfma_f32_16x16x32_bf16 v[52:55], v[156:159], a[228:231], v[52:55]
ds_read_b64_tr_b16 v[146:147], v180 offset:23040
ds_read_b64_tr_b16 v[148:149], v180 offset:27648
v_mul_f32 v87, v127, v87
v_mul_f32 v88, v127, v88
v_mfma_f32_16x16x32_bf16 v[60:63], v[164:167], a[228:231], v[60:63]
ds_read_b64_tr_b16 v[150:151], v180 offset:32256
v_mul_f32 v89, v127, v89
v_mul_f32 v90, v127, v90
v_mul_f32 v91, v127, v91
v_mfma_f32_16x16x32_bf16 v[60:63], v[168:171], a[236:239], v[60:63]
s_waitcnt lgkmcnt(4)
buffer_load_dwordx4 v234, s[12:15], s58 offen offset:3072 sc1 lds
v_mfma_f32_16x16x32_bf16 v[56:59], v[168:171], a[232:235], v[56:59]
s_add_u32 s58, s58, 36864
ds_read_b64_tr_b16 v[152:153], v180 offset:18464
ds_read_b64_tr_b16 v[154:155], v180 offset:23072
v_cvt_pk_bf16_f32 v92, v84, v85
v_cvt_pk_bf16_f32 v93, v86, v87
v_mfma_f32_16x16x32_bf16 v[56:59], v[164:167], a[224:227], v[56:59]
ds_read_b64_tr_b16 v[156:157], v180 offset:27680
ds_read_b64_tr_b16 v[158:159], v180 offset:32288
v_cvt_pk_bf16_f32 v94, v88, v89
v_cvt_pk_bf16_f32 v95, v90, v91
v_mfma_f32_16x16x32_bf16 v[64:67], v[172:175], a[224:227], v[64:67]
buffer_store_dwordx4 v[92:95], v234, s[28:31], s63 offen offset:3072 sc1
v_mfma_f32_16x16x32_bf16 v[64:67], v[176:179], a[232:235], v[64:67]
s_add_u32 m0, s64, 4096
ds_read_b64_tr_b16 v[160:161], v180 offset:18496
s_add_u32 s63, s63, 4096
v_accvgpr_read_b32 v96, a64
v_accvgpr_read_b32 v97, a65
v_mfma_f32_16x16x32_bf16 v[68:71], v[176:179], a[236:239], v[68:71]
s_waitcnt vmcnt(29)
ds_read_b64_tr_b16 v[162:163], v180 offset:23104
v_accvgpr_read_b32 v98, a66
v_accvgpr_read_b32 v99, a67
v_accvgpr_read_b32 v100, a96
v_mfma_f32_16x16x32_bf16 v[68:71], v[172:175], a[228:231], v[68:71]
s_waitcnt lgkmcnt(2)
buffer_load_dwordx4 v234, s[12:15], s59 offen offset:0 sc1 lds
v_mfma_f32_16x16x32_bf16 v[4:7], v[144:147], a[244:247], v[4:7]
ds_read_b64_tr_b16 v[164:165], v180 offset:27712
ds_read_b64_tr_b16 v[166:167], v180 offset:32320
v_accvgpr_read_b32 v101, a97
v_accvgpr_read_b32 v102, a98
v_mfma_f32_16x16x32_bf16 v[4:7], v[148:151], a[252:255], v[4:7]
ds_read_b64_tr_b16 v[168:169], v180 offset:18528
v_accvgpr_read_b32 v103, a99
v_mul_f32 v96, v124, v96
v_mul_f32 v97, v124, v97
v_mfma_f32_16x16x32_bf16 v[0:3], v[148:151], a[248:251], v[0:3]
buffer_load_dwordx4 v234, s[12:15], s59 offen offset:1024 sc1 lds
v_mfma_f32_16x16x32_bf16 v[0:3], v[144:147], a[240:243], v[0:3]
ds_read_b64_tr_b16 v[170:171], v180 offset:23136
ds_read_b64_tr_b16 v[172:173], v180 offset:27744
v_mul_f32 v98, v124, v98
v_mul_f32 v99, v124, v99
v_mfma_f32_16x16x32_bf16 v[8:11], v[152:155], a[240:243], v[8:11]
s_waitcnt vmcnt(20)
ds_add_u32 v188, v190
ds_read_b64_tr_b16 v[174:175], v180 offset:32352
v_mul_f32 v100, v124, v100
v_mul_f32 v101, v124, v101
v_mfma_f32_16x16x32_bf16 v[8:11], v[156:159], a[248:251], v[8:11]
s_waitcnt lgkmcnt(5)
buffer_load_dwordx4 v234, s[12:15], s59 offen offset:2048 sc1 lds
v_mfma_f32_16x16x32_bf16 v[12:15], v[156:159], a[252:255], v[12:15]
s_add_u32 s47, s47, 1
ds_read_b64_tr_b16 v[176:177], v181 offset:18560
ds_read_b64_tr_b16 v[178:179], v181 offset:23168
v_mul_f32 v102, v124, v102
v_mul_f32 v103, v124, v103
v_mfma_f32_16x16x32_bf16 v[12:15], v[152:155], a[244:247], v[12:15]
ds_read_b64_tr_b16 v[144:145], v181 offset:27776
ds_read_b64_tr_b16 v[146:147], v181 offset:32384
v_cvt_pk_bf16_f32 v104, v96, v97
v_cvt_pk_bf16_f32 v105, v98, v99
v_mfma_f32_16x16x32_bf16 v[20:23], v[160:163], a[244:247], v[20:23]
s_add_u32 s45, s45, 1
buffer_load_dwordx4 v234, s[12:15], s59 offen offset:3072 sc1 lds
v_mfma_f32_16x16x32_bf16 v[20:23], v[164:167], a[252:255], v[20:23]
s_add_u32 s59, s59, 36864
ds_read_b64_tr_b16 v[148:149], v182 offset:18432
v_cvt_pk_bf16_f32 v106, v100, v101
v_cvt_pk_bf16_f32 v107, v102, v103
v_mfma_f32_16x16x32_bf16 v[16:19], v[164:167], a[248:251], v[16:19]
s_and_b32 s45, s45, 3
s_cselect_b32 s46, 36864, s42
ds_read_b64_tr_b16 v[150:151], v182 offset:23040
v_mfma_f32_16x16x32_bf16 v[16:19], v[160:163], a[240:243], v[16:19]
s_waitcnt lgkmcnt(2)
buffer_store_dwordx4 v[104:107], v234, s[28:31], s63 offen offset:0 sc1
v_mfma_f32_16x16x32_bf16 v[24:27], v[168:171], a[240:243], v[24:27]
ds_read_b32 v191, v189
v_accvgpr_read_b32 v72, a68
v_accvgpr_read_b32 v73, a69
v_accvgpr_read_b32 v74, a70
v_mfma_f32_16x16x32_bf16 v[24:27], v[172:175], a[248:251], v[24:27]
s_add_u32 m0, s64, 8192
ds_read_b64_tr_b16 v[152:153], v182 offset:27648
ds_read_b64_tr_b16 v[154:155], v182 offset:32256
v_accvgpr_read_b32 v75, a71
v_accvgpr_read_b32 v76, a100
v_mfma_f32_16x16x32_bf16 v[28:31], v[172:175], a[252:255], v[28:31]
buffer_load_dwordx4 v234, s[12:15], s72 offen offset:0 sc1 lds
s_add_u32 s72, s72, 36864
s_add_u32 s64, s64, 36864
s_cmp_ge_u32 s64, 147456
s_cselect_b32 s64, s60, s64
v_mfma_f32_16x16x32_bf16 v[28:31], v[168:171], a[244:247], v[28:31]
ds_read_b64_tr_b16 v[156:157], v182 offset:18464
ds_read_b64_tr_b16 v[158:159], v182 offset:23072
v_add_u32 v180, s46, v180
v_accvgpr_read_b32 v77, a101
v_mfma_f32_16x16x32_bf16 v[36:39], v[176:179], a[244:247], v[36:39]
s_waitcnt vmcnt(24)
ds_read_b64_tr_b16 v[160:161], v182 offset:27680
ds_read_b64_tr_b16 v[162:163], v182 offset:32288
v_add_u32 v181, s46, v181
v_accvgpr_read_b32 v78, a102
v_mfma_f32_16x16x32_bf16 v[36:39], v[144:147], a[252:255], v[36:39]
s_waitcnt lgkmcnt(4)
buffer_load_dwordx4 a[224:227], v183, s[28:31], s61 offen sc1
v_mfma_f32_16x16x32_bf16 v[32:35], v[144:147], a[248:251], v[32:35]
ds_read_b64_tr_b16 v[164:165], v182 offset:18496
v_cmp_gt_u32 vcc, s47, v191
v_accvgpr_read_b32 v79, a103
v_mul_f32 v72, v125, v72
v_mfma_f32_16x16x32_bf16 v[32:35], v[176:179], a[240:243], v[32:35]
ds_read_b64_tr_b16 v[166:167], v182 offset:23104
ds_read_b64_tr_b16 v[168:169], v182 offset:27712
v_mul_f32 v73, v125, v73
v_mul_f32 v74, v125, v74
v_mfma_f32_16x16x32_bf16 v[40:43], v[148:151], a[240:243], v[40:43]
buffer_load_dwordx4 a[228:231], v184, s[28:31], s61 offen sc1
s_add_u32 s61, s61, 4096
v_mfma_f32_16x16x32_bf16 v[40:43], v[152:155], a[248:251], v[40:43]
s_cbranch_vccnz k1_f1_s
k1_f1_b:
ds_read_b64_tr_b16 v[170:171], v182 offset:32320
v_mul_f32 v75, v125, v75
v_mul_f32 v76, v125, v76
v_mul_f32 v77, v125, v77
v_mfma_f32_16x16x32_bf16 v[44:47], v[152:155], a[252:255], v[44:47]
ds_read_b64_tr_b16 v[172:173], v182 offset:18528
ds_read_b64_tr_b16 v[174:175], v182 offset:23136
v_mul_f32 v78, v125, v78
v_mul_f32 v79, v125, v79
v_mfma_f32_16x16x32_bf16 v[44:47], v[148:151], a[244:247], v[44:47]
s_waitcnt lgkmcnt(2)
buffer_load_dwordx4 a[232:235], v183, s[28:31], s61 offen sc1
v_mfma_f32_16x16x32_bf16 v[52:55], v[156:159], a[244:247], v[52:55]
ds_read_b64_tr_b16 v[176:177], v182 offset:27744
ds_read_b64_tr_b16 v[178:179], v182 offset:32352
v_add_u32 v182, s46, v182
v_cvt_pk_bf16_f32 v80, v72, v73
v_mfma_f32_16x16x32_bf16 v[52:55], v[160:163], a[252:255], v[52:55]
ds_read_b64_tr_b16 v[144:145], v180 offset:0
v_cvt_pk_bf16_f32 v81, v74, v75
v_cvt_pk_bf16_f32 v82, v76, v77
v_cvt_pk_bf16_f32 v83, v78, v79
v_mfma_f32_16x16x32_bf16 v[48:51], v[160:163], a[248:251], v[48:51]
buffer_store_dwordx4 v[80:83], v234, s[28:31], s63 offen offset:1024 sc1
v_mfma_f32_16x16x32_bf16 v[48:51], v[156:159], a[240:243], v[48:51]
ds_read_b64_tr_b16 v[146:147], v180 offset:4608
ds_read_b64_tr_b16 v[148:149], v180 offset:9216
v_accvgpr_read_b32 v84, a72
v_accvgpr_read_b32 v85, a73
v_mfma_f32_16x16x32_bf16 v[56:59], v[164:167], a[240:243], v[56:59]
ds_read_b64_tr_b16 v[150:151], v180 offset:13824
v_accvgpr_read_b32 v86, a74
v_accvgpr_read_b32 v87, a75
v_accvgpr_read_b32 v88, a104
v_mfma_f32_16x16x32_bf16 v[56:59], v[168:171], a[248:251], v[56:59]
s_waitcnt lgkmcnt(4)
buffer_load_dwordx4 a[236:239], v184, s[28:31], s61 offen sc1
v_mfma_f32_16x16x32_bf16 v[60:63], v[168:171], a[252:255], v[60:63]
s_add_u32 s61, s61, 4096
ds_read_b64_tr_b16 v[152:153], v180 offset:32
ds_read_b64_tr_b16 v[154:155], v180 offset:4640
v_accvgpr_read_b32 v89, a105
v_accvgpr_read_b32 v90, a106
v_mfma_f32_16x16x32_bf16 v[60:63], v[164:167], a[244:247], v[60:63]
ds_read_b64_tr_b16 v[156:157], v180 offset:9248
ds_read_b64_tr_b16 v[158:159], v180 offset:13856
v_accvgpr_read_b32 v91, a107
v_mul_f32 v84, v126, v84
v_mfma_f32_16x16x32_bf16 v[68:71], v[172:175], a[244:247], v[68:71]
v_mfma_f32_16x16x32_bf16 v[68:71], v[176:179], a[252:255], v[68:71]
ds_read_b64_tr_b16 v[160:161], v180 offset:64
v_mul_f32 v85, v126, v85
v_mul_f32 v86, v126, v86
v_mul_f32 v87, v126, v87
v_mfma_f32_16x16x32_bf16 v[64:67], v[176:179], a[248:251], v[64:67]
s_waitcnt vmcnt(24)
ds_read_b64_tr_b16 v[162:163], v180 offset:4672
v_mul_f32 v88, v126, v88
v_mul_f32 v89, v126, v89
v_mul_f32 v90, v126, v90
v_mfma_f32_16x16x32_bf16 v[64:67], v[172:175], a[240:243], v[64:67]
s_waitcnt lgkmcnt(2)
ds_read_b64_tr_b16 v[164:165], v180 offset:9280
ds_read_b64_tr_b16 v[166:167], v180 offset:13888
v_mul_f32 v91, v126, v91
v_cvt_pk_bf16_f32 v92, v84, v85
v_mfma_f32_16x16x32_bf16 v[0:3], v[144:147], a[192:195], v[0:3]
ds_read_b64_tr_b16 v[168:169], v180 offset:96
v_cvt_pk_bf16_f32 v93, v86, v87
v_cvt_pk_bf16_f32 v94, v88, v89
v_cvt_pk_bf16_f32 v95, v90, v91
v_mfma_f32_16x16x32_bf16 v[0:3], v[148:151], a[200:203], v[0:3]
ds_read_b64_tr_b16 v[170:171], v180 offset:4704
v_mfma_f32_16x16x32_bf16 v[4:7], v[148:151], a[204:207], v[4:7]
buffer_store_dwordx4 v[92:95], v234, s[28:31], s63 offen offset:2048 sc1
v_mfma_f32_16x16x32_bf16 v[4:7], v[144:147], a[196:199], v[4:7]
ds_read_b64_tr_b16 v[172:173], v180 offset:9312
ds_read_b64_tr_b16 v[174:175], v180 offset:13920
v_accvgpr_read_b32 v96, a76
v_accvgpr_read_b32 v97, a77
v_mfma_f32_16x16x32_bf16 v[12:15], v[152:155], a[196:199], v[12:15]
ds_read_b64_tr_b16 v[176:177], v181 offset:128
v_accvgpr_read_b32 v98, a78
v_accvgpr_read_b32 v99, a79
v_accvgpr_read_b32 v100, a108
v_mfma_f32_16x16x32_bf16 v[12:15], v[156:159], a[204:207], v[12:15]
s_waitcnt lgkmcnt(5)
buffer_load_dwordx4 a[240:243], v183, s[28:31], s61 offen sc1
v_mfma_f32_16x16x32_bf16 v[8:11], v[156:159], a[200:203], v[8:11]
ds_read_b64_tr_b16 v[178:179], v181 offset:4736
v_accvgpr_read_b32 v101, a109
v_accvgpr_read_b32 v102, a110
v_accvgpr_read_b32 v103, a111
v_mfma_f32_16x16x32_bf16 v[8:11], v[152:155], a[192:195], v[8:11]
ds_read_b64_tr_b16 v[144:145], v181 offset:9344
ds_read_b64_tr_b16 v[146:147], v181 offset:13952
v_mul_f32 v96, v127, v96
v_mul_f32 v97, v127, v97
v_mfma_f32_16x16x32_bf16 v[16:19], v[160:163], a[192:195], v[16:19]
buffer_load_dwordx4 a[244:247], v184, s[28:31], s61 offen sc1
v_mfma_f32_16x16x32_bf16 v[16:19], v[164:167], a[200:203], v[16:19]
s_add_u32 s61, s61, 4096
ds_read_b64_tr_b16 v[148:149], v182 offset:0
v_mul_f32 v98, v127, v98
v_mul_f32 v99, v127, v99
v_mul_f32 v100, v127, v100
v_mfma_f32_16x16x32_bf16 v[20:23], v[164:167], a[204:207], v[20:23]
ds_read_b64_tr_b16 v[150:151], v182 offset:4608
v_mul_f32 v101, v127, v101
v_mul_f32 v102, v127, v102
v_mul_f32 v103, v127, v103
v_mfma_f32_16x16x32_bf16 v[20:23], v[160:163], a[196:199], v[20:23]
s_waitcnt lgkmcnt(2)
buffer_load_dwordx4 a[248:251], v183, s[28:31], s61 offen sc1
v_mfma_f32_16x16x32_bf16 v[28:31], v[168:171], a[196:199], v[28:31]
ds_read_b64_tr_b16 v[152:153], v182 offset:9216
ds_read_b64_tr_b16 v[154:155], v182 offset:13824
v_cvt_pk_bf16_f32 v104, v96, v97
v_cvt_pk_bf16_f32 v105, v98, v99
v_mfma_f32_16x16x32_bf16 v[28:31], v[172:175], a[204:207], v[28:31]
ds_read_b64_tr_b16 v[156:157], v182 offset:32
v_cvt_pk_bf16_f32 v106, v100, v101
v_cvt_pk_bf16_f32 v107, v102, v103
v_mfma_f32_16x16x32_bf16 v[24:27], v[172:175], a[200:203], v[24:27]
buffer_store_dwordx4 v[104:107], v234, s[28:31], s63 offen offset:3072 sc1
v_mfma_f32_16x16x32_bf16 v[24:27], v[168:171], a[192:195], v[24:27]
ds_read_b64_tr_b16 v[158:159], v182 offset:4640
ds_read_b64_tr_b16 v[160:161], v182 offset:9248
s_add_u32 s63, s63, 4096
v_accvgpr_read_b32 v72, a128
v_mfma_f32_16x16x32_bf16 v[32:35], v[176:179], a[192:195], v[32:35]
s_waitcnt vmcnt(29)
ds_read_b64_tr_b16 v[162:163], v182 offset:13856
v_accvgpr_read_b32 v73, a129
v_accvgpr_read_b32 v74, a130
v_accvgpr_read_b32 v75, a131
v_mfma_f32_16x16x32_bf16 v[32:35], v[144:147], a[200:203], v[32:35]
s_waitcnt lgkmcnt(4)
buffer_load_dwordx4 a[252:255], v184, s[28:31], s61 offen sc1
v_mfma_f32_16x16x32_bf16 v[36:39], v[144:147], a[204:207], v[36:39]
s_add_u32 s61, s61, 4096
ds_read_b64_tr_b16 v[164:165], v182 offset:64
ds_read_b64_tr_b16 v[166:167], v182 offset:4672
v_accvgpr_read_b32 v76, a160
v_accvgpr_read_b32 v77, a161
v_mfma_f32_16x16x32_bf16 v[36:39], v[176:179], a[196:199], v[36:39]
s_add_u32 m0, s64, 0
ds_read_b64_tr_b16 v[168:169], v182 offset:9280
ds_read_b64_tr_b16 v[170:171], v182 offset:13888
v_accvgpr_read_b32 v78, a162
v_accvgpr_read_b32 v79, a163
v_mfma_f32_16x16x32_bf16 v[44:47], v[148:151], a[196:199], v[44:47]
buffer_load_dwordx4 v234, s[12:15], s58 offen offset:0 sc1 lds
v_mfma_f32_16x16x32_bf16 v[44:47], v[152:155], a[204:207], v[44:47]
ds_read_b64_tr_b16 v[172:173], v182 offset:96
v_mul_f32 v72, v124, v72
v_mul_f32 v73, v124, v73
v_mul_f32 v74, v124, v74
v_mfma_f32_16x16x32_bf16 v[40:43], v[152:155], a[200:203], v[40:43]
ds_read_b64_tr_b16 v[174:175], v182 offset:4704
v_mul_f32 v75, v124, v75
v_mul_f32 v76, v124, v76
v_mul_f32 v77, v124, v77
v_mfma_f32_16x16x32_bf16 v[40:43], v[148:151], a[192:195], v[40:43]
s_waitcnt lgkmcnt(2)
buffer_load_dwordx4 v234, s[12:15], s58 offen offset:1024 sc1 lds
v_mfma_f32_16x16x32_bf16 v[48:51], v[156:159], a[192:195], v[48:51]
ds_read_b64_tr_b16 v[176:177], v182 offset:9312
ds_read_b64_tr_b16 v[178:179], v182 offset:13920
v_mul_f32 v78, v124, v78
v_mul_f32 v79, v124, v79
v_mfma_f32_16x16x32_bf16 v[48:51], v[160:163], a[200:203], v[48:51]
ds_read_b64_tr_b16 v[144:145], v180 offset:18432
v_cvt_pk_bf16_f32 v80, v72, v73
v_cvt_pk_bf16_f32 v81, v74, v75
v_cvt_pk_bf16_f32 v82, v76, v77
v_mfma_f32_16x16x32_bf16 v[52:55], v[160:163], a[204:207], v[52:55]
buffer_load_dwordx4 v234, s[12:15], s58 offen offset:2048 sc1 lds
v_mfma_f32_16x16x32_bf16 v[52:55], v[156:159], a[196:199], v[52:55]
ds_read_b64_tr_b16 v[146:147], v180 offset:23040
ds_read_b64_tr_b16 v[148:149], v180 offset:27648
v_cvt_pk_bf16_f32 v83, v78, v79
v_mfma_f32_16x16x32_bf16 v[60:63], v[164:167], a[196:199], v[60:63]
ds_read_b64_tr_b16 v[150:151], v180 offset:32256
v_mfma_f32_16x16x32_bf16 v[60:63], v[168:171], a[204:207], v[60:63]
s_waitcnt lgkmcnt(4)
buffer_store_dwordx4 v[80:83], v234, s[28:31], s63 offen offset:0 sc1
v_mfma_f32_16x16x32_bf16 v[56:59], v[168:171], a[200:203], v[56:59]
ds_read_b64_tr_b16 v[152:153], v180 offset:18464
ds_read_b64_tr_b16 v[154:155], v180 offset:23072
v_accvgpr_read_b32 v84, a132
v_accvgpr_read_b32 v85, a133
v_mfma_f32_16x16x32_bf16 v[56:59], v[164:167], a[192:195], v[56:59]
ds_read_b64_tr_b16 v[156:157], v180 offset:27680
ds_read_b64_tr_b16 v[158:159], v180 offset:32288
v_accvgpr_read_b32 v86, a134
v_accvgpr_read_b32 v87, a135
v_mfma_f32_16x16x32_bf16 v[64:67], v[172:175], a[192:195], v[64:67]
buffer_load_dwordx4 v234, s[12:15], s58 offen offset:3072 sc1 lds
v_mfma_f32_16x16x32_bf16 v[64:67], v[176:179], a[200:203], v[64:67]
s_add_u32 s58, s58, 36864
ds_read_b64_tr_b16 v[160:161], v180 offset:18496
v_accvgpr_read_b32 v88, a164
v_accvgpr_read_b32 v89, a165
v_accvgpr_read_b32 v90, a166
v_mfma_f32_16x16x32_bf16 v[68:71], v[176:179], a[204:207], v[68:71]
s_waitcnt vmcnt(28)
ds_read_b64_tr_b16 v[162:163], v180 offset:23104
v_accvgpr_read_b32 v91, a167
v_mul_f32 v84, v125, v84
v_mul_f32 v85, v125, v85
s_add_u32 m0, s64, 4096
v_mfma_f32_16x16x32_bf16 v[68:71], v[172:175], a[196:199], v[68:71]
s_waitcnt lgkmcnt(2)
buffer_load_dwordx4 v234, s[12:15], s59 offen offset:0 sc1 lds
v_mfma_f32_16x16x32_bf16 v[4:7], v[144:147], a[212:215], v[4:7]
ds_read_b64_tr_b16 v[164:165], v180 offset:27712
ds_read_b64_tr_b16 v[166:167], v180 offset:32320
v_mul_f32 v86, v125, v86
v_mul_f32 v87, v125, v87
v_mfma_f32_16x16x32_bf16 v[4:7], v[148:151], a[220:223], v[4:7]
ds_read_b64_tr_b16 v[168:169], v180 offset:18528
v_mul_f32 v88, v125, v88
v_mul_f32 v89, v125, v89
v_mul_f32 v90, v125, v90
v_mfma_f32_16x16x32_bf16 v[0:3], v[148:151], a[216:219], v[0:3]
buffer_load_dwordx4 v234, s[12:15], s59 offen offset:1024 sc1 lds
v_mfma_f32_16x16x32_bf16 v[0:3], v[144:147], a[208:211], v[0:3]
ds_read_b64_tr_b16 v[170:171], v180 offset:23136
ds_read_b64_tr_b16 v[172:173], v180 offset:27744
v_mul_f32 v91, v125, v91
v_cvt_pk_bf16_f32 v92, v84, v85
v_mfma_f32_16x16x32_bf16 v[8:11], v[152:155], a[208:211], v[8:11]
s_waitcnt vmcnt(18)
ds_add_u32 v188, v190
ds_read_b64_tr_b16 v[174:175], v180 offset:32352
v_cvt_pk_bf16_f32 v93, v86, v87
v_cvt_pk_bf16_f32 v94, v88, v89
v_mfma_f32_16x16x32_bf16 v[8:11], v[156:159], a[216:219], v[8:11]
s_waitcnt lgkmcnt(5)
buffer_load_dwordx4 v234, s[12:15], s59 offen offset:2048 sc1 lds
v_mfma_f32_16x16x32_bf16 v[12:15], v[156:159], a[220:223], v[12:15]
s_add_u32 s47, s47, 1
ds_read_b64_tr_b16 v[176:177], v181 offset:18560
ds_read_b64_tr_b16 v[178:179], v181 offset:23168
v_cvt_pk_bf16_f32 v95, v90, v91
v_mfma_f32_16x16x32_bf16 v[12:15], v[152:155], a[212:215], v[12:15]
ds_read_b64_tr_b16 v[144:145], v181 offset:27776
ds_read_b64_tr_b16 v[146:147], v181 offset:32384
v_mfma_f32_16x16x32_bf16 v[20:23], v[160:163], a[212:215], v[20:23]
s_add_u32 s45, s45, 1
buffer_store_dwordx4 v[92:95], v234, s[28:31], s63 offen offset:1024 sc1
v_mfma_f32_16x16x32_bf16 v[20:23], v[164:167], a[220:223], v[20:23]
ds_read_b64_tr_b16 v[148:149], v182 offset:18432
v_accvgpr_read_b32 v96, a136
v_accvgpr_read_b32 v97, a137
v_accvgpr_read_b32 v98, a138
v_mfma_f32_16x16x32_bf16 v[16:19], v[164:167], a[216:219], v[16:19]
s_and_b32 s45, s45, 3
s_cselect_b32 s46, 36864, s42
ds_read_b64_tr_b16 v[150:151], v182 offset:23040
v_accvgpr_read_b32 v99, a139
v_accvgpr_read_b32 v100, a168
v_accvgpr_read_b32 v101, a169
v_mfma_f32_16x16x32_bf16 v[16:19], v[160:163], a[208:211], v[16:19]
s_waitcnt lgkmcnt(2)
buffer_load_dwordx4 v234, s[12:15], s59 offen offset:3072 sc1 lds
v_mfma_f32_16x16x32_bf16 v[24:27], v[168:171], a[208:211], v[24:27]
s_add_u32 s59, s59, 36864
ds_read_b32 v191, v189
v_accvgpr_read_b32 v102, a170
v_accvgpr_read_b32 v103, a171
v_mul_f32 v96, v126, v96
v_mfma_f32_16x16x32_bf16 v[24:27], v[172:175], a[216:219], v[24:27]
s_add_u32 m0, s64, 8192
ds_read_b64_tr_b16 v[152:153], v182 offset:27648
ds_read_b64_tr_b16 v[154:155], v182 offset:32256
v_mul_f32 v97, v126, v97
v_mul_f32 v98, v126, v98
v_mfma_f32_16x16x32_bf16 v[28:31], v[172:175], a[220:223], v[28:31]
buffer_load_dwordx4 v234, s[12:15], s72 offen offset:0 sc1 lds
s_add_u32 s72, s72, 36864
s_add_u32 s64, s64, 36864
s_cmp_ge_u32 s64, 147456
s_cselect_b32 s64, s60, s64
v_mfma_f32_16x16x32_bf16 v[28:31], v[168:171], a[212:215], v[28:31]
ds_read_b64_tr_b16 v[156:157], v182 offset:18464
ds_read_b64_tr_b16 v[158:159], v182 offset:23072
v_add_u32 v180, s46, v180
v_mul_f32 v99, v126, v99
v_mfma_f32_16x16x32_bf16 v[36:39], v[176:179], a[212:215], v[36:39]
s_waitcnt vmcnt(22)
ds_read_b64_tr_b16 v[160:161], v182 offset:27680
ds_read_b64_tr_b16 v[162:163], v182 offset:32288
v_add_u32 v181, s46, v181
v_mul_f32 v100, v126, v100
v_mfma_f32_16x16x32_bf16 v[36:39], v[144:147], a[220:223], v[36:39]
s_waitcnt lgkmcnt(4)
buffer_load_dwordx4 a[192:195], v183, s[28:31], s61 offen sc1
v_mfma_f32_16x16x32_bf16 v[32:35], v[144:147], a[216:219], v[32:35]
ds_read_b64_tr_b16 v[164:165], v182 offset:18496
v_cmp_gt_u32 vcc, s47, v191
v_mul_f32 v101, v126, v101
v_mul_f32 v102, v126, v102
v_mfma_f32_16x16x32_bf16 v[32:35], v[176:179], a[208:211], v[32:35]
ds_read_b64_tr_b16 v[166:167], v182 offset:23104
ds_read_b64_tr_b16 v[168:169], v182 offset:27712
v_mul_f32 v103, v126, v103
v_cvt_pk_bf16_f32 v104, v96, v97
v_mfma_f32_16x16x32_bf16 v[40:43], v[148:151], a[208:211], v[40:43]
buffer_load_dwordx4 a[196:199], v184, s[28:31], s61 offen sc1
s_add_u32 s61, s61, 4096
v_mfma_f32_16x16x32_bf16 v[40:43], v[152:155], a[216:219], v[40:43]
s_cbranch_vccnz k1_f2_s
k1_f2_b:
ds_read_b64_tr_b16 v[170:171], v182 offset:32320
v_cvt_pk_bf16_f32 v105, v98, v99
v_cvt_pk_bf16_f32 v106, v100, v101
v_cvt_pk_bf16_f32 v107, v102, v103
v_mfma_f32_16x16x32_bf16 v[44:47], v[152:155], a[220:223], v[44:47]
ds_read_b64_tr_b16 v[172:173], v182 offset:18528
ds_read_b64_tr_b16 v[174:175], v182 offset:23136
v_mfma_f32_16x16x32_bf16 v[44:47], v[148:151], a[212:215], v[44:47]
s_waitcnt lgkmcnt(2)
buffer_store_dwordx4 v[104:107], v234, s[28:31], s63 offen offset:2048 sc1
v_mfma_f32_16x16x32_bf16 v[52:55], v[156:159], a[212:215], v[52:55]
ds_read_b64_tr_b16 v[176:177], v182 offset:27744
ds_read_b64_tr_b16 v[178:179], v182 offset:32352
v_add_u32 v182, s46, v182
v_accvgpr_read_b32 v72, a140
v_mfma_f32_16x16x32_bf16 v[52:55], v[160:163], a[220:223], v[52:55]
ds_read_b64_tr_b16 v[144:145], v180 offset:0
v_accvgpr_read_b32 v73, a141
v_accvgpr_read_b32 v74, a142
v_accvgpr_read_b32 v75, a143
v_mfma_f32_16x16x32_bf16 v[48:51], v[160:163], a[216:219], v[48:51]
buffer_load_dwordx4 a[200:203], v183, s[28:31], s61 offen sc1
v_mfma_f32_16x16x32_bf16 v[48:51], v[156:159], a[208:211], v[48:51]
ds_read_b64_tr_b16 v[146:147], v180 offset:4608
ds_read_b64_tr_b16 v[148:149], v180 offset:9216
v_accvgpr_read_b32 v76, a172
v_accvgpr_read_b32 v77, a173
v_mfma_f32_16x16x32_bf16 v[56:59], v[164:167], a[208:211], v[56:59]
ds_read_b64_tr_b16 v[150:151], v180 offset:13824
v_accvgpr_read_b32 v78, a174
v_accvgpr_read_b32 v79, a175
v_mul_f32 v72, v127, v72
v_mfma_f32_16x16x32_bf16 v[56:59], v[168:171], a[216:219], v[56:59]
s_waitcnt lgkmcnt(4)
buffer_load_dwordx4 a[204:207], v184, s[28:31], s61 offen sc1
v_mfma_f32_16x16x32_bf16 v[60:63], v[168:171], a[220:223], v[60:63]
s_add_u32 s61, s61, 4096
ds_read_b64_tr_b16 v[152:153], v180 offset:32
ds_read_b64_tr_b16 v[154:155], v180 offset:4640
v_mul_f32 v73, v127, v73
v_mul_f32 v74, v127, v74
v_mfma_f32_16x16x32_bf16 v[60:63], v[164:167], a[212:215], v[60:63]
ds_read_b64_tr_b16 v[156:157], v180 offset:9248
ds_read_b64_tr_b16 v[158:159], v180 offset:13856
v_mul_f32 v75, v127, v75
v_mul_f32 v76, v127, v76
v_mfma_f32_16x16x32_bf16 v[68:71], v[172:175], a[212:215], v[68:71]
v_mfma_f32_16x16x32_bf16 v[68:71], v[176:179], a[220:223], v[68:71]
ds_read_b64_tr_b16 v[160:161], v180 offset:64
v_mul_f32 v77, v127, v77
v_mul_f32 v78, v127, v78
v_mul_f32 v79, v127, v79
v_mfma_f32_16x16x32_bf16 v[64:67], v[176:179], a[216:219], v[64:67]
s_waitcnt vmcnt(22)
ds_read_b64_tr_b16 v[162:163], v180 offset:4672
v_cvt_pk_bf16_f32 v80, v72, v73
v_cvt_pk_bf16_f32 v81, v74, v75
v_cvt_pk_bf16_f32 v82, v76, v77
v_mfma_f32_16x16x32_bf16 v[64:67], v[172:175], a[208:211], v[64:67]
s_waitcnt lgkmcnt(2)
ds_read_b64_tr_b16 v[164:165], v180 offset:9280
ds_read_b64_tr_b16 v[166:167], v180 offset:13888
v_cvt_pk_bf16_f32 v83, v78, v79
v_mfma_f32_16x16x32_bf16 v[0:3], v[144:147], a[224:227], v[0:3]
ds_read_b64_tr_b16 v[168:169], v180 offset:96
v_mfma_f32_16x16x32_bf16 v[0:3], v[148:151], a[232:235], v[0:3]
ds_read_b64_tr_b16 v[170:171], v180 offset:4704
v_mfma_f32_16x16x32_bf16 v[4:7], v[148:151], a[236:239], v[4:7]
buffer_store_dwordx4 v[80:83], v234, s[28:31], s63 offen offset:3072 sc1
v_mfma_f32_16x16x32_bf16 v[4:7], v[144:147], a[228:231], v[4:7]
ds_read_b64_tr_b16 v[172:173], v180 offset:9312
ds_read_b64_tr_b16 v[174:175], v180 offset:13920
v_mfma_f32_16x16x32_bf16 v[12:15], v[152:155], a[228:231], v[12:15]
ds_read_b64_tr_b16 v[176:177], v181 offset:128
v_mfma_f32_16x16x32_bf16 v[12:15], v[156:159], a[236:239], v[12:15]
s_waitcnt lgkmcnt(5)
buffer_load_dwordx4 a[208:211], v183, s[28:31], s61 offen sc1
v_mfma_f32_16x16x32_bf16 v[8:11], v[156:159], a[232:235], v[8:11]
ds_read_b64_tr_b16 v[178:179], v181 offset:4736
v_mfma_f32_16x16x32_bf16 v[8:11], v[152:155], a[224:227], v[8:11]
ds_read_b64_tr_b16 v[144:145], v181 offset:9344
ds_read_b64_tr_b16 v[146:147], v181 offset:13952
v_mfma_f32_16x16x32_bf16 v[16:19], v[160:163], a[224:227], v[16:19]
ds_read_b64_tr_b16 v[148:149], v182 offset:0
v_mfma_f32_16x16x32_bf16 v[16:19], v[164:167], a[232:235], v[16:19]
buffer_load_dwordx4 a[212:215], v184, s[28:31], s61 offen sc1
v_mfma_f32_16x16x32_bf16 v[20:23], v[164:167], a[236:239], v[20:23]
s_add_u32 s61, s61, 4096
ds_read_b64_tr_b16 v[150:151], v182 offset:4608
v_mfma_f32_16x16x32_bf16 v[20:23], v[160:163], a[228:231], v[20:23]
s_waitcnt lgkmcnt(2)
ds_read_b64_tr_b16 v[152:153], v182 offset:9216
ds_read_b64_tr_b16 v[154:155], v182 offset:13824
v_mfma_f32_16x16x32_bf16 v[28:31], v[168:171], a[228:231], v[28:31]
ds_read_b64_tr_b16 v[156:157], v182 offset:32
v_mfma_f32_16x16x32_bf16 v[28:31], v[172:175], a[236:239], v[28:31]
buffer_load_dwordx4 a[216:219], v183, s[28:31], s61 offen sc1
v_mfma_f32_16x16x32_bf16 v[24:27], v[172:175], a[232:235], v[24:27]
ds_read_b64_tr_b16 v[158:159], v182 offset:4640
v_mfma_f32_16x16x32_bf16 v[24:27], v[168:171], a[224:227], v[24:27]
ds_read_b64_tr_b16 v[160:161], v182 offset:9248
ds_read_b64_tr_b16 v[162:163], v182 offset:13856
v_mfma_f32_16x16x32_bf16 v[32:35], v[176:179], a[224:227], v[32:35]
s_waitcnt vmcnt(26)
ds_read_b64_tr_b16 v[164:165], v182 offset:64
v_mfma_f32_16x16x32_bf16 v[32:35], v[144:147], a[232:235], v[32:35]
s_waitcnt lgkmcnt(5)
buffer_load_dwordx4 a[220:223], v184, s[28:31], s61 offen sc1
v_mfma_f32_16x16x32_bf16 v[36:39], v[144:147], a[236:239], v[36:39]
s_add_u32 s61, s61, 4096
ds_read_b64_tr_b16 v[166:167], v182 offset:4672
v_mfma_f32_16x16x32_bf16 v[36:39], v[176:179], a[228:231], v[36:39]
s_add_u32 m0, s64, 0
ds_read_b64_tr_b16 v[168:169], v182 offset:9280
ds_read_b64_tr_b16 v[170:171], v182 offset:13888
v_mfma_f32_16x16x32_bf16 v[44:47], v[148:151], a[228:231], v[44:47]
buffer_load_dwordx4 v234, s[12:15], s58 offen offset:0 sc1 lds
v_mfma_f32_16x16x32_bf16 v[44:47], v[152:155], a[236:239], v[44:47]
ds_read_b64_tr_b16 v[172:173], v182 offset:96
v_mfma_f32_16x16x32_bf16 v[40:43], v[152:155], a[232:235], v[40:43]
ds_read_b64_tr_b16 v[174:175], v182 offset:4704
v_mfma_f32_16x16x32_bf16 v[40:43], v[148:151], a[224:227], v[40:43]
s_waitcnt lgkmcnt(2)
ds_read_b64_tr_b16 v[176:177], v182 offset:9312
ds_read_b64_tr_b16 v[178:179], v182 offset:13920
v_mfma_f32_16x16x32_bf16 v[48:51], v[156:159], a[224:227], v[48:51]
buffer_load_dwordx4 v234, s[12:15], s58 offen offset:1024 sc1 lds
v_mfma_f32_16x16x32_bf16 v[48:51], v[160:163], a[232:235], v[48:51]
ds_read_b64_tr_b16 v[144:145], v180 offset:18432
v_mfma_f32_16x16x32_bf16 v[52:55], v[160:163], a[236:239], v[52:55]
ds_read_b64_tr_b16 v[146:147], v180 offset:23040
v_mfma_f32_16x16x32_bf16 v[52:55], v[156:159], a[228:231], v[52:55]
ds_read_b64_tr_b16 v[148:149], v180 offset:27648
ds_read_b64_tr_b16 v[150:151], v180 offset:32256
v_mfma_f32_16x16x32_bf16 v[60:63], v[164:167], a[228:231], v[60:63]
buffer_load_dwordx4 v234, s[12:15], s58 offen offset:2048 sc1 lds
v_mfma_f32_16x16x32_bf16 v[60:63], v[168:171], a[236:239], v[60:63]
s_waitcnt lgkmcnt(4)
ds_read_b64_tr_b16 v[152:153], v180 offset:18464
v_mfma_f32_16x16x32_bf16 v[56:59], v[168:171], a[232:235], v[56:59]
ds_read_b64_tr_b16 v[154:155], v180 offset:23072
v_mfma_f32_16x16x32_bf16 v[56:59], v[164:167], a[224:227], v[56:59]
ds_read_b64_tr_b16 v[156:157], v180 offset:27680
ds_read_b64_tr_b16 v[158:159], v180 offset:32288
v_mfma_f32_16x16x32_bf16 v[64:67], v[172:175], a[224:227], v[64:67]
buffer_load_dwordx4 v234, s[12:15], s58 offen offset:3072 sc1 lds
v_mfma_f32_16x16x32_bf16 v[64:67], v[176:179], a[232:235], v[64:67]
s_add_u32 s58, s58, 36864
ds_read_b64_tr_b16 v[160:161], v180 offset:18496
v_mfma_f32_16x16x32_bf16 v[68:71], v[176:179], a[236:239], v[68:71]
s_waitcnt vmcnt(25)
ds_read_b64_tr_b16 v[162:163], v180 offset:23104
s_add_u32 m0, s64, 4096
v_mfma_f32_16x16x32_bf16 v[68:71], v[172:175], a[228:231], v[68:71]
s_waitcnt lgkmcnt(2)
buffer_load_dwordx4 v234, s[12:15], s59 offen offset:0 sc1 lds
v_mfma_f32_16x16x32_bf16 v[4:7], v[144:147], a[244:247], v[4:7]
ds_read_b64_tr_b16 v[164:165], v180 offset:27712
ds_read_b64_tr_b16 v[166:167], v180 offset:32320
v_mfma_f32_16x16x32_bf16 v[4:7], v[148:151], a[252:255], v[4:7]
ds_read_b64_tr_b16 v[168:169], v180 offset:18528
v_mfma_f32_16x16x32_bf16 v[0:3], v[148:151], a[248:251], v[0:3]
ds_read_b64_tr_b16 v[170:171], v180 offset:23136
v_mfma_f32_16x16x32_bf16 v[0:3], v[144:147], a[240:243], v[0:3]
buffer_load_dwordx4 v234, s[12:15], s59 offen offset:1024 sc1 lds
v_mfma_f32_16x16x32_bf16 v[8:11], v[152:155], a[240:243], v[8:11]
s_waitcnt vmcnt(16)
ds_add_u32 v188, v190
v_mfma_f32_16x16x32_bf16 v[8:11], v[156:159], a[248:251], v[8:11]
s_waitcnt lgkmcnt(3)
ds_read_b64_tr_b16 v[172:173], v180 offset:27744
ds_read_b64_tr_b16 v[174:175], v180 offset:32352
v_mfma_f32_16x16x32_bf16 v[12:15], v[156:159], a[252:255], v[12:15]
s_add_u32 s47, s47, 1
ds_read_b64_tr_b16 v[176:177], v181 offset:18560
ds_read_b64_tr_b16 v[178:179], v181 offset:23168
v_mfma_f32_16x16x32_bf16 v[12:15], v[152:155], a[244:247], v[12:15]
buffer_load_dwordx4 v234, s[12:15], s59 offen offset:2048 sc1 lds
v_mfma_f32_16x16x32_bf16 v[20:23], v[160:163], a[244:247], v[20:23]
s_add_u32 s45, s45, 1
ds_read_b64_tr_b16 v[144:145], v181 offset:27776
ds_read_b64_tr_b16 v[146:147], v181 offset:32384
v_mfma_f32_16x16x32_bf16 v[20:23], v[164:167], a[252:255], v[20:23]
ds_read_b64_tr_b16 v[148:149], v182 offset:18432
v_mfma_f32_16x16x32_bf16 v[16:19], v[164:167], a[248:251], v[16:19]
s_and_b32 s45, s45, 3
s_cselect_b32 s46, 36864, s42
ds_read_b64_tr_b16 v[150:151], v182 offset:23040
v_mfma_f32_16x16x32_bf16 v[16:19], v[160:163], a[240:243], v[16:19]
s_waitcnt lgkmcnt(2)
buffer_load_dwordx4 v234, s[12:15], s59 offen offset:3072 sc1 lds
v_mfma_f32_16x16x32_bf16 v[24:27], v[168:171], a[240:243], v[24:27]
s_add_u32 s59, s59, 36864
ds_read_b32 v191, v189
v_mfma_f32_16x16x32_bf16 v[24:27], v[172:175], a[248:251], v[24:27]
s_add_u32 m0, s64, 8192
ds_read_b64_tr_b16 v[152:153], v182 offset:27648
ds_read_b64_tr_b16 v[154:155], v182 offset:32256
v_mfma_f32_16x16x32_bf16 v[28:31], v[172:175], a[252:255], v[28:31]
buffer_load_dwordx4 v234, s[12:15], s72 offen offset:0 sc1 lds
s_add_u32 s72, s72, 36864
s_add_u32 s64, s64, 36864
s_cmp_ge_u32 s64, 147456
s_cselect_b32 s64, s60, s64
v_mfma_f32_16x16x32_bf16 v[28:31], v[168:171], a[244:247], v[28:31]
ds_read_b64_tr_b16 v[156:157], v182 offset:18464
ds_read_b64_tr_b16 v[158:159], v182 offset:23072
v_add_u32 v180, s46, v180
v_mfma_f32_16x16x32_bf16 v[36:39], v[176:179], a[244:247], v[36:39]
s_waitcnt vmcnt(19)
ds_read_b64_tr_b16 v[160:161], v182 offset:27680
ds_read_b64_tr_b16 v[162:163], v182 offset:32288
v_add_u32 v181, s46, v181
v_mfma_f32_16x16x32_bf16 v[36:39], v[144:147], a[252:255], v[36:39]
s_waitcnt lgkmcnt(4)
ds_read_b64_tr_b16 v[164:165], v182 offset:18496
v_cmp_gt_u32 vcc, s47, v191
v_mfma_f32_16x16x32_bf16 v[32:35], v[144:147], a[248:251], v[32:35]
buffer_load_dwordx4 a[224:227], v183, s[28:31], s61 offen sc1
v_mfma_f32_16x16x32_bf16 v[32:35], v[176:179], a[240:243], v[32:35]
ds_read_b64_tr_b16 v[166:167], v182 offset:23104
ds_read_b64_tr_b16 v[168:169], v182 offset:27712
v_mfma_f32_16x16x32_bf16 v[40:43], v[148:151], a[240:243], v[40:43]
ds_read_b64_tr_b16 v[170:171], v182 offset:32320
v_mfma_f32_16x16x32_bf16 v[40:43], v[152:155], a[248:251], v[40:43]
s_cbranch_vccnz k1_f3_s
k1_f3_b:
ds_read_b64_tr_b16 v[172:173], v182 offset:18528
v_mfma_f32_16x16x32_bf16 v[44:47], v[152:155], a[252:255], v[44:47]
buffer_load_dwordx4 a[228:231], v184, s[28:31], s61 offen sc1
s_add_u32 s61, s61, 4096
v_mfma_f32_16x16x32_bf16 v[44:47], v[148:151], a[244:247], v[44:47]
s_waitcnt lgkmcnt(1)
ds_read_b64_tr_b16 v[174:175], v182 offset:23136
ds_read_b64_tr_b16 v[176:177], v182 offset:27744
v_mfma_f32_16x16x32_bf16 v[52:55], v[156:159], a[244:247], v[52:55]
ds_read_b64_tr_b16 v[178:179], v182 offset:32352
v_add_u32 v182, s46, v182
s_waitcnt vmcnt(15)
v_mfma_f32_16x16x32_bf16 v[52:55], v[160:163], a[252:255], v[52:55]
ds_read_b64_tr_b16 v[144:145], v180 offset:0
v_mfma_f32_16x16x32_bf16 v[48:51], v[160:163], a[248:251], v[48:51]
buffer_store_dword v186, v232, s[36:39], s53 offen sc1
v_mfma_f32_16x16x32_bf16 v[48:51], v[156:159], a[240:243], v[48:51]
ds_read_b64_tr_b16 v[146:147], v180 offset:4608
ds_read_b64_tr_b16 v[148:149], v180 offset:9216
v_mfma_f32_16x16x32_bf16 v[56:59], v[164:167], a[240:243], v[56:59]
ds_read_b64_tr_b16 v[150:151], v180 offset:13824
v_mfma_f32_16x16x32_bf16 v[56:59], v[168:171], a[248:251], v[56:59]
s_waitcnt lgkmcnt(4)
buffer_load_dwordx4 a[232:235], v183, s[28:31], s61 offen sc1
v_mfma_f32_16x16x32_bf16 v[60:63], v[168:171], a[252:255], v[60:63]
ds_read_b64_tr_b16 v[152:153], v180 offset:32
ds_read_b64_tr_b16 v[154:155], v180 offset:4640
v_mfma_f32_16x16x32_bf16 v[60:63], v[164:167], a[244:247], v[60:63]
ds_read_b64_tr_b16 v[156:157], v180 offset:9248
ds_read_b64_tr_b16 v[158:159], v180 offset:13856
v_mfma_f32_16x16x32_bf16 v[68:71], v[172:175], a[244:247], v[68:71]
ds_read_b64_tr_b16 v[160:161], v180 offset:64
v_mfma_f32_16x16x32_bf16 v[68:71], v[176:179], a[252:255], v[68:71]
buffer_load_dwordx4 a[236:239], v184, s[28:31], s61 offen sc1
s_add_u32 s61, s61, 4096
v_mfma_f32_16x16x32_bf16 v[64:67], v[176:179], a[248:251], v[64:67]
s_waitcnt vmcnt(18)
ds_read_b64_tr_b16 v[162:163], v180 offset:4672
v_mfma_f32_16x16x32_bf16 v[64:67], v[172:175], a[240:243], v[64:67]
s_waitcnt lgkmcnt(2)
ds_read_b64_tr_b16 v[164:165], v180 offset:9280
ds_read_b64_tr_b16 v[166:167], v180 offset:13888
v_mfma_f32_16x16x32_bf16 v[0:3], v[144:147], a[192:195], v[0:3]
ds_read_b64_tr_b16 v[168:169], v180 offset:96
v_mfma_f32_16x16x32_bf16 v[0:3], v[148:151], a[200:203], v[0:3]
ds_read_b64_tr_b16 v[170:171], v180 offset:4704
v_mfma_f32_16x16x32_bf16 v[4:7], v[148:151], a[204:207], v[4:7]
buffer_load_dwordx4 a[240:243], v183, s[28:31], s61 offen sc1
v_mfma_f32_16x16x32_bf16 v[4:7], v[144:147], a[196:199], v[4:7]
ds_read_b64_tr_b16 v[172:173], v180 offset:9312
ds_read_b64_tr_b16 v[174:175], v180 offset:13920
v_mfma_f32_16x16x32_bf16 v[12:15], v[152:155], a[196:199], v[12:15]
ds_read_b64_tr_b16 v[176:177], v181 offset:128
v_mfma_f32_16x16x32_bf16 v[12:15], v[156:159], a[204:207], v[12:15]
s_waitcnt lgkmcnt(5)
buffer_load_dwordx4 a[244:247], v184, s[28:31], s61 offen sc1
v_mfma_f32_16x16x32_bf16 v[8:11], v[156:159], a[200:203], v[8:11]
s_add_u32 s61, s61, 4096
ds_read_b64_tr_b16 v[178:179], v181 offset:4736
v_mfma_f32_16x16x32_bf16 v[8:11], v[152:155], a[192:195], v[8:11]
ds_read_b64_tr_b16 v[144:145], v181 offset:9344
ds_read_b64_tr_b16 v[146:147], v181 offset:13952
v_mfma_f32_16x16x32_bf16 v[16:19], v[160:163], a[192:195], v[16:19]
ds_read_b64_tr_b16 v[148:149], v182 offset:0
v_mfma_f32_16x16x32_bf16 v[16:19], v[164:167], a[200:203], v[16:19]
buffer_load_dwordx4 a[248:251], v183, s[28:31], s61 offen sc1
v_mfma_f32_16x16x32_bf16 v[20:23], v[164:167], a[204:207], v[20:23]
ds_read_b64_tr_b16 v[150:151], v182 offset:4608
v_mfma_f32_16x16x32_bf16 v[20:23], v[160:163], a[196:199], v[20:23]
s_waitcnt lgkmcnt(2)
ds_read_b64_tr_b16 v[152:153], v182 offset:9216
ds_read_b64_tr_b16 v[154:155], v182 offset:13824
v_mfma_f32_16x16x32_bf16 v[28:31], v[168:171], a[196:199], v[28:31]
ds_read_b64_tr_b16 v[156:157], v182 offset:32
v_mfma_f32_16x16x32_bf16 v[28:31], v[172:175], a[204:207], v[28:31]
buffer_load_dwordx4 a[252:255], v184, s[28:31], s61 offen sc1
v_mfma_f32_16x16x32_bf16 v[24:27], v[172:175], a[200:203], v[24:27]
s_add_u32 s61, s61, 4096
ds_read_b64_tr_b16 v[158:159], v182 offset:4640
v_mfma_f32_16x16x32_bf16 v[24:27], v[168:171], a[192:195], v[24:27]
s_add_u32 m0, s64, 0
ds_read_b64_tr_b16 v[160:161], v182 offset:9248
ds_read_b64_tr_b16 v[162:163], v182 offset:13856
v_mfma_f32_16x16x32_bf16 v[32:35], v[176:179], a[192:195], v[32:35]
s_waitcnt vmcnt(22)
ds_read_b64_tr_b16 v[164:165], v182 offset:64
v_mfma_f32_16x16x32_bf16 v[32:35], v[144:147], a[200:203], v[32:35]
s_waitcnt lgkmcnt(5)
buffer_load_dwordx4 v234, s[12:15], s58 offen offset:0 sc1 lds
v_mfma_f32_16x16x32_bf16 v[36:39], v[144:147], a[204:207], v[36:39]
ds_read_b64_tr_b16 v[166:167], v182 offset:4672
v_mfma_f32_16x16x32_bf16 v[36:39], v[176:179], a[196:199], v[36:39]
ds_read_b64_tr_b16 v[168:169], v182 offset:9280
ds_read_b64_tr_b16 v[170:171], v182 offset:13888
v_mfma_f32_16x16x32_bf16 v[44:47], v[148:151], a[196:199], v[44:47]
buffer_load_dwordx4 v234, s[12:15], s58 offen offset:1024 sc1 lds
v_mfma_f32_16x16x32_bf16 v[44:47], v[152:155], a[204:207], v[44:47]
ds_read_b64_tr_b16 v[172:173], v182 offset:96
v_mfma_f32_16x16x32_bf16 v[40:43], v[152:155], a[200:203], v[40:43]
ds_read_b64_tr_b16 v[174:175], v182 offset:4704
v_mfma_f32_16x16x32_bf16 v[40:43], v[148:151], a[192:195], v[40:43]
s_waitcnt lgkmcnt(2)
ds_read_b64_tr_b16 v[176:177], v182 offset:9312
ds_read_b64_tr_b16 v[178:179], v182 offset:13920
v_mfma_f32_16x16x32_bf16 v[48:51], v[156:159], a[192:195], v[48:51]
buffer_load_dwordx4 v234, s[12:15], s58 offen offset:2048 sc1 lds
v_mfma_f32_16x16x32_bf16 v[48:51], v[160:163], a[200:203], v[48:51]
ds_read_b64_tr_b16 v[144:145], v180 offset:18432
v_mfma_f32_16x16x32_bf16 v[52:55], v[160:163], a[204:207], v[52:55]
ds_read_b64_tr_b16 v[146:147], v180 offset:23040
v_mfma_f32_16x16x32_bf16 v[52:55], v[156:159], a[196:199], v[52:55]
ds_read_b64_tr_b16 v[148:149], v180 offset:27648
ds_read_b64_tr_b16 v[150:151], v180 offset:32256
v_mfma_f32_16x16x32_bf16 v[60:63], v[164:167], a[196:199], v[60:63]
buffer_load_dwordx4 v234, s[12:15], s58 offen offset:3072 sc1 lds
s_add_u32 s58, s58, 36864
v_mfma_f32_16x16x32_bf16 v[60:63], v[168:171], a[204:207], v[60:63]
s_waitcnt lgkmcnt(4)
ds_read_b64_tr_b16 v[152:153], v180 offset:18464
v_mfma_f32_16x16x32_bf16 v[56:59], v[168:171], a[200:203], v[56:59]
ds_read_b64_tr_b16 v[154:155], v180 offset:23072
v_mfma_f32_16x16x32_bf16 v[56:59], v[164:167], a[192:195], v[56:59]
s_add_u32 m0, s64, 4096
ds_read_b64_tr_b16 v[156:157], v180 offset:27680
ds_read_b64_tr_b16 v[158:159], v180 offset:32288
v_mfma_f32_16x16x32_bf16 v[64:67], v[172:175], a[192:195], v[64:67]
buffer_load_dwordx4 v234, s[12:15], s59 offen offset:0 sc1 lds
v_mfma_f32_16x16x32_bf16 v[64:67], v[176:179], a[200:203], v[64:67]
ds_read_b64_tr_b16 v[160:161], v180 offset:18496
v_mfma_f32_16x16x32_bf16 v[68:71], v[176:179], a[204:207], v[68:71]
s_waitcnt vmcnt(23)
ds_read_b64_tr_b16 v[162:163], v180 offset:23104
v_mfma_f32_16x16x32_bf16 v[68:71], v[172:175], a[196:199], v[68:71]
s_waitcnt lgkmcnt(2)
buffer_load_dwordx4 v234, s[12:15], s59 offen offset:1024 sc1 lds
v_mfma_f32_16x16x32_bf16 v[4:7], v[144:147], a[212:215], v[4:7]
ds_read_b64_tr_b16 v[164:165], v180 offset:27712
ds_read_b64_tr_b16 v[166:167], v180 offset:32320
v_mfma_f32_16x16x32_bf16 v[4:7], v[148:151], a[220:223], v[4:7]
ds_read_b64_tr_b16 v[168:169], v180 offset:18528
v_mfma_f32_16x16x32_bf16 v[0:3], v[148:151], a[216:219], v[0:3]
ds_read_b64_tr_b16 v[170:171], v180 offset:23136
v_mfma_f32_16x16x32_bf16 v[0:3], v[144:147], a[208:211], v[0:3]
buffer_load_dwordx4 v234, s[12:15], s59 offen offset:2048 sc1 lds
v_mfma_f32_16x16x32_bf16 v[8:11], v[152:155], a[208:211], v[8:11]
s_waitcnt vmcnt(16)
ds_add_u32 v188, v190
v_mfma_f32_16x16x32_bf16 v[8:11], v[156:159], a[216:219], v[8:11]
s_waitcnt lgkmcnt(3)
ds_read_b64_tr_b16 v[172:173], v180 offset:27744
ds_read_b64_tr_b16 v[174:175], v180 offset:32352
v_mfma_f32_16x16x32_bf16 v[12:15], v[156:159], a[220:223], v[12:15]
s_add_u32 s47, s47, 1
ds_read_b64_tr_b16 v[176:177], v181 offset:18560
ds_read_b64_tr_b16 v[178:179], v181 offset:23168
v_mfma_f32_16x16x32_bf16 v[12:15], v[152:155], a[212:215], v[12:15]
buffer_load_dwordx4 v234, s[12:15], s59 offen offset:3072 sc1 lds
s_add_u32 s59, s59, 36864
v_mfma_f32_16x16x32_bf16 v[20:23], v[160:163], a[212:215], v[20:23]
s_add_u32 s45, s45, 1
ds_read_b64_tr_b16 v[144:145], v181 offset:27776
ds_read_b64_tr_b16 v[146:147], v181 offset:32384
v_mfma_f32_16x16x32_bf16 v[20:23], v[164:167], a[220:223], v[20:23]
s_add_u32 m0, s64, 8192
ds_read_b64_tr_b16 v[148:149], v182 offset:18432
v_mfma_f32_16x16x32_bf16 v[16:19], v[164:167], a[216:219], v[16:19]
s_and_b32 s45, s45, 3
s_cselect_b32 s46, 36864, s42
ds_read_b64_tr_b16 v[150:151], v182 offset:23040
v_mfma_f32_16x16x32_bf16 v[16:19], v[160:163], a[208:211], v[16:19]
s_waitcnt lgkmcnt(2)
buffer_load_dwordx4 v234, s[12:15], s72 offen offset:0 sc1 lds
s_add_u32 s72, s72, 36864
s_add_u32 s64, s64, 36864
s_cmp_ge_u32 s64, 147456
s_cselect_b32 s64, s60, s64
v_mfma_f32_16x16x32_bf16 v[24:27], v[168:171], a[208:211], v[24:27]
ds_read_b32 v191, v189
v_mfma_f32_16x16x32_bf16 v[24:27], v[172:175], a[216:219], v[24:27]
ds_read_b64_tr_b16 v[152:153], v182 offset:27648
ds_read_b64_tr_b16 v[154:155], v182 offset:32256
v_mfma_f32_16x16x32_bf16 v[28:31], v[172:175], a[220:223], v[28:31]
buffer_load_dwordx4 a[192:195], v183, s[28:31], s61 offen sc1
v_mfma_f32_16x16x32_bf16 v[28:31], v[168:171], a[212:215], v[28:31]
ds_read_b64_tr_b16 v[156:157], v182 offset:18464
ds_read_b64_tr_b16 v[158:159], v182 offset:23072
v_add_u32 v180, s46, v180
v_mfma_f32_16x16x32_bf16 v[36:39], v[176:179], a[212:215], v[36:39]
s_waitcnt vmcnt(19)
ds_read_b64_tr_b16 v[160:161], v182 offset:27680
ds_read_b64_tr_b16 v[162:163], v182 offset:32288
v_add_u32 v181, s46, v181
v_mfma_f32_16x16x32_bf16 v[36:39], v[144:147], a[220:223], v[36:39]
s_waitcnt lgkmcnt(4)
ds_read_b64_tr_b16 v[164:165], v182 offset:18496
v_cmp_gt_u32 vcc, s47, v191
v_mfma_f32_16x16x32_bf16 v[32:35], v[144:147], a[216:219], v[32:35]
buffer_load_dwordx4 a[196:199], v184, s[28:31], s61 offen sc1
v_mfma_f32_16x16x32_bf16 v[32:35], v[176:179], a[208:211], v[32:35]
s_add_u32 s61, s61, 4096
ds_read_b64_tr_b16 v[166:167], v182 offset:23104
ds_read_b64_tr_b16 v[168:169], v182 offset:27712
v_mfma_f32_16x16x32_bf16 v[40:43], v[148:151], a[208:211], v[40:43]
ds_read_b64_tr_b16 v[170:171], v182 offset:32320
v_mfma_f32_16x16x32_bf16 v[40:43], v[152:155], a[216:219], v[40:43]
s_cbranch_vccnz k1_f4_s
k1_f4_b:
ds_read_b64_tr_b16 v[172:173], v182 offset:18528
v_mfma_f32_16x16x32_bf16 v[44:47], v[152:155], a[220:223], v[44:47]
buffer_load_dwordx4 a[200:203], v183, s[28:31], s61 offen sc1
v_mfma_f32_16x16x32_bf16 v[44:47], v[148:151], a[212:215], v[44:47]
s_waitcnt lgkmcnt(1)
ds_read_b64_tr_b16 v[174:175], v182 offset:23136
ds_read_b64_tr_b16 v[176:177], v182 offset:27744
v_mfma_f32_16x16x32_bf16 v[52:55], v[156:159], a[212:215], v[52:55]
ds_read_b64_tr_b16 v[178:179], v182 offset:32352
v_add_u32 v182, s46, v182
v_mfma_f32_16x16x32_bf16 v[52:55], v[160:163], a[220:223], v[52:55]
ds_read_b64_tr_b16 v[144:145], v180 offset:0
v_mfma_f32_16x16x32_bf16 v[48:51], v[160:163], a[216:219], v[48:51]
buffer_load_dwordx4 a[204:207], v184, s[28:31], s61 offen sc1
v_mfma_f32_16x16x32_bf16 v[48:51], v[156:159], a[208:211], v[48:51]
s_add_u32 s61, s61, 4096
ds_read_b64_tr_b16 v[146:147], v180 offset:4608
ds_read_b64_tr_b16 v[148:149], v180 offset:9216
v_mfma_f32_16x16x32_bf16 v[56:59], v[164:167], a[208:211], v[56:59]
ds_read_b64_tr_b16 v[150:151], v180 offset:13824
v_mfma_f32_16x16x32_bf16 v[56:59], v[168:171], a[216:219], v[56:59]
s_waitcnt lgkmcnt(4)
v_mfma_f32_16x16x32_bf16 v[60:63], v[168:171], a[220:223], v[60:63]
ds_read_b64_tr_b16 v[152:153], v180 offset:32
ds_read_b64_tr_b16 v[154:155], v180 offset:4640
v_mfma_f32_16x16x32_bf16 v[60:63], v[164:167], a[212:215], v[60:63]
ds_read_b64_tr_b16 v[156:157], v180 offset:9248
ds_read_b64_tr_b16 v[158:159], v180 offset:13856
v_mfma_f32_16x16x32_bf16 v[68:71], v[172:175], a[212:215], v[68:71]
ds_read_b64_tr_b16 v[160:161], v180 offset:64
v_mfma_f32_16x16x32_bf16 v[68:71], v[176:179], a[220:223], v[68:71]
v_mfma_f32_16x16x32_bf16 v[64:67], v[176:179], a[216:219], v[64:67]
s_waitcnt vmcnt(17)
ds_read_b64_tr_b16 v[162:163], v180 offset:4672
v_mfma_f32_16x16x32_bf16 v[64:67], v[172:175], a[208:211], v[64:67]
s_waitcnt lgkmcnt(2)
ds_read_b64_tr_b16 v[164:165], v180 offset:9280
ds_read_b64_tr_b16 v[166:167], v180 offset:13888
v_mfma_f32_16x16x32_bf16 v[0:3], v[144:147], a[224:227], v[0:3]
ds_read_b64_tr_b16 v[168:169], v180 offset:96
v_mfma_f32_16x16x32_bf16 v[0:3], v[148:151], a[232:235], v[0:3]
ds_read_b64_tr_b16 v[170:171], v180 offset:4704
v_mfma_f32_16x16x32_bf16 v[4:7], v[148:151], a[236:239], v[4:7]
buffer_load_dwordx4 a[208:211], v183, s[28:31], s61 offen sc1
v_mfma_f32_16x16x32_bf16 v[4:7], v[144:147], a[228:231], v[4:7]
ds_read_b64_tr_b16 v[172:173], v180 offset:9312
ds_read_b64_tr_b16 v[174:175], v180 offset:13920
v_mfma_f32_16x16x32_bf16 v[12:15], v[152:155], a[228:231], v[12:15]
ds_read_b64_tr_b16 v[176:177], v181 offset:128
v_mfma_f32_16x16x32_bf16 v[12:15], v[156:159], a[236:239], v[12:15]
s_waitcnt lgkmcnt(5)
buffer_load_dwordx4 a[212:215], v184, s[28:31], s61 offen sc1
v_mfma_f32_16x16x32_bf16 v[8:11], v[156:159], a[232:235], v[8:11]
s_add_u32 s61, s61, 4096
ds_read_b64_tr_b16 v[178:179], v181 offset:4736
v_mfma_f32_16x16x32_bf16 v[8:11], v[152:155], a[224:227], v[8:11]
ds_read_b64_tr_b16 v[144:145], v181 offset:9344
ds_read_b64_tr_b16 v[146:147], v181 offset:13952
v_mfma_f32_16x16x32_bf16 v[16:19], v[160:163], a[224:227], v[16:19]
ds_read_b64_tr_b16 v[148:149], v182 offset:0
v_mfma_f32_16x16x32_bf16 v[16:19], v[164:167], a[232:235], v[16:19]
buffer_load_dwordx4 a[216:219], v183, s[28:31], s61 offen sc1
v_mfma_f32_16x16x32_bf16 v[20:23], v[164:167], a[236:239], v[20:23]
ds_read_b64_tr_b16 v[150:151], v182 offset:4608
v_mfma_f32_16x16x32_bf16 v[20:23], v[160:163], a[228:231], v[20:23]
s_waitcnt lgkmcnt(2)
ds_read_b64_tr_b16 v[152:153], v182 offset:9216
ds_read_b64_tr_b16 v[154:155], v182 offset:13824
v_mfma_f32_16x16x32_bf16 v[28:31], v[168:171], a[228:231], v[28:31]
ds_read_b64_tr_b16 v[156:157], v182 offset:32
v_mfma_f32_16x16x32_bf16 v[28:31], v[172:175], a[236:239], v[28:31]
buffer_load_dwordx4 a[220:223], v184, s[28:31], s61 offen sc1
v_mfma_f32_16x16x32_bf16 v[24:27], v[172:175], a[232:235], v[24:27]
s_add_u32 s61, s61, 4096
ds_read_b64_tr_b16 v[158:159], v182 offset:4640
v_mfma_f32_16x16x32_bf16 v[24:27], v[168:171], a[224:227], v[24:27]
s_add_u32 m0, s64, 0
ds_read_b64_tr_b16 v[160:161], v182 offset:9248
ds_read_b64_tr_b16 v[162:163], v182 offset:13856
v_mfma_f32_16x16x32_bf16 v[32:35], v[176:179], a[224:227], v[32:35]
s_waitcnt vmcnt(21)
ds_read_b64_tr_b16 v[164:165], v182 offset:64
v_mfma_f32_16x16x32_bf16 v[32:35], v[144:147], a[232:235], v[32:35]
s_waitcnt lgkmcnt(5)
buffer_load_dwordx4 v234, s[12:15], s58 offen offset:0 sc1 lds
v_mfma_f32_16x16x32_bf16 v[36:39], v[144:147], a[236:239], v[36:39]
ds_read_b64_tr_b16 v[166:167], v182 offset:4672
v_mfma_f32_16x16x32_bf16 v[36:39], v[176:179], a[228:231], v[36:39]
ds_read_b64_tr_b16 v[168:169], v182 offset:9280
ds_read_b64_tr_b16 v[170:171], v182 offset:13888
v_mfma_f32_16x16x32_bf16 v[44:47], v[148:151], a[228:231], v[44:47]
buffer_load_dwordx4 v234, s[12:15], s58 offen offset:1024 sc1 lds
v_mfma_f32_16x16x32_bf16 v[44:47], v[152:155], a[236:239], v[44:47]
ds_read_b64_tr_b16 v[172:173], v182 offset:96
v_mfma_f32_16x16x32_bf16 v[40:43], v[152:155], a[232:235], v[40:43]
ds_read_b64_tr_b16 v[174:175], v182 offset:4704
v_mfma_f32_16x16x32_bf16 v[40:43], v[148:151], a[224:227], v[40:43]
s_waitcnt lgkmcnt(2)
ds_read_b64_tr_b16 v[176:177], v182 offset:9312
ds_read_b64_tr_b16 v[178:179], v182 offset:13920
v_mfma_f32_16x16x32_bf16 v[48:51], v[156:159], a[224:227], v[48:51]
buffer_load_dwordx4 v234, s[12:15], s58 offen offset:2048 sc1 lds
v_mfma_f32_16x16x32_bf16 v[48:51], v[160:163], a[232:235], v[48:51]
ds_read_b64_tr_b16 v[144:145], v180 offset:18432
v_mfma_f32_16x16x32_bf16 v[52:55], v[160:163], a[236:239], v[52:55]
ds_read_b64_tr_b16 v[146:147], v180 offset:23040
v_mfma_f32_16x16x32_bf16 v[52:55], v[156:159], a[228:231], v[52:55]
ds_read_b64_tr_b16 v[148:149], v180 offset:27648
ds_read_b64_tr_b16 v[150:151], v180 offset:32256
v_mfma_f32_16x16x32_bf16 v[60:63], v[164:167], a[228:231], v[60:63]
buffer_load_dwordx4 v234, s[12:15], s58 offen offset:3072 sc1 lds
s_add_u32 s58, s58, 36864
v_mfma_f32_16x16x32_bf16 v[60:63], v[168:171], a[236:239], v[60:63]
s_waitcnt lgkmcnt(4)
ds_read_b64_tr_b16 v[152:153], v180 offset:18464
v_mfma_f32_16x16x32_bf16 v[56:59], v[168:171], a[232:235], v[56:59]
ds_read_b64_tr_b16 v[154:155], v180 offset:23072
v_mfma_f32_16x16x32_bf16 v[56:59], v[164:167], a[224:227], v[56:59]
s_add_u32 m0, s64, 4096
ds_read_b64_tr_b16 v[156:157], v180 offset:27680
ds_read_b64_tr_b16 v[158:159], v180 offset:32288
v_mfma_f32_16x16x32_bf16 v[64:67], v[172:175], a[224:227], v[64:67]
buffer_load_dwordx4 v234, s[12:15], s59 offen offset:0 sc1 lds
v_mfma_f32_16x16x32_bf16 v[64:67], v[176:179], a[232:235], v[64:67]
ds_read_b64_tr_b16 v[160:161], v180 offset:18496
v_mfma_f32_16x16x32_bf16 v[68:71], v[176:179], a[236:239], v[68:71]
s_waitcnt vmcnt(22)
ds_read_b64_tr_b16 v[162:163], v180 offset:23104
v_mfma_f32_16x16x32_bf16 v[68:71], v[172:175], a[228:231], v[68:71]
s_waitcnt lgkmcnt(2)
buffer_load_dwordx4 v234, s[12:15], s59 offen offset:1024 sc1 lds
v_mfma_f32_16x16x32_bf16 v[4:7], v[144:147], a[244:247], v[4:7]
ds_read_b64_tr_b16 v[164:165], v180 offset:27712
ds_read_b64_tr_b16 v[166:167], v180 offset:32320
v_mfma_f32_16x16x32_bf16 v[4:7], v[148:151], a[252:255], v[4:7]
ds_read_b64_tr_b16 v[168:169], v180 offset:18528
v_mfma_f32_16x16x32_bf16 v[0:3], v[148:151], a[248:251], v[0:3]
ds_read_b64_tr_b16 v[170:171], v180 offset:23136
v_mfma_f32_16x16x32_bf16 v[0:3], v[144:147], a[240:243], v[0:3]
buffer_load_dwordx4 v234, s[12:15], s59 offen offset:2048 sc1 lds
v_mfma_f32_16x16x32_bf16 v[8:11], v[152:155], a[240:243], v[8:11]
s_waitcnt vmcnt(15)
ds_add_u32 v188, v190
v_mfma_f32_16x16x32_bf16 v[8:11], v[156:159], a[248:251], v[8:11]
s_waitcnt lgkmcnt(3)
ds_read_b64_tr_b16 v[172:173], v180 offset:27744
ds_read_b64_tr_b16 v[174:175], v180 offset:32352
v_mfma_f32_16x16x32_bf16 v[12:15], v[156:159], a[252:255], v[12:15]
s_add_u32 s47, s47, 1
ds_read_b64_tr_b16 v[176:177], v181 offset:18560
ds_read_b64_tr_b16 v[178:179], v181 offset:23168
v_mfma_f32_16x16x32_bf16 v[12:15], v[152:155], a[244:247], v[12:15]
buffer_load_dwordx4 v234, s[12:15], s59 offen offset:3072 sc1 lds
s_add_u32 s59, s59, 36864
v_mfma_f32_16x16x32_bf16 v[20:23], v[160:163], a[244:247], v[20:23]
s_add_u32 s45, s45, 1
ds_read_b64_tr_b16 v[144:145], v181 offset:27776
ds_read_b64_tr_b16 v[146:147], v181 offset:32384
v_mfma_f32_16x16x32_bf16 v[20:23], v[164:167], a[252:255], v[20:23]
s_add_u32 m0, s64, 8192
ds_read_b64_tr_b16 v[148:149], v182 offset:18432
v_mfma_f32_16x16x32_bf16 v[16:19], v[164:167], a[248:251], v[16:19]
s_and_b32 s45, s45, 3
s_cselect_b32 s46, 36864, s42
ds_read_b64_tr_b16 v[150:151], v182 offset:23040
v_mfma_f32_16x16x32_bf16 v[16:19], v[160:163], a[240:243], v[16:19]
s_waitcnt lgkmcnt(2)
buffer_load_dwordx4 v234, s[12:15], s72 offen offset:0 sc1 lds
s_add_u32 s72, s72, 36864
s_add_u32 s64, s64, 36864
s_cmp_ge_u32 s64, 147456
s_cselect_b32 s64, s60, s64
v_mfma_f32_16x16x32_bf16 v[24:27], v[168:171], a[240:243], v[24:27]
ds_read_b32 v191, v189
v_mfma_f32_16x16x32_bf16 v[24:27], v[172:175], a[248:251], v[24:27]
ds_read_b64_tr_b16 v[152:153], v182 offset:27648
ds_read_b64_tr_b16 v[154:155], v182 offset:32256
v_mfma_f32_16x16x32_bf16 v[28:31], v[172:175], a[252:255], v[28:31]
buffer_load_dwordx4 a[224:227], v183, s[28:31], s61 offen sc1
v_mfma_f32_16x16x32_bf16 v[28:31], v[168:171], a[244:247], v[28:31]
ds_read_b64_tr_b16 v[156:157], v182 offset:18464
ds_read_b64_tr_b16 v[158:159], v182 offset:23072
v_add_u32 v180, s46, v180
v_mfma_f32_16x16x32_bf16 v[36:39], v[176:179], a[244:247], v[36:39]
s_waitcnt vmcnt(18)
ds_read_b64_tr_b16 v[160:161], v182 offset:27680
ds_read_b64_tr_b16 v[162:163], v182 offset:32288
v_add_u32 v181, s46, v181
v_mfma_f32_16x16x32_bf16 v[36:39], v[144:147], a[252:255], v[36:39]
s_waitcnt lgkmcnt(4)
ds_read_b64_tr_b16 v[164:165], v182 offset:18496
v_cmp_gt_u32 vcc, s47, v191
v_mfma_f32_16x16x32_bf16 v[32:35], v[144:147], a[248:251], v[32:35]
buffer_load_dwordx4 a[228:231], v184, s[28:31], s61 offen sc1
v_mfma_f32_16x16x32_bf16 v[32:35], v[176:179], a[240:243], v[32:35]
s_add_u32 s61, s61, 4096
ds_read_b64_tr_b16 v[166:167], v182 offset:23104
ds_read_b64_tr_b16 v[168:169], v182 offset:27712
v_mfma_f32_16x16x32_bf16 v[40:43], v[148:151], a[240:243], v[40:43]
ds_read_b64_tr_b16 v[170:171], v182 offset:32320
v_mfma_f32_16x16x32_bf16 v[40:43], v[152:155], a[248:251], v[40:43]
s_cbranch_vccnz k1_f5_s
k1_f5_b:
ds_read_b64_tr_b16 v[172:173], v182 offset:18528
v_mfma_f32_16x16x32_bf16 v[44:47], v[152:155], a[252:255], v[44:47]
buffer_load_dwordx4 a[232:235], v183, s[28:31], s61 offen sc1
v_mfma_f32_16x16x32_bf16 v[44:47], v[148:151], a[244:247], v[44:47]
s_waitcnt lgkmcnt(1)
ds_read_b64_tr_b16 v[174:175], v182 offset:23136
ds_read_b64_tr_b16 v[176:177], v182 offset:27744
v_mfma_f32_16x16x32_bf16 v[52:55], v[156:159], a[244:247], v[52:55]
ds_read_b64_tr_b16 v[178:179], v182 offset:32352
v_add_u32 v182, s46, v182
v_mfma_f32_16x16x32_bf16 v[52:55], v[160:163], a[252:255], v[52:55]
ds_read_b64_tr_b16 v[144:145], v180 offset:0
v_mfma_f32_16x16x32_bf16 v[48:51], v[160:163], a[248:251], v[48:51]
buffer_load_dwordx4 a[236:239], v184, s[28:31], s61 offen sc1
v_mfma_f32_16x16x32_bf16 v[48:51], v[156:159], a[240:243], v[48:51]
s_add_u32 s61, s61, 4096
ds_read_b64_tr_b16 v[146:147], v180 offset:4608
ds_read_b64_tr_b16 v[148:149], v180 offset:9216
v_mfma_f32_16x16x32_bf16 v[56:59], v[164:167], a[240:243], v[56:59]
ds_read_b64_tr_b16 v[150:151], v180 offset:13824
v_mfma_f32_16x16x32_bf16 v[56:59], v[168:171], a[248:251], v[56:59]
s_waitcnt lgkmcnt(4)
v_mfma_f32_16x16x32_bf16 v[60:63], v[168:171], a[252:255], v[60:63]
ds_read_b64_tr_b16 v[152:153], v180 offset:32
ds_read_b64_tr_b16 v[154:155], v180 offset:4640
v_mfma_f32_16x16x32_bf16 v[60:63], v[164:167], a[244:247], v[60:63]
ds_read_b64_tr_b16 v[156:157], v180 offset:9248
ds_read_b64_tr_b16 v[158:159], v180 offset:13856
v_mfma_f32_16x16x32_bf16 v[68:71], v[172:175], a[244:247], v[68:71]
ds_read_b64_tr_b16 v[160:161], v180 offset:64
v_mfma_f32_16x16x32_bf16 v[68:71], v[176:179], a[252:255], v[68:71]
v_mfma_f32_16x16x32_bf16 v[64:67], v[176:179], a[248:251], v[64:67]
s_waitcnt vmcnt(17)
ds_read_b64_tr_b16 v[162:163], v180 offset:4672
v_mfma_f32_16x16x32_bf16 v[64:67], v[172:175], a[240:243], v[64:67]
s_waitcnt lgkmcnt(2)
ds_read_b64_tr_b16 v[164:165], v180 offset:9280
ds_read_b64_tr_b16 v[166:167], v180 offset:13888
v_mfma_f32_16x16x32_bf16 v[0:3], v[144:147], a[192:195], v[0:3]
ds_read_b64_tr_b16 v[168:169], v180 offset:96
v_mfma_f32_16x16x32_bf16 v[0:3], v[148:151], a[200:203], v[0:3]
ds_read_b64_tr_b16 v[170:171], v180 offset:4704
v_mfma_f32_16x16x32_bf16 v[4:7], v[148:151], a[204:207], v[4:7]
buffer_load_dword v233, v187, s[36:39], s68 offen sc1
v_mfma_f32_16x16x32_bf16 v[4:7], v[144:147], a[196:199], v[4:7]
ds_read_b64_tr_b16 v[172:173], v180 offset:9312
ds_read_b64_tr_b16 v[174:175], v180 offset:13920
v_mfma_f32_16x16x32_bf16 v[12:15], v[152:155], a[196:199], v[12:15]
ds_read_b64_tr_b16 v[176:177], v181 offset:128
v_mfma_f32_16x16x32_bf16 v[12:15], v[156:159], a[204:207], v[12:15]
s_waitcnt lgkmcnt(5)
buffer_load_dwordx4 a[240:243], v183, s[28:31], s61 offen sc1
v_mfma_f32_16x16x32_bf16 v[8:11], v[156:159], a[200:203], v[8:11]
ds_read_b64_tr_b16 v[178:179], v181 offset:4736
v_mfma_f32_16x16x32_bf16 v[8:11], v[152:155], a[192:195], v[8:11]
ds_read_b64_tr_b16 v[144:145], v181 offset:9344
ds_read_b64_tr_b16 v[146:147], v181 offset:13952
v_mfma_f32_16x16x32_bf16 v[16:19], v[160:163], a[192:195], v[16:19]
ds_read_b64_tr_b16 v[148:149], v182 offset:0
v_mfma_f32_16x16x32_bf16 v[16:19], v[164:167], a[200:203], v[16:19]
buffer_load_dwordx4 a[244:247], v184, s[28:31], s61 offen sc1
v_mfma_f32_16x16x32_bf16 v[20:23], v[164:167], a[204:207], v[20:23]
s_add_u32 s61, s61, 4096
ds_read_b64_tr_b16 v[150:151], v182 offset:4608
v_mfma_f32_16x16x32_bf16 v[20:23], v[160:163], a[196:199], v[20:23]
s_waitcnt lgkmcnt(2)
ds_read_b64_tr_b16 v[152:153], v182 offset:9216
ds_read_b64_tr_b16 v[154:155], v182 offset:13824
v_mfma_f32_16x16x32_bf16 v[28:31], v[168:171], a[196:199], v[28:31]
ds_read_b64_tr_b16 v[156:157], v182 offset:32
v_mfma_f32_16x16x32_bf16 v[28:31], v[172:175], a[204:207], v[28:31]
buffer_load_dwordx4 a[248:251], v183, s[28:31], s61 offen sc1
v_mfma_f32_16x16x32_bf16 v[24:27], v[172:175], a[200:203], v[24:27]
ds_read_b64_tr_b16 v[158:159], v182 offset:4640
v_mfma_f32_16x16x32_bf16 v[24:27], v[168:171], a[192:195], v[24:27]
ds_read_b64_tr_b16 v[160:161], v182 offset:9248
ds_read_b64_tr_b16 v[162:163], v182 offset:13856
v_mfma_f32_16x16x32_bf16 v[32:35], v[176:179], a[192:195], v[32:35]
s_waitcnt vmcnt(21)
ds_read_b64_tr_b16 v[164:165], v182 offset:64
v_mfma_f32_16x16x32_bf16 v[32:35], v[144:147], a[200:203], v[32:35]
s_waitcnt lgkmcnt(5)
buffer_load_dwordx4 a[252:255], v184, s[28:31], s61 offen sc1
v_mfma_f32_16x16x32_bf16 v[36:39], v[144:147], a[204:207], v[36:39]
s_add_u32 s61, s61, 4096
ds_read_b64_tr_b16 v[166:167], v182 offset:4672
v_mfma_f32_16x16x32_bf16 v[36:39], v[176:179], a[196:199], v[36:39]
s_add_u32 m0, s64, 0
ds_read_b64_tr_b16 v[168:169], v182 offset:9280
ds_read_b64_tr_b16 v[170:171], v182 offset:13888
v_mfma_f32_16x16x32_bf16 v[44:47], v[148:151], a[196:199], v[44:47]
buffer_load_dwordx4 v234, s[12:15], s58 offen offset:0 sc1 lds
v_mfma_f32_16x16x32_bf16 v[44:47], v[152:155], a[204:207], v[44:47]
ds_read_b64_tr_b16 v[172:173], v182 offset:96
v_mfma_f32_16x16x32_bf16 v[40:43], v[152:155], a[200:203], v[40:43]
ds_read_b64_tr_b16 v[174:175], v182 offset:4704
v_mfma_f32_16x16x32_bf16 v[40:43], v[148:151], a[192:195], v[40:43]
s_waitcnt lgkmcnt(2)
ds_read_b64_tr_b16 v[176:177], v182 offset:9312
ds_read_b64_tr_b16 v[178:179], v182 offset:13920
v_mfma_f32_16x16x32_bf16 v[48:51], v[156:159], a[192:195], v[48:51]
buffer_load_dwordx4 v234, s[12:15], s58 offen offset:1024 sc1 lds
v_mfma_f32_16x16x32_bf16 v[48:51], v[160:163], a[200:203], v[48:51]
ds_read_b64_tr_b16 v[144:145], v180 offset:18432
v_mfma_f32_16x16x32_bf16 v[52:55], v[160:163], a[204:207], v[52:55]
ds_read_b64_tr_b16 v[146:147], v180 offset:23040
v_mfma_f32_16x16x32_bf16 v[52:55], v[156:159], a[196:199], v[52:55]
ds_read_b64_tr_b16 v[148:149], v180 offset:27648
ds_read_b64_tr_b16 v[150:151], v180 offset:32256
v_mfma_f32_16x16x32_bf16 v[60:63], v[164:167], a[196:199], v[60:63]
buffer_load_dwordx4 v234, s[12:15], s58 offen offset:2048 sc1 lds
v_mfma_f32_16x16x32_bf16 v[60:63], v[168:171], a[204:207], v[60:63]
s_waitcnt lgkmcnt(4)
ds_read_b64_tr_b16 v[152:153], v180 offset:18464
v_mfma_f32_16x16x32_bf16 v[56:59], v[168:171], a[200:203], v[56:59]
ds_read_b64_tr_b16 v[154:155], v180 offset:23072
v_mfma_f32_16x16x32_bf16 v[56:59], v[164:167], a[192:195], v[56:59]
ds_read_b64_tr_b16 v[156:157], v180 offset:27680
ds_read_b64_tr_b16 v[158:159], v180 offset:32288
v_mfma_f32_16x16x32_bf16 v[64:67], v[172:175], a[192:195], v[64:67]
buffer_load_dwordx4 v234, s[12:15], s58 offen offset:3072 sc1 lds
v_mfma_f32_16x16x32_bf16 v[64:67], v[176:179], a[200:203], v[64:67]
s_add_u32 s58, s71, 0
ds_read_b64_tr_b16 v[160:161], v180 offset:18496
v_mfma_f32_16x16x32_bf16 v[68:71], v[176:179], a[204:207], v[68:71]
s_waitcnt vmcnt(22)
ds_read_b64_tr_b16 v[162:163], v180 offset:23104
s_add_u32 m0, s64, 4096
v_mfma_f32_16x16x32_bf16 v[68:71], v[172:175], a[196:199], v[68:71]
s_waitcnt lgkmcnt(2)
buffer_load_dwordx4 v234, s[12:15], s59 offen offset:0 sc1 lds
v_mfma_f32_16x16x32_bf16 v[4:7], v[144:147], a[212:215], v[4:7]
ds_read_b64_tr_b16 v[164:165], v180 offset:27712
ds_read_b64_tr_b16 v[166:167], v180 offset:32320
v_mfma_f32_16x16x32_bf16 v[4:7], v[148:151], a[220:223], v[4:7]
ds_read_b64_tr_b16 v[168:169], v180 offset:18528
v_mfma_f32_16x16x32_bf16 v[0:3], v[148:151], a[216:219], v[0:3]
ds_read_b64_tr_b16 v[170:171], v180 offset:23136
v_mfma_f32_16x16x32_bf16 v[0:3], v[144:147], a[208:211], v[0:3]
buffer_load_dwordx4 v234, s[12:15], s59 offen offset:1024 sc1 lds
v_mfma_f32_16x16x32_bf16 v[8:11], v[152:155], a[208:211], v[8:11]
s_waitcnt vmcnt(15)
ds_add_u32 v188, v190
v_mfma_f32_16x16x32_bf16 v[8:11], v[156:159], a[216:219], v[8:11]
s_waitcnt lgkmcnt(3)
ds_read_b64_tr_b16 v[172:173], v180 offset:27744
ds_read_b64_tr_b16 v[174:175], v180 offset:32352
v_mfma_f32_16x16x32_bf16 v[12:15], v[156:159], a[220:223], v[12:15]
s_add_u32 s47, s47, 1
ds_read_b64_tr_b16 v[176:177], v181 offset:18560
ds_read_b64_tr_b16 v[178:179], v181 offset:23168
v_mfma_f32_16x16x32_bf16 v[12:15], v[152:155], a[212:215], v[12:15]
buffer_load_dwordx4 v234, s[12:15], s59 offen offset:2048 sc1 lds
v_mfma_f32_16x16x32_bf16 v[20:23], v[160:163], a[212:215], v[20:23]
s_add_u32 s45, s45, 1
ds_read_b64_tr_b16 v[144:145], v181 offset:27776
ds_read_b64_tr_b16 v[146:147], v181 offset:32384
v_mfma_f32_16x16x32_bf16 v[20:23], v[164:167], a[220:223], v[20:23]
ds_read_b64_tr_b16 v[148:149], v182 offset:18432
v_mfma_f32_16x16x32_bf16 v[16:19], v[164:167], a[216:219], v[16:19]
s_and_b32 s45, s45, 3
s_cselect_b32 s46, 36864, s42
ds_read_b64_tr_b16 v[150:151], v182 offset:23040
v_mfma_f32_16x16x32_bf16 v[16:19], v[160:163], a[208:211], v[16:19]
s_waitcnt lgkmcnt(2)
buffer_load_dwordx4 v234, s[12:15], s59 offen offset:3072 sc1 lds
v_mfma_f32_16x16x32_bf16 v[24:27], v[168:171], a[208:211], v[24:27]
s_add_u32 s59, s71, 4096
ds_read_b32 v191, v189
v_mfma_f32_16x16x32_bf16 v[24:27], v[172:175], a[216:219], v[24:27]
s_add_u32 m0, s64, 8192
ds_read_b64_tr_b16 v[152:153], v182 offset:27648
ds_read_b64_tr_b16 v[154:155], v182 offset:32256
v_mfma_f32_16x16x32_bf16 v[28:31], v[172:175], a[220:223], v[28:31]
buffer_load_dwordx4 v234, s[12:15], s72 offen offset:0 sc1 lds
s_add_u32 s72, s71, 8192
s_add_u32 s64, s64, 36864
s_cmp_ge_u32 s64, 147456
s_cselect_b32 s64, s60, s64
v_mfma_f32_16x16x32_bf16 v[28:31], v[168:171], a[212:215], v[28:31]
ds_read_b64_tr_b16 v[156:157], v182 offset:18464
ds_read_b64_tr_b16 v[158:159], v182 offset:23072
v_add_u32 v180, s46, v180
v_mfma_f32_16x16x32_bf16 v[36:39], v[176:179], a[212:215], v[36:39]
s_waitcnt vmcnt(18)
ds_read_b64_tr_b16 v[160:161], v182 offset:27680
ds_read_b64_tr_b16 v[162:163], v182 offset:32288
v_add_u32 v181, s46, v181
v_mfma_f32_16x16x32_bf16 v[36:39], v[144:147], a[220:223], v[36:39]
s_waitcnt lgkmcnt(4)
ds_read_b64_tr_b16 v[164:165], v182 offset:18496
v_cmp_gt_u32 vcc, s47, v191
v_mfma_f32_16x16x32_bf16 v[32:35], v[144:147], a[216:219], v[32:35]
buffer_load_dwordx4 a[192:195], v183, s[28:31], s61 offen sc1
v_mfma_f32_16x16x32_bf16 v[32:35], v[176:179], a[208:211], v[32:35]
ds_read_b64_tr_b16 v[166:167], v182 offset:23104
ds_read_b64_tr_b16 v[168:169], v182 offset:27712
v_mfma_f32_16x16x32_bf16 v[40:43], v[148:151], a[208:211], v[40:43]
ds_read_b64_tr_b16 v[170:171], v182 offset:32320
v_mfma_f32_16x16x32_bf16 v[40:43], v[152:155], a[216:219], v[40:43]
s_cbranch_vccnz k1_f6_s
k1_f6_b:
ds_read_b64_tr_b16 v[172:173], v182 offset:18528
v_mfma_f32_16x16x32_bf16 v[44:47], v[152:155], a[220:223], v[44:47]
buffer_load_dwordx4 a[196:199], v184, s[28:31], s61 offen sc1
s_add_u32 s61, s61, 4096
v_mfma_f32_16x16x32_bf16 v[44:47], v[148:151], a[212:215], v[44:47]
s_waitcnt lgkmcnt(1)
ds_read_b64_tr_b16 v[174:175], v182 offset:23136
ds_read_b64_tr_b16 v[176:177], v182 offset:27744
v_mfma_f32_16x16x32_bf16 v[52:55], v[156:159], a[212:215], v[52:55]
ds_read_b64_tr_b16 v[178:179], v182 offset:32352
v_add_u32 v182, s46, v182
v_mfma_f32_16x16x32_bf16 v[52:55], v[160:163], a[220:223], v[52:55]
ds_read_b64_tr_b16 v[144:145], v180 offset:0
v_mfma_f32_16x16x32_bf16 v[48:51], v[160:163], a[216:219], v[48:51]
buffer_load_dwordx4 a[200:203], v183, s[28:31], s61 offen sc1
v_mfma_f32_16x16x32_bf16 v[48:51], v[156:159], a[208:211], v[48:51]
ds_read_b64_tr_b16 v[146:147], v180 offset:4608
ds_read_b64_tr_b16 v[148:149], v180 offset:9216
v_mfma_f32_16x16x32_bf16 v[56:59], v[164:167], a[208:211], v[56:59]
ds_read_b64_tr_b16 v[150:151], v180 offset:13824
v_mfma_f32_16x16x32_bf16 v[56:59], v[168:171], a[216:219], v[56:59]
s_waitcnt lgkmcnt(4)
buffer_load_dwordx4 a[204:207], v184, s[28:31], s61 offen sc1
v_mfma_f32_16x16x32_bf16 v[60:63], v[168:171], a[220:223], v[60:63]
s_add_u32 s61, s61, 4096
ds_read_b64_tr_b16 v[152:153], v180 offset:32
ds_read_b64_tr_b16 v[154:155], v180 offset:4640
v_mfma_f32_16x16x32_bf16 v[60:63], v[164:167], a[212:215], v[60:63]
ds_read_b64_tr_b16 v[156:157], v180 offset:9248
ds_read_b64_tr_b16 v[158:159], v180 offset:13856
v_mfma_f32_16x16x32_bf16 v[68:71], v[172:175], a[212:215], v[68:71]
s_add_u32 m0, s64, 0
ds_read_b64_tr_b16 v[160:161], v180 offset:64
v_mfma_f32_16x16x32_bf16 v[68:71], v[176:179], a[220:223], v[68:71]
buffer_load_dwordx4 v234, s[12:15], s58 offen offset:0 sc1 lds
v_mfma_f32_16x16x32_bf16 v[64:67], v[176:179], a[216:219], v[64:67]
s_waitcnt vmcnt(19)
ds_read_b64_tr_b16 v[162:163], v180 offset:4672
v_mfma_f32_16x16x32_bf16 v[64:67], v[172:175], a[208:211], v[64:67]
s_waitcnt lgkmcnt(2)
ds_read_b64_tr_b16 v[164:165], v180 offset:9280
ds_read_b64_tr_b16 v[166:167], v180 offset:13888
v_mfma_f32_16x16x32_bf16 v[0:3], v[144:147], a[224:227], v[0:3]
ds_read_b64_tr_b16 v[168:169], v180 offset:96
v_mfma_f32_16x16x32_bf16 v[0:3], v[148:151], a[232:235], v[0:3]
ds_read_b64_tr_b16 v[170:171], v180 offset:4704
v_mfma_f32_16x16x32_bf16 v[4:7], v[148:151], a[236:239], v[4:7]
buffer_load_dwordx4 a[208:211], v183, s[28:31], s61 offen sc1
v_mfma_f32_16x16x32_bf16 v[4:7], v[144:147], a[228:231], v[4:7]
ds_read_b64_tr_b16 v[172:173], v180 offset:9312
ds_read_b64_tr_b16 v[174:175], v180 offset:13920
v_mfma_f32_16x16x32_bf16 v[12:15], v[152:155], a[228:231], v[12:15]
ds_read_b64_tr_b16 v[176:177], v181 offset:128
v_mfma_f32_16x16x32_bf16 v[12:15], v[156:159], a[236:239], v[12:15]
s_waitcnt lgkmcnt(5)
buffer_load_dwordx4 a[212:215], v184, s[28:31], s61 offen sc1
v_mfma_f32_16x16x32_bf16 v[8:11], v[156:159], a[232:235], v[8:11]
s_add_u32 s61, s61, 4096
ds_read_b64_tr_b16 v[178:179], v181 offset:4736
v_mfma_f32_16x16x32_bf16 v[8:11], v[152:155], a[224:227], v[8:11]
ds_read_b64_tr_b16 v[144:145], v181 offset:9344
ds_read_b64_tr_b16 v[146:147], v181 offset:13952
v_mfma_f32_16x16x32_bf16 v[16:19], v[160:163], a[224:227], v[16:19]
ds_read_b64_tr_b16 v[148:149], v182 offset:0
v_mfma_f32_16x16x32_bf16 v[16:19], v[164:167], a[232:235], v[16:19]
buffer_load_dwordx4 a[216:219], v183, s[28:31], s61 offen sc1
v_mfma_f32_16x16x32_bf16 v[20:23], v[164:167], a[236:239], v[20:23]
ds_read_b64_tr_b16 v[150:151], v182 offset:4608
v_mfma_f32_16x16x32_bf16 v[20:23], v[160:163], a[228:231], v[20:23]
s_waitcnt lgkmcnt(2)
ds_read_b64_tr_b16 v[152:153], v182 offset:9216
ds_read_b64_tr_b16 v[154:155], v182 offset:13824
v_mfma_f32_16x16x32_bf16 v[28:31], v[168:171], a[228:231], v[28:31]
ds_read_b64_tr_b16 v[156:157], v182 offset:32
v_mfma_f32_16x16x32_bf16 v[28:31], v[172:175], a[236:239], v[28:31]
buffer_load_dwordx4 a[220:223], v184, s[28:31], s61 offen sc1
v_mfma_f32_16x16x32_bf16 v[24:27], v[172:175], a[232:235], v[24:27]
s_mov_b32 s61, s70
ds_read_b64_tr_b16 v[158:159], v182 offset:4640
v_mfma_f32_16x16x32_bf16 v[24:27], v[168:171], a[224:227], v[24:27]
ds_read_b64_tr_b16 v[160:161], v182 offset:9248
ds_read_b64_tr_b16 v[162:163], v182 offset:13856
v_mfma_f32_16x16x32_bf16 v[32:35], v[176:179], a[224:227], v[32:35]
s_waitcnt vmcnt(22)
ds_read_b64_tr_b16 v[164:165], v182 offset:64
v_mfma_f32_16x16x32_bf16 v[32:35], v[144:147], a[232:235], v[32:35]
s_waitcnt lgkmcnt(5)
buffer_load_dwordx4 v234, s[12:15], s58 offen offset:1024 sc1 lds
v_cmp_ne_u32 vcc, s51, v233
s_nop 4
s_cbranch_vccnz k1_po1_s
k1_po1_b:
v_mfma_f32_16x16x32_bf16 v[36:39], v[144:147], a[236:239], v[36:39]
ds_read_b64_tr_b16 v[166:167], v182 offset:4672
v_mfma_f32_16x16x32_bf16 v[36:39], v[176:179], a[228:231], v[36:39]
ds_read_b64_tr_b16 v[168:169], v182 offset:9280
ds_read_b64_tr_b16 v[170:171], v182 offset:13888
v_mfma_f32_16x16x32_bf16 v[44:47], v[148:151], a[228:231], v[44:47]
buffer_load_dwordx4 v234, s[12:15], s58 offen offset:2048 sc1 lds
v_mfma_f32_16x16x32_bf16 v[44:47], v[152:155], a[236:239], v[44:47]
ds_read_b64_tr_b16 v[172:173], v182 offset:96
v_mfma_f32_16x16x32_bf16 v[40:43], v[152:155], a[232:235], v[40:43]
ds_read_b64_tr_b16 v[174:175], v182 offset:4704
v_mfma_f32_16x16x32_bf16 v[40:43], v[148:151], a[224:227], v[40:43]
s_waitcnt lgkmcnt(2)
ds_read_b64_tr_b16 v[176:177], v182 offset:9312
ds_read_b64_tr_b16 v[178:179], v182 offset:13920
v_mfma_f32_16x16x32_bf16 v[48:51], v[156:159], a[224:227], v[48:51]
buffer_load_dwordx4 v234, s[12:15], s58 offen offset:3072 sc1 lds
v_mfma_f32_16x16x32_bf16 v[48:51], v[160:163], a[232:235], v[48:51]
s_add_u32 s58, s58, 36864
ds_read_b64_tr_b16 v[144:145], v180 offset:18432
v_mfma_f32_16x16x32_bf16 v[52:55], v[160:163], a[236:239], v[52:55]
ds_read_b64_tr_b16 v[146:147], v180 offset:23040
v_mfma_f32_16x16x32_bf16 v[52:55], v[156:159], a[228:231], v[52:55]
s_add_u32 m0, s64, 4096
ds_read_b64_tr_b16 v[148:149], v180 offset:27648
ds_read_b64_tr_b16 v[150:151], v180 offset:32256
v_mfma_f32_16x16x32_bf16 v[60:63], v[164:167], a[228:231], v[60:63]
buffer_load_dwordx4 v234, s[12:15], s59 offen offset:0 sc1 lds
v_mfma_f32_16x16x32_bf16 v[60:63], v[168:171], a[236:239], v[60:63]
s_waitcnt lgkmcnt(4)
ds_read_b64_tr_b16 v[152:153], v180 offset:18464
v_mfma_f32_16x16x32_bf16 v[56:59], v[168:171], a[232:235], v[56:59]
ds_read_b64_tr_b16 v[154:155], v180 offset:23072
v_mfma_f32_16x16x32_bf16 v[56:59], v[164:167], a[224:227], v[56:59]
ds_read_b64_tr_b16 v[156:157], v180 offset:27680
ds_read_b64_tr_b16 v[158:159], v180 offset:32288
v_mfma_f32_16x16x32_bf16 v[64:67], v[172:175], a[224:227], v[64:67]
buffer_load_dwordx4 v234, s[12:15], s59 offen offset:1024 sc1 lds
v_mfma_f32_16x16x32_bf16 v[64:67], v[176:179], a[232:235], v[64:67]
ds_read_b64_tr_b16 v[160:161], v180 offset:18496
v_mfma_f32_16x16x32_bf16 v[68:71], v[176:179], a[236:239], v[68:71]
s_waitcnt vmcnt(23)
ds_read_b64_tr_b16 v[162:163], v180 offset:23104
v_mfma_f32_16x16x32_bf16 v[68:71], v[172:175], a[228:231], v[68:71]
s_waitcnt lgkmcnt(2)
buffer_load_dwordx4 v234, s[12:15], s59 offen offset:2048 sc1 lds
v_mfma_f32_16x16x32_bf16 v[4:7], v[144:147], a[244:247], v[4:7]
ds_read_b64_tr_b16 v[164:165], v180 offset:27712
ds_read_b64_tr_b16 v[166:167], v180 offset:32320
v_mfma_f32_16x16x32_bf16 v[4:7], v[148:151], a[252:255], v[4:7]
ds_read_b64_tr_b16 v[168:169], v180 offset:18528
v_mfma_f32_16x16x32_bf16 v[0:3], v[148:151], a[248:251], v[0:3]
ds_read_b64_tr_b16 v[170:171], v180 offset:23136
v_mfma_f32_16x16x32_bf16 v[0:3], v[144:147], a[240:243], v[0:3]
buffer_load_dwordx4 v234, s[12:15], s59 offen offset:3072 sc1 lds
s_add_u32 s59, s59, 36864
v_mfma_f32_16x16x32_bf16 v[8:11], v[152:155], a[240:243], v[8:11]
s_waitcnt vmcnt(16)
ds_add_u32 v188, v190
v_mfma_f32_16x16x32_bf16 v[8:11], v[156:159], a[248:251], v[8:11]
s_waitcnt lgkmcnt(3)
ds_read_b64_tr_b16 v[172:173], v180 offset:27744
ds_read_b64_tr_b16 v[174:175], v180 offset:32352
v_mfma_f32_16x16x32_bf16 v[12:15], v[156:159], a[252:255], v[12:15]
s_add_u32 s47, s47, 1
ds_read_b64_tr_b16 v[176:177], v181 offset:18560
ds_read_b64_tr_b16 v[178:179], v181 offset:23168
s_add_u32 m0, s64, 8192
v_mfma_f32_16x16x32_bf16 v[12:15], v[152:155], a[244:247], v[12:15]
buffer_load_dwordx4 v234, s[12:15], s72 offen offset:0 sc1 lds
s_add_u32 s72, s72, 36864
s_add_u32 s64, s64, 36864
s_cmp_ge_u32 s64, 147456
s_cselect_b32 s64, s60, s64
v_mfma_f32_16x16x32_bf16 v[20:23], v[160:163], a[244:247], v[20:23]
s_add_u32 s45, s45, 1
ds_read_b64_tr_b16 v[144:145], v181 offset:27776
ds_read_b64_tr_b16 v[146:147], v181 offset:32384
v_mfma_f32_16x16x32_bf16 v[20:23], v[164:167], a[252:255], v[20:23]
ds_read_b64_tr_b16 v[148:149], v182 offset:18432
v_mfma_f32_16x16x32_bf16 v[16:19], v[164:167], a[248:251], v[16:19]
s_and_b32 s45, s45, 3
s_cselect_b32 s46, 36864, s42
ds_read_b64_tr_b16 v[150:151], v182 offset:23040
v_mfma_f32_16x16x32_bf16 v[16:19], v[160:163], a[240:243], v[16:19]
s_waitcnt lgkmcnt(2)
buffer_load_dwordx4 a[80:83], v183, s[28:31], s61 offen sc1
v_mfma_f32_16x16x32_bf16 v[24:27], v[168:171], a[240:243], v[24:27]
ds_read_b32 v191, v189
v_mfma_f32_16x16x32_bf16 v[24:27], v[172:175], a[248:251], v[24:27]
ds_read_b64_tr_b16 v[152:153], v182 offset:27648
ds_read_b64_tr_b16 v[154:155], v182 offset:32256
v_mfma_f32_16x16x32_bf16 v[28:31], v[172:175], a[252:255], v[28:31]
buffer_load_dwordx4 a[84:87], v184, s[28:31], s61 offen sc1
v_mfma_f32_16x16x32_bf16 v[28:31], v[168:171], a[244:247], v[28:31]
s_add_u32 s61, s61, 4096
ds_read_b64_tr_b16 v[156:157], v182 offset:18464
ds_read_b64_tr_b16 v[158:159], v182 offset:23072
v_add_u32 v180, s46, v180
v_mfma_f32_16x16x32_bf16 v[36:39], v[176:179], a[244:247], v[36:39]
s_waitcnt vmcnt(19)
ds_read_b64_tr_b16 v[160:161], v182 offset:27680
ds_read_b64_tr_b16 v[162:163], v182 offset:32288
v_add_u32 v181, s46, v181
v_mfma_f32_16x16x32_bf16 v[36:39], v[144:147], a[252:255], v[36:39]
s_waitcnt lgkmcnt(4)
ds_read_b64_tr_b16 v[164:165], v182 offset:18496
v_cmp_gt_u32 vcc, s47, v191
v_mfma_f32_16x16x32_bf16 v[32:35], v[144:147], a[248:251], v[32:35]
buffer_load_dwordx4 a[88:91], v183, s[28:31], s61 offen sc1
v_mfma_f32_16x16x32_bf16 v[32:35], v[176:179], a[240:243], v[32:35]
ds_read_b64_tr_b16 v[166:167], v182 offset:23104
ds_read_b64_tr_b16 v[168:169], v182 offset:27712
v_mfma_f32_16x16x32_bf16 v[40:43], v[148:151], a[240:243], v[40:43]
ds_read_b64_tr_b16 v[170:171], v182 offset:32320
v_mfma_f32_16x16x32_bf16 v[40:43], v[152:155], a[248:251], v[40:43]
s_cbranch_vccnz k1_f7_s
k1_f7_b:
ds_read_b64_tr_b16 v[172:173], v182 offset:18528
v_mfma_f32_16x16x32_bf16 v[44:47], v[152:155], a[252:255], v[44:47]
buffer_load_dwordx4 a[92:95], v184, s[28:31], s61 offen sc1
s_add_u32 s61, s61, 4096
v_mfma_f32_16x16x32_bf16 v[44:47], v[148:151], a[244:247], v[44:47]
s_waitcnt lgkmcnt(1)
ds_read_b64_tr_b16 v[174:175], v182 offset:23136
ds_read_b64_tr_b16 v[176:177], v182 offset:27744
v_mfma_f32_16x16x32_bf16 v[52:55], v[156:159], a[244:247], v[52:55]
ds_read_b64_tr_b16 v[178:179], v182 offset:32352
v_add_u32 v182, s46, v182
v_mfma_f32_16x16x32_bf16 v[52:55], v[160:163], a[252:255], v[52:55]
ds_read_b64_tr_b16 v[144:145], v180 offset:0
v_mfma_f32_16x16x32_bf16 v[48:51], v[160:163], a[248:251], v[48:51]
buffer_load_dwordx4 a[112:115], v183, s[28:31], s61 offen sc1
v_mfma_f32_16x16x32_bf16 v[48:51], v[156:159], a[240:243], v[48:51]
ds_read_b64_tr_b16 v[146:147], v180 offset:4608
ds_read_b64_tr_b16 v[148:149], v180 offset:9216
v_mfma_f32_16x16x32_bf16 v[56:59], v[164:167], a[240:243], v[56:59]
ds_read_b64_tr_b16 v[150:151], v180 offset:13824
v_mfma_f32_16x16x32_bf16 v[56:59], v[168:171], a[248:251], v[56:59]
s_waitcnt lgkmcnt(4)
buffer_load_dwordx4 a[116:119], v184, s[28:31], s61 offen sc1
v_mfma_f32_16x16x32_bf16 v[60:63], v[168:171], a[252:255], v[60:63]
s_add_u32 s61, s61, 4096
ds_read_b64_tr_b16 v[152:153], v180 offset:32
ds_read_b64_tr_b16 v[154:155], v180 offset:4640
v_mfma_f32_16x16x32_bf16 v[60:63], v[164:167], a[244:247], v[60:63]
ds_read_b64_tr_b16 v[156:157], v180 offset:9248
ds_read_b64_tr_b16 v[158:159], v180 offset:13856
v_mfma_f32_16x16x32_bf16 v[68:71], v[172:175], a[244:247], v[68:71]
ds_read_b64_tr_b16 v[160:161], v180 offset:64
v_mfma_f32_16x16x32_bf16 v[68:71], v[176:179], a[252:255], v[68:71]
buffer_load_dwordx4 a[120:123], v183, s[28:31], s61 offen sc1
v_mfma_f32_16x16x32_bf16 v[64:67], v[176:179], a[248:251], v[64:67]
s_waitcnt vmcnt(20)
ds_read_b64_tr_b16 v[162:163], v180 offset:4672
v_mfma_f32_16x16x32_bf16 v[64:67], v[172:175], a[240:243], v[64:67]
s_waitcnt lgkmcnt(2)
ds_read_b64_tr_b16 v[164:165], v180 offset:9280
ds_read_b64_tr_b16 v[166:167], v180 offset:13888
v_mfma_f32_16x16x32_bf16 v[0:3], v[144:147], a[192:195], v[0:3]
ds_read_b64_tr_b16 v[168:169], v180 offset:96
v_mfma_f32_16x16x32_bf16 v[0:3], v[148:151], a[200:203], v[0:3]
ds_read_b64_tr_b16 v[170:171], v180 offset:4704
v_mfma_f32_16x16x32_bf16 v[4:7], v[148:151], a[204:207], v[4:7]
buffer_load_dwordx4 a[124:127], v184, s[28:31], s61 offen sc1
v_mfma_f32_16x16x32_bf16 v[4:7], v[144:147], a[196:199], v[4:7]
s_add_u32 s61, s61, 4096
ds_read_b64_tr_b16 v[172:173], v180 offset:9312
ds_read_b64_tr_b16 v[174:175], v180 offset:13920
v_mfma_f32_16x16x32_bf16 v[12:15], v[152:155], a[196:199], v[12:15]
s_add_u32 m0, s64, 0
ds_read_b64_tr_b16 v[176:177], v181 offset:128
v_mfma_f32_16x16x32_bf16 v[12:15], v[156:159], a[204:207], v[12:15]
s_waitcnt lgkmcnt(5)
buffer_load_dwordx4 v234, s[12:15], s58 offen offset:0 sc1 lds
v_mfma_f32_16x16x32_bf16 v[8:11], v[156:159], a[200:203], v[8:11]
ds_read_b64_tr_b16 v[178:179], v181 offset:4736
v_mfma_f32_16x16x32_bf16 v[8:11], v[152:155], a[192:195], v[8:11]
ds_read_b64_tr_b16 v[144:145], v181 offset:9344
ds_read_b64_tr_b16 v[146:147], v181 offset:13952
v_mfma_f32_16x16x32_bf16 v[16:19], v[160:163], a[192:195], v[16:19]
ds_read_b64_tr_b16 v[148:149], v182 offset:0
v_mfma_f32_16x16x32_bf16 v[16:19], v[164:167], a[200:203], v[16:19]
buffer_load_dwordx4 v234, s[12:15], s58 offen offset:1024 sc1 lds
v_mfma_f32_16x16x32_bf16 v[20:23], v[164:167], a[204:207], v[20:23]
ds_read_b64_tr_b16 v[150:151], v182 offset:4608
v_mfma_f32_16x16x32_bf16 v[20:23], v[160:163], a[196:199], v[20:23]
s_waitcnt lgkmcnt(2)
ds_read_b64_tr_b16 v[152:153], v182 offset:9216
ds_read_b64_tr_b16 v[154:155], v182 offset:13824
v_mfma_f32_16x16x32_bf16 v[28:31], v[168:171], a[196:199], v[28:31]
ds_read_b64_tr_b16 v[156:157], v182 offset:32
v_mfma_f32_16x16x32_bf16 v[28:31], v[172:175], a[204:207], v[28:31]
buffer_load_dwordx4 v234, s[12:15], s58 offen offset:2048 sc1 lds
v_mfma_f32_16x16x32_bf16 v[24:27], v[172:175], a[200:203], v[24:27]
ds_read_b64_tr_b16 v[158:159], v182 offset:4640
v_mfma_f32_16x16x32_bf16 v[24:27], v[168:171], a[192:195], v[24:27]
ds_read_b64_tr_b16 v[160:161], v182 offset:9248
ds_read_b64_tr_b16 v[162:163], v182 offset:13856
v_mfma_f32_16x16x32_bf16 v[32:35], v[176:179], a[192:195], v[32:35]
s_waitcnt vmcnt(24)
ds_read_b64_tr_b16 v[164:165], v182 offset:64
v_mfma_f32_16x16x32_bf16 v[32:35], v[144:147], a[200:203], v[32:35]
s_waitcnt lgkmcnt(5)
buffer_load_dwordx4 v234, s[12:15], s58 offen offset:3072 sc1 lds
v_mfma_f32_16x16x32_bf16 v[36:39], v[144:147], a[204:207], v[36:39]
s_add_u32 s58, s58, 36864
ds_read_b64_tr_b16 v[166:167], v182 offset:4672
v_mfma_f32_16x16x32_bf16 v[36:39], v[176:179], a[196:199], v[36:39]
s_add_u32 m0, s64, 4096
ds_read_b64_tr_b16 v[168:169], v182 offset:9280
ds_read_b64_tr_b16 v[170:171], v182 offset:13888
v_mfma_f32_16x16x32_bf16 v[44:47], v[148:151], a[196:199], v[44:47]
buffer_load_dwordx4 v234, s[12:15], s59 offen offset:0 sc1 lds
v_mfma_f32_16x16x32_bf16 v[44:47], v[152:155], a[204:207], v[44:47]
ds_read_b64_tr_b16 v[172:173], v182 offset:96
v_mfma_f32_16x16x32_bf16 v[40:43], v[152:155], a[200:203], v[40:43]
ds_read_b64_tr_b16 v[174:175], v182 offset:4704
v_mfma_f32_16x16x32_bf16 v[40:43], v[148:151], a[192:195], v[40:43]
s_waitcnt lgkmcnt(2)
ds_read_b64_tr_b16 v[176:177], v182 offset:9312
ds_read_b64_tr_b16 v[178:179], v182 offset:13920
v_mfma_f32_16x16x32_bf16 v[48:51], v[156:159], a[192:195], v[48:51]
buffer_load_dwordx4 v234, s[12:15], s59 offen offset:1024 sc1 lds
v_mfma_f32_16x16x32_bf16 v[48:51], v[160:163], a[200:203], v[48:51]
ds_read_b64_tr_b16 v[144:145], v180 offset:18432
v_mfma_f32_16x16x32_bf16 v[52:55], v[160:163], a[204:207], v[52:55]
ds_read_b64_tr_b16 v[146:147], v180 offset:23040
v_mfma_f32_16x16x32_bf16 v[52:55], v[156:159], a[196:199], v[52:55]
ds_read_b64_tr_b16 v[148:149], v180 offset:27648
ds_read_b64_tr_b16 v[150:151], v180 offset:32256
v_mfma_f32_16x16x32_bf16 v[60:63], v[164:167], a[196:199], v[60:63]
buffer_load_dwordx4 v234, s[12:15], s59 offen offset:2048 sc1 lds
v_mfma_f32_16x16x32_bf16 v[60:63], v[168:171], a[204:207], v[60:63]
s_waitcnt lgkmcnt(4)
ds_read_b64_tr_b16 v[152:153], v180 offset:18464
v_mfma_f32_16x16x32_bf16 v[56:59], v[168:171], a[200:203], v[56:59]
ds_read_b64_tr_b16 v[154:155], v180 offset:23072
v_mfma_f32_16x16x32_bf16 v[56:59], v[164:167], a[192:195], v[56:59]
ds_read_b64_tr_b16 v[156:157], v180 offset:27680
ds_read_b64_tr_b16 v[158:159], v180 offset:32288
v_mfma_f32_16x16x32_bf16 v[64:67], v[172:175], a[192:195], v[64:67]
buffer_load_dwordx4 v234, s[12:15], s59 offen offset:3072 sc1 lds
v_mfma_f32_16x16x32_bf16 v[64:67], v[176:179], a[200:203], v[64:67]
s_add_u32 s59, s59, 36864
ds_read_b64_tr_b16 v[160:161], v180 offset:18496
v_mfma_f32_16x16x32_bf16 v[68:71], v[176:179], a[204:207], v[68:71]
s_waitcnt vmcnt(24)
ds_read_b64_tr_b16 v[162:163], v180 offset:23104
s_add_u32 m0, s64, 8192
v_mfma_f32_16x16x32_bf16 v[68:71], v[172:175], a[196:199], v[68:71]
s_waitcnt lgkmcnt(2)
buffer_load_dwordx4 v234, s[12:15], s72 offen offset:0 sc1 lds
s_add_u32 s72, s72, 36864
s_add_u32 s64, s64, 36864
s_cmp_ge_u32 s64, 147456
s_cselect_b32 s64, s60, s64
v_mfma_f32_16x16x32_bf16 v[4:7], v[144:147], a[212:215], v[4:7]
ds_read_b64_tr_b16 v[164:165], v180 offset:27712
ds_read_b64_tr_b16 v[166:167], v180 offset:32320
v_mfma_f32_16x16x32_bf16 v[4:7], v[148:151], a[220:223], v[4:7]
ds_read_b64_tr_b16 v[168:169], v180 offset:18528
v_mfma_f32_16x16x32_bf16 v[0:3], v[148:151], a[216:219], v[0:3]
ds_read_b64_tr_b16 v[170:171], v180 offset:23136
v_mfma_f32_16x16x32_bf16 v[0:3], v[144:147], a[208:211], v[0:3]
buffer_load_dwordx4 a[144:147], v183, s[28:31], s61 offen sc1
v_mfma_f32_16x16x32_bf16 v[8:11], v[152:155], a[208:211], v[8:11]
s_waitcnt vmcnt(18)
ds_add_u32 v188, v190
v_mfma_f32_16x16x32_bf16 v[8:11], v[156:159], a[216:219], v[8:11]
s_waitcnt lgkmcnt(3)
ds_read_b64_tr_b16 v[172:173], v180 offset:27744
ds_read_b64_tr_b16 v[174:175], v180 offset:32352
v_mfma_f32_16x16x32_bf16 v[12:15], v[156:159], a[220:223], v[12:15]
s_add_u32 s47, s47, 1
ds_read_b64_tr_b16 v[176:177], v181 offset:18560
ds_read_b64_tr_b16 v[178:179], v181 offset:23168
v_mfma_f32_16x16x32_bf16 v[12:15], v[152:155], a[212:215], v[12:15]
buffer_load_dwordx4 a[148:151], v184, s[28:31], s61 offen sc1
s_add_u32 s61, s61, 4096
v_mfma_f32_16x16x32_bf16 v[20:23], v[160:163], a[212:215], v[20:23]
s_add_u32 s45, s45, 1
ds_read_b64_tr_b16 v[144:145], v181 offset:27776
ds_read_b64_tr_b16 v[146:147], v181 offset:32384
v_mfma_f32_16x16x32_bf16 v[20:23], v[164:167], a[220:223], v[20:23]
ds_read_b64_tr_b16 v[148:149], v182 offset:18432
v_mfma_f32_16x16x32_bf16 v[16:19], v[164:167], a[216:219], v[16:19]
s_and_b32 s45, s45, 3
s_cselect_b32 s46, 36864, s42
ds_read_b64_tr_b16 v[150:151], v182 offset:23040
v_mfma_f32_16x16x32_bf16 v[16:19], v[160:163], a[208:211], v[16:19]
s_waitcnt lgkmcnt(2)
buffer_load_dwordx4 a[152:155], v183, s[28:31], s61 offen sc1
v_mfma_f32_16x16x32_bf16 v[24:27], v[168:171], a[208:211], v[24:27]
ds_read_b32 v191, v189
v_mfma_f32_16x16x32_bf16 v[24:27], v[172:175], a[216:219], v[24:27]
ds_read_b64_tr_b16 v[152:153], v182 offset:27648
ds_read_b64_tr_b16 v[154:155], v182 offset:32256
v_mfma_f32_16x16x32_bf16 v[28:31], v[172:175], a[220:223], v[28:31]
buffer_load_dwordx4 a[156:159], v184, s[28:31], s61 offen sc1
v_mfma_f32_16x16x32_bf16 v[28:31], v[168:171], a[212:215], v[28:31]
s_add_u32 s61, s61, 4096
ds_read_b64_tr_b16 v[156:157], v182 offset:18464
ds_read_b64_tr_b16 v[158:159], v182 offset:23072
v_add_u32 v180, s46, v180
v_mfma_f32_16x16x32_bf16 v[36:39], v[176:179], a[212:215], v[36:39]
s_waitcnt vmcnt(21)
ds_read_b64_tr_b16 v[160:161], v182 offset:27680
ds_read_b64_tr_b16 v[162:163], v182 offset:32288
v_add_u32 v181, s46, v181
v_mfma_f32_16x16x32_bf16 v[36:39], v[144:147], a[220:223], v[36:39]
s_waitcnt lgkmcnt(4)
ds_read_b64_tr_b16 v[164:165], v182 offset:18496
v_cmp_gt_u32 vcc, s47, v191
v_mfma_f32_16x16x32_bf16 v[32:35], v[144:147], a[216:219], v[32:35]
buffer_load_dwordx4 a[176:179], v183, s[28:31], s61 offen sc1
v_mfma_f32_16x16x32_bf16 v[32:35], v[176:179], a[208:211], v[32:35]
ds_read_b64_tr_b16 v[166:167], v182 offset:23104
ds_read_b64_tr_b16 v[168:169], v182 offset:27712
v_mfma_f32_16x16x32_bf16 v[40:43], v[148:151], a[208:211], v[40:43]
ds_read_b64_tr_b16 v[170:171], v182 offset:32320
v_mfma_f32_16x16x32_bf16 v[40:43], v[152:155], a[216:219], v[40:43]
s_cbranch_vccnz k1_f8_s
k1_f8_b:
ds_read_b64_tr_b16 v[172:173], v182 offset:18528
v_mfma_f32_16x16x32_bf16 v[44:47], v[152:155], a[220:223], v[44:47]
buffer_load_dwordx4 a[180:183], v184, s[28:31], s61 offen sc1
s_add_u32 s61, s61, 4096
v_mfma_f32_16x16x32_bf16 v[44:47], v[148:151], a[212:215], v[44:47]
s_waitcnt lgkmcnt(1)
ds_read_b64_tr_b16 v[174:175], v182 offset:23136
ds_read_b64_tr_b16 v[176:177], v182 offset:27744
v_mfma_f32_16x16x32_bf16 v[52:55], v[156:159], a[212:215], v[52:55]
ds_read_b64_tr_b16 v[178:179], v182 offset:32352
v_add_u32 v182, s46, v182
v_mfma_f32_16x16x32_bf16 v[52:55], v[160:163], a[220:223], v[52:55]
ds_read_b64_tr_b16 v[144:145], v180 offset:0
v_mfma_f32_16x16x32_bf16 v[48:51], v[160:163], a[216:219], v[48:51]
buffer_load_dwordx4 a[184:187], v183, s[28:31], s61 offen sc1
v_mfma_f32_16x16x32_bf16 v[48:51], v[156:159], a[208:211], v[48:51]
ds_read_b64_tr_b16 v[146:147], v180 offset:4608
ds_read_b64_tr_b16 v[148:149], v180 offset:9216
v_mfma_f32_16x16x32_bf16 v[56:59], v[164:167], a[208:211], v[56:59]
ds_read_b64_tr_b16 v[150:151], v180 offset:13824
v_mfma_f32_16x16x32_bf16 v[56:59], v[168:171], a[216:219], v[56:59]
s_waitcnt lgkmcnt(4)
buffer_load_dwordx4 a[188:191], v184, s[28:31], s61 offen sc1
v_mfma_f32_16x16x32_bf16 v[60:63], v[168:171], a[220:223], v[60:63]
s_add_u32 s61, s61, 4096
ds_read_b64_tr_b16 v[152:153], v180 offset:32
ds_read_b64_tr_b16 v[154:155], v180 offset:4640
v_mfma_f32_16x16x32_bf16 v[60:63], v[164:167], a[212:215], v[60:63]
ds_read_b64_tr_b16 v[156:157], v180 offset:9248
ds_read_b64_tr_b16 v[158:159], v180 offset:13856
v_mfma_f32_16x16x32_bf16 v[68:71], v[172:175], a[212:215], v[68:71]
s_add_u32 m0, s64, 0
ds_read_b64_tr_b16 v[160:161], v180 offset:64
v_mfma_f32_16x16x32_bf16 v[68:71], v[176:179], a[220:223], v[68:71]
buffer_load_dwordx4 v234, s[12:15], s58 offen offset:0 sc1 lds
v_mfma_f32_16x16x32_bf16 v[64:67], v[176:179], a[216:219], v[64:67]
s_waitcnt vmcnt(22)
ds_read_b64_tr_b16 v[162:163], v180 offset:4672
v_mfma_f32_16x16x32_bf16 v[64:67], v[172:175], a[208:211], v[64:67]
s_waitcnt lgkmcnt(2)
ds_read_b64_tr_b16 v[164:165], v180 offset:9280
ds_read_b64_tr_b16 v[166:167], v180 offset:13888
v_mfma_f32_16x16x32_bf16 v[72:75], v[144:147], a[80:83], 0
ds_read_b64_tr_b16 v[168:169], v180 offset:96
v_mfma_f32_16x16x32_bf16 v[72:75], v[148:151], a[88:91], v[72:75]
ds_read_b64_tr_b16 v[170:171], v180 offset:4704
v_mfma_f32_16x16x32_bf16 v[76:79], v[148:151], a[92:95], 0
buffer_load_dwordx4 v234, s[12:15], s58 offen offset:1024 sc1 lds
v_mfma_f32_16x16x32_bf16 v[76:79], v[144:147], a[84:87], v[76:79]
ds_read_b64_tr_b16 v[172:173], v180 offset:9312
ds_read_b64_tr_b16 v[174:175], v180 offset:13920
v_mfma_f32_16x16x32_bf16 v[84:87], v[152:155], a[84:87], 0
ds_read_b64_tr_b16 v[176:177], v181 offset:128
v_mfma_f32_16x16x32_bf16 v[84:87], v[156:159], a[92:95], v[84:87]
s_waitcnt lgkmcnt(5)
buffer_load_dwordx4 v234, s[12:15], s58 offen offset:2048 sc1 lds
v_mfma_f32_16x16x32_bf16 v[80:83], v[156:159], a[88:91], 0
ds_read_b64_tr_b16 v[178:179], v181 offset:4736
v_mfma_f32_16x16x32_bf16 v[80:83], v[152:155], a[80:83], v[80:83]
ds_read_b64_tr_b16 v[144:145], v181 offset:9344
ds_read_b64_tr_b16 v[146:147], v181 offset:13952
v_mfma_f32_16x16x32_bf16 v[88:91], v[160:163], a[80:83], 0
ds_read_b64_tr_b16 v[148:149], v182 offset:0
s_mul_i32 s75, s54, 40960
s_add_u32 s75, s75, s40
v_mfma_f32_16x16x32_bf16 v[88:91], v[164:167], a[88:91], v[88:91]
buffer_load_dwordx4 v234, s[12:15], s58 offen offset:3072 sc1 lds
v_mfma_f32_16x16x32_bf16 v[92:95], v[164:167], a[92:95], 0
s_add_u32 s58, s58, 36864
ds_read_b64_tr_b16 v[150:151], v182 offset:4608
s_add_u32 s75, s75, 0
s_and_b32 s76, s54, 1
v_mfma_f32_16x16x32_bf16 v[92:95], v[160:163], a[84:87], v[92:95]
s_waitcnt lgkmcnt(2)
ds_read_b64_tr_b16 v[152:153], v182 offset:9216
ds_read_b64_tr_b16 v[154:155], v182 offset:13824
s_mul_i32 s76, s76, 5120
v_mfma_f32_16x16x32_bf16 v[100:103], v[168:171], a[84:87], 0
s_add_u32 m0, s64, 4096
ds_read_b64_tr_b16 v[156:157], v182 offset:32
s_mul_i32 s77, s73, 3072
s_add_u32 s74, s75, s76
v_mfma_f32_16x16x32_bf16 v[100:103], v[172:175], a[92:95], v[100:103]
buffer_load_dwordx4 v234, s[12:15], s59 offen offset:0 sc1 lds
v_mfma_f32_16x16x32_bf16 v[96:99], v[172:175], a[88:91], 0
ds_read_b64_tr_b16 v[158:159], v182 offset:4640
v_cvt_pk_bf16_f32 v248, v32, v33
v_cvt_pk_bf16_f32 v249, v34, v35
v_mfma_f32_16x16x32_bf16 v[96:99], v[168:171], a[80:83], v[96:99]
ds_read_b64_tr_b16 v[160:161], v182 offset:9248
ds_read_b64_tr_b16 v[162:163], v182 offset:13856
v_mfma_f32_16x16x32_bf16 v[104:107], v[176:179], a[80:83], 0
s_waitcnt vmcnt(26)
ds_read_b64_tr_b16 v[164:165], v182 offset:64
v_mfma_f32_16x16x32_bf16 v[104:107], v[144:147], a[88:91], v[104:107]
s_waitcnt lgkmcnt(5)
buffer_store_dwordx4 v[248:251], v234, s[36:39], s74 offen offset:2048 sc1
v_mfma_f32_16x16x32_bf16 v[108:111], v[144:147], a[92:95], 0
ds_read_b64_tr_b16 v[166:167], v182 offset:4672
v_mfma_f32_16x16x32_bf16 v[108:111], v[176:179], a[84:87], v[108:111]
ds_read_b64_tr_b16 v[168:169], v182 offset:9280
ds_read_b64_tr_b16 v[170:171], v182 offset:13888
v_mfma_f32_16x16x32_bf16 v[116:119], v[148:151], a[84:87], 0
buffer_load_dwordx4 v234, s[12:15], s59 offen offset:1024 sc1 lds
v_mfma_f32_16x16x32_bf16 v[116:119], v[152:155], a[92:95], v[116:119]
ds_read_b64_tr_b16 v[172:173], v182 offset:96
v_mfma_f32_16x16x32_bf16 v[112:115], v[152:155], a[88:91], 0
ds_read_b64_tr_b16 v[174:175], v182 offset:4704
v_mfma_f32_16x16x32_bf16 v[112:115], v[148:151], a[80:83], v[112:115]
s_waitcnt lgkmcnt(2)
ds_read_b64_tr_b16 v[176:177], v182 offset:9312
ds_read_b64_tr_b16 v[178:179], v182 offset:13920
v_mfma_f32_16x16x32_bf16 v[120:123], v[156:159], a[80:83], 0
buffer_load_dwordx4 v234, s[12:15], s59 offen offset:2048 sc1 lds
v_mfma_f32_16x16x32_bf16 v[120:123], v[160:163], a[88:91], v[120:123]
ds_read_b64_tr_b16 v[144:145], v180 offset:18432
s_sub_u32 s74, s74, s77
s_add_u32 s74, s74, 3072
v_mfma_f32_16x16x32_bf16 v[124:127], v[160:163], a[92:95], 0
ds_read_b64_tr_b16 v[146:147], v180 offset:23040
v_cvt_pk_bf16_f32 v40, v40, v41
v_cvt_pk_bf16_f32 v41, v42, v43
v_mfma_f32_16x16x32_bf16 v[124:127], v[156:159], a[84:87], v[124:127]
ds_read_b64_tr_b16 v[148:149], v180 offset:27648
ds_read_b64_tr_b16 v[150:151], v180 offset:32256
v_cvt_pk_bf16_f32 v42, v48, v49
v_mfma_f32_16x16x32_bf16 v[132:135], v[164:167], a[84:87], 0
buffer_load_dwordx4 v234, s[12:15], s59 offen offset:3072 sc1 lds
s_add_u32 s59, s59, 36864
v_mfma_f32_16x16x32_bf16 v[132:135], v[168:171], a[92:95], v[132:135]
s_waitcnt lgkmcnt(4)
ds_read_b64_tr_b16 v[152:153], v180 offset:18464
v_cvt_pk_bf16_f32 v43, v50, v51
v_mfma_f32_16x16x32_bf16 v[128:131], v[168:171], a[88:91], 0
ds_read_b64_tr_b16 v[154:155], v180 offset:23072
v_mfma_f32_16x16x32_bf16 v[128:131], v[164:167], a[80:83], v[128:131]
ds_read_b64_tr_b16 v[156:157], v180 offset:27680
ds_read_b64_tr_b16 v[158:159], v180 offset:32288
v_mfma_f32_16x16x32_bf16 v[136:139], v[172:175], a[80:83], 0
buffer_store_dwordx4 v[40:43], v234, s[36:39], s74 offen offset:0 sc1
v_mfma_f32_16x16x32_bf16 v[136:139], v[176:179], a[88:91], v[136:139]
s_add_u32 m0, s64, 8192
ds_read_b64_tr_b16 v[160:161], v180 offset:18496
v_mfma_f32_16x16x32_bf16 v[140:143], v[176:179], a[92:95], 0
s_waitcnt vmcnt(27)
ds_read_b64_tr_b16 v[162:163], v180 offset:23104
v_mfma_f32_16x16x32_bf16 v[140:143], v[172:175], a[84:87], v[140:143]
s_waitcnt lgkmcnt(2)
buffer_load_dwordx4 v234, s[12:15], s72 offen offset:0 sc1 lds
s_add_u32 s72, s72, 36864
s_add_u32 s64, s64, 36864
s_cmp_ge_u32 s64, 147456
s_cselect_b32 s64, s60, s64
v_mfma_f32_16x16x32_bf16 v[76:79], v[144:147], a[116:119], v[76:79]
ds_read_b64_tr_b16 v[164:165], v180 offset:27712
ds_read_b64_tr_b16 v[166:167], v180 offset:32320
v_mfma_f32_16x16x32_bf16 v[76:79], v[148:151], a[124:127], v[76:79]
ds_read_b64_tr_b16 v[168:169], v180 offset:18528
v_mfma_f32_16x16x32_bf16 v[72:75], v[148:151], a[120:123], v[72:75]
ds_read_b64_tr_b16 v[170:171], v180 offset:23136
v_mfma_f32_16x16x32_bf16 v[72:75], v[144:147], a[112:115], v[72:75]
buffer_load_dwordx4 a[192:195], v183, s[28:31], s61 offen sc1
v_mfma_f32_16x16x32_bf16 v[80:83], v[152:155], a[112:115], v[80:83]
s_waitcnt vmcnt(20)
ds_add_u32 v188, v190
v_cvt_pk_bf16_f32 v56, v56, v57
v_cvt_pk_bf16_f32 v57, v58, v59
v_mfma_f32_16x16x32_bf16 v[80:83], v[156:159], a[120:123], v[80:83]
s_waitcnt lgkmcnt(3)
ds_read_b64_tr_b16 v[172:173], v180 offset:27744
ds_read_b64_tr_b16 v[174:175], v180 offset:32352
v_cvt_pk_bf16_f32 v58, v64, v65
v_mfma_f32_16x16x32_bf16 v[84:87], v[156:159], a[124:127], v[84:87]
s_add_u32 s47, s47, 1
ds_read_b64_tr_b16 v[176:177], v181 offset:18560
ds_read_b64_tr_b16 v[178:179], v181 offset:23168
v_cvt_pk_bf16_f32 v59, v66, v67
v_mfma_f32_16x16x32_bf16 v[84:87], v[152:155], a[116:119], v[84:87]
buffer_store_dwordx4 v[56:59], v234, s[36:39], s74 offen offset:1024 sc1
v_mfma_f32_16x16x32_bf16 v[92:95], v[160:163], a[116:119], v[92:95]
s_add_u32 s45, s45, 1
ds_read_b64_tr_b16 v[144:145], v181 offset:27776
ds_read_b64_tr_b16 v[146:147], v181 offset:32384
v_mfma_f32_16x16x32_bf16 v[92:95], v[164:167], a[124:127], v[92:95]
ds_read_b64_tr_b16 v[148:149], v182 offset:18432
v_mfma_f32_16x16x32_bf16 v[88:91], v[164:167], a[120:123], v[88:91]
s_and_b32 s45, s45, 3
s_cselect_b32 s46, 36864, s42
ds_read_b64_tr_b16 v[150:151], v182 offset:23040
v_mfma_f32_16x16x32_bf16 v[88:91], v[160:163], a[112:115], v[88:91]
s_waitcnt lgkmcnt(2)
buffer_load_dwordx4 a[196:199], v184, s[28:31], s61 offen sc1
v_mfma_f32_16x16x32_bf16 v[96:99], v[168:171], a[112:115], v[96:99]
s_add_u32 s61, s61, 4096
ds_read_b32 v191, v189
v_mfma_f32_16x16x32_bf16 v[96:99], v[172:175], a[120:123], v[96:99]
ds_read_b64_tr_b16 v[152:153], v182 offset:27648
ds_read_b64_tr_b16 v[154:155], v182 offset:32256
v_mfma_f32_16x16x32_bf16 v[100:103], v[172:175], a[124:127], v[100:103]
buffer_load_dwordx4 a[200:203], v183, s[28:31], s61 offen sc1
v_mfma_f32_16x16x32_bf16 v[100:103], v[168:171], a[116:119], v[100:103]
ds_read_b64_tr_b16 v[156:157], v182 offset:18464
ds_read_b64_tr_b16 v[158:159], v182 offset:23072
v_add_u32 v180, s46, v180
v_mfma_f32_16x16x32_bf16 v[108:111], v[176:179], a[116:119], v[108:111]
s_waitcnt vmcnt(23)
ds_read_b64_tr_b16 v[160:161], v182 offset:27680
ds_read_b64_tr_b16 v[162:163], v182 offset:32288
v_add_u32 v181, s46, v181
v_mfma_f32_16x16x32_bf16 v[108:111], v[144:147], a[124:127], v[108:111]
s_waitcnt lgkmcnt(4)
ds_read_b64_tr_b16 v[164:165], v182 offset:18496
v_cmp_gt_u32 vcc, s47, v191
s_sub_u32 s74, s75, s76
v_mfma_f32_16x16x32_bf16 v[104:107], v[144:147], a[120:123], v[104:107]
buffer_load_dwordx4 a[204:207], v184, s[28:31], s61 offen sc1
v_mfma_f32_16x16x32_bf16 v[104:107], v[176:179], a[112:115], v[104:107]
s_add_u32 s61, s61, 4096
ds_read_b64_tr_b16 v[166:167], v182 offset:23104
ds_read_b64_tr_b16 v[168:169], v182 offset:27712
s_add_u32 s74, s74, 5120
v_mfma_f32_16x16x32_bf16 v[112:115], v[148:151], a[112:115], v[112:115]
ds_read_b64_tr_b16 v[170:171], v182 offset:32320
v_cvt_pk_bf16_f32 v248, v36, v37
v_cvt_pk_bf16_f32 v249, v38, v39
v_mfma_f32_16x16x32_bf16 v[112:115], v[152:155], a[120:123], v[112:115]
s_cbranch_vccnz k1_f9_s
k1_f9_b:
ds_read_b64_tr_b16 v[172:173], v182 offset:18528
v_mfma_f32_16x16x32_bf16 v[116:119], v[152:155], a[124:127], v[116:119]
buffer_store_dwordx4 v[248:251], v234, s[36:39], s74 offen offset:2048 sc1
v_mfma_f32_16x16x32_bf16 v[116:119], v[148:151], a[116:119], v[116:119]
s_waitcnt lgkmcnt(1)
ds_read_b64_tr_b16 v[174:175], v182 offset:23136
ds_read_b64_tr_b16 v[176:177], v182 offset:27744
v_mfma_f32_16x16x32_bf16 v[124:127], v[156:159], a[116:119], v[124:127]
ds_read_b64_tr_b16 v[178:179], v182 offset:32352
v_add_u32 v182, s46, v182
v_mfma_f32_16x16x32_bf16 v[124:127], v[160:163], a[124:127], v[124:127]
ds_read_b64_tr_b16 v[144:145], v180 offset:0
v_mfma_f32_16x16x32_bf16 v[120:123], v[160:163], a[120:123], v[120:123]
buffer_load_dwordx4 a[208:211], v183, s[28:31], s61 offen sc1
v_mfma_f32_16x16x32_bf16 v[120:123], v[156:159], a[112:115], v[120:123]
ds_read_b64_tr_b16 v[146:147], v180 offset:4608
ds_read_b64_tr_b16 v[148:149], v180 offset:9216
v_mfma_f32_16x16x32_bf16 v[128:131], v[164:167], a[112:115], v[128:131]
ds_read_b64_tr_b16 v[150:151], v180 offset:13824
v_mfma_f32_16x16x32_bf16 v[128:131], v[168:171], a[120:123], v[128:131]
s_waitcnt lgkmcnt(4)
buffer_load_dwordx4 a[212:215], v184, s[28:31], s61 offen sc1
v_mfma_f32_16x16x32_bf16 v[132:135], v[168:171], a[124:127], v[132:135]
s_add_u32 s61, s61, 4096
ds_read_b64_tr_b16 v[152:153], v180 offset:32
ds_read_b64_tr_b16 v[154:155], v180 offset:4640
s_add_u32 s75, s74, s77
v_mfma_f32_16x16x32_bf16 v[132:135], v[164:167], a[116:119], v[132:135]
ds_read_b64_tr_b16 v[156:157], v180 offset:9248
ds_read_b64_tr_b16 v[158:159], v180 offset:13856
v_cvt_pk_bf16_f32 v4, v4, v5
v_mfma_f32_16x16x32_bf16 v[140:143], v[172:175], a[116:119], v[140:143]
ds_read_b64_tr_b16 v[160:161], v180 offset:64
v_cvt_pk_bf16_f32 v5, v6, v7
v_cvt_pk_bf16_f32 v6, v12, v13
v_mfma_f32_16x16x32_bf16 v[140:143], v[176:179], a[124:127], v[140:143]
buffer_load_dwordx4 a[216:219], v183, s[28:31], s61 offen sc1
v_mfma_f32_16x16x32_bf16 v[136:139], v[176:179], a[120:123], v[136:139]
s_waitcnt vmcnt(24)
ds_read_b64_tr_b16 v[162:163], v180 offset:4672
v_cvt_pk_bf16_f32 v7, v14, v15
v_mfma_f32_16x16x32_bf16 v[136:139], v[172:175], a[112:115], v[136:139]
s_waitcnt lgkmcnt(2)
ds_read_b64_tr_b16 v[164:165], v180 offset:9280
ds_read_b64_tr_b16 v[166:167], v180 offset:13888
v_mfma_f32_16x16x32_bf16 v[72:75], v[144:147], a[144:147], v[72:75]
ds_read_b64_tr_b16 v[168:169], v180 offset:96
v_mfma_f32_16x16x32_bf16 v[72:75], v[148:151], a[152:155], v[72:75]
ds_read_b64_tr_b16 v[170:171], v180 offset:4704
v_mfma_f32_16x16x32_bf16 v[76:79], v[148:151], a[156:159], v[76:79]
buffer_store_dwordx4 v[4:7], v234, s[36:39], s75 offen offset:0 sc1
v_mfma_f32_16x16x32_bf16 v[76:79], v[144:147], a[148:151], v[76:79]
ds_read_b64_tr_b16 v[172:173], v180 offset:9312
ds_read_b64_tr_b16 v[174:175], v180 offset:13920
v_mfma_f32_16x16x32_bf16 v[84:87], v[152:155], a[148:151], v[84:87]
ds_read_b64_tr_b16 v[176:177], v181 offset:128
v_mfma_f32_16x16x32_bf16 v[84:87], v[156:159], a[156:159], v[84:87]
s_waitcnt lgkmcnt(5)
buffer_load_dwordx4 a[220:223], v184, s[28:31], s61 offen sc1
v_mfma_f32_16x16x32_bf16 v[80:83], v[156:159], a[152:155], v[80:83]
s_add_u32 s61, s61, 4096
ds_read_b64_tr_b16 v[178:179], v181 offset:4736
v_mfma_f32_16x16x32_bf16 v[80:83], v[152:155], a[144:147], v[80:83]
ds_read_b64_tr_b16 v[144:145], v181 offset:9344
ds_read_b64_tr_b16 v[146:147], v181 offset:13952
v_mfma_f32_16x16x32_bf16 v[88:91], v[160:163], a[144:147], v[88:91]
s_add_u32 m0, s64, 0
ds_read_b64_tr_b16 v[148:149], v182 offset:0
v_mfma_f32_16x16x32_bf16 v[88:91], v[164:167], a[152:155], v[88:91]
buffer_load_dwordx4 v234, s[12:15], s58 offen offset:0 sc1 lds
v_mfma_f32_16x16x32_bf16 v[92:95], v[164:167], a[156:159], v[92:95]
ds_read_b64_tr_b16 v[150:151], v182 offset:4608
v_cvt_pk_bf16_f32 v20, v20, v21
v_cvt_pk_bf16_f32 v21, v22, v23
v_mfma_f32_16x16x32_bf16 v[92:95], v[160:163], a[148:151], v[92:95]
s_waitcnt lgkmcnt(2)
ds_read_b64_tr_b16 v[152:153], v182 offset:9216
ds_read_b64_tr_b16 v[154:155], v182 offset:13824
v_cvt_pk_bf16_f32 v22, v28, v29
v_mfma_f32_16x16x32_bf16 v[100:103], v[168:171], a[148:151], v[100:103]
ds_read_b64_tr_b16 v[156:157], v182 offset:32
v_cvt_pk_bf16_f32 v23, v30, v31
v_mfma_f32_16x16x32_bf16 v[100:103], v[172:175], a[156:159], v[100:103]
buffer_store_dwordx4 v[20:23], v234, s[36:39], s75 offen offset:1024 sc1
v_mfma_f32_16x16x32_bf16 v[96:99], v[172:175], a[152:155], v[96:99]
ds_read_b64_tr_b16 v[158:159], v182 offset:4640
v_mfma_f32_16x16x32_bf16 v[96:99], v[168:171], a[144:147], v[96:99]
ds_read_b64_tr_b16 v[160:161], v182 offset:9248
ds_read_b64_tr_b16 v[162:163], v182 offset:13856
v_mfma_f32_16x16x32_bf16 v[104:107], v[176:179], a[144:147], v[104:107]
s_waitcnt vmcnt(28)
ds_read_b64_tr_b16 v[164:165], v182 offset:64
v_mfma_f32_16x16x32_bf16 v[104:107], v[144:147], a[152:155], v[104:107]
s_waitcnt lgkmcnt(5)
buffer_load_dwordx4 v234, s[12:15], s58 offen offset:1024 sc1 lds
v_mfma_f32_16x16x32_bf16 v[108:111], v[144:147], a[156:159], v[108:111]
ds_read_b64_tr_b16 v[166:167], v182 offset:4672
v_mfma_f32_16x16x32_bf16 v[108:111], v[176:179], a[148:151], v[108:111]
ds_read_b64_tr_b16 v[168:169], v182 offset:9280
ds_read_b64_tr_b16 v[170:171], v182 offset:13888
v_mfma_f32_16x16x32_bf16 v[116:119], v[148:151], a[148:151], v[116:119]
buffer_load_dwordx4 v234, s[12:15], s58 offen offset:2048 sc1 lds
v_mfma_f32_16x16x32_bf16 v[116:119], v[152:155], a[156:159], v[116:119]
ds_read_b64_tr_b16 v[172:173], v182 offset:96
s_sub_u32 s74, s74, s77
s_add_u32 s74, s74, 3072
v_mfma_f32_16x16x32_bf16 v[112:115], v[152:155], a[152:155], v[112:115]
ds_read_b64_tr_b16 v[174:175], v182 offset:4704
v_cvt_pk_bf16_f32 v44, v44, v45
v_cvt_pk_bf16_f32 v45, v46, v47
v_mfma_f32_16x16x32_bf16 v[112:115], v[148:151], a[144:147], v[112:115]
s_waitcnt lgkmcnt(2)
ds_read_b64_tr_b16 v[176:177], v182 offset:9312
ds_read_b64_tr_b16 v[178:179], v182 offset:13920
v_cvt_pk_bf16_f32 v46, v52, v53
v_mfma_f32_16x16x32_bf16 v[120:123], v[156:159], a[144:147], v[120:123]
buffer_load_dwordx4 v234, s[12:15], s58 offen offset:3072 sc1 lds
v_mfma_f32_16x16x32_bf16 v[120:123], v[160:163], a[152:155], v[120:123]
s_add_u32 s58, s58, 36864
ds_read_b64_tr_b16 v[144:145], v180 offset:18432
v_cvt_pk_bf16_f32 v47, v54, v55
v_mfma_f32_16x16x32_bf16 v[124:127], v[160:163], a[156:159], v[124:127]
ds_read_b64_tr_b16 v[146:147], v180 offset:23040
v_mfma_f32_16x16x32_bf16 v[124:127], v[156:159], a[148:151], v[124:127]
ds_read_b64_tr_b16 v[148:149], v180 offset:27648
ds_read_b64_tr_b16 v[150:151], v180 offset:32256
v_mfma_f32_16x16x32_bf16 v[132:135], v[164:167], a[148:151], v[132:135]
buffer_store_dwordx4 v[44:47], v234, s[36:39], s74 offen offset:0 sc1
v_mfma_f32_16x16x32_bf16 v[132:135], v[168:171], a[156:159], v[132:135]
s_waitcnt lgkmcnt(4)
ds_read_b64_tr_b16 v[152:153], v180 offset:18464
v_mfma_f32_16x16x32_bf16 v[128:131], v[168:171], a[152:155], v[128:131]
ds_read_b64_tr_b16 v[154:155], v180 offset:23072
v_mfma_f32_16x16x32_bf16 v[128:131], v[164:167], a[144:147], v[128:131]
s_add_u32 m0, s64, 4096
ds_read_b64_tr_b16 v[156:157], v180 offset:27680
ds_read_b64_tr_b16 v[158:159], v180 offset:32288
v_mfma_f32_16x16x32_bf16 v[136:139], v[172:175], a[144:147], v[136:139]
buffer_load_dwordx4 v234, s[12:15], s59 offen offset:0 sc1 lds
v_mfma_f32_16x16x32_bf16 v[136:139], v[176:179], a[152:155], v[136:139]
ds_read_b64_tr_b16 v[160:161], v180 offset:18496
v_mfma_f32_16x16x32_bf16 v[140:143], v[176:179], a[156:159], v[140:143]
s_waitcnt vmcnt(29)
ds_read_b64_tr_b16 v[162:163], v180 offset:23104
v_mfma_f32_16x16x32_bf16 v[140:143], v[172:175], a[148:151], v[140:143]
s_waitcnt lgkmcnt(2)
buffer_load_dwordx4 v234, s[12:15], s59 offen offset:1024 sc1 lds
v_mfma_f32_16x16x32_bf16 v[76:79], v[144:147], a[180:183], v[76:79]
ds_read_b64_tr_b16 v[164:165], v180 offset:27712
ds_read_b64_tr_b16 v[166:167], v180 offset:32320
v_cvt_pk_bf16_f32 v60, v60, v61
v_mfma_f32_16x16x32_bf16 v[76:79], v[148:151], a[188:191], v[76:79]
ds_read_b64_tr_b16 v[168:169], v180 offset:18528
v_cvt_pk_bf16_f32 v61, v62, v63
v_cvt_pk_bf16_f32 v62, v68, v69
v_mfma_f32_16x16x32_bf16 v[72:75], v[148:151], a[184:187], v[72:75]
ds_read_b64_tr_b16 v[170:171], v180 offset:23136
v_cvt_pk_bf16_f32 v63, v70, v71
v_mfma_f32_16x16x32_bf16 v[72:75], v[144:147], a[176:179], v[72:75]
buffer_store_dwordx4 v[60:63], v234, s[36:39], s74 offen offset:1024 sc1
v_mfma_f32_16x16x32_bf16 v[80:83], v[152:155], a[176:179], v[80:83]
s_waitcnt vmcnt(20)
ds_add_u32 v188, v190
v_mfma_f32_16x16x32_bf16 v[80:83], v[156:159], a[184:187], v[80:83]
s_waitcnt lgkmcnt(3)
ds_read_b64_tr_b16 v[172:173], v180 offset:27744
ds_read_b64_tr_b16 v[174:175], v180 offset:32352
v_mfma_f32_16x16x32_bf16 v[84:87], v[156:159], a[188:191], v[84:87]
s_add_u32 s47, s47, 1
ds_read_b64_tr_b16 v[176:177], v181 offset:18560
ds_read_b64_tr_b16 v[178:179], v181 offset:23168
v_mfma_f32_16x16x32_bf16 v[84:87], v[152:155], a[180:183], v[84:87]
buffer_load_dwordx4 v234, s[12:15], s59 offen offset:2048 sc1 lds
v_mfma_f32_16x16x32_bf16 v[92:95], v[160:163], a[180:183], v[92:95]
s_add_u32 s45, s45, 1
ds_read_b64_tr_b16 v[144:145], v181 offset:27776
ds_read_b64_tr_b16 v[146:147], v181 offset:32384
v_mfma_f32_16x16x32_bf16 v[92:95], v[164:167], a[188:191], v[92:95]
ds_read_b64_tr_b16 v[148:149], v182 offset:18432
v_mfma_f32_16x16x32_bf16 v[88:91], v[164:167], a[184:187], v[88:91]
s_and_b32 s45, s45, 3
s_cselect_b32 s46, 36864, s42
ds_read_b64_tr_b16 v[150:151], v182 offset:23040
v_mfma_f32_16x16x32_bf16 v[88:91], v[160:163], a[176:179], v[88:91]
s_waitcnt lgkmcnt(2)
buffer_load_dwordx4 v234, s[12:15], s59 offen offset:3072 sc1 lds
v_mfma_f32_16x16x32_bf16 v[96:99], v[168:171], a[176:179], v[96:99]
s_add_u32 s59, s59, 36864
ds_read_b32 v191, v189
v_mfma_f32_16x16x32_bf16 v[96:99], v[172:175], a[184:187], v[96:99]
s_add_u32 m0, s64, 8192
ds_read_b64_tr_b16 v[152:153], v182 offset:27648
ds_read_b64_tr_b16 v[154:155], v182 offset:32256
v_mfma_f32_16x16x32_bf16 v[100:103], v[172:175], a[188:191], v[100:103]
buffer_load_dwordx4 v234, s[12:15], s72 offen offset:0 sc1 lds
s_add_u32 s72, s72, 36864
s_add_u32 s64, s64, 36864
s_cmp_ge_u32 s64, 147456
s_cselect_b32 s64, s60, s64
v_mfma_f32_16x16x32_bf16 v[100:103], v[168:171], a[180:183], v[100:103]
ds_read_b64_tr_b16 v[156:157], v182 offset:18464
ds_read_b64_tr_b16 v[158:159], v182 offset:23072
v_add_u32 v180, s46, v180
v_mfma_f32_16x16x32_bf16 v[108:111], v[176:179], a[180:183], v[108:111]
s_waitcnt vmcnt(23)
ds_read_b64_tr_b16 v[160:161], v182 offset:27680
ds_read_b64_tr_b16 v[162:163], v182 offset:32288
v_add_u32 v181, s46, v181
v_mfma_f32_16x16x32_bf16 v[108:111], v[144:147], a[188:191], v[108:111]
s_waitcnt lgkmcnt(4)
ds_read_b64_tr_b16 v[164:165], v182 offset:18496
v_cmp_gt_u32 vcc, s47, v191
v_mfma_f32_16x16x32_bf16 v[104:107], v[144:147], a[184:187], v[104:107]
buffer_load_dwordx4 a[224:227], v183, s[28:31], s61 offen sc1
v_mfma_f32_16x16x32_bf16 v[104:107], v[176:179], a[176:179], v[104:107]
ds_read_b64_tr_b16 v[166:167], v182 offset:23104
ds_read_b64_tr_b16 v[168:169], v182 offset:27712
v_mfma_f32_16x16x32_bf16 v[112:115], v[148:151], a[176:179], v[112:115]
ds_read_b64_tr_b16 v[170:171], v182 offset:32320
v_mfma_f32_16x16x32_bf16 v[112:115], v[152:155], a[184:187], v[112:115]
s_cbranch_vccnz k1_f10_s
k1_f10_b:
ds_read_b64_tr_b16 v[172:173], v182 offset:18528
v_mfma_f32_16x16x32_bf16 v[116:119], v[152:155], a[188:191], v[116:119]
buffer_load_dwordx4 a[228:231], v184, s[28:31], s61 offen sc1
s_add_u32 s61, s61, 4096
v_mfma_f32_16x16x32_bf16 v[116:119], v[148:151], a[180:183], v[116:119]
s_waitcnt lgkmcnt(1)
ds_read_b64_tr_b16 v[174:175], v182 offset:23136
ds_read_b64_tr_b16 v[176:177], v182 offset:27744
v_mfma_f32_16x16x32_bf16 v[124:127], v[156:159], a[180:183], v[124:127]
ds_read_b64_tr_b16 v[178:179], v182 offset:32352
v_add_u32 v182, s46, v182
v_mfma_f32_16x16x32_bf16 v[124:127], v[160:163], a[188:191], v[124:127]
ds_read_b64_tr_b16 v[144:145], v180 offset:0
v_mfma_f32_16x16x32_bf16 v[120:123], v[160:163], a[184:187], v[120:123]
buffer_load_dwordx4 a[232:235], v183, s[28:31], s61 offen sc1
v_mfma_f32_16x16x32_bf16 v[120:123], v[156:159], a[176:179], v[120:123]
ds_read_b64_tr_b16 v[146:147], v180 offset:4608
ds_read_b64_tr_b16 v[148:149], v180 offset:9216
v_mfma_f32_16x16x32_bf16 v[128:131], v[164:167], a[176:179], v[128:131]
ds_read_b64_tr_b16 v[150:151], v180 offset:13824
v_mfma_f32_16x16x32_bf16 v[128:131], v[168:171], a[184:187], v[128:131]
s_waitcnt lgkmcnt(4)
buffer_load_dwordx4 a[236:239], v184, s[28:31], s61 offen sc1
v_mfma_f32_16x16x32_bf16 v[132:135], v[168:171], a[188:191], v[132:135]
s_add_u32 s61, s61, 4096
ds_read_b64_tr_b16 v[152:153], v180 offset:32
ds_read_b64_tr_b16 v[154:155], v180 offset:4640
v_mfma_f32_16x16x32_bf16 v[132:135], v[164:167], a[180:183], v[132:135]
ds_read_b64_tr_b16 v[156:157], v180 offset:9248
ds_read_b64_tr_b16 v[158:159], v180 offset:13856
v_mfma_f32_16x16x32_bf16 v[140:143], v[172:175], a[180:183], v[140:143]
ds_read_b64_tr_b16 v[160:161], v180 offset:64
v_mfma_f32_16x16x32_bf16 v[140:143], v[176:179], a[188:191], v[140:143]
buffer_load_dwordx4 a[240:243], v183, s[28:31], s61 offen sc1
v_mfma_f32_16x16x32_bf16 v[136:139], v[176:179], a[184:187], v[136:139]
s_waitcnt vmcnt(23)
ds_read_b64_tr_b16 v[162:163], v180 offset:4672
v_mfma_f32_16x16x32_bf16 v[136:139], v[172:175], a[176:179], v[136:139]
s_waitcnt lgkmcnt(2)
ds_read_b64_tr_b16 v[164:165], v180 offset:9280
ds_read_b64_tr_b16 v[166:167], v180 offset:13888
v_mfma_f32_16x16x32_bf16 v[72:75], v[144:147], a[192:195], v[72:75]
ds_read_b64_tr_b16 v[168:169], v180 offset:96
v_mfma_f32_16x16x32_bf16 v[72:75], v[148:151], a[200:203], v[72:75]
ds_read_b64_tr_b16 v[170:171], v180 offset:4704
v_mfma_f32_16x16x32_bf16 v[76:79], v[148:151], a[204:207], v[76:79]
buffer_load_dwordx4 a[244:247], v184, s[28:31], s61 offen sc1
v_mfma_f32_16x16x32_bf16 v[76:79], v[144:147], a[196:199], v[76:79]
s_add_u32 s61, s61, 4096
ds_read_b64_tr_b16 v[172:173], v180 offset:9312
ds_read_b64_tr_b16 v[174:175], v180 offset:13920
v_mfma_f32_16x16x32_bf16 v[84:87], v[152:155], a[196:199], v[84:87]
ds_read_b64_tr_b16 v[176:177], v181 offset:128
v_mfma_f32_16x16x32_bf16 v[84:87], v[156:159], a[204:207], v[84:87]
s_waitcnt lgkmcnt(5)
buffer_load_dwordx4 a[248:251], v183, s[28:31], s61 offen sc1
v_mfma_f32_16x16x32_bf16 v[80:83], v[156:159], a[200:203], v[80:83]
ds_read_b64_tr_b16 v[178:179], v181 offset:4736
v_mfma_f32_16x16x32_bf16 v[80:83], v[152:155], a[192:195], v[80:83]
ds_read_b64_tr_b16 v[144:145], v181 offset:9344
ds_read_b64_tr_b16 v[146:147], v181 offset:13952
v_mfma_f32_16x16x32_bf16 v[88:91], v[160:163], a[192:195], v[88:91]
ds_read_b64_tr_b16 v[148:149], v182 offset:0
v_mfma_f32_16x16x32_bf16 v[88:91], v[164:167], a[200:203], v[88:91]
buffer_load_dwordx4 a[252:255], v184, s[28:31], s61 offen sc1
v_mfma_f32_16x16x32_bf16 v[92:95], v[164:167], a[204:207], v[92:95]
s_add_u32 s61, s61, 4096
ds_read_b64_tr_b16 v[150:151], v182 offset:4608
v_mfma_f32_16x16x32_bf16 v[92:95], v[160:163], a[196:199], v[92:95]
s_waitcnt lgkmcnt(2)
ds_read_b64_tr_b16 v[152:153], v182 offset:9216
ds_read_b64_tr_b16 v[154:155], v182 offset:13824
v_mfma_f32_16x16x32_bf16 v[100:103], v[168:171], a[196:199], v[100:103]
s_add_u32 m0, s64, 0
ds_read_b64_tr_b16 v[156:157], v182 offset:32
v_mfma_f32_16x16x32_bf16 v[100:103], v[172:175], a[204:207], v[100:103]
buffer_load_dwordx4 v234, s[12:15], s58 offen offset:0 sc1 lds
v_mfma_f32_16x16x32_bf16 v[96:99], v[172:175], a[200:203], v[96:99]
ds_read_b64_tr_b16 v[158:159], v182 offset:4640
v_mfma_f32_16x16x32_bf16 v[96:99], v[168:171], a[192:195], v[96:99]
ds_read_b64_tr_b16 v[160:161], v182 offset:9248
ds_read_b64_tr_b16 v[162:163], v182 offset:13856
v_mfma_f32_16x16x32_bf16 v[104:107], v[176:179], a[192:195], v[104:107]
s_waitcnt vmcnt(27)
ds_read_b64_tr_b16 v[164:165], v182 offset:64
v_mfma_f32_16x16x32_bf16 v[104:107], v[144:147], a[200:203], v[104:107]
s_waitcnt lgkmcnt(5)
buffer_load_dwordx4 v234, s[12:15], s58 offen offset:1024 sc1 lds
v_mfma_f32_16x16x32_bf16 v[108:111], v[144:147], a[204:207], v[108:111]
ds_read_b64_tr_b16 v[166:167], v182 offset:4672
v_mfma_f32_16x16x32_bf16 v[108:111], v[176:179], a[196:199], v[108:111]
ds_read_b64_tr_b16 v[168:169], v182 offset:9280
ds_read_b64_tr_b16 v[170:171], v182 offset:13888
v_mfma_f32_16x16x32_bf16 v[116:119], v[148:151], a[196:199], v[116:119]
buffer_load_dwordx4 v234, s[12:15], s58 offen offset:2048 sc1 lds
v_mfma_f32_16x16x32_bf16 v[116:119], v[152:155], a[204:207], v[116:119]
ds_read_b64_tr_b16 v[172:173], v182 offset:96
v_mfma_f32_16x16x32_bf16 v[112:115], v[152:155], a[200:203], v[112:115]
ds_read_b64_tr_b16 v[174:175], v182 offset:4704
v_mfma_f32_16x16x32_bf16 v[112:115], v[148:151], a[192:195], v[112:115]
s_waitcnt lgkmcnt(2)
ds_read_b64_tr_b16 v[176:177], v182 offset:9312
ds_read_b64_tr_b16 v[178:179], v182 offset:13920
v_mfma_f32_16x16x32_bf16 v[120:123], v[156:159], a[192:195], v[120:123]
buffer_load_dwordx4 v234, s[12:15], s58 offen offset:3072 sc1 lds
v_mfma_f32_16x16x32_bf16 v[120:123], v[160:163], a[200:203], v[120:123]
s_add_u32 s58, s58, 36864
ds_read_b64_tr_b16 v[144:145], v180 offset:18432
v_mfma_f32_16x16x32_bf16 v[124:127], v[160:163], a[204:207], v[124:127]
ds_read_b64_tr_b16 v[146:147], v180 offset:23040
v_mfma_f32_16x16x32_bf16 v[124:127], v[156:159], a[196:199], v[124:127]
s_add_u32 m0, s64, 4096
ds_read_b64_tr_b16 v[148:149], v180 offset:27648
ds_read_b64_tr_b16 v[150:151], v180 offset:32256
v_mfma_f32_16x16x32_bf16 v[132:135], v[164:167], a[196:199], v[132:135]
buffer_load_dwordx4 v234, s[12:15], s59 offen offset:0 sc1 lds
v_mfma_f32_16x16x32_bf16 v[132:135], v[168:171], a[204:207], v[132:135]
s_waitcnt lgkmcnt(4)
ds_read_b64_tr_b16 v[152:153], v180 offset:18464
v_mfma_f32_16x16x32_bf16 v[128:131], v[168:171], a[200:203], v[128:131]
ds_read_b64_tr_b16 v[154:155], v180 offset:23072
v_mfma_f32_16x16x32_bf16 v[128:131], v[164:167], a[192:195], v[128:131]
ds_read_b64_tr_b16 v[156:157], v180 offset:27680
ds_read_b64_tr_b16 v[158:159], v180 offset:32288
v_mfma_f32_16x16x32_bf16 v[136:139], v[172:175], a[192:195], v[136:139]
buffer_load_dwordx4 v234, s[12:15], s59 offen offset:1024 sc1 lds
v_mfma_f32_16x16x32_bf16 v[136:139], v[176:179], a[200:203], v[136:139]
ds_read_b64_tr_b16 v[160:161], v180 offset:18496
v_mfma_f32_16x16x32_bf16 v[140:143], v[176:179], a[204:207], v[140:143]
s_waitcnt vmcnt(26)
ds_read_b64_tr_b16 v[162:163], v180 offset:23104
v_mfma_f32_16x16x32_bf16 v[140:143], v[172:175], a[196:199], v[140:143]
s_waitcnt lgkmcnt(2)
buffer_load_dwordx4 v234, s[12:15], s59 offen offset:2048 sc1 lds
v_mfma_f32_16x16x32_bf16 v[76:79], v[144:147], a[212:215], v[76:79]
ds_read_b64_tr_b16 v[164:165], v180 offset:27712
ds_read_b64_tr_b16 v[166:167], v180 offset:32320
v_mfma_f32_16x16x32_bf16 v[76:79], v[148:151], a[220:223], v[76:79]
ds_read_b64_tr_b16 v[168:169], v180 offset:18528
v_mfma_f32_16x16x32_bf16 v[72:75], v[148:151], a[216:219], v[72:75]
ds_read_b64_tr_b16 v[170:171], v180 offset:23136
v_mfma_f32_16x16x32_bf16 v[72:75], v[144:147], a[208:211], v[72:75]
buffer_load_dwordx4 v234, s[12:15], s59 offen offset:3072 sc1 lds
s_add_u32 s59, s59, 36864
v_mfma_f32_16x16x32_bf16 v[80:83], v[152:155], a[208:211], v[80:83]
s_waitcnt vmcnt(16)
ds_add_u32 v188, v190
v_mfma_f32_16x16x32_bf16 v[80:83], v[156:159], a[216:219], v[80:83]
s_waitcnt lgkmcnt(3)
ds_read_b64_tr_b16 v[172:173], v180 offset:27744
ds_read_b64_tr_b16 v[174:175], v180 offset:32352
v_mfma_f32_16x16x32_bf16 v[84:87], v[156:159], a[220:223], v[84:87]
s_add_u32 s47, s47, 1
ds_read_b64_tr_b16 v[176:177], v181 offset:18560
ds_read_b64_tr_b16 v[178:179], v181 offset:23168
s_add_u32 m0, s64, 8192
v_mfma_f32_16x16x32_bf16 v[84:87], v[152:155], a[212:215], v[84:87]
buffer_load_dwordx4 v234, s[12:15], s72 offen offset:0 sc1 lds
s_add_u32 s72, s72, 36864
s_add_u32 s64, s64, 36864
s_cmp_ge_u32 s64, 147456
s_cselect_b32 s64, s60, s64
v_mfma_f32_16x16x32_bf16 v[92:95], v[160:163], a[212:215], v[92:95]
s_add_u32 s45, s45, 1
ds_read_b64_tr_b16 v[144:145], v181 offset:27776
ds_read_b64_tr_b16 v[146:147], v181 offset:32384
v_mfma_f32_16x16x32_bf16 v[92:95], v[164:167], a[220:223], v[92:95]
ds_read_b64_tr_b16 v[148:149], v182 offset:18432
v_mfma_f32_16x16x32_bf16 v[88:91], v[164:167], a[216:219], v[88:91]
s_and_b32 s45, s45, 3
s_cselect_b32 s46, 36864, s42
ds_read_b64_tr_b16 v[150:151], v182 offset:23040
v_mfma_f32_16x16x32_bf16 v[88:91], v[160:163], a[208:211], v[88:91]
s_waitcnt lgkmcnt(2)
buffer_load_dwordx4 a[80:83], v183, s[28:31], s61 offen sc1
v_mfma_f32_16x16x32_bf16 v[96:99], v[168:171], a[208:211], v[96:99]
ds_read_b32 v191, v189
v_mfma_f32_16x16x32_bf16 v[96:99], v[172:175], a[216:219], v[96:99]
ds_read_b64_tr_b16 v[152:153], v182 offset:27648
ds_read_b64_tr_b16 v[154:155], v182 offset:32256
v_mfma_f32_16x16x32_bf16 v[100:103], v[172:175], a[220:223], v[100:103]
buffer_load_dwordx4 a[84:87], v184, s[28:31], s61 offen sc1
v_mfma_f32_16x16x32_bf16 v[100:103], v[168:171], a[212:215], v[100:103]
s_add_u32 s61, s61, 4096
ds_read_b64_tr_b16 v[156:157], v182 offset:18464
ds_read_b64_tr_b16 v[158:159], v182 offset:23072
v_add_u32 v180, s46, v180
v_mfma_f32_16x16x32_bf16 v[108:111], v[176:179], a[212:215], v[108:111]
s_waitcnt vmcnt(19)
ds_read_b64_tr_b16 v[160:161], v182 offset:27680
ds_read_b64_tr_b16 v[162:163], v182 offset:32288
v_add_u32 v181, s46, v181
v_mfma_f32_16x16x32_bf16 v[108:111], v[144:147], a[220:223], v[108:111]
s_waitcnt lgkmcnt(4)
ds_read_b64_tr_b16 v[164:165], v182 offset:18496
v_cmp_gt_u32 vcc, s47, v191
v_mfma_f32_16x16x32_bf16 v[104:107], v[144:147], a[216:219], v[104:107]
buffer_load_dwordx4 a[88:91], v183, s[28:31], s61 offen sc1
v_mfma_f32_16x16x32_bf16 v[104:107], v[176:179], a[208:211], v[104:107]
ds_read_b64_tr_b16 v[166:167], v182 offset:23104
ds_read_b64_tr_b16 v[168:169], v182 offset:27712
v_mfma_f32_16x16x32_bf16 v[112:115], v[148:151], a[208:211], v[112:115]
ds_read_b64_tr_b16 v[170:171], v182 offset:32320
v_mfma_f32_16x16x32_bf16 v[112:115], v[152:155], a[216:219], v[112:115]
s_cbranch_vccnz k1_f11_s
k1_f11_b:
ds_read_b64_tr_b16 v[172:173], v182 offset:18528
v_mfma_f32_16x16x32_bf16 v[116:119], v[152:155], a[220:223], v[116:119]
buffer_load_dwordx4 a[92:95], v184, s[28:31], s61 offen sc1
s_add_u32 s61, s61, 4096
v_mfma_f32_16x16x32_bf16 v[116:119], v[148:151], a[212:215], v[116:119]
s_waitcnt lgkmcnt(1)
ds_read_b64_tr_b16 v[174:175], v182 offset:23136
ds_read_b64_tr_b16 v[176:177], v182 offset:27744
v_mfma_f32_16x16x32_bf16 v[124:127], v[156:159], a[212:215], v[124:127]
ds_read_b64_tr_b16 v[178:179], v182 offset:32352
v_add_u32 v182, s46, v182
v_mfma_f32_16x16x32_bf16 v[124:127], v[160:163], a[220:223], v[124:127]
ds_read_b64_tr_b16 v[144:145], v180 offset:0
v_mfma_f32_16x16x32_bf16 v[120:123], v[160:163], a[216:219], v[120:123]
buffer_load_dwordx4 a[112:115], v183, s[28:31], s61 offen sc1
v_mfma_f32_16x16x32_bf16 v[120:123], v[156:159], a[208:211], v[120:123]
ds_read_b64_tr_b16 v[146:147], v180 offset:4608
ds_read_b64_tr_b16 v[148:149], v180 offset:9216
v_mfma_f32_16x16x32_bf16 v[128:131], v[164:167], a[208:211], v[128:131]
ds_read_b64_tr_b16 v[150:151], v180 offset:13824
v_mfma_f32_16x16x32_bf16 v[128:131], v[168:171], a[216:219], v[128:131]
s_waitcnt lgkmcnt(4)
buffer_load_dwordx4 a[116:119], v184, s[28:31], s61 offen sc1
v_mfma_f32_16x16x32_bf16 v[132:135], v[168:171], a[220:223], v[132:135]
s_add_u32 s61, s61, 4096
ds_read_b64_tr_b16 v[152:153], v180 offset:32
ds_read_b64_tr_b16 v[154:155], v180 offset:4640
s_lshl_b32 s74, s54, 2
s_add_u32 s74, s74, s69
v_mfma_f32_16x16x32_bf16 v[132:135], v[164:167], a[212:215], v[132:135]
ds_read_b64_tr_b16 v[156:157], v180 offset:9248
ds_read_b64_tr_b16 v[158:159], v180 offset:13856
s_waitcnt vmcnt(23)
v_mfma_f32_16x16x32_bf16 v[140:143], v[172:175], a[212:215], v[140:143]
ds_read_b64_tr_b16 v[160:161], v180 offset:64
v_mfma_f32_16x16x32_bf16 v[140:143], v[176:179], a[220:223], v[140:143]
buffer_store_dword v186, v232, s[36:39], s74 offen sc1
v_mfma_f32_16x16x32_bf16 v[136:139], v[176:179], a[216:219], v[136:139]
s_waitcnt vmcnt(20)
ds_read_b64_tr_b16 v[162:163], v180 offset:4672
v_mfma_f32_16x16x32_bf16 v[136:139], v[172:175], a[208:211], v[136:139]
s_waitcnt lgkmcnt(2)
ds_read_b64_tr_b16 v[164:165], v180 offset:9280
ds_read_b64_tr_b16 v[166:167], v180 offset:13888
v_mfma_f32_16x16x32_bf16 v[72:75], v[144:147], a[224:227], v[72:75]
ds_read_b64_tr_b16 v[168:169], v180 offset:96
v_mfma_f32_16x16x32_bf16 v[72:75], v[148:151], a[232:235], v[72:75]
ds_read_b64_tr_b16 v[170:171], v180 offset:4704
v_mfma_f32_16x16x32_bf16 v[76:79], v[148:151], a[236:239], v[76:79]
buffer_load_dwordx4 a[120:123], v183, s[28:31], s61 offen sc1
v_mfma_f32_16x16x32_bf16 v[76:79], v[144:147], a[228:231], v[76:79]
ds_read_b64_tr_b16 v[172:173], v180 offset:9312
ds_read_b64_tr_b16 v[174:175], v180 offset:13920
v_mfma_f32_16x16x32_bf16 v[84:87], v[152:155], a[228:231], v[84:87]
ds_read_b64_tr_b16 v[176:177], v181 offset:128
v_mfma_f32_16x16x32_bf16 v[84:87], v[156:159], a[236:239], v[84:87]
s_waitcnt lgkmcnt(5)
buffer_load_dwordx4 a[124:127], v184, s[28:31], s61 offen sc1
v_mfma_f32_16x16x32_bf16 v[80:83], v[156:159], a[232:235], v[80:83]
s_add_u32 s61, s61, 4096
ds_read_b64_tr_b16 v[178:179], v181 offset:4736
v_mfma_f32_16x16x32_bf16 v[80:83], v[152:155], a[224:227], v[80:83]
ds_read_b64_tr_b16 v[144:145], v181 offset:9344
ds_read_b64_tr_b16 v[146:147], v181 offset:13952
v_mfma_f32_16x16x32_bf16 v[88:91], v[160:163], a[224:227], v[88:91]
s_add_u32 m0, s64, 0
ds_read_b64_tr_b16 v[148:149], v182 offset:0
v_mfma_f32_16x16x32_bf16 v[88:91], v[164:167], a[232:235], v[88:91]
buffer_load_dwordx4 v234, s[12:15], s58 offen offset:0 sc1 lds
v_mfma_f32_16x16x32_bf16 v[92:95], v[164:167], a[236:239], v[92:95]
ds_read_b64_tr_b16 v[150:151], v182 offset:4608
v_mfma_f32_16x16x32_bf16 v[92:95], v[160:163], a[228:231], v[92:95]
s_waitcnt lgkmcnt(2)
ds_read_b64_tr_b16 v[152:153], v182 offset:9216
ds_read_b64_tr_b16 v[154:155], v182 offset:13824
v_mfma_f32_16x16x32_bf16 v[100:103], v[168:171], a[228:231], v[100:103]
ds_read_b64_tr_b16 v[156:157], v182 offset:32
v_mfma_f32_16x16x32_bf16 v[100:103], v[172:175], a[236:239], v[100:103]
buffer_load_dwordx4 v234, s[12:15], s58 offen offset:1024 sc1 lds
v_mfma_f32_16x16x32_bf16 v[96:99], v[172:175], a[232:235], v[96:99]
ds_read_b64_tr_b16 v[158:159], v182 offset:4640
v_mfma_f32_16x16x32_bf16 v[96:99], v[168:171], a[224:227], v[96:99]
ds_read_b64_tr_b16 v[160:161], v182 offset:9248
ds_read_b64_tr_b16 v[162:163], v182 offset:13856
v_mfma_f32_16x16x32_bf16 v[104:107], v[176:179], a[224:227], v[104:107]
s_waitcnt vmcnt(24)
ds_read_b64_tr_b16 v[164:165], v182 offset:64
v_mfma_f32_16x16x32_bf16 v[104:107], v[144:147], a[232:235], v[104:107]
s_waitcnt lgkmcnt(5)
buffer_load_dwordx4 v234, s[12:15], s58 offen offset:2048 sc1 lds
v_mfma_f32_16x16x32_bf16 v[108:111], v[144:147], a[236:239], v[108:111]
ds_read_b64_tr_b16 v[166:167], v182 offset:4672
v_mfma_f32_16x16x32_bf16 v[108:111], v[176:179], a[228:231], v[108:111]
ds_read_b64_tr_b16 v[168:169], v182 offset:9280
ds_read_b64_tr_b16 v[170:171], v182 offset:13888
v_mfma_f32_16x16x32_bf16 v[116:119], v[148:151], a[228:231], v[116:119]
buffer_load_dwordx4 v234, s[12:15], s58 offen offset:3072 sc1 lds
v_mfma_f32_16x16x32_bf16 v[116:119], v[152:155], a[236:239], v[116:119]
s_add_u32 s58, s58, 36864
ds_read_b64_tr_b16 v[172:173], v182 offset:96
v_mfma_f32_16x16x32_bf16 v[112:115], v[152:155], a[232:235], v[112:115]
s_add_u32 m0, s64, 4096
ds_read_b64_tr_b16 v[174:175], v182 offset:4704
v_mfma_f32_16x16x32_bf16 v[112:115], v[148:151], a[224:227], v[112:115]
s_waitcnt lgkmcnt(2)
ds_read_b64_tr_b16 v[176:177], v182 offset:9312
ds_read_b64_tr_b16 v[178:179], v182 offset:13920
v_mfma_f32_16x16x32_bf16 v[120:123], v[156:159], a[224:227], v[120:123]
buffer_load_dwordx4 v234, s[12:15], s59 offen offset:0 sc1 lds
v_mfma_f32_16x16x32_bf16 v[120:123], v[160:163], a[232:235], v[120:123]
ds_read_b64_tr_b16 v[144:145], v180 offset:18432
v_mfma_f32_16x16x32_bf16 v[124:127], v[160:163], a[236:239], v[124:127]
ds_read_b64_tr_b16 v[146:147], v180 offset:23040
v_mfma_f32_16x16x32_bf16 v[124:127], v[156:159], a[228:231], v[124:127]
ds_read_b64_tr_b16 v[148:149], v180 offset:27648
ds_read_b64_tr_b16 v[150:151], v180 offset:32256
v_mfma_f32_16x16x32_bf16 v[132:135], v[164:167], a[228:231], v[132:135]
buffer_load_dwordx4 v234, s[12:15], s59 offen offset:1024 sc1 lds
v_mfma_f32_16x16x32_bf16 v[132:135], v[168:171], a[236:239], v[132:135]
s_waitcnt lgkmcnt(4)
ds_read_b64_tr_b16 v[152:153], v180 offset:18464
v_mfma_f32_16x16x32_bf16 v[128:131], v[168:171], a[232:235], v[128:131]
ds_read_b64_tr_b16 v[154:155], v180 offset:23072
v_mfma_f32_16x16x32_bf16 v[128:131], v[164:167], a[224:227], v[128:131]
ds_read_b64_tr_b16 v[156:157], v180 offset:27680
ds_read_b64_tr_b16 v[158:159], v180 offset:32288
v_mfma_f32_16x16x32_bf16 v[136:139], v[172:175], a[224:227], v[136:139]
buffer_load_dwordx4 v234, s[12:15], s59 offen offset:2048 sc1 lds
v_mfma_f32_16x16x32_bf16 v[136:139], v[176:179], a[232:235], v[136:139]
ds_read_b64_tr_b16 v[160:161], v180 offset:18496
v_mfma_f32_16x16x32_bf16 v[140:143], v[176:179], a[236:239], v[140:143]
s_waitcnt vmcnt(25)
ds_read_b64_tr_b16 v[162:163], v180 offset:23104
v_mfma_f32_16x16x32_bf16 v[140:143], v[172:175], a[228:231], v[140:143]
s_waitcnt lgkmcnt(2)
buffer_load_dwordx4 v234, s[12:15], s59 offen offset:3072 sc1 lds
v_mfma_f32_16x16x32_bf16 v[76:79], v[144:147], a[244:247], v[76:79]
s_add_u32 s59, s59, 36864
ds_read_b64_tr_b16 v[164:165], v180 offset:27712
ds_read_b64_tr_b16 v[166:167], v180 offset:32320
v_mfma_f32_16x16x32_bf16 v[76:79], v[148:151], a[252:255], v[76:79]
ds_read_b64_tr_b16 v[168:169], v180 offset:18528
v_mfma_f32_16x16x32_bf16 v[72:75], v[148:151], a[248:251], v[72:75]
s_add_u32 m0, s64, 8192
ds_read_b64_tr_b16 v[170:171], v180 offset:23136
v_mfma_f32_16x16x32_bf16 v[72:75], v[144:147], a[240:243], v[72:75]
buffer_load_dwordx4 v234, s[12:15], s72 offen offset:0 sc1 lds
s_add_u32 s72, s72, 36864
s_add_u32 s64, s64, 36864
s_cmp_ge_u32 s64, 147456
s_cselect_b32 s64, s60, s64
v_mfma_f32_16x16x32_bf16 v[80:83], v[152:155], a[240:243], v[80:83]
s_waitcnt vmcnt(18)
ds_add_u32 v188, v190
v_mfma_f32_16x16x32_bf16 v[80:83], v[156:159], a[248:251], v[80:83]
s_waitcnt lgkmcnt(3)
ds_read_b64_tr_b16 v[172:173], v180 offset:27744
ds_read_b64_tr_b16 v[174:175], v180 offset:32352
v_mfma_f32_16x16x32_bf16 v[84:87], v[156:159], a[252:255], v[84:87]
s_add_u32 s47, s47, 1
ds_read_b64_tr_b16 v[176:177], v181 offset:18560
ds_read_b64_tr_b16 v[178:179], v181 offset:23168
v_mfma_f32_16x16x32_bf16 v[84:87], v[152:155], a[244:247], v[84:87]
buffer_load_dwordx4 a[144:147], v183, s[28:31], s61 offen sc1
v_mfma_f32_16x16x32_bf16 v[92:95], v[160:163], a[244:247], v[92:95]
s_add_u32 s45, s45, 1
ds_read_b64_tr_b16 v[144:145], v181 offset:27776
ds_read_b64_tr_b16 v[146:147], v181 offset:32384
v_mfma_f32_16x16x32_bf16 v[92:95], v[164:167], a[252:255], v[92:95]
ds_read_b64_tr_b16 v[148:149], v182 offset:18432
v_mfma_f32_16x16x32_bf16 v[88:91], v[164:167], a[248:251], v[88:91]
s_and_b32 s45, s45, 3
s_cselect_b32 s46, 36864, s42
ds_read_b64_tr_b16 v[150:151], v182 offset:23040
v_mfma_f32_16x16x32_bf16 v[88:91], v[160:163], a[240:243], v[88:91]
s_waitcnt lgkmcnt(2)
buffer_load_dwordx4 a[148:151], v184, s[28:31], s61 offen sc1
v_mfma_f32_16x16x32_bf16 v[96:99], v[168:171], a[240:243], v[96:99]
s_add_u32 s61, s61, 4096
ds_read_b32 v191, v189
v_mfma_f32_16x16x32_bf16 v[96:99], v[172:175], a[248:251], v[96:99]
ds_read_b64_tr_b16 v[152:153], v182 offset:27648
ds_read_b64_tr_b16 v[154:155], v182 offset:32256
v_mfma_f32_16x16x32_bf16 v[100:103], v[172:175], a[252:255], v[100:103]
buffer_load_dwordx4 a[152:155], v183, s[28:31], s61 offen sc1
v_mfma_f32_16x16x32_bf16 v[100:103], v[168:171], a[244:247], v[100:103]
ds_read_b64_tr_b16 v[156:157], v182 offset:18464
ds_read_b64_tr_b16 v[158:159], v182 offset:23072
v_add_u32 v180, s46, v180
v_mfma_f32_16x16x32_bf16 v[108:111], v[176:179], a[244:247], v[108:111]
s_waitcnt vmcnt(21)
ds_read_b64_tr_b16 v[160:161], v182 offset:27680
ds_read_b64_tr_b16 v[162:163], v182 offset:32288
v_add_u32 v181, s46, v181
v_mfma_f32_16x16x32_bf16 v[108:111], v[144:147], a[252:255], v[108:111]
s_waitcnt lgkmcnt(4)
ds_read_b64_tr_b16 v[164:165], v182 offset:18496
v_cmp_gt_u32 vcc, s47, v191
v_mfma_f32_16x16x32_bf16 v[104:107], v[144:147], a[248:251], v[104:107]
buffer_load_dwordx4 a[156:159], v184, s[28:31], s61 offen sc1
v_mfma_f32_16x16x32_bf16 v[104:107], v[176:179], a[240:243], v[104:107]
s_add_u32 s61, s61, 4096
ds_read_b64_tr_b16 v[166:167], v182 offset:23104
ds_read_b64_tr_b16 v[168:169], v182 offset:27712
v_mfma_f32_16x16x32_bf16 v[112:115], v[148:151], a[240:243], v[112:115]
ds_read_b64_tr_b16 v[170:171], v182 offset:32320
v_mfma_f32_16x16x32_bf16 v[112:115], v[152:155], a[248:251], v[112:115]
s_cbranch_vccnz k1_f12_s
k1_f12_b:
ds_read_b64_tr_b16 v[172:173], v182 offset:18528
v_mfma_f32_16x16x32_bf16 v[116:119], v[152:155], a[252:255], v[116:119]
buffer_load_dwordx4 a[176:179], v183, s[28:31], s61 offen sc1
v_mfma_f32_16x16x32_bf16 v[116:119], v[148:151], a[244:247], v[116:119]
s_waitcnt lgkmcnt(1)
ds_read_b64_tr_b16 v[174:175], v182 offset:23136
ds_read_b64_tr_b16 v[176:177], v182 offset:27744
v_mfma_f32_16x16x32_bf16 v[124:127], v[156:159], a[244:247], v[124:127]
ds_read_b64_tr_b16 v[178:179], v182 offset:32352
v_add_u32 v182, s46, v182
v_mfma_f32_16x16x32_bf16 v[124:127], v[160:163], a[252:255], v[124:127]
ds_read_b64_tr_b16 v[144:145], v180 offset:0
v_mfma_f32_16x16x32_bf16 v[120:123], v[160:163], a[248:251], v[120:123]
buffer_load_dwordx4 a[180:183], v184, s[28:31], s61 offen sc1
v_mfma_f32_16x16x32_bf16 v[120:123], v[156:159], a[240:243], v[120:123]
s_add_u32 s61, s61, 4096
ds_read_b64_tr_b16 v[146:147], v180 offset:4608
ds_read_b64_tr_b16 v[148:149], v180 offset:9216
v_mfma_f32_16x16x32_bf16 v[128:131], v[164:167], a[240:243], v[128:131]
ds_read_b64_tr_b16 v[150:151], v180 offset:13824
v_mfma_f32_16x16x32_bf16 v[128:131], v[168:171], a[248:251], v[128:131]
s_waitcnt lgkmcnt(4)
buffer_load_dwordx4 a[184:187], v183, s[28:31], s61 offen sc1
v_mfma_f32_16x16x32_bf16 v[132:135], v[168:171], a[252:255], v[132:135]
ds_read_b64_tr_b16 v[152:153], v180 offset:32
ds_read_b64_tr_b16 v[154:155], v180 offset:4640
v_mfma_f32_16x16x32_bf16 v[132:135], v[164:167], a[244:247], v[132:135]
ds_read_b64_tr_b16 v[156:157], v180 offset:9248
ds_read_b64_tr_b16 v[158:159], v180 offset:13856
v_mfma_f32_16x16x32_bf16 v[140:143], v[172:175], a[244:247], v[140:143]
ds_read_b64_tr_b16 v[160:161], v180 offset:64
v_mfma_f32_16x16x32_bf16 v[140:143], v[176:179], a[252:255], v[140:143]
buffer_load_dwordx4 a[188:191], v184, s[28:31], s61 offen sc1
s_add_u32 s61, s61, 4096
v_mfma_f32_16x16x32_bf16 v[136:139], v[176:179], a[248:251], v[136:139]
s_waitcnt vmcnt(22)
ds_read_b64_tr_b16 v[162:163], v180 offset:4672
v_mfma_f32_16x16x32_bf16 v[136:139], v[172:175], a[240:243], v[136:139]
s_waitcnt lgkmcnt(2)
ds_read_b64_tr_b16 v[164:165], v180 offset:9280
ds_read_b64_tr_b16 v[166:167], v180 offset:13888
v_mfma_f32_16x16x32_bf16 v[72:75], v[144:147], a[80:83], v[72:75]
ds_read_b64_tr_b16 v[168:169], v180 offset:96
v_mfma_f32_16x16x32_bf16 v[72:75], v[148:151], a[88:91], v[72:75]
s_add_u32 m0, s64, 0
ds_read_b64_tr_b16 v[170:171], v180 offset:4704
v_mfma_f32_16x16x32_bf16 v[76:79], v[148:151], a[92:95], v[76:79]
buffer_load_dwordx4 v234, s[12:15], s58 offen offset:0 sc1 lds
v_mfma_f32_16x16x32_bf16 v[76:79], v[144:147], a[84:87], v[76:79]
ds_read_b64_tr_b16 v[172:173], v180 offset:9312
ds_read_b64_tr_b16 v[174:175], v180 offset:13920
v_mfma_f32_16x16x32_bf16 v[84:87], v[152:155], a[84:87], v[84:87]
ds_read_b64_tr_b16 v[176:177], v181 offset:128
v_mfma_f32_16x16x32_bf16 v[84:87], v[156:159], a[92:95], v[84:87]
s_waitcnt lgkmcnt(5)
buffer_load_dwordx4 v234, s[12:15], s58 offen offset:1024 sc1 lds
v_mfma_f32_16x16x32_bf16 v[80:83], v[156:159], a[88:91], v[80:83]
ds_read_b64_tr_b16 v[178:179], v181 offset:4736
v_mfma_f32_16x16x32_bf16 v[80:83], v[152:155], a[80:83], v[80:83]
ds_read_b64_tr_b16 v[144:145], v181 offset:9344
ds_read_b64_tr_b16 v[146:147], v181 offset:13952
v_mfma_f32_16x16x32_bf16 v[88:91], v[160:163], a[80:83], v[88:91]
ds_read_b64_tr_b16 v[148:149], v182 offset:0
v_mfma_f32_16x16x32_bf16 v[88:91], v[164:167], a[88:91], v[88:91]
buffer_load_dwordx4 v234, s[12:15], s58 offen offset:2048 sc1 lds
v_mfma_f32_16x16x32_bf16 v[92:95], v[164:167], a[92:95], v[92:95]
ds_read_b64_tr_b16 v[150:151], v182 offset:4608
v_mfma_f32_16x16x32_bf16 v[92:95], v[160:163], a[84:87], v[92:95]
s_waitcnt lgkmcnt(2)
ds_read_b64_tr_b16 v[152:153], v182 offset:9216
ds_read_b64_tr_b16 v[154:155], v182 offset:13824
v_mfma_f32_16x16x32_bf16 v[100:103], v[168:171], a[84:87], v[100:103]
ds_read_b64_tr_b16 v[156:157], v182 offset:32
v_mfma_f32_16x16x32_bf16 v[100:103], v[172:175], a[92:95], v[100:103]
buffer_load_dwordx4 v234, s[12:15], s58 offen offset:3072 sc1 lds
v_mfma_f32_16x16x32_bf16 v[96:99], v[172:175], a[88:91], v[96:99]
s_add_u32 s58, s58, 36864
ds_read_b64_tr_b16 v[158:159], v182 offset:4640
v_mfma_f32_16x16x32_bf16 v[96:99], v[168:171], a[80:83], v[96:99]
s_add_u32 m0, s64, 4096
ds_read_b64_tr_b16 v[160:161], v182 offset:9248
ds_read_b64_tr_b16 v[162:163], v182 offset:13856
v_mfma_f32_16x16x32_bf16 v[104:107], v[176:179], a[80:83], v[104:107]
s_waitcnt vmcnt(26)
ds_read_b64_tr_b16 v[164:165], v182 offset:64
v_mfma_f32_16x16x32_bf16 v[104:107], v[144:147], a[88:91], v[104:107]
s_waitcnt lgkmcnt(5)
buffer_load_dwordx4 v234, s[12:15], s59 offen offset:0 sc1 lds
v_mfma_f32_16x16x32_bf16 v[108:111], v[144:147], a[92:95], v[108:111]
ds_read_b64_tr_b16 v[166:167], v182 offset:4672
v_mfma_f32_16x16x32_bf16 v[108:111], v[176:179], a[84:87], v[108:111]
ds_read_b64_tr_b16 v[168:169], v182 offset:9280
ds_read_b64_tr_b16 v[170:171], v182 offset:13888
v_mfma_f32_16x16x32_bf16 v[116:119], v[148:151], a[84:87], v[116:119]
buffer_load_dwordx4 v234, s[12:15], s59 offen offset:1024 sc1 lds
v_mfma_f32_16x16x32_bf16 v[116:119], v[152:155], a[92:95], v[116:119]
ds_read_b64_tr_b16 v[172:173], v182 offset:96
v_mfma_f32_16x16x32_bf16 v[112:115], v[152:155], a[88:91], v[112:115]
ds_read_b64_tr_b16 v[174:175], v182 offset:4704
v_mfma_f32_16x16x32_bf16 v[112:115], v[148:151], a[80:83], v[112:115]
s_waitcnt lgkmcnt(2)
ds_read_b64_tr_b16 v[176:177], v182 offset:9312
ds_read_b64_tr_b16 v[178:179], v182 offset:13920
v_mfma_f32_16x16x32_bf16 v[120:123], v[156:159], a[80:83], v[120:123]
buffer_load_dwordx4 v234, s[12:15], s59 offen offset:2048 sc1 lds
v_mfma_f32_16x16x32_bf16 v[120:123], v[160:163], a[88:91], v[120:123]
ds_read_b64_tr_b16 v[144:145], v180 offset:18432
v_mfma_f32_16x16x32_bf16 v[124:127], v[160:163], a[92:95], v[124:127]
ds_read_b64_tr_b16 v[146:147], v180 offset:23040
v_mfma_f32_16x16x32_bf16 v[124:127], v[156:159], a[84:87], v[124:127]
ds_read_b64_tr_b16 v[148:149], v180 offset:27648
ds_read_b64_tr_b16 v[150:151], v180 offset:32256
v_mfma_f32_16x16x32_bf16 v[132:135], v[164:167], a[84:87], v[132:135]
buffer_load_dwordx4 v234, s[12:15], s59 offen offset:3072 sc1 lds
s_add_u32 s59, s59, 36864
v_mfma_f32_16x16x32_bf16 v[132:135], v[168:171], a[92:95], v[132:135]
s_waitcnt lgkmcnt(4)
ds_read_b64_tr_b16 v[152:153], v180 offset:18464
v_mfma_f32_16x16x32_bf16 v[128:131], v[168:171], a[88:91], v[128:131]
ds_read_b64_tr_b16 v[154:155], v180 offset:23072
v_mfma_f32_16x16x32_bf16 v[128:131], v[164:167], a[80:83], v[128:131]
s_add_u32 m0, s64, 8192
ds_read_b64_tr_b16 v[156:157], v180 offset:27680
ds_read_b64_tr_b16 v[158:159], v180 offset:32288
v_mfma_f32_16x16x32_bf16 v[136:139], v[172:175], a[80:83], v[136:139]
buffer_load_dwordx4 v234, s[12:15], s72 offen offset:0 sc1 lds
s_add_u32 s72, s72, 36864
s_add_u32 s64, s64, 36864
s_cmp_ge_u32 s64, 147456
s_cselect_b32 s64, s60, s64
v_mfma_f32_16x16x32_bf16 v[136:139], v[176:179], a[88:91], v[136:139]
ds_read_b64_tr_b16 v[160:161], v180 offset:18496
v_mfma_f32_16x16x32_bf16 v[140:143], v[176:179], a[92:95], v[140:143]
s_waitcnt vmcnt(26)
ds_read_b64_tr_b16 v[162:163], v180 offset:23104
v_mfma_f32_16x16x32_bf16 v[140:143], v[172:175], a[84:87], v[140:143]
s_waitcnt lgkmcnt(2)
buffer_load_dwordx4 a[192:195], v183, s[28:31], s61 offen sc1
v_mfma_f32_16x16x32_bf16 v[76:79], v[144:147], a[116:119], v[76:79]
ds_read_b64_tr_b16 v[164:165], v180 offset:27712
ds_read_b64_tr_b16 v[166:167], v180 offset:32320
v_mfma_f32_16x16x32_bf16 v[76:79], v[148:151], a[124:127], v[76:79]
ds_read_b64_tr_b16 v[168:169], v180 offset:18528
v_mfma_f32_16x16x32_bf16 v[72:75], v[148:151], a[120:123], v[72:75]
ds_read_b64_tr_b16 v[170:171], v180 offset:23136
v_mfma_f32_16x16x32_bf16 v[72:75], v[144:147], a[112:115], v[72:75]
buffer_load_dwordx4 a[196:199], v184, s[28:31], s61 offen sc1
s_add_u32 s61, s61, 4096
v_mfma_f32_16x16x32_bf16 v[80:83], v[152:155], a[112:115], v[80:83]
s_waitcnt vmcnt(19)
ds_add_u32 v188, v190
v_mfma_f32_16x16x32_bf16 v[80:83], v[156:159], a[120:123], v[80:83]
s_waitcnt lgkmcnt(3)
ds_read_b64_tr_b16 v[172:173], v180 offset:27744
ds_read_b64_tr_b16 v[174:175], v180 offset:32352
v_mfma_f32_16x16x32_bf16 v[84:87], v[156:159], a[124:127], v[84:87]
s_add_u32 s47, s47, 1
ds_read_b64_tr_b16 v[176:177], v181 offset:18560
ds_read_b64_tr_b16 v[178:179], v181 offset:23168
v_mfma_f32_16x16x32_bf16 v[84:87], v[152:155], a[116:119], v[84:87]
buffer_load_dwordx4 a[200:203], v183, s[28:31], s61 offen sc1
v_mfma_f32_16x16x32_bf16 v[92:95], v[160:163], a[116:119], v[92:95]
s_add_u32 s45, s45, 1
ds_read_b64_tr_b16 v[144:145], v181 offset:27776
ds_read_b64_tr_b16 v[146:147], v181 offset:32384
v_mfma_f32_16x16x32_bf16 v[92:95], v[164:167], a[124:127], v[92:95]
ds_read_b64_tr_b16 v[148:149], v182 offset:18432
v_mfma_f32_16x16x32_bf16 v[88:91], v[164:167], a[120:123], v[88:91]
s_and_b32 s45, s45, 3
s_cselect_b32 s46, 36864, s42
ds_read_b64_tr_b16 v[150:151], v182 offset:23040
v_mfma_f32_16x16x32_bf16 v[88:91], v[160:163], a[112:115], v[88:91]
s_waitcnt lgkmcnt(2)
buffer_load_dwordx4 a[204:207], v184, s[28:31], s61 offen sc1
v_mfma_f32_16x16x32_bf16 v[96:99], v[168:171], a[112:115], v[96:99]
s_add_u32 s61, s61, 4096
ds_read_b32 v191, v189
v_mfma_f32_16x16x32_bf16 v[96:99], v[172:175], a[120:123], v[96:99]
ds_read_b64_tr_b16 v[152:153], v182 offset:27648
ds_read_b64_tr_b16 v[154:155], v182 offset:32256
v_mfma_f32_16x16x32_bf16 v[100:103], v[172:175], a[124:127], v[100:103]
buffer_load_dwordx4 a[208:211], v183, s[28:31], s61 offen sc1
v_mfma_f32_16x16x32_bf16 v[100:103], v[168:171], a[116:119], v[100:103]
ds_read_b64_tr_b16 v[156:157], v182 offset:18464
ds_read_b64_tr_b16 v[158:159], v182 offset:23072
v_add_u32 v180, s46, v180
v_mfma_f32_16x16x32_bf16 v[108:111], v[176:179], a[116:119], v[108:111]
s_waitcnt vmcnt(22)
ds_read_b64_tr_b16 v[160:161], v182 offset:27680
ds_read_b64_tr_b16 v[162:163], v182 offset:32288
v_add_u32 v181, s46, v181
v_mfma_f32_16x16x32_bf16 v[108:111], v[144:147], a[124:127], v[108:111]
s_waitcnt lgkmcnt(4)
ds_read_b64_tr_b16 v[164:165], v182 offset:18496
v_cmp_gt_u32 vcc, s47, v191
v_mfma_f32_16x16x32_bf16 v[104:107], v[144:147], a[120:123], v[104:107]
buffer_load_dwordx4 a[212:215], v184, s[28:31], s61 offen sc1
v_mfma_f32_16x16x32_bf16 v[104:107], v[176:179], a[112:115], v[104:107]
s_add_u32 s61, s61, 4096
ds_read_b64_tr_b16 v[166:167], v182 offset:23104
ds_read_b64_tr_b16 v[168:169], v182 offset:27712
v_mfma_f32_16x16x32_bf16 v[112:115], v[148:151], a[112:115], v[112:115]
ds_read_b64_tr_b16 v[170:171], v182 offset:32320
v_mfma_f32_16x16x32_bf16 v[112:115], v[152:155], a[120:123], v[112:115]
s_cbranch_vccnz k1_f13_s
k1_f13_b:
ds_read_b64_tr_b16 v[172:173], v182 offset:18528
v_mfma_f32_16x16x32_bf16 v[116:119], v[152:155], a[124:127], v[116:119]
buffer_load_dwordx4 a[216:219], v183, s[28:31], s61 offen sc1
v_mfma_f32_16x16x32_bf16 v[116:119], v[148:151], a[116:119], v[116:119]
s_waitcnt lgkmcnt(1)
ds_read_b64_tr_b16 v[174:175], v182 offset:23136
ds_read_b64_tr_b16 v[176:177], v182 offset:27744
v_mfma_f32_16x16x32_bf16 v[124:127], v[156:159], a[116:119], v[124:127]
ds_read_b64_tr_b16 v[178:179], v182 offset:32352
v_add_u32 v182, s46, v182
v_mfma_f32_16x16x32_bf16 v[124:127], v[160:163], a[124:127], v[124:127]
ds_read_b64_tr_b16 v[144:145], v180 offset:0
v_mfma_f32_16x16x32_bf16 v[120:123], v[160:163], a[120:123], v[120:123]
buffer_load_dwordx4 a[220:223], v184, s[28:31], s61 offen sc1
v_mfma_f32_16x16x32_bf16 v[120:123], v[156:159], a[112:115], v[120:123]
s_add_u32 s61, s61, 4096
ds_read_b64_tr_b16 v[146:147], v180 offset:4608
ds_read_b64_tr_b16 v[148:149], v180 offset:9216
v_mfma_f32_16x16x32_bf16 v[128:131], v[164:167], a[112:115], v[128:131]
s_add_u32 m0, s64, 0
ds_read_b64_tr_b16 v[150:151], v180 offset:13824
v_mfma_f32_16x16x32_bf16 v[128:131], v[168:171], a[120:123], v[128:131]
s_waitcnt lgkmcnt(4)
buffer_load_dwordx4 v234, s[12:15], s58 offen offset:0 sc1 lds
v_mfma_f32_16x16x32_bf16 v[132:135], v[168:171], a[124:127], v[132:135]
ds_read_b64_tr_b16 v[152:153], v180 offset:32
ds_read_b64_tr_b16 v[154:155], v180 offset:4640
v_mfma_f32_16x16x32_bf16 v[132:135], v[164:167], a[116:119], v[132:135]
ds_read_b64_tr_b16 v[156:157], v180 offset:9248
ds_read_b64_tr_b16 v[158:159], v180 offset:13856
v_mfma_f32_16x16x32_bf16 v[140:143], v[172:175], a[116:119], v[140:143]
ds_read_b64_tr_b16 v[160:161], v180 offset:64
v_mfma_f32_16x16x32_bf16 v[140:143], v[176:179], a[124:127], v[140:143]
buffer_load_dwordx4 v234, s[12:15], s58 offen offset:1024 sc1 lds
v_mfma_f32_16x16x32_bf16 v[136:139], v[176:179], a[120:123], v[136:139]
s_waitcnt vmcnt(23)
ds_read_b64_tr_b16 v[162:163], v180 offset:4672
v_mfma_f32_16x16x32_bf16 v[136:139], v[172:175], a[112:115], v[136:139]
s_waitcnt lgkmcnt(2)
ds_read_b64_tr_b16 v[164:165], v180 offset:9280
ds_read_b64_tr_b16 v[166:167], v180 offset:13888
v_mfma_f32_16x16x32_bf16 v[72:75], v[144:147], a[144:147], v[72:75]
ds_read_b64_tr_b16 v[168:169], v180 offset:96
v_mfma_f32_16x16x32_bf16 v[72:75], v[148:151], a[152:155], v[72:75]
ds_read_b64_tr_b16 v[170:171], v180 offset:4704
v_mfma_f32_16x16x32_bf16 v[76:79], v[148:151], a[156:159], v[76:79]
buffer_load_dword v233, v247, s[36:39], s69 offen sc1
v_mfma_f32_16x16x32_bf16 v[76:79], v[144:147], a[148:151], v[76:79]
ds_read_b64_tr_b16 v[172:173], v180 offset:9312
ds_read_b64_tr_b16 v[174:175], v180 offset:13920
v_mfma_f32_16x16x32_bf16 v[84:87], v[152:155], a[148:151], v[84:87]
ds_read_b64_tr_b16 v[176:177], v181 offset:128
v_mfma_f32_16x16x32_bf16 v[84:87], v[156:159], a[156:159], v[84:87]
s_waitcnt lgkmcnt(5)
buffer_load_dwordx4 v234, s[12:15], s58 offen offset:2048 sc1 lds
v_mfma_f32_16x16x32_bf16 v[80:83], v[156:159], a[152:155], v[80:83]
ds_read_b64_tr_b16 v[178:179], v181 offset:4736
v_mfma_f32_16x16x32_bf16 v[80:83], v[152:155], a[144:147], v[80:83]
ds_read_b64_tr_b16 v[144:145], v181 offset:9344
ds_read_b64_tr_b16 v[146:147], v181 offset:13952
v_mfma_f32_16x16x32_bf16 v[88:91], v[160:163], a[144:147], v[88:91]
ds_read_b64_tr_b16 v[148:149], v182 offset:0
v_mfma_f32_16x16x32_bf16 v[88:91], v[164:167], a[152:155], v[88:91]
buffer_load_dwordx4 v234, s[12:15], s58 offen offset:3072 sc1 lds
v_mfma_f32_16x16x32_bf16 v[92:95], v[164:167], a[156:159], v[92:95]
s_add_u32 s58, s58, 36864
ds_read_b64_tr_b16 v[150:151], v182 offset:4608
v_mfma_f32_16x16x32_bf16 v[92:95], v[160:163], a[148:151], v[92:95]
s_waitcnt lgkmcnt(2)
ds_read_b64_tr_b16 v[152:153], v182 offset:9216
ds_read_b64_tr_b16 v[154:155], v182 offset:13824
v_mfma_f32_16x16x32_bf16 v[100:103], v[168:171], a[148:151], v[100:103]
s_add_u32 m0, s64, 4096
ds_read_b64_tr_b16 v[156:157], v182 offset:32
v_mfma_f32_16x16x32_bf16 v[100:103], v[172:175], a[156:159], v[100:103]
buffer_load_dwordx4 v234, s[12:15], s59 offen offset:0 sc1 lds
v_mfma_f32_16x16x32_bf16 v[96:99], v[172:175], a[152:155], v[96:99]
ds_read_b64_tr_b16 v[158:159], v182 offset:4640
v_mfma_f32_16x16x32_bf16 v[96:99], v[168:171], a[144:147], v[96:99]
ds_read_b64_tr_b16 v[160:161], v182 offset:9248
ds_read_b64_tr_b16 v[162:163], v182 offset:13856
v_mfma_f32_16x16x32_bf16 v[104:107], v[176:179], a[144:147], v[104:107]
s_waitcnt vmcnt(27)
ds_read_b64_tr_b16 v[164:165], v182 offset:64
v_mfma_f32_16x16x32_bf16 v[104:107], v[144:147], a[152:155], v[104:107]
s_waitcnt lgkmcnt(5)
buffer_load_dwordx4 v234, s[12:15], s59 offen offset:1024 sc1 lds
v_mfma_f32_16x16x32_bf16 v[108:111], v[144:147], a[156:159], v[108:111]
ds_read_b64_tr_b16 v[166:167], v182 offset:4672
v_mfma_f32_16x16x32_bf16 v[108:111], v[176:179], a[148:151], v[108:111]
ds_read_b64_tr_b16 v[168:169], v182 offset:9280
ds_read_b64_tr_b16 v[170:171], v182 offset:13888
v_mfma_f32_16x16x32_bf16 v[116:119], v[148:151], a[148:151], v[116:119]
buffer_load_dwordx4 v234, s[12:15], s59 offen offset:2048 sc1 lds
v_mfma_f32_16x16x32_bf16 v[116:119], v[152:155], a[156:159], v[116:119]
ds_read_b64_tr_b16 v[172:173], v182 offset:96
v_mfma_f32_16x16x32_bf16 v[112:115], v[152:155], a[152:155], v[112:115]
ds_read_b64_tr_b16 v[174:175], v182 offset:4704
v_mfma_f32_16x16x32_bf16 v[112:115], v[148:151], a[144:147], v[112:115]
s_waitcnt lgkmcnt(2)
ds_read_b64_tr_b16 v[176:177], v182 offset:9312
ds_read_b64_tr_b16 v[178:179], v182 offset:13920
v_mfma_f32_16x16x32_bf16 v[120:123], v[156:159], a[144:147], v[120:123]
buffer_load_dwordx4 v234, s[12:15], s59 offen offset:3072 sc1 lds
v_mfma_f32_16x16x32_bf16 v[120:123], v[160:163], a[152:155], v[120:123]
s_add_u32 s59, s59, 36864
ds_read_b64_tr_b16 v[144:145], v180 offset:18432
v_mfma_f32_16x16x32_bf16 v[124:127], v[160:163], a[156:159], v[124:127]
ds_read_b64_tr_b16 v[146:147], v180 offset:23040
v_mfma_f32_16x16x32_bf16 v[124:127], v[156:159], a[148:151], v[124:127]
s_add_u32 m0, s64, 8192
ds_read_b64_tr_b16 v[148:149], v180 offset:27648
ds_read_b64_tr_b16 v[150:151], v180 offset:32256
v_mfma_f32_16x16x32_bf16 v[132:135], v[164:167], a[148:151], v[132:135]
buffer_load_dwordx4 v234, s[12:15], s72 offen offset:0 sc1 lds
s_add_u32 s72, s72, 36864
s_add_u32 s64, s64, 36864
s_cmp_ge_u32 s64, 147456
s_cselect_b32 s64, s60, s64
v_mfma_f32_16x16x32_bf16 v[132:135], v[168:171], a[156:159], v[132:135]
s_waitcnt lgkmcnt(4)
ds_read_b64_tr_b16 v[152:153], v180 offset:18464
v_mfma_f32_16x16x32_bf16 v[128:131], v[168:171], a[152:155], v[128:131]
ds_read_b64_tr_b16 v[154:155], v180 offset:23072
v_mfma_f32_16x16x32_bf16 v[128:131], v[164:167], a[144:147], v[128:131]
ds_read_b64_tr_b16 v[156:157], v180 offset:27680
ds_read_b64_tr_b16 v[158:159], v180 offset:32288
v_mfma_f32_16x16x32_bf16 v[136:139], v[172:175], a[144:147], v[136:139]
buffer_load_dwordx4 a[224:227], v183, s[28:31], s61 offen sc1
v_mfma_f32_16x16x32_bf16 v[136:139], v[176:179], a[152:155], v[136:139]
ds_read_b64_tr_b16 v[160:161], v180 offset:18496
v_mfma_f32_16x16x32_bf16 v[140:143], v[176:179], a[156:159], v[140:143]
s_waitcnt vmcnt(28)
ds_read_b64_tr_b16 v[162:163], v180 offset:23104
v_mfma_f32_16x16x32_bf16 v[140:143], v[172:175], a[148:151], v[140:143]
s_waitcnt lgkmcnt(2)
buffer_load_dwordx4 a[228:231], v184, s[28:31], s61 offen sc1
v_mfma_f32_16x16x32_bf16 v[76:79], v[144:147], a[180:183], v[76:79]
s_add_u32 s61, s61, 4096
ds_read_b64_tr_b16 v[164:165], v180 offset:27712
ds_read_b64_tr_b16 v[166:167], v180 offset:32320
v_mfma_f32_16x16x32_bf16 v[76:79], v[148:151], a[188:191], v[76:79]
ds_read_b64_tr_b16 v[168:169], v180 offset:18528
v_mfma_f32_16x16x32_bf16 v[72:75], v[148:151], a[184:187], v[72:75]
ds_read_b64_tr_b16 v[170:171], v180 offset:23136
v_mfma_f32_16x16x32_bf16 v[72:75], v[144:147], a[176:179], v[72:75]
buffer_load_dwordx4 a[232:235], v183, s[28:31], s61 offen sc1
v_mfma_f32_16x16x32_bf16 v[80:83], v[152:155], a[176:179], v[80:83]
s_waitcnt vmcnt(21)
ds_add_u32 v188, v190
v_mfma_f32_16x16x32_bf16 v[80:83], v[156:159], a[184:187], v[80:83]
s_waitcnt lgkmcnt(3)
ds_read_b64_tr_b16 v[172:173], v180 offset:27744
ds_read_b64_tr_b16 v[174:175], v180 offset:32352
v_mfma_f32_16x16x32_bf16 v[84:87], v[156:159], a[188:191], v[84:87]
s_add_u32 s47, s47, 1
ds_read_b64_tr_b16 v[176:177], v181 offset:18560
ds_read_b64_tr_b16 v[178:179], v181 offset:23168
v_mfma_f32_16x16x32_bf16 v[84:87], v[152:155], a[180:183], v[84:87]
buffer_load_dwordx4 a[236:239], v184, s[28:31], s61 offen sc1
s_add_u32 s61, s61, 4096
v_mfma_f32_16x16x32_bf16 v[92:95], v[160:163], a[180:183], v[92:95]
s_add_u32 s45, s45, 1
ds_read_b64_tr_b16 v[144:145], v181 offset:27776
ds_read_b64_tr_b16 v[146:147], v181 offset:32384
v_mfma_f32_16x16x32_bf16 v[92:95], v[164:167], a[188:191], v[92:95]
ds_read_b64_tr_b16 v[148:149], v182 offset:18432
v_mfma_f32_16x16x32_bf16 v[88:91], v[164:167], a[184:187], v[88:91]
s_and_b32 s45, s45, 3
s_cselect_b32 s46, 36864, s42
ds_read_b64_tr_b16 v[150:151], v182 offset:23040
v_mfma_f32_16x16x32_bf16 v[88:91], v[160:163], a[176:179], v[88:91]
s_waitcnt lgkmcnt(2)
buffer_load_dwordx4 a[240:243], v183, s[28:31], s61 offen sc1
v_mfma_f32_16x16x32_bf16 v[96:99], v[168:171], a[176:179], v[96:99]
ds_read_b32 v191, v189
v_mfma_f32_16x16x32_bf16 v[96:99], v[172:175], a[184:187], v[96:99]
ds_read_b64_tr_b16 v[152:153], v182 offset:27648
ds_read_b64_tr_b16 v[154:155], v182 offset:32256
v_mfma_f32_16x16x32_bf16 v[100:103], v[172:175], a[188:191], v[100:103]
buffer_load_dwordx4 a[244:247], v184, s[28:31], s61 offen sc1
v_mfma_f32_16x16x32_bf16 v[100:103], v[168:171], a[180:183], v[100:103]
s_add_u32 s61, s61, 4096
ds_read_b64_tr_b16 v[156:157], v182 offset:18464
ds_read_b64_tr_b16 v[158:159], v182 offset:23072
v_add_u32 v180, s46, v180
v_mfma_f32_16x16x32_bf16 v[108:111], v[176:179], a[180:183], v[108:111]
s_waitcnt vmcnt(24)
ds_read_b64_tr_b16 v[160:161], v182 offset:27680
ds_read_b64_tr_b16 v[162:163], v182 offset:32288
v_add_u32 v181, s46, v181
v_mfma_f32_16x16x32_bf16 v[108:111], v[144:147], a[188:191], v[108:111]
s_waitcnt lgkmcnt(4)
ds_read_b64_tr_b16 v[164:165], v182 offset:18496
v_cmp_gt_u32 vcc, s47, v191
v_mfma_f32_16x16x32_bf16 v[104:107], v[144:147], a[184:187], v[104:107]
buffer_load_dwordx4 a[248:251], v183, s[28:31], s61 offen sc1
v_mfma_f32_16x16x32_bf16 v[104:107], v[176:179], a[176:179], v[104:107]
ds_read_b64_tr_b16 v[166:167], v182 offset:23104
ds_read_b64_tr_b16 v[168:169], v182 offset:27712
v_mfma_f32_16x16x32_bf16 v[112:115], v[148:151], a[176:179], v[112:115]
ds_read_b64_tr_b16 v[170:171], v182 offset:32320
v_mfma_f32_16x16x32_bf16 v[112:115], v[152:155], a[184:187], v[112:115]
s_cbranch_vccnz k1_f14_s
k1_f14_b:
ds_read_b64_tr_b16 v[172:173], v182 offset:18528
v_mfma_f32_16x16x32_bf16 v[116:119], v[152:155], a[188:191], v[116:119]
buffer_load_dwordx4 a[252:255], v184, s[28:31], s61 offen sc1
s_add_u32 s61, s61, 4096
v_mfma_f32_16x16x32_bf16 v[116:119], v[148:151], a[180:183], v[116:119]
s_waitcnt lgkmcnt(1)
ds_read_b64_tr_b16 v[174:175], v182 offset:23136
ds_read_b64_tr_b16 v[176:177], v182 offset:27744
v_mfma_f32_16x16x32_bf16 v[124:127], v[156:159], a[180:183], v[124:127]
ds_read_b64_tr_b16 v[178:179], v182 offset:32352
v_add_u32 v182, s46, v182
v_mfma_f32_16x16x32_bf16 v[124:127], v[160:163], a[188:191], v[124:127]
ds_read_b64_tr_b16 v[144:145], v180 offset:0
v_mfma_f32_16x16x32_bf16 v[120:123], v[160:163], a[184:187], v[120:123]
v_mfma_f32_16x16x32_bf16 v[120:123], v[156:159], a[176:179], v[120:123]
ds_read_b64_tr_b16 v[146:147], v180 offset:4608
ds_read_b64_tr_b16 v[148:149], v180 offset:9216
v_mfma_f32_16x16x32_bf16 v[128:131], v[164:167], a[176:179], v[128:131]
ds_read_b64_tr_b16 v[150:151], v180 offset:13824
v_mfma_f32_16x16x32_bf16 v[128:131], v[168:171], a[184:187], v[128:131]
s_waitcnt lgkmcnt(4)
v_mfma_f32_16x16x32_bf16 v[132:135], v[168:171], a[188:191], v[132:135]
ds_read_b64_tr_b16 v[152:153], v180 offset:32
ds_read_b64_tr_b16 v[154:155], v180 offset:4640
v_mfma_f32_16x16x32_bf16 v[132:135], v[164:167], a[180:183], v[132:135]
ds_read_b64_tr_b16 v[156:157], v180 offset:9248
ds_read_b64_tr_b16 v[158:159], v180 offset:13856
v_mfma_f32_16x16x32_bf16 v[140:143], v[172:175], a[180:183], v[140:143]
ds_read_b64_tr_b16 v[160:161], v180 offset:64
v_mfma_f32_16x16x32_bf16 v[140:143], v[176:179], a[188:191], v[140:143]
v_mfma_f32_16x16x32_bf16 v[136:139], v[176:179], a[184:187], v[136:139]
s_waitcnt vmcnt(15)
ds_read_b64_tr_b16 v[162:163], v180 offset:4672
v_mfma_f32_16x16x32_bf16 v[136:139], v[172:175], a[176:179], v[136:139]
s_waitcnt lgkmcnt(2)
ds_read_b64_tr_b16 v[164:165], v180 offset:9280
ds_read_b64_tr_b16 v[166:167], v180 offset:13888
v_cmp_ne_u32 vcc, s51, v233
s_nop 4
s_cbranch_vccnz k1_pf_s
k1_pf_b:
v_mfma_f32_16x16x32_bf16 v[72:75], v[144:147], a[192:195], v[72:75]
ds_read_b64_tr_b16 v[168:169], v180 offset:96
s_and_b32 s75, s54, 1
s_mul_i32 s75, s75, 5120
v_mfma_f32_16x16x32_bf16 v[72:75], v[148:151], a[200:203], v[72:75]
ds_read_b64_tr_b16 v[170:171], v180 offset:4704
s_add_u32 s75, s75, s40
s_add_u32 s75, s75, 0
v_mfma_f32_16x16x32_bf16 v[76:79], v[148:151], a[204:207], v[76:79]
v_mfma_f32_16x16x32_bf16 v[76:79], v[144:147], a[196:199], v[76:79]
ds_read_b64_tr_b16 v[172:173], v180 offset:9312
ds_read_b64_tr_b16 v[174:175], v180 offset:13920
s_xor_b32 s74, s54, 1
v_mfma_f32_16x16x32_bf16 v[84:87], v[152:155], a[196:199], v[84:87]
ds_read_b64_tr_b16 v[176:177], v181 offset:128
s_mul_i32 s74, s74, 40960
s_add_u32 s74, s74, s75
v_mfma_f32_16x16x32_bf16 v[84:87], v[156:159], a[204:207], v[84:87]
s_waitcnt lgkmcnt(5)
v_mfma_f32_16x16x32_bf16 v[80:83], v[156:159], a[200:203], v[80:83]
ds_read_b64_tr_b16 v[178:179], v181 offset:4736
s_mul_i32 s76, s73, 3072
s_add_u32 s76, s76, s74
v_mfma_f32_16x16x32_bf16 v[80:83], v[152:155], a[192:195], v[80:83]
ds_read_b64_tr_b16 v[144:145], v181 offset:9344
ds_read_b64_tr_b16 v[146:147], v181 offset:13952
v_mfma_f32_16x16x32_bf16 v[88:91], v[160:163], a[192:195], v[88:91]
ds_read_b64_tr_b16 v[148:149], v182 offset:0
v_mfma_f32_16x16x32_bf16 v[88:91], v[164:167], a[200:203], v[88:91]
buffer_load_dwordx4 v[192:195], v234, s[36:39], s76 offen offset:0 sc1
v_mfma_f32_16x16x32_bf16 v[92:95], v[164:167], a[204:207], v[92:95]
ds_read_b64_tr_b16 v[150:151], v182 offset:4608
v_mfma_f32_16x16x32_bf16 v[92:95], v[160:163], a[196:199], v[92:95]
s_waitcnt lgkmcnt(2)
ds_read_b64_tr_b16 v[152:153], v182 offset:9216
ds_read_b64_tr_b16 v[154:155], v182 offset:13824
v_mfma_f32_16x16x32_bf16 v[100:103], v[168:171], a[196:199], v[100:103]
ds_read_b64_tr_b16 v[156:157], v182 offset:32
v_mfma_f32_16x16x32_bf16 v[100:103], v[172:175], a[204:207], v[100:103]
buffer_load_dwordx4 v[196:199], v234, s[36:39], s76 offen offset:1024 sc1
v_mfma_f32_16x16x32_bf16 v[96:99], v[172:175], a[200:203], v[96:99]
ds_read_b64_tr_b16 v[158:159], v182 offset:4640
s_lshl_b32 s76, s73, 30
s_add_u32 s76, s76, s74
v_mfma_f32_16x16x32_bf16 v[96:99], v[168:171], a[192:195], v[96:99]
ds_read_b64_tr_b16 v[160:161], v182 offset:9248
ds_read_b64_tr_b16 v[162:163], v182 offset:13856
v_mfma_f32_16x16x32_bf16 v[104:107], v[176:179], a[192:195], v[104:107]
s_waitcnt vmcnt(17)
ds_read_b64_tr_b16 v[164:165], v182 offset:64
v_mfma_f32_16x16x32_bf16 v[104:107], v[144:147], a[200:203], v[104:107]
s_waitcnt lgkmcnt(5)
buffer_load_dwordx4 v[200:203], v234, s[36:39], s76 offen offset:2048 sc1
v_mfma_f32_16x16x32_bf16 v[108:111], v[144:147], a[204:207], v[108:111]
ds_read_b64_tr_b16 v[166:167], v182 offset:4672
s_xor_b32 s74, s54, 2
s_mul_i32 s74, s74, 40960
v_mfma_f32_16x16x32_bf16 v[108:111], v[176:179], a[196:199], v[108:111]
ds_read_b64_tr_b16 v[168:169], v182 offset:9280
ds_read_b64_tr_b16 v[170:171], v182 offset:13888
s_add_u32 s74, s74, s75
v_mfma_f32_16x16x32_bf16 v[116:119], v[148:151], a[196:199], v[116:119]
v_mfma_f32_16x16x32_bf16 v[116:119], v[152:155], a[204:207], v[116:119]
ds_read_b64_tr_b16 v[172:173], v182 offset:96
s_mul_i32 s76, s73, 3072
s_add_u32 s76, s76, s74
v_mfma_f32_16x16x32_bf16 v[112:115], v[152:155], a[200:203], v[112:115]
ds_read_b64_tr_b16 v[174:175], v182 offset:4704
v_mfma_f32_16x16x32_bf16 v[112:115], v[148:151], a[192:195], v[112:115]
s_waitcnt lgkmcnt(2)
ds_read_b64_tr_b16 v[176:177], v182 offset:9312
ds_read_b64_tr_b16 v[178:179], v182 offset:13920
v_mfma_f32_16x16x32_bf16 v[120:123], v[156:159], a[192:195], v[120:123]
buffer_load_dwordx4 v[204:207], v234, s[36:39], s76 offen offset:0 sc1
v_mfma_f32_16x16x32_bf16 v[120:123], v[160:163], a[200:203], v[120:123]
ds_read_b64_tr_b16 v[144:145], v180 offset:18432
v_mfma_f32_16x16x32_bf16 v[124:127], v[160:163], a[204:207], v[124:127]
ds_read_b64_tr_b16 v[146:147], v180 offset:23040
v_mfma_f32_16x16x32_bf16 v[124:127], v[156:159], a[196:199], v[124:127]
ds_read_b64_tr_b16 v[148:149], v180 offset:27648
ds_read_b64_tr_b16 v[150:151], v180 offset:32256
v_mfma_f32_16x16x32_bf16 v[132:135], v[164:167], a[196:199], v[132:135]
buffer_load_dwordx4 v[220:223], v234, s[36:39], s76 offen offset:1024 sc1
v_mfma_f32_16x16x32_bf16 v[132:135], v[168:171], a[204:207], v[132:135]
s_waitcnt lgkmcnt(4)
ds_read_b64_tr_b16 v[152:153], v180 offset:18464
s_lshl_b32 s76, s73, 30
s_add_u32 s76, s76, s74
v_mfma_f32_16x16x32_bf16 v[128:131], v[168:171], a[200:203], v[128:131]
ds_read_b64_tr_b16 v[154:155], v180 offset:23072
v_mfma_f32_16x16x32_bf16 v[128:131], v[164:167], a[192:195], v[128:131]
ds_read_b64_tr_b16 v[156:157], v180 offset:27680
ds_read_b64_tr_b16 v[158:159], v180 offset:32288
v_mfma_f32_16x16x32_bf16 v[136:139], v[172:175], a[192:195], v[136:139]
buffer_load_dwordx4 v[224:227], v234, s[36:39], s76 offen offset:2048 sc1
v_mfma_f32_16x16x32_bf16 v[136:139], v[176:179], a[200:203], v[136:139]
ds_read_b64_tr_b16 v[160:161], v180 offset:18496
s_xor_b32 s74, s54, 3
s_mul_i32 s74, s74, 40960
v_mfma_f32_16x16x32_bf16 v[140:143], v[176:179], a[204:207], v[140:143]
s_waitcnt vmcnt(21)
ds_read_b64_tr_b16 v[162:163], v180 offset:23104
s_add_u32 s74, s74, s75
s_mul_i32 s76, s73, 3072
v_mfma_f32_16x16x32_bf16 v[140:143], v[172:175], a[196:199], v[140:143]
s_waitcnt lgkmcnt(2)
v_mfma_f32_16x16x32_bf16 v[76:79], v[144:147], a[212:215], v[76:79]
ds_read_b64_tr_b16 v[164:165], v180 offset:27712
ds_read_b64_tr_b16 v[166:167], v180 offset:32320
s_add_u32 s76, s76, s74
v_mfma_f32_16x16x32_bf16 v[76:79], v[148:151], a[220:223], v[76:79]
ds_read_b64_tr_b16 v[168:169], v180 offset:18528
v_mfma_f32_16x16x32_bf16 v[72:75], v[148:151], a[216:219], v[72:75]
ds_read_b64_tr_b16 v[170:171], v180 offset:23136
v_mfma_f32_16x16x32_bf16 v[72:75], v[144:147], a[208:211], v[72:75]
buffer_load_dwordx4 v[228:231], v234, s[36:39], s76 offen offset:0 sc1
v_mfma_f32_16x16x32_bf16 v[80:83], v[152:155], a[208:211], v[80:83]
s_waitcnt vmcnt(15)
ds_add_u32 v188, v190
v_mfma_f32_16x16x32_bf16 v[80:83], v[156:159], a[216:219], v[80:83]
s_waitcnt lgkmcnt(3)
ds_read_b64_tr_b16 v[172:173], v180 offset:27744
ds_read_b64_tr_b16 v[174:175], v180 offset:32352
v_mfma_f32_16x16x32_bf16 v[84:87], v[156:159], a[220:223], v[84:87]
s_add_u32 s47, s47, 1
ds_read_b64_tr_b16 v[176:177], v181 offset:18560
ds_read_b64_tr_b16 v[178:179], v181 offset:23168
v_mfma_f32_16x16x32_bf16 v[84:87], v[152:155], a[212:215], v[84:87]
buffer_load_dwordx4 v[236:239], v234, s[36:39], s76 offen offset:1024 sc1
v_mfma_f32_16x16x32_bf16 v[92:95], v[160:163], a[212:215], v[92:95]
s_add_u32 s45, s45, 1
ds_read_b64_tr_b16 v[144:145], v181 offset:27776
ds_read_b64_tr_b16 v[146:147], v181 offset:32384
s_lshl_b32 s76, s73, 30
v_mfma_f32_16x16x32_bf16 v[92:95], v[164:167], a[220:223], v[92:95]
ds_read_b64_tr_b16 v[148:149], v182 offset:18432
s_add_u32 s76, s76, s74
v_mfma_f32_16x16x32_bf16 v[88:91], v[164:167], a[216:219], v[88:91]
s_and_b32 s45, s45, 3
s_cselect_b32 s46, 36864, s42
ds_read_b64_tr_b16 v[150:151], v182 offset:23040
v_mfma_f32_16x16x32_bf16 v[88:91], v[160:163], a[208:211], v[88:91]
s_waitcnt lgkmcnt(2)
buffer_load_dwordx4 v[240:243], v234, s[36:39], s76 offen offset:2048 sc1
v_mfma_f32_16x16x32_bf16 v[96:99], v[168:171], a[208:211], v[96:99]
ds_read_b32 v191, v189
v_mfma_f32_16x16x32_bf16 v[96:99], v[172:175], a[216:219], v[96:99]
ds_read_b64_tr_b16 v[152:153], v182 offset:27648
ds_read_b64_tr_b16 v[154:155], v182 offset:32256
v_mfma_f32_16x16x32_bf16 v[100:103], v[172:175], a[220:223], v[100:103]
v_mfma_f32_16x16x32_bf16 v[100:103], v[168:171], a[212:215], v[100:103]
ds_read_b64_tr_b16 v[156:157], v182 offset:18464
ds_read_b64_tr_b16 v[158:159], v182 offset:23072
v_add_u32 v180, s46, v180
v_mfma_f32_16x16x32_bf16 v[108:111], v[176:179], a[212:215], v[108:111]
s_waitcnt vmcnt(17)
ds_read_b64_tr_b16 v[160:161], v182 offset:27680
ds_read_b64_tr_b16 v[162:163], v182 offset:32288
v_add_u32 v181, s46, v181
v_mfma_f32_16x16x32_bf16 v[108:111], v[144:147], a[220:223], v[108:111]
s_waitcnt lgkmcnt(4)
ds_read_b64_tr_b16 v[164:165], v182 offset:18496
v_cmp_gt_u32 vcc, s47, v191
v_mfma_f32_16x16x32_bf16 v[104:107], v[144:147], a[216:219], v[104:107]
v_mfma_f32_16x16x32_bf16 v[104:107], v[176:179], a[208:211], v[104:107]
ds_read_b64_tr_b16 v[166:167], v182 offset:23104
ds_read_b64_tr_b16 v[168:169], v182 offset:27712
v_mfma_f32_16x16x32_bf16 v[112:115], v[148:151], a[208:211], v[112:115]
ds_read_b64_tr_b16 v[170:171], v182 offset:32320
v_mfma_f32_16x16x32_bf16 v[112:115], v[152:155], a[216:219], v[112:115]
s_cbranch_vccnz k1_f15_s
k1_f15_b:
ds_read_b64_tr_b16 v[172:173], v182 offset:18528
v_mfma_f32_16x16x32_bf16 v[116:119], v[152:155], a[220:223], v[116:119]
v_mfma_f32_16x16x32_bf16 v[116:119], v[148:151], a[212:215], v[116:119]
s_waitcnt lgkmcnt(1)
ds_read_b64_tr_b16 v[174:175], v182 offset:23136
ds_read_b64_tr_b16 v[176:177], v182 offset:27744
v_mfma_f32_16x16x32_bf16 v[124:127], v[156:159], a[212:215], v[124:127]
ds_read_b64_tr_b16 v[178:179], v182 offset:32352
v_add_u32 v182, s46, v182
v_mfma_f32_16x16x32_bf16 v[124:127], v[160:163], a[220:223], v[124:127]
ds_read_b64_tr_b16 v[144:145], v182 offset:0
v_mfma_f32_16x16x32_bf16 v[120:123], v[160:163], a[216:219], v[120:123]
v_mfma_f32_16x16x32_bf16 v[120:123], v[156:159], a[208:211], v[120:123]
ds_read_b64_tr_b16 v[146:147], v182 offset:4608
ds_read_b64_tr_b16 v[148:149], v182 offset:9216
v_mfma_f32_16x16x32_bf16 v[128:131], v[164:167], a[208:211], v[128:131]
ds_read_b64_tr_b16 v[150:151], v182 offset:13824
ds_read_b64_tr_b16 v[152:153], v182 offset:18432
v_mfma_f32_16x16x32_bf16 v[128:131], v[168:171], a[216:219], v[128:131]
s_waitcnt lgkmcnt(5)
v_mfma_f32_16x16x32_bf16 v[132:135], v[168:171], a[220:223], v[132:135]
ds_read_b64_tr_b16 v[154:155], v182 offset:23040
ds_read_b64_tr_b16 v[156:157], v182 offset:27648
v_mfma_f32_16x16x32_bf16 v[132:135], v[164:167], a[212:215], v[132:135]
ds_read_b64_tr_b16 v[158:159], v182 offset:32256
v_mfma_f32_16x16x32_bf16 v[140:143], v[172:175], a[212:215], v[140:143]
ds_read_b64_tr_b16 v[160:161], v182 offset:32
ds_read_b64_tr_b16 v[162:163], v182 offset:4640
v_mfma_f32_16x16x32_bf16 v[140:143], v[176:179], a[220:223], v[140:143]
v_mfma_f32_16x16x32_bf16 v[136:139], v[176:179], a[216:219], v[136:139]
s_waitcnt vmcnt(9)
ds_read_b64_tr_b16 v[164:165], v182 offset:9248
ds_read_b64_tr_b16 v[166:167], v182 offset:13856
v_mfma_f32_16x16x32_bf16 v[136:139], v[172:175], a[208:211], v[136:139]
s_waitcnt lgkmcnt(4)
v_mfma_f32_16x16x32_bf16 v[112:115], v[144:147], a[224:227], v[112:115]
ds_read_b64_tr_b16 v[168:169], v182 offset:18464
ds_read_b64_tr_b16 v[170:171], v182 offset:23072
v_mfma_f32_16x16x32_bf16 v[112:115], v[148:151], a[232:235], v[112:115]
ds_read_b64_tr_b16 v[172:173], v182 offset:27680
ds_read_b64_tr_b16 v[174:175], v182 offset:32288
v_mfma_f32_16x16x32_bf16 v[116:119], v[148:151], a[236:239], v[116:119]
v_mfma_f32_16x16x32_bf16 v[116:119], v[144:147], a[228:231], v[116:119]
v_mfma_f32_16x16x32_bf16 v[116:119], v[152:155], a[244:247], v[116:119]
ds_read_b64_tr_b16 v[176:177], v182 offset:64
ds_read_b64_tr_b16 v[178:179], v182 offset:4672
v_mfma_f32_16x16x32_bf16 v[116:119], v[156:159], a[252:255], v[116:119]
s_waitcnt lgkmcnt(6)
ds_read_b64_tr_b16 v[144:145], v182 offset:9280
ds_read_b64_tr_b16 v[146:147], v182 offset:13888
v_mfma_f32_16x16x32_bf16 v[112:115], v[156:159], a[248:251], v[112:115]
v_mfma_f32_16x16x32_bf16 v[112:115], v[152:155], a[240:243], v[112:115]
v_mfma_f32_16x16x32_bf16 v[120:123], v[160:163], a[224:227], v[120:123]
ds_read_b64_tr_b16 v[148:149], v182 offset:18496
ds_read_b64_tr_b16 v[150:151], v182 offset:23104
v_mfma_f32_16x16x32_bf16 v[120:123], v[164:167], a[232:235], v[120:123]
ds_read_b64_tr_b16 v[152:153], v182 offset:27712
ds_read_b64_tr_b16 v[154:155], v182 offset:32320
v_mfma_f32_16x16x32_bf16 v[124:127], v[164:167], a[236:239], v[124:127]
v_mfma_f32_16x16x32_bf16 v[124:127], v[160:163], a[228:231], v[124:127]
s_waitcnt lgkmcnt(4)
v_mfma_f32_16x16x32_bf16 v[124:127], v[168:171], a[244:247], v[124:127]
ds_read_b64_tr_b16 v[156:157], v182 offset:96
ds_read_b64_tr_b16 v[158:159], v182 offset:4704
v_mfma_f32_16x16x32_bf16 v[124:127], v[172:175], a[252:255], v[124:127]
ds_read_b64_tr_b16 v[160:161], v182 offset:9312
ds_read_b64_tr_b16 v[162:163], v182 offset:13920
v_mfma_f32_16x16x32_bf16 v[120:123], v[172:175], a[248:251], v[120:123]
v_mfma_f32_16x16x32_bf16 v[120:123], v[168:171], a[240:243], v[120:123]
v_mfma_f32_16x16x32_bf16 v[128:131], v[176:179], a[224:227], v[128:131]
ds_read_b64_tr_b16 v[164:165], v182 offset:18528
ds_read_b64_tr_b16 v[166:167], v182 offset:23136
v_mfma_f32_16x16x32_bf16 v[128:131], v[144:147], a[232:235], v[128:131]
s_waitcnt lgkmcnt(6)
ds_read_b64_tr_b16 v[168:169], v182 offset:27744
ds_read_b64_tr_b16 v[170:171], v182 offset:32352
s_mul_i32 s75, s54, 40960
s_add_u32 s75, s75, s40
s_add_u32 s75, s75, 10485760
s_and_b32 s76, s54, 1
s_mul_i32 s76, s76, 5120
s_mul_i32 s77, s73, 3072
s_add_u32 s32, s75, s76
s_sub_u32 s33, s75, s76
s_add_u32 s33, s33, 5120
s_add_u32 s74, s33, s77
s_sub_u32 s77, 3072, s77
s_add_u32 s34, s32, s77
s_add_u32 s35, s33, s77
v_mfma_f32_16x16x32_bf16 v[132:135], v[144:147], a[236:239], v[132:135]
v_mfma_f32_16x16x32_bf16 v[132:135], v[176:179], a[228:231], v[132:135]
v_mfma_f32_16x16x32_bf16 v[132:135], v[148:151], a[244:247], v[132:135]
ds_read_b64_tr_b16 v[172:173], v181 offset:128
ds_read_b64_tr_b16 v[174:175], v181 offset:4736
v_cvt_pk_bf16_f32 v112, v112, v113
v_cvt_pk_bf16_f32 v113, v114, v115
v_mfma_f32_16x16x32_bf16 v[132:135], v[152:155], a[252:255], v[132:135]
ds_read_b64_tr_b16 v[176:177], v181 offset:9344
ds_read_b64_tr_b16 v[178:179], v181 offset:13952
v_cvt_pk_bf16_f32 v114, v120, v121
v_cvt_pk_bf16_f32 v115, v122, v123
v_mfma_f32_16x16x32_bf16 v[128:131], v[152:155], a[248:251], v[128:131]
v_min_u32 v112, -2, v112
v_min_u32 v113, -2, v113
v_min_u32 v114, -2, v114
v_min_u32 v115, -2, v115
v_mfma_f32_16x16x32_bf16 v[128:131], v[148:151], a[240:243], v[128:131]
s_waitcnt lgkmcnt(4)
buffer_store_dwordx4 v[112:115], v234, s[36:39], s34 offen offset:0 sc1
v_mfma_f32_16x16x32_bf16 v[136:139], v[156:159], a[224:227], v[136:139]
ds_read_b64_tr_b16 v[144:145], v181 offset:18560
ds_read_b64_tr_b16 v[146:147], v181 offset:23168
v_cvt_pk_bf16_f32 v116, v116, v117
v_cvt_pk_bf16_f32 v117, v118, v119
v_mfma_f32_16x16x32_bf16 v[136:139], v[160:163], a[232:235], v[136:139]
ds_read_b64_tr_b16 v[148:149], v181 offset:27776
ds_read_b64_tr_b16 v[150:151], v181 offset:32384
v_cvt_pk_bf16_f32 v118, v124, v125
v_cvt_pk_bf16_f32 v119, v126, v127
v_mfma_f32_16x16x32_bf16 v[140:143], v[160:163], a[236:239], v[140:143]
v_min_u32 v116, -2, v116
v_min_u32 v117, -2, v117
v_min_u32 v118, -2, v118
v_min_u32 v119, -2, v119
v_mfma_f32_16x16x32_bf16 v[140:143], v[156:159], a[228:231], v[140:143]
buffer_store_dwordx4 v[116:119], v234, s[36:39], s35 offen offset:0 sc1
v_mfma_f32_16x16x32_bf16 v[140:143], v[164:167], a[244:247], v[140:143]
ds_read_b64_tr_b16 v[152:153], v180 offset:0
ds_read_b64_tr_b16 v[154:155], v180 offset:4608
v_mfma_f32_16x16x32_bf16 v[140:143], v[168:171], a[252:255], v[140:143]
s_waitcnt lgkmcnt(6)
ds_read_b64_tr_b16 v[156:157], v180 offset:9216
ds_read_b64_tr_b16 v[158:159], v180 offset:13824
v_mfma_f32_16x16x32_bf16 v[136:139], v[168:171], a[248:251], v[136:139]
v_mfma_f32_16x16x32_bf16 v[136:139], v[164:167], a[240:243], v[136:139]
v_mfma_f32_16x16x32_bf16 v[104:107], v[172:175], a[224:227], v[104:107]
ds_read_b64_tr_b16 v[160:161], v180 offset:18432
ds_read_b64_tr_b16 v[162:163], v180 offset:23040
v_mfma_f32_16x16x32_bf16 v[104:107], v[176:179], a[232:235], v[104:107]
ds_read_b64_tr_b16 v[164:165], v180 offset:27648
ds_read_b64_tr_b16 v[166:167], v180 offset:32256
v_mfma_f32_16x16x32_bf16 v[108:111], v[176:179], a[236:239], v[108:111]
v_mfma_f32_16x16x32_bf16 v[108:111], v[172:175], a[228:231], v[108:111]
s_waitcnt lgkmcnt(8)
v_mfma_f32_16x16x32_bf16 v[108:111], v[144:147], a[244:247], v[108:111]
ds_read_b64_tr_b16 v[168:169], v180 offset:32
ds_read_b64_tr_b16 v[170:171], v180 offset:4640
v_cvt_pk_bf16_f32 v128, v128, v129
v_cvt_pk_bf16_f32 v129, v130, v131
v_mfma_f32_16x16x32_bf16 v[108:111], v[148:151], a[252:255], v[108:111]
ds_read_b64_tr_b16 v[172:173], v180 offset:9248
ds_read_b64_tr_b16 v[174:175], v180 offset:13856
v_cvt_pk_bf16_f32 v130, v136, v137
v_cvt_pk_bf16_f32 v131, v138, v139
v_mfma_f32_16x16x32_bf16 v[104:107], v[148:151], a[248:251], v[104:107]
s_waitcnt lgkmcnt(8)
v_min_u32 v128, -2, v128
v_min_u32 v129, -2, v129
v_min_u32 v130, -2, v130
v_min_u32 v131, -2, v131
v_mfma_f32_16x16x32_bf16 v[104:107], v[144:147], a[240:243], v[104:107]
buffer_store_dwordx4 v[128:131], v234, s[36:39], s34 offen offset:1024 sc1
v_mfma_f32_16x16x32_bf16 v[76:79], v[152:155], a[228:231], v[76:79]
ds_read_b64_tr_b16 v[176:177], v180 offset:18464
ds_read_b64_tr_b16 v[178:179], v180 offset:23072
v_cvt_pk_bf16_f32 v132, v132, v133
v_cvt_pk_bf16_f32 v133, v134, v135
v_mfma_f32_16x16x32_bf16 v[76:79], v[156:159], a[236:239], v[76:79]
s_waitcnt lgkmcnt(4)
ds_read_b64_tr_b16 v[144:145], v180 offset:27680
ds_read_b64_tr_b16 v[146:147], v180 offset:32288
v_cvt_pk_bf16_f32 v134, v140, v141
v_cvt_pk_bf16_f32 v135, v142, v143
v_mfma_f32_16x16x32_bf16 v[76:79], v[160:163], a[244:247], v[76:79]
ds_read_b64_tr_b16 v[148:149], v180 offset:64
ds_read_b64_tr_b16 v[150:151], v180 offset:4672
v_min_u32 v132, -2, v132
v_min_u32 v133, -2, v133
v_mfma_f32_16x16x32_bf16 v[76:79], v[164:167], a[252:255], v[76:79]
ds_read_b64_tr_b16 v[152:153], v180 offset:9280
ds_read_b64_tr_b16 v[154:155], v180 offset:13888
v_min_u32 v134, -2, v134
v_min_u32 v135, -2, v135
v_mfma_f32_16x16x32_bf16 v[84:87], v[168:171], a[228:231], v[84:87]
s_waitcnt lgkmcnt(4)
ds_read_b64_tr_b16 v[156:157], v180 offset:18496
ds_read_b64_tr_b16 v[158:159], v180 offset:23104
buffer_store_dwordx4 v[132:135], v234, s[36:39], s35 offen offset:1024 sc1
v_mfma_f32_16x16x32_bf16 v[84:87], v[172:175], a[236:239], v[84:87]
ds_read_b64_tr_b16 v[160:161], v180 offset:27712
ds_read_b64_tr_b16 v[162:163], v180 offset:32320
v_cvt_pk_bf16_f32 v64, v104, v105
v_cvt_pk_bf16_f32 v65, v106, v107
v_mfma_f32_16x16x32_bf16 v[84:87], v[176:179], a[244:247], v[84:87]
ds_read_b64_tr_b16 v[164:165], v180 offset:96
ds_read_b64_tr_b16 v[166:167], v180 offset:4704
v_min_u32 v64, -2, v64
v_min_u32 v65, -2, v65
v_mfma_f32_16x16x32_bf16 v[84:87], v[144:147], a[252:255], v[84:87]
s_waitcnt lgkmcnt(4)
ds_read_b64_tr_b16 v[168:169], v180 offset:9312
ds_read_b64_tr_b16 v[170:171], v180 offset:13920
buffer_store_dwordx4 v[64:67], v234, s[36:39], s32 offen offset:2048 sc1
v_mfma_f32_16x16x32_bf16 v[92:95], v[148:151], a[228:231], v[92:95]
ds_read_b64_tr_b16 v[172:173], v180 offset:18528
ds_read_b64_tr_b16 v[174:175], v180 offset:23136
v_cvt_pk_bf16_f32 v68, v108, v109
v_cvt_pk_bf16_f32 v69, v110, v111
v_mfma_f32_16x16x32_bf16 v[92:95], v[152:155], a[236:239], v[92:95]
ds_read_b64_tr_b16 v[176:177], v180 offset:27744
ds_read_b64_tr_b16 v[178:179], v180 offset:32352
v_min_u32 v68, -2, v68
v_min_u32 v69, -2, v69
v_mfma_f32_16x16x32_bf16 v[92:95], v[156:159], a[244:247], v[92:95]
s_waitcnt lgkmcnt(4)
ds_read_b64_tr_b16 v[144:145], v180 offset:0
ds_read_b64_tr_b16 v[146:147], v180 offset:4608
buffer_store_dwordx4 v[68:71], v234, s[36:39], s33 offen offset:2048 sc1
v_mfma_f32_16x16x32_bf16 v[92:95], v[160:163], a[252:255], v[92:95]
ds_read_b64_tr_b16 v[148:149], v180 offset:9216
ds_read_b64_tr_b16 v[150:151], v180 offset:13824
v_mfma_f32_16x16x32_bf16 v[100:103], v[164:167], a[228:231], v[100:103]
ds_read_b64_tr_b16 v[152:153], v180 offset:18432
ds_read_b64_tr_b16 v[154:155], v180 offset:23040
v_cvt_pk_bf16_f32 v76, v76, v77
v_cvt_pk_bf16_f32 v77, v78, v79
v_mfma_f32_16x16x32_bf16 v[100:103], v[168:171], a[236:239], v[100:103]
s_waitcnt lgkmcnt(4)
ds_read_b64_tr_b16 v[156:157], v180 offset:27648
ds_read_b64_tr_b16 v[158:159], v180 offset:32256
v_cvt_pk_bf16_f32 v78, v84, v85
v_cvt_pk_bf16_f32 v79, v86, v87
v_mfma_f32_16x16x32_bf16 v[100:103], v[172:175], a[244:247], v[100:103]
ds_read_b64_tr_b16 v[160:161], v180 offset:32
ds_read_b64_tr_b16 v[162:163], v180 offset:4640
v_min_u32 v76, -2, v76
v_min_u32 v77, -2, v77
v_mfma_f32_16x16x32_bf16 v[100:103], v[176:179], a[252:255], v[100:103]
ds_read_b64_tr_b16 v[164:165], v180 offset:9248
ds_read_b64_tr_b16 v[166:167], v180 offset:13856
v_min_u32 v78, -2, v78
v_min_u32 v79, -2, v79
v_mfma_f32_16x16x32_bf16 v[72:75], v[144:147], a[224:227], v[72:75]
s_waitcnt lgkmcnt(4)
ds_read_b64_tr_b16 v[168:169], v180 offset:18464
ds_read_b64_tr_b16 v[170:171], v180 offset:23072
buffer_store_dwordx4 v[76:79], v234, s[36:39], s74 offen offset:0 sc1
v_mfma_f32_16x16x32_bf16 v[72:75], v[148:151], a[232:235], v[72:75]
ds_read_b64_tr_b16 v[172:173], v180 offset:27680
ds_read_b64_tr_b16 v[174:175], v180 offset:32288
v_mfma_f32_16x16x32_bf16 v[72:75], v[152:155], a[240:243], v[72:75]
ds_read_b64_tr_b16 v[176:177], v180 offset:64
ds_read_b64_tr_b16 v[178:179], v180 offset:4672
v_mfma_f32_16x16x32_bf16 v[72:75], v[156:159], a[248:251], v[72:75]
s_waitcnt lgkmcnt(4)
ds_read_b64_tr_b16 v[144:145], v180 offset:9280
ds_read_b64_tr_b16 v[146:147], v180 offset:13888
v_mfma_f32_16x16x32_bf16 v[80:83], v[160:163], a[224:227], v[80:83]
ds_read_b64_tr_b16 v[148:149], v180 offset:18496
ds_read_b64_tr_b16 v[150:151], v180 offset:23104
v_cvt_pk_bf16_f32 v92, v92, v93
v_cvt_pk_bf16_f32 v93, v94, v95
v_mfma_f32_16x16x32_bf16 v[80:83], v[164:167], a[232:235], v[80:83]
ds_read_b64_tr_b16 v[152:153], v180 offset:27712
ds_read_b64_tr_b16 v[154:155], v180 offset:32320
v_cvt_pk_bf16_f32 v94, v100, v101
v_cvt_pk_bf16_f32 v95, v102, v103
v_mfma_f32_16x16x32_bf16 v[80:83], v[168:171], a[240:243], v[80:83]
s_waitcnt lgkmcnt(4)
ds_read_b64_tr_b16 v[156:157], v180 offset:96
ds_read_b64_tr_b16 v[158:159], v180 offset:4704
v_min_u32 v92, -2, v92
v_min_u32 v93, -2, v93
v_mfma_f32_16x16x32_bf16 v[80:83], v[172:175], a[248:251], v[80:83]
ds_read_b64_tr_b16 v[160:161], v180 offset:9312
ds_read_b64_tr_b16 v[162:163], v180 offset:13920
v_min_u32 v94, -2, v94
v_min_u32 v95, -2, v95
v_mfma_f32_16x16x32_bf16 v[88:91], v[176:179], a[224:227], v[88:91]
ds_read_b64_tr_b16 v[164:165], v180 offset:18528
ds_read_b64_tr_b16 v[166:167], v180 offset:23136
buffer_store_dwordx4 v[92:95], v234, s[36:39], s74 offen offset:1024 sc1
v_mfma_f32_16x16x32_bf16 v[88:91], v[144:147], a[232:235], v[88:91]
s_waitcnt lgkmcnt(4)
ds_read_b64_tr_b16 v[168:169], v180 offset:27744
ds_read_b64_tr_b16 v[170:171], v180 offset:32352
v_mfma_f32_16x16x32_bf16 v[88:91], v[148:151], a[240:243], v[88:91]
v_mfma_f32_16x16x32_bf16 v[88:91], v[152:155], a[248:251], v[88:91]
v_mfma_f32_16x16x32_bf16 v[96:99], v[156:159], a[224:227], v[96:99]
s_waitcnt lgkmcnt(0)
v_mfma_f32_16x16x32_bf16 v[96:99], v[160:163], a[232:235], v[96:99]
v_mfma_f32_16x16x32_bf16 v[96:99], v[164:167], a[240:243], v[96:99]
v_mfma_f32_16x16x32_bf16 v[96:99], v[168:171], a[248:251], v[96:99]
s_waitcnt lgkmcnt(0)
s_nop 4
s_waitcnt vmcnt(8)
v_lshlrev_b32 v252, 16, v192
v_and_b32 v192, s43, v192
v_lshlrev_b32 v253, 16, v193
v_and_b32 v193, s43, v193
v_add_f32 v0, v0, v252
v_add_f32 v1, v1, v192
v_add_f32 v2, v2, v253
v_add_f32 v3, v3, v193
v_lshlrev_b32 v252, 16, v194
v_and_b32 v194, s43, v194
v_lshlrev_b32 v253, 16, v195
v_and_b32 v195, s43, v195
v_add_f32 v8, v8, v252
v_add_f32 v9, v9, v194
v_add_f32 v10, v10, v253
v_add_f32 v11, v11, v195
v_lshlrev_b32 v252, 16, v196
v_and_b32 v196, s43, v196
v_lshlrev_b32 v253, 16, v197
v_and_b32 v197, s43, v197
v_add_f32 v16, v16, v252
v_add_f32 v17, v17, v196
v_add_f32 v18, v18, v253
v_add_f32 v19, v19, v197
v_lshlrev_b32 v252, 16, v198
v_and_b32 v198, s43, v198
v_lshlrev_b32 v253, 16, v199
v_and_b32 v199, s43, v199
v_add_f32 v24, v24, v252
v_add_f32 v25, v25, v198
v_add_f32 v26, v26, v253
v_add_f32 v27, v27, v199
v_lshlrev_b32 v252, 16, v200
v_and_b32 v200, s43, v200
v_lshlrev_b32 v253, 16, v201
v_and_b32 v201, s43, v201
v_add_f32 v32, v32, v252
v_add_f32 v33, v33, v200
v_add_f32 v34, v34, v253
v_add_f32 v35, v35, v201
v_lshlrev_b32 v252, 16, v204
v_and_b32 v204, s43, v204
v_lshlrev_b32 v253, 16, v205
v_and_b32 v205, s43, v205
v_add_f32 v0, v0, v252
v_add_f32 v1, v1, v204
v_add_f32 v2, v2, v253
v_add_f32 v3, v3, v205
v_lshlrev_b32 v252, 16, v206
v_and_b32 v206, s43, v206
v_lshlrev_b32 v253, 16, v207
v_and_b32 v207, s43, v207
v_add_f32 v8, v8, v252
v_add_f32 v9, v9, v206
v_add_f32 v10, v10, v253
v_add_f32 v11, v11, v207
v_lshlrev_b32 v252, 16, v220
v_and_b32 v220, s43, v220
v_lshlrev_b32 v253, 16, v221
v_and_b32 v221, s43, v221
v_add_f32 v16, v16, v252
v_add_f32 v17, v17, v220
v_add_f32 v18, v18, v253
v_add_f32 v19, v19, v221
v_lshlrev_b32 v252, 16, v222
v_and_b32 v222, s43, v222
v_lshlrev_b32 v253, 16, v223
v_and_b32 v223, s43, v223
v_add_f32 v24, v24, v252
v_add_f32 v25, v25, v222
v_add_f32 v26, v26, v253
v_add_f32 v27, v27, v223
v_lshlrev_b32 v252, 16, v224
v_and_b32 v224, s43, v224
v_lshlrev_b32 v253, 16, v225
v_and_b32 v225, s43, v225
v_add_f32 v32, v32, v252
v_add_f32 v33, v33, v224
v_add_f32 v34, v34, v253
v_add_f32 v35, v35, v225
v_lshlrev_b32 v252, 16, v228
v_and_b32 v228, s43, v228
v_lshlrev_b32 v253, 16, v229
v_and_b32 v229, s43, v229
v_add_f32 v0, v0, v252
v_add_f32 v1, v1, v228
v_add_f32 v2, v2, v253
v_add_f32 v3, v3, v229
v_lshlrev_b32 v252, 16, v230
v_and_b32 v230, s43, v230
v_lshlrev_b32 v253, 16, v231
v_and_b32 v231, s43, v231
v_add_f32 v8, v8, v252
v_add_f32 v9, v9, v230
v_add_f32 v10, v10, v253
v_add_f32 v11, v11, v231
v_lshlrev_b32 v252, 16, v236
v_and_b32 v236, s43, v236
v_lshlrev_b32 v253, 16, v237
v_and_b32 v237, s43, v237
v_add_f32 v16, v16, v252
v_add_f32 v17, v17, v236
v_add_f32 v18, v18, v253
v_add_f32 v19, v19, v237
v_lshlrev_b32 v252, 16, v238
v_and_b32 v238, s43, v238
v_lshlrev_b32 v253, 16, v239
v_and_b32 v239, s43, v239
v_add_f32 v24, v24, v252
v_add_f32 v25, v25, v238
v_add_f32 v26, v26, v253
v_add_f32 v27, v27, v239
v_lshlrev_b32 v252, 16, v240
v_and_b32 v240, s43, v240
v_lshlrev_b32 v253, 16, v241
v_and_b32 v241, s43, v241
v_add_f32 v32, v32, v252
v_add_f32 v33, v33, v240
v_add_f32 v34, v34, v253
v_add_f32 v35, v35, v241
v_mul_f32 v252, s44, v0
v_mul_f32 v253, s44, v1
v_mul_f32 v254, s44, v2
v_mul_f32 v255, s44, v3
v_exp_f32 v252, v252
v_exp_f32 v253, v253
v_exp_f32 v254, v254
v_exp_f32 v255, v255
v_add_f32 v252, 1.0, v252
v_add_f32 v253, 1.0, v253
v_add_f32 v254, 1.0, v254
v_add_f32 v255, 1.0, v255
v_rcp_f32 v252, v252
v_rcp_f32 v253, v253
v_rcp_f32 v254, v254
v_rcp_f32 v255, v255
v_mul_f32 v0, v0, v252
v_mul_f32 v1, v1, v253
v_mul_f32 v2, v2, v254
v_mul_f32 v3, v3, v255
v_mul_f32 v252, s44, v8
v_mul_f32 v253, s44, v9
v_mul_f32 v254, s44, v10
v_mul_f32 v255, s44, v11
v_exp_f32 v252, v252
v_exp_f32 v253, v253
v_exp_f32 v254, v254
v_exp_f32 v255, v255
v_add_f32 v252, 1.0, v252
v_add_f32 v253, 1.0, v253
v_add_f32 v254, 1.0, v254
v_add_f32 v255, 1.0, v255
v_rcp_f32 v252, v252
v_rcp_f32 v253, v253
v_rcp_f32 v254, v254
v_rcp_f32 v255, v255
v_mul_f32 v8, v8, v252
v_mul_f32 v9, v9, v253
v_mul_f32 v10, v10, v254
v_mul_f32 v11, v11, v255
v_mul_f32 v252, s44, v16
v_mul_f32 v253, s44, v17
v_mul_f32 v254, s44, v18
v_mul_f32 v255, s44, v19
v_exp_f32 v252, v252
v_exp_f32 v253, v253
v_exp_f32 v254, v254
v_exp_f32 v255, v255
v_add_f32 v252, 1.0, v252
v_add_f32 v253, 1.0, v253
v_add_f32 v254, 1.0, v254
v_add_f32 v255, 1.0, v255
v_rcp_f32 v252, v252
v_rcp_f32 v253, v253
v_rcp_f32 v254, v254
v_rcp_f32 v255, v255
v_mul_f32 v16, v16, v252
v_mul_f32 v17, v17, v253
v_mul_f32 v18, v18, v254
v_mul_f32 v19, v19, v255
v_mul_f32 v252, s44, v24
v_mul_f32 v253, s44, v25
v_mul_f32 v254, s44, v26
v_mul_f32 v255, s44, v27
v_exp_f32 v252, v252
v_exp_f32 v253, v253
v_exp_f32 v254, v254
v_exp_f32 v255, v255
v_add_f32 v252, 1.0, v252
v_add_f32 v253, 1.0, v253
v_add_f32 v254, 1.0, v254
v_add_f32 v255, 1.0, v255
v_rcp_f32 v252, v252
v_rcp_f32 v253, v253
v_rcp_f32 v254, v254
v_rcp_f32 v255, v255
v_mul_f32 v24, v24, v252
v_mul_f32 v25, v25, v253
v_mul_f32 v26, v26, v254
v_mul_f32 v27, v27, v255
v_mul_f32 v252, s44, v32
v_mul_f32 v253, s44, v33
v_mul_f32 v254, s44, v34
v_mul_f32 v255, s44, v35
v_exp_f32 v252, v252
v_exp_f32 v253, v253
v_exp_f32 v254, v254
v_exp_f32 v255, v255
v_add_f32 v252, 1.0, v252
v_add_f32 v253, 1.0, v253
v_add_f32 v254, 1.0, v254
v_add_f32 v255, 1.0, v255
v_rcp_f32 v252, v252
v_rcp_f32 v253, v253
v_rcp_f32 v254, v254
v_rcp_f32 v255, v255
v_mul_f32 v32, v32, v252
v_mul_f32 v33, v33, v253
v_mul_f32 v34, v34, v254
v_mul_f32 v35, v35, v255
v_lshlrev_b32 v40, 16, v208
v_and_b32 v41, s43, v208
v_lshlrev_b32 v42, 16, v209
v_and_b32 v43, s43, v209
v_lshlrev_b32 v48, 16, v210
v_and_b32 v49, s43, v210
v_lshlrev_b32 v50, 16, v211
v_and_b32 v51, s43, v211
v_lshlrev_b32 v56, 16, v212
v_and_b32 v57, s43, v212
v_lshlrev_b32 v58, 16, v213
v_and_b32 v59, s43, v213
v_lshlrev_b32 v64, 16, v214
v_and_b32 v65, s43, v214
v_lshlrev_b32 v66, 16, v215
v_and_b32 v67, s43, v215
v_lshlrev_b32 v44, 16, v216
v_and_b32 v45, s43, v216
v_lshlrev_b32 v46, 16, v217
v_and_b32 v47, s43, v217
v_bfe_u32 v251, v234, 4, 4
v_mul_u32_u24 v251, 1152, v251
v_bfe_u32 v252, v234, 8, 1
v_lshl_add_u32 v251, v252, 5, v251
v_lshrrev_b32 v252, 9, v234
v_lshl_add_u32 v251, v252, 4, v251
s_and_b32 s75, s54, 1
s_mul_i32 s75, s75, 5120
s_add_u32 s75, s75, s40
s_add_u32 s75, s75, 10485760
s_xor_b32 s74, s54, 1
s_mul_i32 s74, s74, 40960
s_add_u32 s74, s74, s75
s_mul_i32 s76, s73, 3072
s_add_u32 s76, s76, s74
buffer_load_dwordx4 v[192:195], v234, s[36:39], s76 offen offset:0 sc1
buffer_load_dwordx4 v[196:199], v234, s[36:39], s76 offen offset:1024 sc1
s_lshl_b32 s76, s73, 30
s_add_u32 s76, s76, s74
buffer_load_dwordx4 v[200:203], v234, s[36:39], s76 offen offset:2048 sc1
s_xor_b32 s74, s54, 2
s_mul_i32 s74, s74, 40960
s_add_u32 s74, s74, s75
s_mul_i32 s76, s73, 3072
s_add_u32 s76, s76, s74
buffer_load_dwordx4 v[204:207], v234, s[36:39], s76 offen offset:0 sc1
buffer_load_dwordx4 v[220:223], v234, s[36:39], s76 offen offset:1024 sc1
s_lshl_b32 s76, s73, 30
s_add_u32 s76, s76, s74
buffer_load_dwordx4 v[224:227], v234, s[36:39], s76 offen offset:2048 sc1
s_xor_b32 s74, s54, 3
s_mul_i32 s74, s74, 40960
s_add_u32 s74, s74, s75
s_mul_i32 s76, s73, 3072
s_add_u32 s76, s76, s74
buffer_load_dwordx4 v[228:231], v234, s[36:39], s76 offen offset:0 sc1
buffer_load_dwordx4 v[236:239], v234, s[36:39], s76 offen offset:1024 sc1
s_lshl_b32 s76, s73, 30
s_add_u32 s76, s76, s74
buffer_load_dwordx4 v[240:243], v234, s[36:39], s76 offen offset:2048 sc1
s_waitcnt vmcnt(6)
v_max_u32 v252, v192, v193
v_max3_u32 v252, v252, v194, v195
v_max3_u32 v252, v252, v196, v197
v_max3_u32 v252, v252, v198, v199
v_max3_u32 v252, v252, v200, v201
v_cmp_eq_u32 vcc, -1, v252
s_nop 4
s_cbranch_vccnz k1_ps0_s
k1_ps0_b:
v_lshlrev_b32 v252, 16, v192
v_and_b32 v192, s43, v192
v_lshlrev_b32 v253, 16, v193
v_and_b32 v193, s43, v193
v_add_f32 v72, v72, v252
v_add_f32 v73, v73, v192
v_add_f32 v74, v74, v253
v_add_f32 v75, v75, v193
v_lshlrev_b32 v252, 16, v194
v_and_b32 v194, s43, v194
v_lshlrev_b32 v253, 16, v195
v_and_b32 v195, s43, v195
v_add_f32 v80, v80, v252
v_add_f32 v81, v81, v194
v_add_f32 v82, v82, v253
v_add_f32 v83, v83, v195
v_lshlrev_b32 v252, 16, v196
v_and_b32 v196, s43, v196
v_lshlrev_b32 v253, 16, v197
v_and_b32 v197, s43, v197
v_add_f32 v88, v88, v252
v_add_f32 v89, v89, v196
v_add_f32 v90, v90, v253
v_add_f32 v91, v91, v197
v_lshlrev_b32 v252, 16, v198
v_and_b32 v198, s43, v198
v_lshlrev_b32 v253, 16, v199
v_and_b32 v199, s43, v199
v_add_f32 v96, v96, v252
v_add_f32 v97, v97, v198
v_add_f32 v98, v98, v253
v_add_f32 v99, v99, v199
v_lshlrev_b32 v252, 16, v200
v_and_b32 v200, s43, v200
v_lshlrev_b32 v253, 16, v201
v_and_b32 v201, s43, v201
v_add_f32 v104, v104, v252
v_add_f32 v105, v105, v200
v_add_f32 v106, v106, v253
v_add_f32 v107, v107, v201
s_waitcnt vmcnt(3)
v_max_u32 v252, v204, v205
v_max3_u32 v252, v252, v206, v207
v_max3_u32 v252, v252, v220, v221
v_max3_u32 v252, v252, v222, v223
v_max3_u32 v252, v252, v224, v225
v_cmp_eq_u32 vcc, -1, v252
s_nop 4
s_cbranch_vccnz k1_ps1_s
k1_ps1_b:
v_lshlrev_b32 v252, 16, v204
v_and_b32 v204, s43, v204
v_lshlrev_b32 v253, 16, v205
v_and_b32 v205, s43, v205
v_add_f32 v72, v72, v252
v_add_f32 v73, v73, v204
v_add_f32 v74, v74, v253
v_add_f32 v75, v75, v205
v_lshlrev_b32 v252, 16, v206
v_and_b32 v206, s43, v206
v_lshlrev_b32 v253, 16, v207
v_and_b32 v207, s43, v207
v_add_f32 v80, v80, v252
v_add_f32 v81, v81, v206
v_add_f32 v82, v82, v253
v_add_f32 v83, v83, v207
v_lshlrev_b32 v252, 16, v220
v_and_b32 v220, s43, v220
v_lshlrev_b32 v253, 16, v221
v_and_b32 v221, s43, v221
v_add_f32 v88, v88, v252
v_add_f32 v89, v89, v220
v_add_f32 v90, v90, v253
v_add_f32 v91, v91, v221
v_lshlrev_b32 v252, 16, v222
v_and_b32 v222, s43, v222
v_lshlrev_b32 v253, 16, v223
v_and_b32 v223, s43, v223
v_add_f32 v96, v96, v252
v_add_f32 v97, v97, v222
v_add_f32 v98, v98, v253
v_add_f32 v99, v99, v223
v_lshlrev_b32 v252, 16, v224
v_and_b32 v224, s43, v224
v_lshlrev_b32 v253, 16, v225
v_and_b32 v225, s43, v225
v_add_f32 v104, v104, v252
v_add_f32 v105, v105, v224
v_add_f32 v106, v106, v253
v_add_f32 v107, v107, v225
s_waitcnt vmcnt(0)
v_max_u32 v252, v228, v229
v_max3_u32 v252, v252, v230, v231
v_max3_u32 v252, v252, v236, v237
v_max3_u32 v252, v252, v238, v239
v_max3_u32 v252, v252, v240, v241
v_cmp_eq_u32 vcc, -1, v252
s_nop 4
s_cbranch_vccnz k1_ps2_s
k1_ps2_b:
v_lshlrev_b32 v252, 16, v228
v_and_b32 v228, s43, v228
v_lshlrev_b32 v253, 16, v229
v_and_b32 v229, s43, v229
v_add_f32 v72, v72, v252
v_add_f32 v73, v73, v228
v_add_f32 v74, v74, v253
v_add_f32 v75, v75, v229
v_lshlrev_b32 v252, 16, v230
v_and_b32 v230, s43, v230
v_lshlrev_b32 v253, 16, v231
v_and_b32 v231, s43, v231
v_add_f32 v80, v80, v252
v_add_f32 v81, v81, v230
v_add_f32 v82, v82, v253
v_add_f32 v83, v83, v231
v_lshlrev_b32 v252, 16, v236
v_and_b32 v236, s43, v236
v_lshlrev_b32 v253, 16, v237
v_and_b32 v237, s43, v237
v_add_f32 v88, v88, v252
v_add_f32 v89, v89, v236
v_add_f32 v90, v90, v253
v_add_f32 v91, v91, v237
v_lshlrev_b32 v252, 16, v238
v_and_b32 v238, s43, v238
v_lshlrev_b32 v253, 16, v239
v_and_b32 v239, s43, v239
v_add_f32 v96, v96, v252
v_add_f32 v97, v97, v238
v_add_f32 v98, v98, v253
v_add_f32 v99, v99, v239
v_lshlrev_b32 v252, 16, v240
v_and_b32 v240, s43, v240
v_lshlrev_b32 v253, 16, v241
v_and_b32 v241, s43, v241
v_add_f32 v104, v104, v252
v_add_f32 v105, v105, v240
v_add_f32 v106, v106, v253
v_add_f32 v107, v107, v241
v_fmac_f32 v40, v72, v0
v_fmac_f32 v41, v73, v1
v_fmac_f32 v42, v74, v2
v_fmac_f32 v43, v75, v3
v_cvt_pk_bf16_f32 v208, v40, v41
v_cvt_pk_bf16_f32 v209, v42, v43
v_fmac_f32 v48, v80, v8
v_fmac_f32 v49, v81, v9
v_fmac_f32 v50, v82, v10
v_fmac_f32 v51, v83, v11
v_cvt_pk_bf16_f32 v210, v48, v49
v_cvt_pk_bf16_f32 v211, v50, v51
s_nop 1
v_permlane16_swap_b32 v208, v210
v_permlane16_swap_b32 v209, v211
buffer_store_dwordx4 v[208:211], v251, s[16:19], s41 offen offset:0
v_fmac_f32 v56, v88, v16
v_fmac_f32 v57, v89, v17
v_fmac_f32 v58, v90, v18
v_fmac_f32 v59, v91, v19
v_cvt_pk_bf16_f32 v212, v56, v57
v_cvt_pk_bf16_f32 v213, v58, v59
v_fmac_f32 v64, v96, v24
v_fmac_f32 v65, v97, v25
v_fmac_f32 v66, v98, v26
v_fmac_f32 v67, v99, v27
v_cvt_pk_bf16_f32 v214, v64, v65
v_cvt_pk_bf16_f32 v215, v66, v67
s_nop 1
v_permlane16_swap_b32 v212, v214
v_permlane16_swap_b32 v213, v215
buffer_store_dwordx4 v[212:215], v251, s[16:19], s41 offen offset:64
v_fmac_f32 v44, v104, v32
v_fmac_f32 v45, v105, v33
v_fmac_f32 v46, v106, v34
v_fmac_f32 v47, v107, v35
v_cvt_pk_bf16_f32 v216, v44, v45
v_cvt_pk_bf16_f32 v217, v46, v47
buffer_store_dwordx2 v[216:217], v185, s[16:19], s78 offen offset:128
k1_end:
s_endpgm
k1_fb:
s_waitcnt vmcnt(0) lgkmcnt(0)
s_barrier
s_mov_b32 s66, 1
s_mov_b32 s63, s67
s_mov_b32 s62, 0
s_mov_b32 s14, 0
s_mov_b32 s34, 0
s_mov_b32 s35, 0x20000
s_mov_b32 s79, 99
s_mov_b32 s59, 0x40000000
v_mov_b32 v252, 0xff800000
v_mov_b32 v253, 0xff800000
v_mov_b32 v254, 0xff800000
v_mov_b32 v255, 0xff800000
k1_fbl:
s_add_u32 m0, s65, 0
s_nop 0
buffer_load_dwordx4 v224, s[20:23], s63 offen offset:0 lds
buffer_load_dwordx4 v225, s[20:23], s63 offen offset:1024 lds
buffer_load_dwordx4 v226, s[20:23], s63 offen offset:2048 lds
buffer_load_dwordx4 v227, s[20:23], s63 offen offset:3072 lds
s_add_u32 s63, s63, 16384
s_waitcnt vmcnt(0)
s_barrier
ds_read_b128 a[192:195], v235 offset:0
ds_read_b128 a[196:199], v236 offset:0
ds_read_b128 a[200:203], v237 offset:0
ds_read_b128 a[204:207], v238 offset:0
ds_read_b128 a[208:211], v235 offset:4096
ds_read_b128 a[212:215], v236 offset:4096
ds_read_b128 a[216:219], v237 offset:4096
ds_read_b128 a[220:223], v238 offset:4096
s_waitcnt lgkmcnt(0)
v_mfma_f32_16x16x32_bf16 v[0:3], a[192:195], a[80:83], 0
v_mfma_f32_16x16x32_bf16 v[0:3], a[196:199], a[112:115], v[0:3]
v_mfma_f32_16x16x32_bf16 v[0:3], a[200:203], a[144:147], v[0:3]
v_mfma_f32_16x16x32_bf16 v[0:3], a[204:207], a[176:179], v[0:3]
v_mfma_f32_16x16x32_bf16 v[4:7], a[204:207], a[180:183], 0
v_mfma_f32_16x16x32_bf16 v[4:7], a[200:203], a[148:151], v[4:7]
v_mfma_f32_16x16x32_bf16 v[4:7], a[196:199], a[116:119], v[4:7]
v_mfma_f32_16x16x32_bf16 v[4:7], a[192:195], a[84:87], v[4:7]
v_mfma_f32_16x16x32_bf16 v[8:11], a[192:195], a[88:91], 0
v_mfma_f32_16x16x32_bf16 v[8:11], a[196:199], a[120:123], v[8:11]
v_mfma_f32_16x16x32_bf16 v[8:11], a[200:203], a[152:155], v[8:11]
v_mfma_f32_16x16x32_bf16 v[8:11], a[204:207], a[184:187], v[8:11]
v_mfma_f32_16x16x32_bf16 v[12:15], a[204:207], a[188:191], 0
v_mfma_f32_16x16x32_bf16 v[12:15], a[200:203], a[156:159], v[12:15]
v_mfma_f32_16x16x32_bf16 v[12:15], a[196:199], a[124:127], v[12:15]
v_mfma_f32_16x16x32_bf16 v[12:15], a[192:195], a[92:95], v[12:15]
v_mfma_f32_16x16x32_bf16 v[28:31], a[208:211], a[92:95], 0
v_mfma_f32_16x16x32_bf16 v[28:31], a[212:215], a[124:127], v[28:31]
v_mfma_f32_16x16x32_bf16 v[28:31], a[216:219], a[156:159], v[28:31]
v_mfma_f32_16x16x32_bf16 v[28:31], a[220:223], a[188:191], v[28:31]
v_mfma_f32_16x16x32_bf16 v[24:27], a[220:223], a[184:187], 0
v_mfma_f32_16x16x32_bf16 v[24:27], a[216:219], a[152:155], v[24:27]
v_mfma_f32_16x16x32_bf16 v[24:27], a[212:215], a[120:123], v[24:27]
v_mfma_f32_16x16x32_bf16 v[24:27], a[208:211], a[88:91], v[24:27]
v_mfma_f32_16x16x32_bf16 v[20:23], a[208:211], a[84:87], 0
v_mfma_f32_16x16x32_bf16 v[20:23], a[212:215], a[116:119], v[20:23]
v_mfma_f32_16x16x32_bf16 v[20:23], a[216:219], a[148:151], v[20:23]
v_mfma_f32_16x16x32_bf16 v[20:23], a[220:223], a[180:183], v[20:23]
v_mfma_f32_16x16x32_bf16 v[16:19], a[220:223], a[176:179], 0
v_mfma_f32_16x16x32_bf16 v[16:19], a[216:219], a[144:147], v[16:19]
v_mfma_f32_16x16x32_bf16 v[16:19], a[212:215], a[112:115], v[16:19]
v_mfma_f32_16x16x32_bf16 v[16:19], a[208:211], a[80:83], v[16:19]
s_nop 7
v_max3_f32 v252, v252, v0, v1
v_max3_f32 v252, v252, v2, v3
v_max3_f32 v252, v252, v16, v17
v_max3_f32 v252, v252, v18, v19
v_max3_f32 v253, v253, v4, v5
v_max3_f32 v253, v253, v6, v7
v_max3_f32 v253, v253, v20, v21
v_max3_f32 v253, v253, v22, v23
v_max3_f32 v254, v254, v8, v9
v_max3_f32 v254, v254, v10, v11
v_max3_f32 v254, v254, v24, v25
v_max3_f32 v254, v254, v26, v27
v_max3_f32 v255, v255, v12, v13
v_max3_f32 v255, v255, v14, v15
v_max3_f32 v255, v255, v28, v29
v_max3_f32 v255, v255, v30, v31
ds_read_b128 a[192:195], v235 offset:8192
ds_read_b128 a[196:199], v236 offset:8192
ds_read_b128 a[200:203], v237 offset:8192
ds_read_b128 a[204:207], v238 offset:8192
ds_read_b128 a[208:211], v235 offset:12288
ds_read_b128 a[212:215], v236 offset:12288
ds_read_b128 a[216:219], v237 offset:12288
ds_read_b128 a[220:223], v238 offset:12288
s_waitcnt lgkmcnt(0)
v_mfma_f32_16x16x32_bf16 v[0:3], a[192:195], a[80:83], 0
v_mfma_f32_16x16x32_bf16 v[0:3], a[196:199], a[112:115], v[0:3]
v_mfma_f32_16x16x32_bf16 v[0:3], a[200:203], a[144:147], v[0:3]
v_mfma_f32_16x16x32_bf16 v[0:3], a[204:207], a[176:179], v[0:3]
v_mfma_f32_16x16x32_bf16 v[4:7], a[204:207], a[180:183], 0
v_mfma_f32_16x16x32_bf16 v[4:7], a[200:203], a[148:151], v[4:7]
v_mfma_f32_16x16x32_bf16 v[4:7], a[196:199], a[116:119], v[4:7]
v_mfma_f32_16x16x32_bf16 v[4:7], a[192:195], a[84:87], v[4:7]
v_mfma_f32_16x16x32_bf16 v[8:11], a[192:195], a[88:91], 0
v_mfma_f32_16x16x32_bf16 v[8:11], a[196:199], a[120:123], v[8:11]
v_mfma_f32_16x16x32_bf16 v[8:11], a[200:203], a[152:155], v[8:11]
v_mfma_f32_16x16x32_bf16 v[8:11], a[204:207], a[184:187], v[8:11]
v_mfma_f32_16x16x32_bf16 v[12:15], a[204:207], a[188:191], 0
v_mfma_f32_16x16x32_bf16 v[12:15], a[200:203], a[156:159], v[12:15]
v_mfma_f32_16x16x32_bf16 v[12:15], a[196:199], a[124:127], v[12:15]
v_mfma_f32_16x16x32_bf16 v[12:15], a[192:195], a[92:95], v[12:15]
v_mfma_f32_16x16x32_bf16 v[28:31], a[208:211], a[92:95], 0
v_mfma_f32_16x16x32_bf16 v[28:31], a[212:215], a[124:127], v[28:31]
v_mfma_f32_16x16x32_bf16 v[28:31], a[216:219], a[156:159], v[28:31]
v_mfma_f32_16x16x32_bf16 v[28:31], a[220:223], a[188:191], v[28:31]
v_mfma_f32_16x16x32_bf16 v[24:27], a[220:223], a[184:187], 0
v_mfma_f32_16x16x32_bf16 v[24:27], a[216:219], a[152:155], v[24:27]
v_mfma_f32_16x16x32_bf16 v[24:27], a[212:215], a[120:123], v[24:27]
v_mfma_f32_16x16x32_bf16 v[24:27], a[208:211], a[88:91], v[24:27]
v_mfma_f32_16x16x32_bf16 v[20:23], a[208:211], a[84:87], 0
v_mfma_f32_16x16x32_bf16 v[20:23], a[212:215], a[116:119], v[20:23]
v_mfma_f32_16x16x32_bf16 v[20:23], a[216:219], a[148:151], v[20:23]
v_mfma_f32_16x16x32_bf16 v[20:23], a[220:223], a[180:183], v[20:23]
v_mfma_f32_16x16x32_bf16 v[16:19], a[220:223], a[176:179], 0
v_mfma_f32_16x16x32_bf16 v[16:19], a[216:219], a[144:147], v[16:19]
v_mfma_f32_16x16x32_bf16 v[16:19], a[212:215], a[112:115], v[16:19]
v_mfma_f32_16x16x32_bf16 v[16:19], a[208:211], a[80:83], v[16:19]
s_nop 7
v_max3_f32 v252, v252, v0, v1
v_max3_f32 v252, v252, v2, v3
v_max3_f32 v252, v252, v16, v17
v_max3_f32 v252, v252, v18, v19
v_max3_f32 v253, v253, v4, v5
v_max3_f32 v253, v253, v6, v7
v_max3_f32 v253, v253, v20, v21
v_max3_f32 v253, v253, v22, v23
v_max3_f32 v254, v254, v8, v9
v_max3_f32 v254, v254, v10, v11
v_max3_f32 v254, v254, v24, v25
v_max3_f32 v254, v254, v26, v27
v_max3_f32 v255, v255, v12, v13
v_max3_f32 v255, v255, v14, v15
v_max3_f32 v255, v255, v28, v29
v_max3_f32 v255, v255, v30, v31
s_barrier
s_add_u32 s62, s62, 1
s_cmp_lt_u32 s62, 32
s_cbranch_scc1 k1_fbl
v_mov_b32 v248, v252
v_mov_b32 v249, v253
v_mov_b32 v250, v254
v_mov_b32 v251, v255
s_nop 1
v_permlane16_swap_b32 v252, v248
v_permlane16_swap_b32 v253, v249
v_permlane16_swap_b32 v254, v250
v_permlane16_swap_b32 v255, v251
v_max_f32 v252, v252, v248
v_max_f32 v253, v253, v249
v_max_f32 v254, v254, v250
v_max_f32 v255, v255, v251
v_mov_b32 v248, v252
v_mov_b32 v249, v253
v_mov_b32 v250, v254
v_mov_b32 v251, v255
s_nop 1
v_permlane32_swap_b32 v252, v248
v_permlane32_swap_b32 v253, v249
v_permlane32_swap_b32 v254, v250
v_permlane32_swap_b32 v255, v251
v_max_f32 v252, v252, v248
v_max_f32 v253, v253, v249
v_max_f32 v254, v254, v250
v_max_f32 v255, v255, v251
v_sub_f32 v96, 0, v252
v_sub_f32 v97, 0, v252
v_sub_f32 v98, 0, v252
v_sub_f32 v99, 0, v252
v_sub_f32 v100, 0, v253
v_sub_f32 v101, 0, v253
v_sub_f32 v102, 0, v253
v_sub_f32 v103, 0, v253
v_sub_f32 v104, 0, v254
v_sub_f32 v105, 0, v254
v_sub_f32 v106, 0, v254
v_sub_f32 v107, 0, v254
v_sub_f32 v108, 0, v255
v_sub_f32 v109, 0, v255
v_sub_f32 v110, 0, v255
v_sub_f32 v111, 0, v255
s_mov_b32 s63, s67
s_mov_b32 s64, s67
s_add_u32 m0, s65, 0
s_nop 0
buffer_load_dwordx4 v224, s[20:23], s63 offen offset:0 lds
buffer_load_dwordx4 v225, s[20:23], s63 offen offset:1024 lds
buffer_load_dwordx4 v226, s[20:23], s63 offen offset:2048 lds
buffer_load_dwordx4 v227, s[20:23], s63 offen offset:3072 lds
s_add_u32 s63, s63, 16384
s_add_u32 m0, s65, 16384
s_nop 0
buffer_load_dwordx4 v224, s[20:23], s63 offen offset:0 lds
buffer_load_dwordx4 v225, s[20:23], s63 offen offset:1024 lds
buffer_load_dwordx4 v226, s[20:23], s63 offen offset:2048 lds
buffer_load_dwordx4 v227, s[20:23], s63 offen offset:3072 lds
s_add_u32 s63, s63, 16384
s_add_u32 m0, s65, 32768
s_nop 0
buffer_load_dwordx4 v224, s[20:23], s63 offen offset:0 lds
buffer_load_dwordx4 v225, s[20:23], s63 offen offset:1024 lds
buffer_load_dwordx4 v226, s[20:23], s63 offen offset:2048 lds
buffer_load_dwordx4 v227, s[20:23], s63 offen offset:3072 lds
s_add_u32 s63, s63, 16384
s_add_u32 m0, s65, 49152
s_nop 0
buffer_load_dwordx4 v224, s[20:23], s63 offen offset:0 lds
buffer_load_dwordx4 v225, s[20:23], s63 offen offset:1024 lds
buffer_load_dwordx4 v226, s[20:23], s63 offen offset:2048 lds
buffer_load_dwordx4 v227, s[20:23], s63 offen offset:3072 lds
s_add_u32 s63, s63, 16384
s_add_u32 m0, s65, 65536
s_nop 0
buffer_load_dwordx4 v228, s[24:27], s64 offen offset:0 lds
buffer_load_dwordx4 v229, s[24:27], s64 offen offset:1024 lds
buffer_load_dwordx4 v228, s[24:27], s64 offen offset:2048 lds
buffer_load_dwordx4 v229, s[24:27], s64 offen offset:3072 lds
s_add_u32 s64, s64, 16384
s_add_u32 m0, s65, 81920
s_nop 0
buffer_load_dwordx4 v228, s[24:27], s64 offen offset:0 lds
buffer_load_dwordx4 v229, s[24:27], s64 offen offset:1024 lds
buffer_load_dwordx4 v228, s[24:27], s64 offen offset:2048 lds
buffer_load_dwordx4 v229, s[24:27], s64 offen offset:3072 lds
s_add_u32 s64, s64, 16384
v_mov_b32 v124, 0
v_mov_b32 v125, 0
s_waitcnt vmcnt(0)
s_barrier
ds_read_b128 a[192:195], v235 offset:0
ds_read_b128 a[196:199], v236 offset:0
ds_read_b128 a[200:203], v237 offset:0
ds_read_b128 a[204:207], v238 offset:0
ds_read_b128 a[208:211], v235 offset:4096
ds_read_b128 a[212:215], v236 offset:4096
ds_read_b128 a[216:219], v237 offset:4096
ds_read_b128 a[220:223], v238 offset:4096
s_waitcnt lgkmcnt(0)
v_mfma_f32_16x16x32_bf16 v[0:3], a[192:195], a[80:83], v[96:99]
v_mfma_f32_16x16x32_bf16 v[0:3], a[196:199], a[112:115], v[0:3]
v_mfma_f32_16x16x32_bf16 v[0:3], a[200:203], a[144:147], v[0:3]
v_mfma_f32_16x16x32_bf16 v[0:3], a[204:207], a[176:179], v[0:3]
v_mfma_f32_16x16x32_bf16 v[4:7], a[204:207], a[180:183], v[100:103]
v_mfma_f32_16x16x32_bf16 v[4:7], a[200:203], a[148:151], v[4:7]
v_mfma_f32_16x16x32_bf16 v[4:7], a[196:199], a[116:119], v[4:7]
v_mfma_f32_16x16x32_bf16 v[4:7], a[192:195], a[84:87], v[4:7]
v_mfma_f32_16x16x32_bf16 v[8:11], a[192:195], a[88:91], v[104:107]
v_mfma_f32_16x16x32_bf16 v[8:11], a[196:199], a[120:123], v[8:11]
v_mfma_f32_16x16x32_bf16 v[8:11], a[200:203], a[152:155], v[8:11]
v_mfma_f32_16x16x32_bf16 v[8:11], a[204:207], a[184:187], v[8:11]
v_mfma_f32_16x16x32_bf16 v[12:15], a[204:207], a[188:191], v[108:111]
v_mfma_f32_16x16x32_bf16 v[12:15], a[200:203], a[156:159], v[12:15]
v_mfma_f32_16x16x32_bf16 v[12:15], a[196:199], a[124:127], v[12:15]
v_mfma_f32_16x16x32_bf16 v[12:15], a[192:195], a[92:95], v[12:15]
v_mfma_f32_16x16x32_bf16 v[28:31], a[208:211], a[92:95], v[108:111]
v_mfma_f32_16x16x32_bf16 v[28:31], a[212:215], a[124:127], v[28:31]
v_mfma_f32_16x16x32_bf16 v[28:31], a[216:219], a[156:159], v[28:31]
v_mfma_f32_16x16x32_bf16 v[28:31], a[220:223], a[188:191], v[28:31]
v_mfma_f32_16x16x32_bf16 v[24:27], a[220:223], a[184:187], v[104:107]
v_mfma_f32_16x16x32_bf16 v[24:27], a[216:219], a[152:155], v[24:27]
v_mfma_f32_16x16x32_bf16 v[24:27], a[212:215], a[120:123], v[24:27]
v_mfma_f32_16x16x32_bf16 v[24:27], a[208:211], a[88:91], v[24:27]
v_mfma_f32_16x16x32_bf16 v[20:23], a[208:211], a[84:87], v[100:103]
v_mfma_f32_16x16x32_bf16 v[20:23], a[212:215], a[116:119], v[20:23]
v_mfma_f32_16x16x32_bf16 v[20:23], a[216:219], a[148:151], v[20:23]
v_mfma_f32_16x16x32_bf16 v[20:23], a[220:223], a[180:183], v[20:23]
v_mfma_f32_16x16x32_bf16 v[16:19], a[220:223], a[176:179], v[96:99]
v_mfma_f32_16x16x32_bf16 v[16:19], a[216:219], a[144:147], v[16:19]
v_mfma_f32_16x16x32_bf16 v[16:19], a[212:215], a[112:115], v[16:19]
v_mfma_f32_16x16x32_bf16 v[16:19], a[208:211], a[80:83], v[16:19]
ds_read_b128 a[192:195], v235 offset:8192
ds_read_b128 a[196:199], v236 offset:8192
ds_read_b128 a[200:203], v237 offset:8192
ds_read_b128 a[204:207], v238 offset:8192
ds_read_b128 a[208:211], v235 offset:12288
ds_read_b128 a[212:215], v236 offset:12288
ds_read_b128 a[216:219], v237 offset:12288
ds_read_b128 a[220:223], v238 offset:12288
s_waitcnt lgkmcnt(0)
v_mfma_f32_16x16x32_bf16 v[32:35], a[192:195], a[80:83], v[96:99]
v_mfma_f32_16x16x32_bf16 v[32:35], a[196:199], a[112:115], v[32:35]
v_mfma_f32_16x16x32_bf16 v[32:35], a[200:203], a[144:147], v[32:35]
v_mfma_f32_16x16x32_bf16 v[32:35], a[204:207], a[176:179], v[32:35]
v_mfma_f32_16x16x32_bf16 v[36:39], a[204:207], a[180:183], v[100:103]
v_mfma_f32_16x16x32_bf16 v[36:39], a[200:203], a[148:151], v[36:39]
v_mfma_f32_16x16x32_bf16 v[36:39], a[196:199], a[116:119], v[36:39]
v_mfma_f32_16x16x32_bf16 v[36:39], a[192:195], a[84:87], v[36:39]
v_mfma_f32_16x16x32_bf16 v[40:43], a[192:195], a[88:91], v[104:107]
v_mfma_f32_16x16x32_bf16 v[40:43], a[196:199], a[120:123], v[40:43]
v_mfma_f32_16x16x32_bf16 v[40:43], a[200:203], a[152:155], v[40:43]
v_mfma_f32_16x16x32_bf16 v[40:43], a[204:207], a[184:187], v[40:43]
v_mfma_f32_16x16x32_bf16 v[44:47], a[204:207], a[188:191], v[108:111]
v_mfma_f32_16x16x32_bf16 v[44:47], a[200:203], a[156:159], v[44:47]
v_mfma_f32_16x16x32_bf16 v[44:47], a[196:199], a[124:127], v[44:47]
v_mfma_f32_16x16x32_bf16 v[44:47], a[192:195], a[92:95], v[44:47]
v_mfma_f32_16x16x32_bf16 v[60:63], a[208:211], a[92:95], v[108:111]
v_mfma_f32_16x16x32_bf16 v[60:63], a[212:215], a[124:127], v[60:63]
v_mfma_f32_16x16x32_bf16 v[60:63], a[216:219], a[156:159], v[60:63]
v_mfma_f32_16x16x32_bf16 v[60:63], a[220:223], a[188:191], v[60:63]
v_mfma_f32_16x16x32_bf16 v[56:59], a[220:223], a[184:187], v[104:107]
v_mfma_f32_16x16x32_bf16 v[56:59], a[216:219], a[152:155], v[56:59]
v_mfma_f32_16x16x32_bf16 v[56:59], a[212:215], a[120:123], v[56:59]
v_mfma_f32_16x16x32_bf16 v[56:59], a[208:211], a[88:91], v[56:59]
v_mfma_f32_16x16x32_bf16 v[52:55], a[208:211], a[84:87], v[100:103]
v_mfma_f32_16x16x32_bf16 v[52:55], a[212:215], a[116:119], v[52:55]
v_mfma_f32_16x16x32_bf16 v[52:55], a[216:219], a[148:151], v[52:55]
v_mfma_f32_16x16x32_bf16 v[52:55], a[220:223], a[180:183], v[52:55]
v_mfma_f32_16x16x32_bf16 v[48:51], a[220:223], a[176:179], v[96:99]
v_mfma_f32_16x16x32_bf16 v[48:51], a[216:219], a[144:147], v[48:51]
v_mfma_f32_16x16x32_bf16 v[48:51], a[212:215], a[112:115], v[48:51]
v_mfma_f32_16x16x32_bf16 v[48:51], a[208:211], a[80:83], v[48:51]
s_nop 7
s_branch k1_att
k1_pl_s:
s_mov_b32 s77, 0
k1_pl_l:
buffer_load_dword v53, v50, s[36:39], s62 offen sc1
s_add_u32 s77, s77, 1
s_waitcnt vmcnt(0)
v_cmp_ne_u32 vcc, v53, v52
s_cmp_ge_u32 s77, 0x40000
s_cbranch_scc1 k1_pl_b
s_nop 2
s_cbranch_vccnz k1_pl_l
s_branch k1_pl_b
k1_g1_s:
ds_read_b32 v255, v252
s_waitcnt lgkmcnt(0)
v_cmp_gt_u32 vcc, 1, v255
s_nop 4
s_cbranch_vccnz k1_g1_s
s_branch k1_g1_b
k1_g2_s:
ds_read_b32 v255, v252
s_waitcnt lgkmcnt(0)
v_cmp_gt_u32 vcc, 2, v255
s_nop 4
s_cbranch_vccnz k1_g2_s
s_branch k1_g2_b
k1_g3_s:
ds_read_b32 v255, v252
s_waitcnt lgkmcnt(0)
v_cmp_gt_u32 vcc, 3, v255
s_nop 4
s_cbranch_vccnz k1_g3_s
s_branch k1_g3_b
k1_g4_s:
ds_read_b32 v255, v252
s_waitcnt lgkmcnt(0)
v_cmp_gt_u32 vcc, 4, v255
s_nop 4
s_cbranch_vccnz k1_g4_s
s_branch k1_g4_b
k1_g5_s:
ds_read_b32 v255, v252
s_waitcnt lgkmcnt(0)
v_cmp_gt_u32 vcc, 5, v255
s_nop 4
s_cbranch_vccnz k1_g5_s
s_branch k1_g5_b
k1_g6_s:
ds_read_b32 v255, v252
s_waitcnt lgkmcnt(0)
v_cmp_gt_u32 vcc, 6, v255
s_nop 4
s_cbranch_vccnz k1_g6_s
s_branch k1_g6_b
k1_g7_s:
ds_read_b32 v255, v252
s_waitcnt lgkmcnt(0)
v_cmp_gt_u32 vcc, 7, v255
s_nop 4
s_cbranch_vccnz k1_g7_s
s_branch k1_g7_b
k1_g8_s:
ds_read_b32 v255, v252
s_waitcnt lgkmcnt(0)
v_cmp_gt_u32 vcc, 8, v255
s_nop 4
s_cbranch_vccnz k1_g8_s
s_branch k1_g8_b
k1_g9_s:
ds_read_b32 v255, v252
s_waitcnt lgkmcnt(0)
v_cmp_gt_u32 vcc, 9, v255
s_nop 4
s_cbranch_vccnz k1_g9_s
s_branch k1_g9_b
k1_g10_s:
ds_read_b32 v255, v252
s_waitcnt lgkmcnt(0)
v_cmp_gt_u32 vcc, 10, v255
s_nop 4
s_cbranch_vccnz k1_g10_s
s_branch k1_g10_b
k1_g11_s:
ds_read_b32 v255, v252
s_waitcnt lgkmcnt(0)
v_cmp_gt_u32 vcc, 11, v255
s_nop 4
s_cbranch_vccnz k1_g11_s
s_branch k1_g11_b
k1_g12_s:
ds_read_b32 v255, v252
s_waitcnt lgkmcnt(0)
v_cmp_gt_u32 vcc, 12, v255
s_nop 4
s_cbranch_vccnz k1_g12_s
s_branch k1_g12_b
k1_g13_s:
ds_read_b32 v255, v252
s_waitcnt lgkmcnt(0)
v_cmp_gt_u32 vcc, 13, v255
s_nop 4
s_cbranch_vccnz k1_g13_s
s_branch k1_g13_b
k1_g14_s:
ds_read_b32 v255, v252
s_waitcnt lgkmcnt(0)
v_cmp_gt_u32 vcc, 14, v255
s_nop 4
s_cbranch_vccnz k1_g14_s
s_branch k1_g14_b
k1_g15_s:
ds_read_b32 v255, v252
s_waitcnt lgkmcnt(0)
v_cmp_gt_u32 vcc, 15, v255
s_nop 4
s_cbranch_vccnz k1_g15_s
s_branch k1_g15_b
k1_g16_s:
ds_read_b32 v255, v252
s_waitcnt lgkmcnt(0)
v_cmp_gt_u32 vcc, 16, v255
s_nop 4
s_cbranch_vccnz k1_g16_s
s_branch k1_g16_b
k1_y02_s:
ds_read_b32 v135, v133
s_waitcnt lgkmcnt(0)
v_cmp_gt_u32 vcc, s47, v135
s_nop 4
s_cbranch_vccnz k1_y02_s
s_branch k1_y02_b
k1_y04_s:
ds_read_b32 v135, v133
s_waitcnt lgkmcnt(0)
v_cmp_gt_u32 vcc, s47, v135
s_nop 4
s_cbranch_vccnz k1_y04_s
s_branch k1_y04_b
k1_y06_s:
ds_read_b32 v135, v133
s_waitcnt lgkmcnt(0)
v_cmp_gt_u32 vcc, s47, v135
s_nop 4
s_cbranch_vccnz k1_y06_s
s_branch k1_y06_b
k1_y00_s:
ds_read_b32 v135, v133
s_waitcnt lgkmcnt(0)
v_cmp_gt_u32 vcc, s47, v135
s_nop 4
s_cbranch_vccnz k1_y00_s
s_branch k1_y00_b
k1_y12_s:
ds_read_b32 v135, v133
s_waitcnt lgkmcnt(0)
v_cmp_gt_u32 vcc, s47, v135
s_nop 4
s_cbranch_vccnz k1_y12_s
s_branch k1_y12_b
k1_y14_s:
ds_read_b32 v135, v133
s_waitcnt lgkmcnt(0)
v_cmp_gt_u32 vcc, s47, v135
s_nop 4
s_cbranch_vccnz k1_y14_s
s_branch k1_y14_b
k1_y16_s:
ds_read_b32 v135, v133
s_waitcnt lgkmcnt(0)
v_cmp_gt_u32 vcc, s47, v135
s_nop 4
s_cbranch_vccnz k1_y16_s
s_branch k1_y16_b
k1_y10_s:
ds_read_b32 v135, v133
s_waitcnt lgkmcnt(0)
v_cmp_gt_u32 vcc, s47, v135
s_nop 4
s_cbranch_vccnz k1_y10_s
s_branch k1_y10_b
k1_pa_s:
s_mov_b32 s77, 0
k1_pa_l:
buffer_load_dwordx4 v[188:191], v234, s[36:39], 0 offen sc1
s_add_u32 s77, s77, 1
s_waitcnt vmcnt(0)
v_xor_b32 v188, v188, v186
v_xor_b32 v189, v189, v186
v_xor_b32 v190, v190, v186
v_xor_b32 v191, v191, v186
v_or3_b32 v188, v188, v189, v190
v_or_b32 v188, v188, v191
v_cmp_ne_u32 vcc, 0, v188
s_cmp_ge_u32 s77, 0x40000
s_cbranch_scc1 k1_pa_b
s_nop 2
s_cbranch_vccnz k1_pa_l
s_branch k1_pa_b
k1_f0_s:
ds_read_b32 v191, v189
s_waitcnt lgkmcnt(0)
v_cmp_gt_u32 vcc, s47, v191
s_nop 4
s_cbranch_vccnz k1_f0_s
s_branch k1_f0_b
k1_f1_s:
ds_read_b32 v191, v189
s_waitcnt lgkmcnt(0)
v_cmp_gt_u32 vcc, s47, v191
s_nop 4
s_cbranch_vccnz k1_f1_s
s_branch k1_f1_b
k1_f2_s:
ds_read_b32 v191, v189
s_waitcnt lgkmcnt(0)
v_cmp_gt_u32 vcc, s47, v191
s_nop 4
s_cbranch_vccnz k1_f2_s
s_branch k1_f2_b
k1_f3_s:
ds_read_b32 v191, v189
s_waitcnt lgkmcnt(0)
v_cmp_gt_u32 vcc, s47, v191
s_nop 4
s_cbranch_vccnz k1_f3_s
s_branch k1_f3_b
k1_f4_s:
ds_read_b32 v191, v189
s_waitcnt lgkmcnt(0)
v_cmp_gt_u32 vcc, s47, v191
s_nop 4
s_cbranch_vccnz k1_f4_s
s_branch k1_f4_b
k1_f5_s:
ds_read_b32 v191, v189
s_waitcnt lgkmcnt(0)
v_cmp_gt_u32 vcc, s47, v191
s_nop 4
s_cbranch_vccnz k1_f5_s
s_branch k1_f5_b
k1_f6_s:
ds_read_b32 v191, v189
s_waitcnt lgkmcnt(0)
v_cmp_gt_u32 vcc, s47, v191
s_nop 4
s_cbranch_vccnz k1_f6_s
s_branch k1_f6_b
k1_f7_s:
ds_read_b32 v191, v189
s_waitcnt lgkmcnt(0)
v_cmp_gt_u32 vcc, s47, v191
s_nop 4
s_cbranch_vccnz k1_f7_s
s_branch k1_f7_b
k1_f8_s:
ds_read_b32 v191, v189
s_waitcnt lgkmcnt(0)
v_cmp_gt_u32 vcc, s47, v191
s_nop 4
s_cbranch_vccnz k1_f8_s
s_branch k1_f8_b
k1_f9_s:
ds_read_b32 v191, v189
s_waitcnt lgkmcnt(0)
v_cmp_gt_u32 vcc, s47, v191
s_nop 4
s_cbranch_vccnz k1_f9_s
s_branch k1_f9_b
k1_f10_s:
ds_read_b32 v191, v189
s_waitcnt lgkmcnt(0)
v_cmp_gt_u32 vcc, s47, v191
s_nop 4
s_cbranch_vccnz k1_f10_s
s_branch k1_f10_b
k1_f11_s:
ds_read_b32 v191, v189
s_waitcnt lgkmcnt(0)
v_cmp_gt_u32 vcc, s47, v191
s_nop 4
s_cbranch_vccnz k1_f11_s
s_branch k1_f11_b
k1_f12_s:
ds_read_b32 v191, v189
s_waitcnt lgkmcnt(0)
v_cmp_gt_u32 vcc, s47, v191
s_nop 4
s_cbranch_vccnz k1_f12_s
s_branch k1_f12_b
k1_f13_s:
ds_read_b32 v191, v189
s_waitcnt lgkmcnt(0)
v_cmp_gt_u32 vcc, s47, v191
s_nop 4
s_cbranch_vccnz k1_f13_s
s_branch k1_f13_b
k1_f14_s:
ds_read_b32 v191, v189
s_waitcnt lgkmcnt(0)
v_cmp_gt_u32 vcc, s47, v191
s_nop 4
s_cbranch_vccnz k1_f14_s
s_branch k1_f14_b
k1_f15_s:
ds_read_b32 v191, v189
s_waitcnt lgkmcnt(0)
v_cmp_gt_u32 vcc, s47, v191
s_nop 4
s_cbranch_vccnz k1_f15_s
s_branch k1_f15_b
k1_po1_s:
s_mov_b32 s77, 0
k1_po1_l:
buffer_load_dword v233, v187, s[36:39], s68 offen sc1
s_add_u32 s77, s77, 1
s_waitcnt vmcnt(0)
v_cmp_ne_u32 vcc, s51, v233
s_cmp_ge_u32 s77, 0x40000
s_cbranch_scc1 k1_po1_b
s_nop 2
s_cbranch_vccnz k1_po1_l
s_branch k1_po1_b
k1_pf_s:
s_mov_b32 s77, 0
k1_pf_l:
buffer_load_dword v233, v247, s[36:39], s69 offen sc1
s_add_u32 s77, s77, 1
s_waitcnt vmcnt(0)
v_cmp_ne_u32 vcc, s51, v233
s_cmp_ge_u32 s77, 0x40000
s_cbranch_scc1 k1_pf_b
s_nop 2
s_cbranch_vccnz k1_pf_l
s_branch k1_pf_b
k1_ps0_s:
s_mov_b32 s77, 0
k1_ps0_l:
s_and_b32 s75, s54, 1
s_mul_i32 s75, s75, 5120
s_add_u32 s75, s75, s40
s_add_u32 s75, s75, 10485760
s_xor_b32 s74, s54, 1
s_mul_i32 s74, s74, 40960
s_add_u32 s74, s74, s75
s_mul_i32 s76, s73, 3072
s_add_u32 s76, s76, s74
buffer_load_dwordx4 v[192:195], v234, s[36:39], s76 offen offset:0 sc1
buffer_load_dwordx4 v[196:199], v234, s[36:39], s76 offen offset:1024 sc1
s_lshl_b32 s76, s73, 30
s_add_u32 s76, s76, s74
buffer_load_dwordx4 v[200:203], v234, s[36:39], s76 offen offset:2048 sc1
s_xor_b32 s74, s54, 2
s_mul_i32 s74, s74, 40960
s_add_u32 s74, s74, s75
s_mul_i32 s76, s73, 3072
s_add_u32 s76, s76, s74
buffer_load_dwordx4 v[204:207], v234, s[36:39], s76 offen offset:0 sc1
buffer_load_dwordx4 v[220:223], v234, s[36:39], s76 offen offset:1024 sc1
s_lshl_b32 s76, s73, 30
s_add_u32 s76, s76, s74
buffer_load_dwordx4 v[224:227], v234, s[36:39], s76 offen offset:2048 sc1
s_xor_b32 s74, s54, 3
s_mul_i32 s74, s74, 40960
s_add_u32 s74, s74, s75
s_mul_i32 s76, s73, 3072
s_add_u32 s76, s76, s74
buffer_load_dwordx4 v[228:231], v234, s[36:39], s76 offen offset:0 sc1
buffer_load_dwordx4 v[236:239], v234, s[36:39], s76 offen offset:1024 sc1
s_lshl_b32 s76, s73, 30
s_add_u32 s76, s76, s74
buffer_load_dwordx4 v[240:243], v234, s[36:39], s76 offen offset:2048 sc1
s_add_u32 s77, s77, 1
s_waitcnt vmcnt(0)
v_max_u32 v252, v192, v193
v_max3_u32 v252, v252, v194, v195
v_max3_u32 v252, v252, v196, v197
v_max3_u32 v252, v252, v198, v199
v_max3_u32 v252, v252, v200, v201
v_cmp_eq_u32 vcc, -1, v252
s_cmp_ge_u32 s77, 0x40000
s_cbranch_scc1 k1_ps0_b
s_nop 2
s_cbranch_vccnz k1_ps0_l
s_branch k1_ps0_b
k1_ps1_s:
s_mov_b32 s77, 0
k1_ps1_l:
s_and_b32 s75, s54, 1
s_mul_i32 s75, s75, 5120
s_add_u32 s75, s75, s40
s_add_u32 s75, s75, 10485760
s_xor_b32 s74, s54, 2
s_mul_i32 s74, s74, 40960
s_add_u32 s74, s74, s75
s_mul_i32 s76, s73, 3072
s_add_u32 s76, s76, s74
buffer_load_dwordx4 v[204:207], v234, s[36:39], s76 offen offset:0 sc1
buffer_load_dwordx4 v[220:223], v234, s[36:39], s76 offen offset:1024 sc1
s_lshl_b32 s76, s73, 30
s_add_u32 s76, s76, s74
buffer_load_dwordx4 v[224:227], v234, s[36:39], s76 offen offset:2048 sc1
s_xor_b32 s74, s54, 3
s_mul_i32 s74, s74, 40960
s_add_u32 s74, s74, s75
s_mul_i32 s76, s73, 3072
s_add_u32 s76, s76, s74
buffer_load_dwordx4 v[228:231], v234, s[36:39], s76 offen offset:0 sc1
buffer_load_dwordx4 v[236:239], v234, s[36:39], s76 offen offset:1024 sc1
s_lshl_b32 s76, s73, 30
s_add_u32 s76, s76, s74
buffer_load_dwordx4 v[240:243], v234, s[36:39], s76 offen offset:2048 sc1
s_add_u32 s77, s77, 1
s_waitcnt vmcnt(0)
v_max_u32 v252, v204, v205
v_max3_u32 v252, v252, v206, v207
v_max3_u32 v252, v252, v220, v221
v_max3_u32 v252, v252, v222, v223
v_max3_u32 v252, v252, v224, v225
v_cmp_eq_u32 vcc, -1, v252
s_cmp_ge_u32 s77, 0x40000
s_cbranch_scc1 k1_ps1_b
s_nop 2
s_cbranch_vccnz k1_ps1_l
s_branch k1_ps1_b
k1_ps2_s:
s_mov_b32 s77, 0
k1_ps2_l:
s_and_b32 s75, s54, 1
s_mul_i32 s75, s75, 5120
s_add_u32 s75, s75, s40
s_add_u32 s75, s75, 10485760
s_xor_b32 s74, s54, 3
s_mul_i32 s74, s74, 40960
s_add_u32 s74, s74, s75
s_mul_i32 s76, s73, 3072
s_add_u32 s76, s76, s74
buffer_load_dwordx4 v[228:231], v234, s[36:39], s76 offen offset:0 sc1
buffer_load_dwordx4 v[236:239], v234, s[36:39], s76 offen offset:1024 sc1
s_lshl_b32 s76, s73, 30
s_add_u32 s76, s76, s74
buffer_load_dwordx4 v[240:243], v234, s[36:39], s76 offen offset:2048 sc1
s_add_u32 s77, s77, 1
s_waitcnt vmcnt(0)
v_max_u32 v252, v228, v229
v_max3_u32 v252, v252, v230, v231
v_max3_u32 v252, v252, v236, v237
v_max3_u32 v252, v252, v238, v239
v_max3_u32 v252, v252, v240, v241
v_cmp_eq_u32 vcc, -1, v252
s_cmp_ge_u32 s77, 0x40000
s_cbranch_scc1 k1_ps2_b
s_nop 2
s_cbranch_vccnz k1_ps2_l
s_branch k1_ps2_b
k1_last:
s_endpgm
.section .rodata,"a"
.p2align 6
.amdhsa_kernel recurrent_scan__gqa_block_cached__glu_gated_swiglu__prompt_kernel
  .amdhsa_next_free_vgpr 512
  .amdhsa_next_free_sgpr 102
  .amdhsa_accum_offset 256
  .amdhsa_group_segment_fixed_size 0
  .amdhsa_kernarg_size 96
  .amdhsa_user_sgpr_count 2
  .amdhsa_user_sgpr_kernarg_segment_ptr 1
  .amdhsa_system_sgpr_workgroup_id_x 1
.end_amdhsa_kernel
.text
```
